```python
import torch

def _softmax(x, axis=-1):
    return torch.softmax(x, dim=axis)

def _gelu(x):
    return torch.nn.functional.gelu(x, approximate='tanh')

def _silu(x):
    return torch.nn.functional.silu(x)

def _sigmoid(x):
    return torch.sigmoid(x)

def _layernorm(x, axis=-1, eps=1e-05):
    m = x.mean(dim=axis, keepdim=True)
    v = x.var(dim=axis, keepdim=True, unbiased=False)
    return (x - m) / torch.sqrt(v + eps)

def _scatter_add(tgt, idx, src, axis=0):
    return tgt.clone().index_add_(axis, idx, src)

def _segment_sum(src, seg, n):
    out = torch.zeros((n,) + src.shape[1:], dtype=src.dtype)
    return out.index_add_(0, seg, src)

def _pad(x, pw):
    flat = tuple((v for pair in reversed(pw) for v in pair))
    return torch.nn.functional.pad(x, flat)
kernel_name = 'gated_mix__sliding_local_dilated__mixer_gmlp__prompt'

def setup_inputs():

    _w = lambda a: (lambda t: t.to(torch.bfloat16) if t.is_floating_point() else t)(torch.as_tensor(a))

    def _A_setup():
        B, S, D = (1, 2048, 1024)
        return {'x': _w((lambda *s: torch.randn(*s, dtype=torch.bfloat16) * 0.05)(B, S, D)), 'wqkv': _w((lambda *s: torch.randn(*s, dtype=torch.bfloat16) * 0.8)(D, 3 * D)), 'wo': _w((lambda *s: torch.randn(*s, dtype=torch.bfloat16) * 0.05)(D, D))}
    _A_in = _A_setup()

    def _B_setup():
        B, S, D, F = (1, 2048, 1024, 3584)
        Fh = F // 2
        return {'x': _w((lambda *s: torch.randn(*s, dtype=torch.bfloat16) * 0.05)(B, S, D)), 'w_in': _w((lambda *s: torch.randn(*s, dtype=torch.bfloat16) * 0.4)(D, 2 * Fh)), 'w_sp': _w(0.01 * (lambda *s: torch.randn(*s, dtype=torch.bfloat16) * 0.4)(S, S)), 'b_sp': _w(1.0 + 0.01 * (lambda *s: torch.randn(*s, dtype=torch.bfloat16) * 0.1)(S)), 'w_out': _w((lambda *s: torch.randn(*s, dtype=torch.bfloat16) * 0.1)(Fh, D))}
    _B_in = _B_setup()
    return {'A_x': _A_in['x'], 'A_wqkv': _A_in['wqkv'], 'A_wo': _A_in['wo'], 'B_x': _B_in['x'], 'B_w_in': _B_in['w_in'], 'B_w_sp': _B_in['w_sp'], 'B_b_sp': _B_in['b_sp'], 'B_w_out': _B_in['w_out'], 'gate_w': _w((lambda *s: torch.randn(*s, dtype=torch.bfloat16) * 0.05)(1024) * 16.0)}

def reference(A_x, A_wqkv, A_wo, B_x, B_w_in, B_w_sp, B_b_sp, B_w_out, gate_w):

    def _A_ref(x, wqkv, wo):
        B, S, D = x.shape
        H = 32
        Dh = D // H
        W, dil = (8, 2)
        qkv = (lambda x, *d: x.permute(*d))((x @ wqkv).reshape(B, S, 3, H, Dh), 2, 0, 3, 1, 4)
        q, k, v = (qkv[0], qkv[1], qkv[2])
        scale = Dh ** (-0.5)
        pos = torch.arange(S)
        off = torch.arange(W) * dil
        idx = pos[:, None] - off[None, :]
        mask = idx >= 0
        idx_c = torch.where(mask, idx, 0).reshape(-1)
        kg = k[:, :, idx_c, :].reshape(B, H, S, W, Dh)
        vg = v[:, :, idx_c, :].reshape(B, H, S, W, Dh)
        logits = torch.einsum('bhsd,bhswd->bhsw', q, kg) * scale
        logits = torch.where(mask[None, None, :, :], logits, -1000000000.0)
        attn = _softmax(logits, axis=-1)
        o = torch.einsum('bhsw,bhswd->bhsd', attn, vg)
        return (lambda x, *d: x.permute(*d))(o, 0, 2, 1, 3).reshape(B, S, D) @ wo

    def _B_ref(x, w_in, w_sp, b_sp, w_out):
        B, S, D = x.shape
        F = w_in.shape[-1]
        Fh = F // 2
        z = _gelu(torch.einsum('bsd,df->bsf', x, w_in))
        z1 = z[..., :Fh].clone()
        z2 = _layernorm(z[..., Fh:], axis=-1)
        g = torch.einsum('ts,bsf->btf', w_sp, z2) + b_sp[None, :, None]
        return torch.einsum('bsf,fd->bsd', z1 * g, w_out)
    x = A_x
    g = _sigmoid((x * gate_w).sum(-1, keepdims=True))
    a = _A_ref(x, A_wqkv, A_wo)
    b = _B_ref(x, B_w_in, B_w_sp, B_b_sp, B_w_out)
    return g * a + (1 - g) * b
```

```asm
; @launch grid=(256,1,1) block=(256,1,1) lds=163840
.amdgcn_target "amdgcn-amd-amdhsa--gfx950"
.text
.globl gated_mix__sliding_local_dilated__mixer_gmlp__prompt_kernel
.p2align 8
.type gated_mix__sliding_local_dilated__mixer_gmlp__prompt_kernel,@function
gated_mix__sliding_local_dilated__mixer_gmlp__prompt_kernel:
    s_cmp_ge_u32 s2, 256
    s_cbranch_scc1 L_end
    s_load_dwordx16 s[64:79], s[0:1], 0
    s_load_dwordx8 s[80:87], s[0:1], 64
    v_lshrrev_b32 v1, 6, v0
    v_and_b32 v0, 63, v0
    v_readfirstlane_b32 s3, v1
    s_and_b32 s46, s2, 7
    s_lshr_b32 s48, s2, 3
    s_and_b32 s50, s48, 7
    s_lshr_b32 s47, s48, 3
    s_lshr_b32 s49, s46, 1
    s_lshl_b32 s49, s49, 2
    s_add_u32 s38, s49, s47
    s_and_b32 s49, s46, 1
    s_lshl_b32 s49, s49, 3
    s_add_u32 s39, s49, s50
    s_and_b32 s49, s46, 1
    s_lshl_b32 s49, s49, 2
    s_and_b32 s50, s48, 3
    s_add_u32 s35, s49, s50
    s_lshr_b32 s49, s46, 1
    s_lshl_b32 s49, s49, 2
    s_and_b32 s50, s48, 15
    s_lshr_b32 s50, s50, 2
    s_add_u32 s44, s49, s50
    s_lshl_b32 s49, s44, 4
    s_lshl_b32 s50, s35, 8
    s_add_u32 s49, s49, s50
    s_lshl_b32 s50, s3, 2
    s_add_u32 s43, s49, s50
    s_mov_b32 s32, -1
    s_mov_b32 s33, 0
    s_add_u32 s49, s35, s44
    s_and_b32 s49, s49, 3
    s_mov_b32 s36, 0x65472103
    s_mov_b32 s37, 0xedcfa98b
    s_cmp_eq_u32 s49, 1
    s_cselect_b32 s36, 0x65832140, s36
    s_cselect_b32 s37, 0xfedba9c7, s37
    s_cmp_eq_u32 s49, 2
    s_cselect_b32 s36, 0x69432510, s36
    s_cselect_b32 s37, 0xfecbad87, s37
    s_cmp_eq_u32 s49, 3
    s_cselect_b32 s36, 0xa5436210, s36
    s_cselect_b32 s37, 0xfdcbe987, s37
    v_lshrrev_b32 v20, 3, v0
    v_and_b32 v21, 7, v0
    v_lshrrev_b32 v22, 4, v0
    s_lshl_b32 s48, s35, 8
    s_lshl_b32 s49, s3, 6
    s_add_u32 s48, s48, s49
    v_add_u32 v23, s48, v20
    v_mul_u32_u24 v23, 2048, v23
    v_xor_b32 v24, v21, v22
    v_xor_b32 v25, 4, v24
    v_lshl_add_u32 v24, v24, 4, v23
    v_lshl_add_u32 v25, v25, 4, v23
    v_add_u32 v2, 0, v24
    v_add_u32 v3, 15360, v25
    v_add_u32 v4, 30720, v24
    v_add_u32 v5, 46080, v25
    v_add_u32 v6, 65536, v24
    v_add_u32 v7, 80896, v25
    v_add_u32 v8, 96256, v24
    v_add_u32 v9, 111616, v25
    s_lshl_b32 s49, s3, 3
    v_add_u32 v23, s49, v20
    s_and_b32 s50, s3, 1
    s_lshl_b32 s50, s50, 1
    v_and_b32 v24, 1, v22
    v_or_b32 v24, s50, v24
    v_lshrrev_b32 v25, 1, v21
    v_xor_b32 v25, v25, v24
    v_lshlrev_b32 v25, 5, v25
    v_and_b32 v26, 1, v0
    v_lshl_add_u32 v25, v26, 4, v25
    s_mov_b32 s27, 0
    s_mov_b32 s28, 0
    s_cmp_ge_u32 s47, 2
    s_cbranch_scc1 L_z
    v_mul_u32_u24 v23, 6144, v23
    v_add_u32 v25, v25, v23
    s_lshl_b32 s48, s44, 7
    v_add_u32 v25, s48, v25
    v_add_u32 v10, 0, v25
    v_add_u32 v11, 1024, v25
    v_add_u32 v12, 2048, v25
    v_lshrrev_b32 v23, 2, v0
    v_and_b32 v23, 7, v23
    v_add_u32 v23, s49, v23
    v_mul_u32_u24 v23, 7168, v23
    s_and_b32 s50, s3, 1
    v_lshrrev_b32 v24, 1, v0
    v_and_b32 v24, 1, v24
    v_xor_b32 v24, s50, v24
    v_lshlrev_b32 v24, 5, v24
    v_lshl_add_u32 v24, v26, 4, v24
    s_lshl_b32 s48, s44, 6
    s_add_u32 s48, s48, 3584
    v_add_u32 v24, v24, v23
    v_add_u32 v13, s48, v24
    s_lshl_b32 s48, s35, 8
    s_max_u32 s48, s48, 16
    s_sub_u32 s48, s48, 16
    s_lshl_b32 s50, s3, 2
    s_add_u32 s48, s48, s50
    v_add_u32 v23, s48, v20
    v_lshlrev_b32 v23, 11, v23
    s_lshl_b32 s50, s3, 1
    v_add_u32 v24, s50, v22
    v_and_b32 v24, 7, v24
    v_xor_b32 v24, v24, v21
    v_lshl_add_u32 v1, v24, 4, v23
    s_lshl_b32 s29, s3, 13
    s_add_u32 s29, s29, 2048
    s_lshl_b32 s45, s3, 9
    s_mul_i32 s30, s3, 3584
    s_add_u32 s30, s30, 104448
    s_waitcnt lgkmcnt(0)
    s_mov_b32 s8, s64
    s_mov_b32 s9, s65
    s_mov_b32 s10, 0x400000
    s_mov_b32 s11, 0x20000
    s_mov_b32 s12, s66
    s_mov_b32 s13, s67
    s_mov_b32 s14, 0x600000
    s_mov_b32 s15, 0x20000
    s_sub_u32 s16, s72, 4096
    s_subb_u32 s17, s73, 0
    s_mov_b32 s18, 0x701000
    s_mov_b32 s19, 0x20000
    s_mov_b32 s20, s86
    s_mov_b32 s21, s87
    s_mov_b32 s22, 0x1a00000
    s_mov_b32 s23, 0x20000
    s_cmp_ge_u32 s2, 32
    s_cbranch_scc1 L_zf_1_1
    s_cmp_lg_u32 s3, 0
    s_cbranch_scc1 L_zf_1_1
    s_lshl_b32 s46, s2, 7
    s_add_u32 s46, s46, 26607616
    v_mov_b32 v30, 0
    buffer_store_dword v30, v30, s[20:23], s46 offen sc1
L_zf_1_1:
    s_nop 1
    s_and_b32 s31, s36, 15
    s_lshr_b64 s[36:37], s[36:37], 4
    s_lshl_b32 s24, s31, 7
    s_add_u32 m0, s29, s27
    s_nop 0
    buffer_load_dwordx4 v2, s[8:11], s24 offen offset:0 lds
    buffer_load_dwordx4 v3, s[8:11], s24 offen offset:1024 lds
    buffer_load_dwordx4 v4, s[8:11], s24 offen offset:2048 lds
    buffer_load_dwordx4 v5, s[8:11], s24 offen offset:3072 lds
    s_add_u32 m0, s29, s27
    s_add_u32 m0, m0, 4096
    s_nop 0
    buffer_load_dwordx4 v6, s[8:11], s24 offen offset:0 lds
    buffer_load_dwordx4 v7, s[8:11], s24 offen offset:1024 lds
    buffer_load_dwordx4 v8, s[8:11], s24 offen offset:2048 lds
    buffer_load_dwordx4 v9, s[8:11], s24 offen offset:3072 lds
    s_add_u32 m0, s45, s27
    s_mov_b64 exec, s[32:33]
    buffer_load_dwordx4 v1, s[8:11], s24 offen lds
    s_mov_b64 exec, -1
    s_add_u32 s27, s27, 34816
    s_cmp_eq_u32 s27, 104448
    s_cselect_b32 s27, 0, s27
    s_mul_i32 s25, s31, 393216
    s_mul_i32 s26, s31, 458752
    s_add_u32 m0, s30, 0
    s_nop 0
    buffer_load_dwordx4 v10, s[12:15], s25 offen lds
    buffer_load_dwordx4 v11, s[12:15], s25 offen offset:1024 lds
    buffer_load_dwordx4 v12, s[12:15], s25 offen offset:2048 lds
    s_mov_b64 exec, s[32:33]
    buffer_load_dwordx4 v13, s[16:19], s26 offen offset:3072 lds
    s_mov_b64 exec, -1
    s_add_u32 s25, s25, 196608
    s_add_u32 s26, s26, 229376
    s_add_u32 m0, s30, 14336
    s_nop 0
    buffer_load_dwordx4 v10, s[12:15], s25 offen lds
    buffer_load_dwordx4 v11, s[12:15], s25 offen offset:1024 lds
    buffer_load_dwordx4 v12, s[12:15], s25 offen offset:2048 lds
    s_mov_b64 exec, s[32:33]
    buffer_load_dwordx4 v13, s[16:19], s26 offen offset:3072 lds
    s_mov_b64 exec, -1
    v_and_b32 v20, 15, v0
    v_lshrrev_b32 v21, 4, v0
    v_lshrrev_b32 v22, 1, v20
    v_xor_b32 v22, v22, v21
    v_lshlrev_b32 v22, 4, v22
    v_lshl_add_u32 v22, v20, 7, v22
    s_lshr_b32 s49, s3, 1
    s_lshl_b32 s49, s49, 14
    v_add_u32 v14, s49, v22
    v_xor_b32 v15, 64, v14
    v_mov_b32 v16, v14
    v_mov_b32 v17, v15
    v_lshrrev_b32 v20, 2, v0
    v_and_b32 v20, 3, v20
    v_and_b32 v22, 3, v0
    v_lshrrev_b32 v23, 1, v20
    v_and_b32 v24, 1, v21
    v_lshl_or_b32 v23, v24, 1, v23
    v_mul_u32_u24 v25, 3584, v21
    v_lshl_add_u32 v26, v20, 7, v25
    v_lshl_add_u32 v26, v22, 3, v26
    v_add_u32 v26, 104448, v26
    s_and_b32 s49, s3, 1
    s_lshl_b32 s50, s49, 1
    v_xor_b32 v30, s50, v23
    v_lshl_add_u32 v18, v30, 5, v26
    v_xor_b32 v30, 1, v30
    v_lshl_add_u32 v19, v30, 5, v26
    v_lshl_add_u32 v26, v20, 6, v25
    v_lshl_add_u32 v26, v22, 3, v26
    v_add_u32 v26, 107520, v26
    v_xor_b32 v30, s49, v24
    v_lshl_add_u32 v28, v30, 5, v26
    v_accvgpr_write_b32 a128, 0
    v_accvgpr_write_b32 a129, 0
    v_accvgpr_write_b32 a130, 0
    v_accvgpr_write_b32 a131, 0
    v_accvgpr_write_b32 a132, 0
    v_accvgpr_write_b32 a133, 0
    v_accvgpr_write_b32 a134, 0
    v_accvgpr_write_b32 a135, 0
    v_accvgpr_write_b32 a136, 0
    v_accvgpr_write_b32 a137, 0
    v_accvgpr_write_b32 a138, 0
    v_accvgpr_write_b32 a139, 0
    v_accvgpr_write_b32 a140, 0
    v_accvgpr_write_b32 a141, 0
    v_accvgpr_write_b32 a142, 0
    v_accvgpr_write_b32 a143, 0
    v_accvgpr_write_b32 a144, 0
    v_accvgpr_write_b32 a145, 0
    v_accvgpr_write_b32 a146, 0
    v_accvgpr_write_b32 a147, 0
    v_accvgpr_write_b32 a148, 0
    v_accvgpr_write_b32 a149, 0
    v_accvgpr_write_b32 a150, 0
    v_accvgpr_write_b32 a151, 0
    v_accvgpr_write_b32 a152, 0
    v_accvgpr_write_b32 a153, 0
    v_accvgpr_write_b32 a154, 0
    v_accvgpr_write_b32 a155, 0
    v_accvgpr_write_b32 a156, 0
    v_accvgpr_write_b32 a157, 0
    v_accvgpr_write_b32 a158, 0
    v_accvgpr_write_b32 a159, 0
    v_mov_b32 v48, 0
    v_mov_b32 v49, 0
    v_mov_b32 v50, 0
    v_mov_b32 v51, 0
    v_mov_b32 v52, 0
    v_mov_b32 v53, 0
    v_mov_b32 v54, 0
    v_mov_b32 v55, 0
    v_mov_b32 v56, 0
    v_mov_b32 v57, 0
    v_mov_b32 v58, 0
    v_mov_b32 v59, 0
    v_mov_b32 v60, 0
    v_mov_b32 v61, 0
    v_mov_b32 v62, 0
    v_mov_b32 v63, 0
    v_mov_b32 v64, 0
    v_mov_b32 v65, 0
    v_mov_b32 v66, 0
    v_mov_b32 v67, 0
    v_mov_b32 v68, 0
    v_mov_b32 v69, 0
    v_mov_b32 v70, 0
    v_mov_b32 v71, 0
    v_mov_b32 v72, 0
    v_mov_b32 v73, 0
    v_mov_b32 v74, 0
    v_mov_b32 v75, 0
    v_mov_b32 v76, 0
    v_mov_b32 v77, 0
    v_mov_b32 v78, 0
    v_mov_b32 v79, 0
    v_mov_b32 v80, 0
    v_mov_b32 v81, 0
    v_mov_b32 v82, 0
    v_mov_b32 v83, 0
    v_mov_b32 v84, 0
    v_mov_b32 v85, 0
    v_mov_b32 v86, 0
    v_mov_b32 v87, 0
    v_mov_b32 v88, 0
    v_mov_b32 v89, 0
    v_mov_b32 v90, 0
    v_mov_b32 v91, 0
    v_mov_b32 v92, 0
    v_mov_b32 v93, 0
    v_mov_b32 v94, 0
    v_mov_b32 v95, 0
    v_mov_b32 v96, 0
    v_mov_b32 v97, 0
    v_mov_b32 v98, 0
    v_mov_b32 v99, 0
    v_mov_b32 v100, 0
    v_mov_b32 v101, 0
    v_mov_b32 v102, 0
    v_mov_b32 v103, 0
    v_mov_b32 v104, 0
    v_mov_b32 v105, 0
    v_mov_b32 v106, 0
    v_mov_b32 v107, 0
    v_mov_b32 v108, 0
    v_mov_b32 v109, 0
    v_mov_b32 v110, 0
    v_mov_b32 v111, 0
    v_mov_b32 v112, 0
    v_mov_b32 v113, 0
    v_mov_b32 v114, 0
    v_mov_b32 v115, 0
    v_mov_b32 v116, 0
    v_mov_b32 v117, 0
    v_mov_b32 v118, 0
    v_mov_b32 v119, 0
    v_mov_b32 v120, 0
    v_mov_b32 v121, 0
    v_mov_b32 v122, 0
    v_mov_b32 v123, 0
    v_mov_b32 v124, 0
    v_mov_b32 v125, 0
    v_mov_b32 v126, 0
    v_mov_b32 v127, 0
    v_mov_b32 v128, 0
    v_mov_b32 v129, 0
    v_mov_b32 v130, 0
    v_mov_b32 v131, 0
    v_mov_b32 v132, 0
    v_mov_b32 v133, 0
    v_mov_b32 v134, 0
    v_mov_b32 v135, 0
    v_mov_b32 v136, 0
    v_mov_b32 v137, 0
    v_mov_b32 v138, 0
    v_mov_b32 v139, 0
    v_mov_b32 v140, 0
    v_mov_b32 v141, 0
    v_mov_b32 v142, 0
    v_mov_b32 v143, 0
    v_mov_b32 v144, 0
    v_mov_b32 v145, 0
    v_mov_b32 v146, 0
    v_mov_b32 v147, 0
    v_mov_b32 v148, 0
    v_mov_b32 v149, 0
    v_mov_b32 v150, 0
    v_mov_b32 v151, 0
    v_mov_b32 v152, 0
    v_mov_b32 v153, 0
    v_mov_b32 v154, 0
    v_mov_b32 v155, 0
    v_mov_b32 v156, 0
    v_mov_b32 v157, 0
    v_mov_b32 v158, 0
    v_mov_b32 v159, 0
    v_mov_b32 v160, 0
    v_mov_b32 v161, 0
    v_mov_b32 v162, 0
    v_mov_b32 v163, 0
    v_mov_b32 v164, 0
    v_mov_b32 v165, 0
    v_mov_b32 v166, 0
    v_mov_b32 v167, 0
    v_mov_b32 v168, 0
    v_mov_b32 v169, 0
    v_mov_b32 v170, 0
    v_mov_b32 v171, 0
    v_mov_b32 v172, 0
    v_mov_b32 v173, 0
    v_mov_b32 v174, 0
    v_mov_b32 v175, 0
    v_mov_b32 v176, 0
    v_mov_b32 v177, 0
    v_mov_b32 v178, 0
    v_mov_b32 v179, 0
    v_mov_b32 v180, 0
    v_mov_b32 v181, 0
    v_mov_b32 v182, 0
    v_mov_b32 v183, 0
    v_mov_b32 v184, 0
    v_mov_b32 v185, 0
    v_mov_b32 v186, 0
    v_mov_b32 v187, 0
    v_mov_b32 v188, 0
    v_mov_b32 v189, 0
    v_mov_b32 v190, 0
    v_mov_b32 v191, 0
    v_mov_b32 v192, 0
    v_mov_b32 v193, 0
    v_mov_b32 v194, 0
    v_mov_b32 v195, 0
    v_mov_b32 v196, 0
    v_mov_b32 v197, 0
    v_mov_b32 v198, 0
    v_mov_b32 v199, 0
    v_mov_b32 v200, 0
    v_mov_b32 v201, 0
    v_mov_b32 v202, 0
    v_mov_b32 v203, 0
    v_mov_b32 v204, 0
    v_mov_b32 v205, 0
    v_mov_b32 v206, 0
    v_mov_b32 v207, 0
    v_mov_b32 v208, 0
    v_mov_b32 v209, 0
    v_mov_b32 v210, 0
    v_mov_b32 v211, 0
    v_mov_b32 v212, 0
    v_mov_b32 v213, 0
    v_mov_b32 v214, 0
    v_mov_b32 v215, 0
    v_mov_b32 v216, 0
    v_mov_b32 v217, 0
    v_mov_b32 v218, 0
    v_mov_b32 v219, 0
    v_mov_b32 v220, 0
    v_mov_b32 v221, 0
    v_mov_b32 v222, 0
    v_mov_b32 v223, 0
    v_mov_b32 v224, 0
    v_mov_b32 v225, 0
    v_mov_b32 v226, 0
    v_mov_b32 v227, 0
    v_mov_b32 v228, 0
    v_mov_b32 v229, 0
    v_mov_b32 v230, 0
    v_mov_b32 v231, 0
    v_mov_b32 v232, 0
    v_mov_b32 v233, 0
    v_mov_b32 v234, 0
    v_mov_b32 v235, 0
    v_mov_b32 v236, 0
    v_mov_b32 v237, 0
    v_mov_b32 v238, 0
    v_mov_b32 v239, 0
    v_mov_b32 v240, 0
    v_mov_b32 v241, 0
    v_mov_b32 v242, 0
    v_mov_b32 v243, 0
    v_mov_b32 v244, 0
    v_mov_b32 v245, 0
    v_mov_b32 v246, 0
    v_mov_b32 v247, 0
    v_mov_b32 v248, 0
    v_mov_b32 v249, 0
    v_mov_b32 v250, 0
    v_mov_b32 v251, 0
    v_mov_b32 v252, 0
    v_mov_b32 v253, 0
    v_mov_b32 v254, 0
    v_mov_b32 v255, 0
    s_lshr_b32 s46, s2, 3
    s_lshl_b32 s46, s46, 2
    s_add_u32 s46, s46, s3
    s_lshl_b32 s46, s46, 10
    s_getpc_b64 s[4:5]
L_pc_1_2:
    s_sub_u32 s4, s4, L_pc_1_2-gated_mix__sliding_local_dilated__mixer_gmlp__prompt_kernel
    s_subb_u32 s5, s5, 0
    s_mov_b32 s6, L_codeend-gated_mix__sliding_local_dilated__mixer_gmlp__prompt_kernel
    s_mov_b32 s7, 0x20000
    v_lshlrev_b32 v42, 7, v0
    s_mov_b64 exec, 0xff
    buffer_load_dword v42, v42, s[4:7], s46 offen
    s_mov_b64 exec, -1
    s_and_b32 s31, s36, 15
    s_lshr_b64 s[36:37], s[36:37], 4
    s_lshl_b32 s24, s31, 7
    s_add_u32 m0, s29, s27
    s_nop 0
    buffer_load_dwordx4 v2, s[8:11], s24 offen offset:0 lds
    buffer_load_dwordx4 v3, s[8:11], s24 offen offset:1024 lds
    buffer_load_dwordx4 v4, s[8:11], s24 offen offset:2048 lds
    buffer_load_dwordx4 v5, s[8:11], s24 offen offset:3072 lds
    s_mul_i32 s25, s31, 393216
    s_mul_i32 s26, s31, 458752
    s_add_u32 m0, s30, 28672
    s_nop 0
    buffer_load_dwordx4 v10, s[12:15], s25 offen lds
    buffer_load_dwordx4 v11, s[12:15], s25 offen offset:1024 lds
    buffer_load_dwordx4 v12, s[12:15], s25 offen offset:2048 lds
    s_mov_b64 exec, s[32:33]
    buffer_load_dwordx4 v13, s[16:19], s26 offen offset:3072 lds
    s_mov_b64 exec, -1
    s_add_u32 m0, s29, s27
    s_add_u32 m0, m0, 4096
    s_nop 0
    buffer_load_dwordx4 v6, s[8:11], s24 offen offset:0 lds
    buffer_load_dwordx4 v7, s[8:11], s24 offen offset:1024 lds
    buffer_load_dwordx4 v8, s[8:11], s24 offen offset:2048 lds
    buffer_load_dwordx4 v9, s[8:11], s24 offen offset:3072 lds
    s_add_u32 m0, s45, s27
    s_mov_b64 exec, s[32:33]
    buffer_load_dwordx4 v1, s[8:11], s24 offen lds
    s_mov_b64 exec, -1
    s_add_u32 s27, s27, 34816
    s_cmp_eq_u32 s27, 104448
    s_cselect_b32 s27, 0, s27
    s_waitcnt vmcnt(17)
    s_barrier
    s_cmp_ge_u32 s2, 32
    s_cbranch_scc1 L_an_1_3
    s_cmp_lg_u32 s3, 0
    s_cbranch_scc1 L_an_1_3
    s_mov_b32 s4, s84
    s_mov_b32 s5, s85
    s_mov_b32 s6, 0x100
    s_mov_b32 s7, 0x20000
    v_mov_b32 v30, 0
    v_mov_b32 v31, 1
    s_mov_b64 exec, 1
    buffer_atomic_add v31, v30, s[4:7], 0 offen
    s_mov_b64 exec, -1
L_an_1_3:
    s_nop 1
    ds_read_b128 a[0:3], v16 offset:0
    ds_read_b128 a[4:7], v16 offset:2048
    ds_read_b128 a[8:11], v16 offset:4096
    ds_read_b128 a[12:15], v16 offset:6144
    ds_read_b128 a[16:19], v16 offset:8192
    ds_read_b128 a[20:23], v16 offset:10240
    ds_read_b128 a[24:27], v16 offset:12288
    ds_read_b128 a[28:31], v16 offset:14336
    ds_read_b128 a[32:35], v16 offset:16384
    ds_read_b64_tr_b16 a[36:37], v18 offset:0
    ds_read_b64_tr_b16 a[38:39], v18 offset:512
    ds_read_b64_tr_b16 a[40:41], v19 offset:0
    ds_read_b64_tr_b16 a[42:43], v19 offset:512
    ds_read_b64_tr_b16 a[44:45], v18 offset:1024
    ds_read_b64_tr_b16 a[46:47], v18 offset:1536
    ds_read_b64_tr_b16 a[48:49], v19 offset:1024
    ds_read_b64_tr_b16 a[50:51], v19 offset:1536
    ds_read_b64_tr_b16 a[52:53], v18 offset:2048
    ds_read_b64_tr_b16 a[54:55], v18 offset:2560
    ds_read_b64_tr_b16 a[56:57], v19 offset:2048
    ds_read_b64_tr_b16 a[58:59], v19 offset:2560
    ds_read_b64_tr_b16 a[60:61], v28 offset:0
    ds_read_b64_tr_b16 a[62:63], v28 offset:256
    s_waitcnt lgkmcnt(0)
    v_mfma_f32_16x16x32_bf16 v[112:115], a[44:47], a[0:3], v[112:115]
    s_waitcnt vmcnt(13)
    s_barrier
    v_mfma_f32_16x16x32_bf16 v[116:119], a[48:51], a[0:3], v[116:119]
    ds_read_b128 a[64:67], v17 offset:0
    v_mfma_f32_16x16x32_bf16 v[184:187], a[0:3], a[52:55], v[184:187]
    v_mfma_f32_16x16x32_bf16 v[220:223], a[0:3], a[56:59], v[220:223]
    ds_read_b128 a[68:71], v17 offset:2048
    v_mfma_f32_16x16x32_bf16 a[128:131], a[60:63], a[4:7], a[128:131]
    v_mfma_f32_16x16x32_bf16 v[224:227], a[4:7], a[56:59], v[224:227]
    ds_read_b128 a[72:75], v17 offset:4096
    v_mfma_f32_16x16x32_bf16 v[188:191], a[4:7], a[52:55], v[188:191]
    v_mfma_f32_16x16x32_bf16 v[124:127], a[48:51], a[4:7], v[124:127]
    ds_read_b128 a[76:79], v17 offset:6144
    v_mfma_f32_16x16x32_bf16 v[120:123], a[44:47], a[4:7], v[120:123]
    v_mfma_f32_16x16x32_bf16 v[52:55], a[40:43], a[4:7], v[52:55]
    v_mfma_f32_16x16x32_bf16 v[48:51], a[36:39], a[4:7], v[48:51]
    ds_read_b128 a[80:83], v17 offset:8192
    v_mfma_f32_16x16x32_bf16 v[56:59], a[36:39], a[8:11], v[56:59]
    v_mfma_f32_16x16x32_bf16 v[60:63], a[40:43], a[8:11], v[60:63]
    ds_read_b128 a[84:87], v17 offset:10240
    v_mfma_f32_16x16x32_bf16 v[128:131], a[44:47], a[8:11], v[128:131]
    v_mfma_f32_16x16x32_bf16 v[132:135], a[48:51], a[8:11], v[132:135]
    ds_read_b128 a[88:91], v17 offset:12288
    v_mfma_f32_16x16x32_bf16 v[192:195], a[8:11], a[52:55], v[192:195]
    v_mfma_f32_16x16x32_bf16 v[228:231], a[8:11], a[56:59], v[228:231]
    v_mfma_f32_16x16x32_bf16 a[132:135], a[60:63], a[8:11], a[132:135]
    ds_read_b128 a[92:95], v17 offset:14336
    v_mfma_f32_16x16x32_bf16 a[136:139], a[60:63], a[12:15], a[136:139]
    v_mfma_f32_16x16x32_bf16 v[232:235], a[12:15], a[56:59], v[232:235]
    s_add_u32 s25, s25, 196608
    ds_read_b128 a[96:99], v17 offset:16384
    v_mfma_f32_16x16x32_bf16 v[196:199], a[12:15], a[52:55], v[196:199]
    s_add_u32 s26, s26, 229376
    s_add_u32 m0, s30, 43008
    v_mfma_f32_16x16x32_bf16 v[140:143], a[48:51], a[12:15], v[140:143]
    buffer_load_dwordx4 v10, s[12:15], s25 offen lds
    ds_read_b64_tr_b16 a[100:101], v18 offset:14336
    v_mfma_f32_16x16x32_bf16 v[136:139], a[44:47], a[12:15], v[136:139]
    v_mfma_f32_16x16x32_bf16 v[68:71], a[40:43], a[12:15], v[68:71]
    v_mfma_f32_16x16x32_bf16 v[64:67], a[36:39], a[12:15], v[64:67]
    ds_read_b64_tr_b16 a[102:103], v18 offset:14848
    v_mfma_f32_16x16x32_bf16 v[72:75], a[36:39], a[16:19], v[72:75]
    buffer_load_dwordx4 v11, s[12:15], s25 offen offset:1024 lds
    v_mfma_f32_16x16x32_bf16 v[76:79], a[40:43], a[16:19], v[76:79]
    ds_read_b64_tr_b16 a[104:105], v19 offset:14336
    v_mfma_f32_16x16x32_bf16 v[144:147], a[44:47], a[16:19], v[144:147]
    v_mfma_f32_16x16x32_bf16 v[148:151], a[48:51], a[16:19], v[148:151]
    ds_read_b64_tr_b16 a[106:107], v19 offset:14848
    v_mfma_f32_16x16x32_bf16 v[200:203], a[16:19], a[52:55], v[200:203]
    v_mfma_f32_16x16x32_bf16 v[236:239], a[16:19], a[56:59], v[236:239]
    ds_read_b64_tr_b16 a[108:109], v18 offset:15360
    v_mfma_f32_16x16x32_bf16 a[140:143], a[60:63], a[16:19], a[140:143]
    buffer_load_dwordx4 v12, s[12:15], s25 offen offset:2048 lds
    v_mfma_f32_16x16x32_bf16 a[144:147], a[60:63], a[20:23], a[144:147]
    v_mfma_f32_16x16x32_bf16 v[240:243], a[20:23], a[56:59], v[240:243]
    ds_read_b64_tr_b16 a[110:111], v18 offset:15872
    v_mfma_f32_16x16x32_bf16 v[204:207], a[20:23], a[52:55], v[204:207]
    v_mfma_f32_16x16x32_bf16 v[156:159], a[48:51], a[20:23], v[156:159]
    ds_read_b64_tr_b16 a[112:113], v19 offset:15360
    v_mfma_f32_16x16x32_bf16 v[152:155], a[44:47], a[20:23], v[152:155]
    s_mov_b64 exec, s[32:33]
    buffer_load_dwordx4 v13, s[16:19], s26 offen offset:3072 lds
    s_mov_b64 exec, -1
    v_mfma_f32_16x16x32_bf16 v[84:87], a[40:43], a[20:23], v[84:87]
    ds_read_b64_tr_b16 a[114:115], v19 offset:15872
    v_mfma_f32_16x16x32_bf16 v[80:83], a[36:39], a[20:23], v[80:83]
    v_mfma_f32_16x16x32_bf16 v[88:91], a[36:39], a[24:27], v[88:91]
    s_and_b32 s31, s36, 15
    v_mfma_f32_16x16x32_bf16 v[92:95], a[40:43], a[24:27], v[92:95]
    s_lshr_b64 s[36:37], s[36:37], 4
    ds_read_b64_tr_b16 a[116:117], v18 offset:16384
    v_mfma_f32_16x16x32_bf16 v[160:163], a[44:47], a[24:27], v[160:163]
    s_lshl_b32 s24, s31, 7
    s_add_u32 m0, s29, s27
    v_mfma_f32_16x16x32_bf16 v[164:167], a[48:51], a[24:27], v[164:167]
    buffer_load_dwordx4 v2, s[8:11], s24 offen offset:0 lds
    ds_read_b64_tr_b16 a[118:119], v18 offset:16896
    v_mfma_f32_16x16x32_bf16 v[208:211], a[24:27], a[52:55], v[208:211]
    v_mfma_f32_16x16x32_bf16 v[244:247], a[24:27], a[56:59], v[244:247]
    ds_read_b64_tr_b16 a[120:121], v19 offset:16384
    v_mfma_f32_16x16x32_bf16 a[148:151], a[60:63], a[24:27], a[148:151]
    v_mfma_f32_16x16x32_bf16 a[152:155], a[60:63], a[28:31], a[152:155]
    buffer_load_dwordx4 v3, s[8:11], s24 offen offset:1024 lds
    v_mfma_f32_16x16x32_bf16 v[248:251], a[28:31], a[56:59], v[248:251]
    ds_read_b64_tr_b16 a[122:123], v19 offset:16896
    v_mfma_f32_16x16x32_bf16 v[212:215], a[28:31], a[52:55], v[212:215]
    v_mfma_f32_16x16x32_bf16 v[172:175], a[48:51], a[28:31], v[172:175]
    ds_read_b64_tr_b16 a[124:125], v28 offset:14336
    v_mfma_f32_16x16x32_bf16 v[168:171], a[44:47], a[28:31], v[168:171]
    v_mfma_f32_16x16x32_bf16 v[100:103], a[40:43], a[28:31], v[100:103]
    ds_read_b64_tr_b16 a[126:127], v28 offset:14592
    v_mfma_f32_16x16x32_bf16 v[96:99], a[36:39], a[28:31], v[96:99]
    buffer_load_dwordx4 v4, s[8:11], s24 offen offset:2048 lds
    v_mfma_f32_16x16x32_bf16 v[104:107], a[36:39], a[32:35], v[104:107]
    v_mfma_f32_16x16x32_bf16 v[108:111], a[40:43], a[32:35], v[108:111]
    v_mfma_f32_16x16x32_bf16 v[176:179], a[44:47], a[32:35], v[176:179]
    v_mfma_f32_16x16x32_bf16 v[180:183], a[48:51], a[32:35], v[180:183]
    v_mfma_f32_16x16x32_bf16 v[216:219], a[32:35], a[52:55], v[216:219]
    buffer_load_dwordx4 v5, s[8:11], s24 offen offset:3072 lds
    v_mfma_f32_16x16x32_bf16 v[252:255], a[32:35], a[56:59], v[252:255]
    v_mfma_f32_16x16x32_bf16 a[156:159], a[60:63], a[32:35], a[156:159]
    s_waitcnt lgkmcnt(0)
    v_mfma_f32_16x16x32_bf16 v[112:115], a[108:111], a[64:67], v[112:115]
    s_waitcnt vmcnt(8)
    s_barrier
    v_mfma_f32_16x16x32_bf16 v[116:119], a[112:115], a[64:67], v[116:119]
    s_add_u32 s28, s28, 34816
    v_mfma_f32_16x16x32_bf16 v[184:187], a[64:67], a[116:119], v[184:187]
    s_cmp_eq_u32 s28, 104448
    s_cselect_b32 s28, 0, s28
    v_mfma_f32_16x16x32_bf16 v[220:223], a[64:67], a[120:123], v[220:223]
    v_mfma_f32_16x16x32_bf16 a[128:131], a[124:127], a[68:71], a[128:131]
    v_add_u32 v16, s28, v14
    v_mfma_f32_16x16x32_bf16 v[224:227], a[68:71], a[120:123], v[224:227]
    v_mfma_f32_16x16x32_bf16 v[188:191], a[68:71], a[116:119], v[188:191]
    ds_read_b64_tr_b16 a[36:37], v18 offset:28672
    v_mfma_f32_16x16x32_bf16 v[124:127], a[112:115], a[68:71], v[124:127]
    v_mfma_f32_16x16x32_bf16 v[120:123], a[108:111], a[68:71], v[120:123]
    ds_read_b64_tr_b16 a[38:39], v18 offset:29184
    v_mfma_f32_16x16x32_bf16 v[52:55], a[104:107], a[68:71], v[52:55]
    v_mfma_f32_16x16x32_bf16 v[48:51], a[100:103], a[68:71], v[48:51]
    ds_read_b64_tr_b16 a[40:41], v19 offset:28672
    v_mfma_f32_16x16x32_bf16 v[56:59], a[100:103], a[72:75], v[56:59]
    v_mfma_f32_16x16x32_bf16 v[60:63], a[104:107], a[72:75], v[60:63]
    ds_read_b64_tr_b16 a[42:43], v19 offset:29184
    v_mfma_f32_16x16x32_bf16 v[128:131], a[108:111], a[72:75], v[128:131]
    v_mfma_f32_16x16x32_bf16 v[132:135], a[112:115], a[72:75], v[132:135]
    ds_read_b64_tr_b16 a[44:45], v18 offset:29696
    v_mfma_f32_16x16x32_bf16 v[192:195], a[72:75], a[116:119], v[192:195]
    v_mfma_f32_16x16x32_bf16 v[228:231], a[72:75], a[120:123], v[228:231]
    ds_read_b64_tr_b16 a[46:47], v18 offset:30208
    v_mfma_f32_16x16x32_bf16 a[132:135], a[124:127], a[72:75], a[132:135]
    v_mfma_f32_16x16x32_bf16 a[136:139], a[124:127], a[76:79], a[136:139]
    s_mul_i32 s25, s31, 393216
    s_mul_i32 s26, s31, 458752
    v_mfma_f32_16x16x32_bf16 v[232:235], a[76:79], a[120:123], v[232:235]
    ds_read_b64_tr_b16 a[48:49], v19 offset:29696
    s_add_u32 m0, s30, 0
    v_mfma_f32_16x16x32_bf16 v[196:199], a[76:79], a[116:119], v[196:199]
    buffer_load_dwordx4 v10, s[12:15], s25 offen lds
    ds_read_b64_tr_b16 a[50:51], v19 offset:30208
    v_mfma_f32_16x16x32_bf16 v[140:143], a[112:115], a[76:79], v[140:143]
    v_mfma_f32_16x16x32_bf16 v[136:139], a[108:111], a[76:79], v[136:139]
    ds_read_b64_tr_b16 a[52:53], v18 offset:30720
    buffer_load_dwordx4 v11, s[12:15], s25 offen offset:1024 lds
    v_mfma_f32_16x16x32_bf16 v[68:71], a[104:107], a[76:79], v[68:71]
    v_mfma_f32_16x16x32_bf16 v[64:67], a[100:103], a[76:79], v[64:67]
    ds_read_b64_tr_b16 a[54:55], v18 offset:31232
    v_mfma_f32_16x16x32_bf16 v[72:75], a[100:103], a[80:83], v[72:75]
    v_mfma_f32_16x16x32_bf16 v[76:79], a[104:107], a[80:83], v[76:79]
    buffer_load_dwordx4 v12, s[12:15], s25 offen offset:2048 lds
    ds_read_b64_tr_b16 a[56:57], v19 offset:30720
    v_mfma_f32_16x16x32_bf16 v[144:147], a[108:111], a[80:83], v[144:147]
    v_mfma_f32_16x16x32_bf16 v[148:151], a[112:115], a[80:83], v[148:151]
    ds_read_b64_tr_b16 a[58:59], v19 offset:31232
    v_mfma_f32_16x16x32_bf16 v[200:203], a[80:83], a[116:119], v[200:203]
    s_mov_b64 exec, s[32:33]
    buffer_load_dwordx4 v13, s[16:19], s26 offen offset:3072 lds
    s_mov_b64 exec, -1
    v_mfma_f32_16x16x32_bf16 v[236:239], a[80:83], a[120:123], v[236:239]
    ds_read_b64_tr_b16 a[60:61], v28 offset:28672
    v_mfma_f32_16x16x32_bf16 a[140:143], a[124:127], a[80:83], a[140:143]
    s_add_u32 m0, s29, s27
    v_mfma_f32_16x16x32_bf16 a[144:147], a[124:127], a[84:87], a[144:147]
    s_add_u32 m0, m0, 4096
    ds_read_b64_tr_b16 a[62:63], v28 offset:28928
    v_mfma_f32_16x16x32_bf16 v[240:243], a[84:87], a[120:123], v[240:243]
    buffer_load_dwordx4 v6, s[8:11], s24 offen offset:0 lds
    v_mfma_f32_16x16x32_bf16 v[204:207], a[84:87], a[116:119], v[204:207]
    v_add_u32 v17, s28, v15
    v_mfma_f32_16x16x32_bf16 v[156:159], a[112:115], a[84:87], v[156:159]
    buffer_load_dwordx4 v7, s[8:11], s24 offen offset:1024 lds
    v_mfma_f32_16x16x32_bf16 v[152:155], a[108:111], a[84:87], v[152:155]
    ds_read_b128 a[0:3], v16 offset:0
    v_mfma_f32_16x16x32_bf16 v[84:87], a[104:107], a[84:87], v[84:87]
    v_mfma_f32_16x16x32_bf16 v[80:83], a[100:103], a[84:87], v[80:83]
    ds_read_b128 a[4:7], v16 offset:2048
    v_mfma_f32_16x16x32_bf16 v[88:91], a[100:103], a[88:91], v[88:91]
    buffer_load_dwordx4 v8, s[8:11], s24 offen offset:2048 lds
    v_mfma_f32_16x16x32_bf16 v[92:95], a[104:107], a[88:91], v[92:95]
    ds_read_b128 a[8:11], v16 offset:4096
    v_mfma_f32_16x16x32_bf16 v[160:163], a[108:111], a[88:91], v[160:163]
    v_mfma_f32_16x16x32_bf16 v[164:167], a[112:115], a[88:91], v[164:167]
    ds_read_b128 a[12:15], v16 offset:6144
    buffer_load_dwordx4 v9, s[8:11], s24 offen offset:3072 lds
    v_mfma_f32_16x16x32_bf16 v[208:211], a[88:91], a[116:119], v[208:211]
    v_mfma_f32_16x16x32_bf16 v[244:247], a[88:91], a[120:123], v[244:247]
    ds_read_b128 a[16:19], v16 offset:8192
    s_add_u32 m0, s45, s27
    v_mfma_f32_16x16x32_bf16 a[148:151], a[124:127], a[88:91], a[148:151]
    s_mov_b64 exec, s[32:33]
    buffer_load_dwordx4 v1, s[8:11], s24 offen lds
    s_mov_b64 exec, -1
    v_mfma_f32_16x16x32_bf16 a[152:155], a[124:127], a[92:95], a[152:155]
    ds_read_b128 a[20:23], v16 offset:10240
    s_add_u32 s27, s27, 34816
    v_mfma_f32_16x16x32_bf16 v[248:251], a[92:95], a[120:123], v[248:251]
    s_cmp_eq_u32 s27, 104448
    s_cselect_b32 s27, 0, s27
    v_mfma_f32_16x16x32_bf16 v[212:215], a[92:95], a[116:119], v[212:215]
    s_add_u32 s25, s25, 196608
    s_add_u32 s26, s26, 229376
    v_mfma_f32_16x16x32_bf16 v[172:175], a[112:115], a[92:95], v[172:175]
    ds_read_b128 a[24:27], v16 offset:12288
    s_add_u32 m0, s30, 14336
    v_mfma_f32_16x16x32_bf16 v[168:171], a[108:111], a[92:95], v[168:171]
    buffer_load_dwordx4 v10, s[12:15], s25 offen lds
    ds_read_b128 a[28:31], v16 offset:14336
    v_mfma_f32_16x16x32_bf16 v[100:103], a[104:107], a[92:95], v[100:103]
    buffer_load_dwordx4 v11, s[12:15], s25 offen offset:1024 lds
    v_mfma_f32_16x16x32_bf16 v[96:99], a[100:103], a[92:95], v[96:99]
    ds_read_b128 a[32:35], v16 offset:16384
    v_mfma_f32_16x16x32_bf16 v[104:107], a[100:103], a[96:99], v[104:107]
    v_mfma_f32_16x16x32_bf16 v[108:111], a[104:107], a[96:99], v[108:111]
    v_mfma_f32_16x16x32_bf16 v[176:179], a[108:111], a[96:99], v[176:179]
    buffer_load_dwordx4 v12, s[12:15], s25 offen offset:2048 lds
    v_mfma_f32_16x16x32_bf16 v[180:183], a[112:115], a[96:99], v[180:183]
    v_mfma_f32_16x16x32_bf16 v[216:219], a[96:99], a[116:119], v[216:219]
    v_mfma_f32_16x16x32_bf16 v[252:255], a[96:99], a[120:123], v[252:255]
    s_mov_b64 exec, s[32:33]
    buffer_load_dwordx4 v13, s[16:19], s26 offen offset:3072 lds
    s_mov_b64 exec, -1
    v_mfma_f32_16x16x32_bf16 a[156:159], a[124:127], a[96:99], a[156:159]
    s_waitcnt lgkmcnt(0)
    v_mfma_f32_16x16x32_bf16 v[112:115], a[44:47], a[0:3], v[112:115]
    s_waitcnt vmcnt(17)
    s_barrier
    v_mfma_f32_16x16x32_bf16 v[116:119], a[48:51], a[0:3], v[116:119]
    ds_read_b128 a[64:67], v17 offset:0
    v_mfma_f32_16x16x32_bf16 v[184:187], a[0:3], a[52:55], v[184:187]
    v_mfma_f32_16x16x32_bf16 v[220:223], a[0:3], a[56:59], v[220:223]
    ds_read_b128 a[68:71], v17 offset:2048
    v_mfma_f32_16x16x32_bf16 a[128:131], a[60:63], a[4:7], a[128:131]
    v_mfma_f32_16x16x32_bf16 v[224:227], a[4:7], a[56:59], v[224:227]
    ds_read_b128 a[72:75], v17 offset:4096
    v_mfma_f32_16x16x32_bf16 v[188:191], a[4:7], a[52:55], v[188:191]
    v_mfma_f32_16x16x32_bf16 v[124:127], a[48:51], a[4:7], v[124:127]
    ds_read_b128 a[76:79], v17 offset:6144
    v_mfma_f32_16x16x32_bf16 v[120:123], a[44:47], a[4:7], v[120:123]
    v_mfma_f32_16x16x32_bf16 v[52:55], a[40:43], a[4:7], v[52:55]
    v_mfma_f32_16x16x32_bf16 v[48:51], a[36:39], a[4:7], v[48:51]
    ds_read_b128 a[80:83], v17 offset:8192
    v_mfma_f32_16x16x32_bf16 v[56:59], a[36:39], a[8:11], v[56:59]
    v_mfma_f32_16x16x32_bf16 v[60:63], a[40:43], a[8:11], v[60:63]
    ds_read_b128 a[84:87], v17 offset:10240
    v_mfma_f32_16x16x32_bf16 v[128:131], a[44:47], a[8:11], v[128:131]
    v_mfma_f32_16x16x32_bf16 v[132:135], a[48:51], a[8:11], v[132:135]
    ds_read_b128 a[88:91], v17 offset:12288
    v_mfma_f32_16x16x32_bf16 v[192:195], a[8:11], a[52:55], v[192:195]
    v_mfma_f32_16x16x32_bf16 v[228:231], a[8:11], a[56:59], v[228:231]
    v_mfma_f32_16x16x32_bf16 a[132:135], a[60:63], a[8:11], a[132:135]
    ds_read_b128 a[92:95], v17 offset:14336
    v_mfma_f32_16x16x32_bf16 a[136:139], a[60:63], a[12:15], a[136:139]
    s_and_b32 s31, s36, 15
    s_lshr_b64 s[36:37], s[36:37], 4
    v_mfma_f32_16x16x32_bf16 v[232:235], a[12:15], a[56:59], v[232:235]
    s_lshl_b32 s24, s31, 7
    s_add_u32 m0, s29, s27
    v_mfma_f32_16x16x32_bf16 v[196:199], a[12:15], a[52:55], v[196:199]
    ds_read_b128 a[96:99], v17 offset:16384
    buffer_load_dwordx4 v2, s[8:11], s24 offen offset:0 lds
    v_mfma_f32_16x16x32_bf16 v[140:143], a[48:51], a[12:15], v[140:143]
    ds_read_b64_tr_b16 a[100:101], v18 offset:43008
    v_mfma_f32_16x16x32_bf16 v[136:139], a[44:47], a[12:15], v[136:139]
    buffer_load_dwordx4 v3, s[8:11], s24 offen offset:1024 lds
    v_mfma_f32_16x16x32_bf16 v[68:71], a[40:43], a[12:15], v[68:71]
    v_mfma_f32_16x16x32_bf16 v[64:67], a[36:39], a[12:15], v[64:67]
    ds_read_b64_tr_b16 a[102:103], v18 offset:43520
    v_mfma_f32_16x16x32_bf16 v[72:75], a[36:39], a[16:19], v[72:75]
    v_mfma_f32_16x16x32_bf16 v[76:79], a[40:43], a[16:19], v[76:79]
    buffer_load_dwordx4 v4, s[8:11], s24 offen offset:2048 lds
    ds_read_b64_tr_b16 a[104:105], v19 offset:43008
    v_mfma_f32_16x16x32_bf16 v[144:147], a[44:47], a[16:19], v[144:147]
    v_mfma_f32_16x16x32_bf16 v[148:151], a[48:51], a[16:19], v[148:151]
    ds_read_b64_tr_b16 a[106:107], v19 offset:43520
    v_mfma_f32_16x16x32_bf16 v[200:203], a[16:19], a[52:55], v[200:203]
    buffer_load_dwordx4 v5, s[8:11], s24 offen offset:3072 lds
    v_mfma_f32_16x16x32_bf16 v[236:239], a[16:19], a[56:59], v[236:239]
    ds_read_b64_tr_b16 a[108:109], v18 offset:44032
    v_mfma_f32_16x16x32_bf16 a[140:143], a[60:63], a[16:19], a[140:143]
    s_mul_i32 s25, s31, 393216
    s_mul_i32 s26, s31, 458752
    v_mfma_f32_16x16x32_bf16 a[144:147], a[60:63], a[20:23], a[144:147]
    s_add_u32 m0, s30, 28672
    s_nop 0
    buffer_load_dwordx4 v10, s[12:15], s25 offen lds
    v_mfma_f32_16x16x32_bf16 v[240:243], a[20:23], a[56:59], v[240:243]
    ds_read_b64_tr_b16 a[110:111], v18 offset:44544
    v_mfma_f32_16x16x32_bf16 v[204:207], a[20:23], a[52:55], v[204:207]
    v_mfma_f32_16x16x32_bf16 v[156:159], a[48:51], a[20:23], v[156:159]
    ds_read_b64_tr_b16 a[112:113], v19 offset:44032
    buffer_load_dwordx4 v11, s[12:15], s25 offen offset:1024 lds
    v_mfma_f32_16x16x32_bf16 v[152:155], a[44:47], a[20:23], v[152:155]
    v_mfma_f32_16x16x32_bf16 v[84:87], a[40:43], a[20:23], v[84:87]
    ds_read_b64_tr_b16 a[114:115], v19 offset:44544
    v_mfma_f32_16x16x32_bf16 v[80:83], a[36:39], a[20:23], v[80:83]
    v_mfma_f32_16x16x32_bf16 v[88:91], a[36:39], a[24:27], v[88:91]
    buffer_load_dwordx4 v12, s[12:15], s25 offen offset:2048 lds
    v_mfma_f32_16x16x32_bf16 v[92:95], a[40:43], a[24:27], v[92:95]
    ds_read_b64_tr_b16 a[116:117], v18 offset:45056
    v_mfma_f32_16x16x32_bf16 v[160:163], a[44:47], a[24:27], v[160:163]
    v_mfma_f32_16x16x32_bf16 v[164:167], a[48:51], a[24:27], v[164:167]
    s_mov_b64 exec, s[32:33]
    buffer_load_dwordx4 v13, s[16:19], s26 offen offset:3072 lds
    s_mov_b64 exec, -1
    v_mfma_f32_16x16x32_bf16 v[208:211], a[24:27], a[52:55], v[208:211]
    ds_read_b64_tr_b16 a[118:119], v18 offset:45568
    v_mfma_f32_16x16x32_bf16 v[244:247], a[24:27], a[56:59], v[244:247]
    s_add_u32 m0, s29, s27
    ds_read_b64_tr_b16 a[120:121], v19 offset:45056
    v_mfma_f32_16x16x32_bf16 a[148:151], a[60:63], a[24:27], a[148:151]
    s_add_u32 m0, m0, 4096
    s_nop 0
    buffer_load_dwordx4 v6, s[8:11], s24 offen offset:0 lds
    v_mfma_f32_16x16x32_bf16 a[152:155], a[60:63], a[28:31], a[152:155]
    v_mfma_f32_16x16x32_bf16 v[248:251], a[28:31], a[56:59], v[248:251]
    ds_read_b64_tr_b16 a[122:123], v19 offset:45568
    v_mfma_f32_16x16x32_bf16 v[212:215], a[28:31], a[52:55], v[212:215]
    buffer_load_dwordx4 v7, s[8:11], s24 offen offset:1024 lds
    v_mfma_f32_16x16x32_bf16 v[172:175], a[48:51], a[28:31], v[172:175]
    ds_read_b64_tr_b16 a[124:125], v28 offset:43008
    v_mfma_f32_16x16x32_bf16 v[168:171], a[44:47], a[28:31], v[168:171]
    v_mfma_f32_16x16x32_bf16 v[100:103], a[40:43], a[28:31], v[100:103]
    ds_read_b64_tr_b16 a[126:127], v28 offset:43264
    buffer_load_dwordx4 v8, s[8:11], s24 offen offset:2048 lds
    v_mfma_f32_16x16x32_bf16 v[96:99], a[36:39], a[28:31], v[96:99]
    v_mfma_f32_16x16x32_bf16 v[104:107], a[36:39], a[32:35], v[104:107]
    v_mfma_f32_16x16x32_bf16 v[108:111], a[40:43], a[32:35], v[108:111]
    v_mfma_f32_16x16x32_bf16 v[176:179], a[44:47], a[32:35], v[176:179]
    buffer_load_dwordx4 v9, s[8:11], s24 offen offset:3072 lds
    v_mfma_f32_16x16x32_bf16 v[180:183], a[48:51], a[32:35], v[180:183]
    v_mfma_f32_16x16x32_bf16 v[216:219], a[32:35], a[52:55], v[216:219]
    s_add_u32 m0, s45, s27
    v_mfma_f32_16x16x32_bf16 v[252:255], a[32:35], a[56:59], v[252:255]
    s_mov_b64 exec, s[32:33]
    buffer_load_dwordx4 v1, s[8:11], s24 offen lds
    s_mov_b64 exec, -1
    v_mfma_f32_16x16x32_bf16 a[156:159], a[60:63], a[32:35], a[156:159]
    s_add_u32 s27, s27, 34816
    s_cmp_eq_u32 s27, 104448
    s_cselect_b32 s27, 0, s27
    s_waitcnt lgkmcnt(0)
    v_mfma_f32_16x16x32_bf16 v[112:115], a[108:111], a[64:67], v[112:115]
    s_waitcnt vmcnt(17)
    s_barrier
    v_mfma_f32_16x16x32_bf16 v[116:119], a[112:115], a[64:67], v[116:119]
    s_add_u32 s28, s28, 34816
    v_mfma_f32_16x16x32_bf16 v[184:187], a[64:67], a[116:119], v[184:187]
    s_cmp_eq_u32 s28, 104448
    s_cselect_b32 s28, 0, s28
    v_mfma_f32_16x16x32_bf16 v[220:223], a[64:67], a[120:123], v[220:223]
    v_mfma_f32_16x16x32_bf16 a[128:131], a[124:127], a[68:71], a[128:131]
    v_add_u32 v16, s28, v14
    v_mfma_f32_16x16x32_bf16 v[224:227], a[68:71], a[120:123], v[224:227]
    v_mfma_f32_16x16x32_bf16 v[188:191], a[68:71], a[116:119], v[188:191]
    ds_read_b64_tr_b16 a[36:37], v18 offset:0
    v_mfma_f32_16x16x32_bf16 v[124:127], a[112:115], a[68:71], v[124:127]
    v_mfma_f32_16x16x32_bf16 v[120:123], a[108:111], a[68:71], v[120:123]
    ds_read_b64_tr_b16 a[38:39], v18 offset:512
    v_mfma_f32_16x16x32_bf16 v[52:55], a[104:107], a[68:71], v[52:55]
    v_mfma_f32_16x16x32_bf16 v[48:51], a[100:103], a[68:71], v[48:51]
    ds_read_b64_tr_b16 a[40:41], v19 offset:0
    v_mfma_f32_16x16x32_bf16 v[56:59], a[100:103], a[72:75], v[56:59]
    v_mfma_f32_16x16x32_bf16 v[60:63], a[104:107], a[72:75], v[60:63]
    ds_read_b64_tr_b16 a[42:43], v19 offset:512
    v_mfma_f32_16x16x32_bf16 v[128:131], a[108:111], a[72:75], v[128:131]
    v_mfma_f32_16x16x32_bf16 v[132:135], a[112:115], a[72:75], v[132:135]
    ds_read_b64_tr_b16 a[44:45], v18 offset:1024
    v_mfma_f32_16x16x32_bf16 v[192:195], a[72:75], a[116:119], v[192:195]
    v_mfma_f32_16x16x32_bf16 v[228:231], a[72:75], a[120:123], v[228:231]
    ds_read_b64_tr_b16 a[46:47], v18 offset:1536
    v_mfma_f32_16x16x32_bf16 a[132:135], a[124:127], a[72:75], a[132:135]
    v_mfma_f32_16x16x32_bf16 a[136:139], a[124:127], a[76:79], a[136:139]
    ds_read_b64_tr_b16 a[48:49], v19 offset:1024
    v_mfma_f32_16x16x32_bf16 v[232:235], a[76:79], a[120:123], v[232:235]
    s_add_u32 s25, s25, 196608
    s_add_u32 s26, s26, 229376
    v_mfma_f32_16x16x32_bf16 v[196:199], a[76:79], a[116:119], v[196:199]
    s_add_u32 m0, s30, 43008
    s_nop 0
    buffer_load_dwordx4 v10, s[12:15], s25 offen lds
    v_mfma_f32_16x16x32_bf16 v[140:143], a[112:115], a[76:79], v[140:143]
    ds_read_b64_tr_b16 a[50:51], v19 offset:1536
    v_mfma_f32_16x16x32_bf16 v[136:139], a[108:111], a[76:79], v[136:139]
    ds_read_b64_tr_b16 a[52:53], v18 offset:2048
    v_mfma_f32_16x16x32_bf16 v[68:71], a[104:107], a[76:79], v[68:71]
    v_mfma_f32_16x16x32_bf16 v[64:67], a[100:103], a[76:79], v[64:67]
    ds_read_b64_tr_b16 a[54:55], v18 offset:2560
    v_mfma_f32_16x16x32_bf16 v[72:75], a[100:103], a[80:83], v[72:75]
    buffer_load_dwordx4 v11, s[12:15], s25 offen offset:1024 lds
    v_mfma_f32_16x16x32_bf16 v[76:79], a[104:107], a[80:83], v[76:79]
    ds_read_b64_tr_b16 a[56:57], v19 offset:2048
    v_mfma_f32_16x16x32_bf16 v[144:147], a[108:111], a[80:83], v[144:147]
    v_mfma_f32_16x16x32_bf16 v[148:151], a[112:115], a[80:83], v[148:151]
    ds_read_b64_tr_b16 a[58:59], v19 offset:2560
    v_mfma_f32_16x16x32_bf16 v[200:203], a[80:83], a[116:119], v[200:203]
    v_mfma_f32_16x16x32_bf16 v[236:239], a[80:83], a[120:123], v[236:239]
    ds_read_b64_tr_b16 a[60:61], v28 offset:0
    v_mfma_f32_16x16x32_bf16 a[140:143], a[124:127], a[80:83], a[140:143]
    buffer_load_dwordx4 v12, s[12:15], s25 offen offset:2048 lds
    v_mfma_f32_16x16x32_bf16 a[144:147], a[124:127], a[84:87], a[144:147]
    ds_read_b64_tr_b16 a[62:63], v28 offset:256
    v_mfma_f32_16x16x32_bf16 v[240:243], a[84:87], a[120:123], v[240:243]
    v_mfma_f32_16x16x32_bf16 v[204:207], a[84:87], a[116:119], v[204:207]
    v_add_u32 v17, s28, v15
    v_mfma_f32_16x16x32_bf16 v[156:159], a[112:115], a[84:87], v[156:159]
    v_mfma_f32_16x16x32_bf16 v[152:155], a[108:111], a[84:87], v[152:155]
    ds_read_b128 a[0:3], v16 offset:0
    v_mfma_f32_16x16x32_bf16 v[84:87], a[104:107], a[84:87], v[84:87]
    s_mov_b64 exec, s[32:33]
    buffer_load_dwordx4 v13, s[16:19], s26 offen offset:3072 lds
    s_mov_b64 exec, -1
    v_mfma_f32_16x16x32_bf16 v[80:83], a[100:103], a[84:87], v[80:83]
    ds_read_b128 a[4:7], v16 offset:2048
    v_mfma_f32_16x16x32_bf16 v[88:91], a[100:103], a[88:91], v[88:91]
    s_and_b32 s31, s36, 15
    v_mfma_f32_16x16x32_bf16 v[92:95], a[104:107], a[88:91], v[92:95]
    s_lshr_b64 s[36:37], s[36:37], 4
    ds_read_b128 a[8:11], v16 offset:4096
    v_mfma_f32_16x16x32_bf16 v[160:163], a[108:111], a[88:91], v[160:163]
    s_lshl_b32 s24, s31, 7
    s_add_u32 m0, s29, s27
    v_mfma_f32_16x16x32_bf16 v[164:167], a[112:115], a[88:91], v[164:167]
    buffer_load_dwordx4 v2, s[8:11], s24 offen offset:0 lds
    ds_read_b128 a[12:15], v16 offset:6144
    v_mfma_f32_16x16x32_bf16 v[208:211], a[88:91], a[116:119], v[208:211]
    v_mfma_f32_16x16x32_bf16 v[244:247], a[88:91], a[120:123], v[244:247]
    ds_read_b128 a[16:19], v16 offset:8192
    v_mfma_f32_16x16x32_bf16 a[148:151], a[124:127], a[88:91], a[148:151]
    v_mfma_f32_16x16x32_bf16 a[152:155], a[124:127], a[92:95], a[152:155]
    ds_read_b128 a[20:23], v16 offset:10240
    buffer_load_dwordx4 v3, s[8:11], s24 offen offset:1024 lds
    v_mfma_f32_16x16x32_bf16 v[248:251], a[92:95], a[120:123], v[248:251]
    v_mfma_f32_16x16x32_bf16 v[212:215], a[92:95], a[116:119], v[212:215]
    ds_read_b128 a[24:27], v16 offset:12288
    v_mfma_f32_16x16x32_bf16 v[172:175], a[112:115], a[92:95], v[172:175]
    v_mfma_f32_16x16x32_bf16 v[168:171], a[108:111], a[92:95], v[168:171]
    ds_read_b128 a[28:31], v16 offset:14336
    v_mfma_f32_16x16x32_bf16 v[100:103], a[104:107], a[92:95], v[100:103]
    v_mfma_f32_16x16x32_bf16 v[96:99], a[100:103], a[92:95], v[96:99]
    ds_read_b128 a[32:35], v16 offset:16384
    buffer_load_dwordx4 v4, s[8:11], s24 offen offset:2048 lds
    v_mfma_f32_16x16x32_bf16 v[104:107], a[100:103], a[96:99], v[104:107]
    v_mfma_f32_16x16x32_bf16 v[108:111], a[104:107], a[96:99], v[108:111]
    v_mfma_f32_16x16x32_bf16 v[176:179], a[108:111], a[96:99], v[176:179]
    v_mfma_f32_16x16x32_bf16 v[180:183], a[112:115], a[96:99], v[180:183]
    v_mfma_f32_16x16x32_bf16 v[216:219], a[96:99], a[116:119], v[216:219]
    buffer_load_dwordx4 v5, s[8:11], s24 offen offset:3072 lds
    v_mfma_f32_16x16x32_bf16 v[252:255], a[96:99], a[120:123], v[252:255]
    v_mfma_f32_16x16x32_bf16 a[156:159], a[124:127], a[96:99], a[156:159]
    s_mov_b32 s4, s72
    s_mov_b32 s5, s73
    s_mov_b32 s6, 0x700000
    s_mov_b32 s7, 0x20000
    s_lshl_b32 s46, s2, 2
    s_add_u32 s46, s46, s3
    s_mul_i32 s46, s46, 14336
    s_add_u32 s46, s46, 3584
    v_cmp_le_u32 vcc, 28, v0
    v_mov_b32 v47, 3584
    s_nop 0
    v_cndmask_b32 v47, 0, v47, vcc
    v_lshl_add_u32 v46, v0, 7, v47
    s_mov_b32 exec_hi, 0xffffff
    buffer_load_dword v47, v46, s[4:7], s46 offen
    s_mov_b64 exec, -1
    s_mov_b32 s34, 0
    s_nop 1
L_loop_1_4:
    s_waitcnt lgkmcnt(0)
    v_mfma_f32_16x16x32_bf16 v[112:115], a[44:47], a[0:3], v[112:115]
    s_waitcnt vmcnt(17)
    s_barrier
    v_mfma_f32_16x16x32_bf16 v[116:119], a[48:51], a[0:3], v[116:119]
    ds_read_b128 a[64:67], v17 offset:0
    v_mfma_f32_16x16x32_bf16 v[184:187], a[0:3], a[52:55], v[184:187]
    s_mul_i32 s25, s31, 393216
    v_mfma_f32_16x16x32_bf16 v[220:223], a[0:3], a[56:59], v[220:223]
    s_mul_i32 s26, s31, 458752
    ds_read_b128 a[68:71], v17 offset:2048
    v_mfma_f32_16x16x32_bf16 a[128:131], a[60:63], a[4:7], a[128:131]
    s_add_u32 m0, s30, 0
    s_nop 0
    buffer_load_dwordx4 v10, s[12:15], s25 offen lds
    v_mfma_f32_16x16x32_bf16 v[224:227], a[4:7], a[56:59], v[224:227]
    ds_read_b128 a[72:75], v17 offset:4096
    v_mfma_f32_16x16x32_bf16 v[188:191], a[4:7], a[52:55], v[188:191]
    v_mfma_f32_16x16x32_bf16 v[124:127], a[48:51], a[4:7], v[124:127]
    ds_read_b128 a[76:79], v17 offset:6144
    v_mfma_f32_16x16x32_bf16 v[120:123], a[44:47], a[4:7], v[120:123]
    v_mfma_f32_16x16x32_bf16 v[52:55], a[40:43], a[4:7], v[52:55]
    v_mfma_f32_16x16x32_bf16 v[48:51], a[36:39], a[4:7], v[48:51]
    ds_read_b128 a[80:83], v17 offset:8192
    buffer_load_dwordx4 v11, s[12:15], s25 offen offset:1024 lds
    v_mfma_f32_16x16x32_bf16 v[56:59], a[36:39], a[8:11], v[56:59]
    v_mfma_f32_16x16x32_bf16 v[60:63], a[40:43], a[8:11], v[60:63]
    ds_read_b128 a[84:87], v17 offset:10240
    v_mfma_f32_16x16x32_bf16 v[128:131], a[44:47], a[8:11], v[128:131]
    v_mfma_f32_16x16x32_bf16 v[132:135], a[48:51], a[8:11], v[132:135]
    ds_read_b128 a[88:91], v17 offset:12288
    v_mfma_f32_16x16x32_bf16 v[192:195], a[8:11], a[52:55], v[192:195]
    v_mfma_f32_16x16x32_bf16 v[228:231], a[8:11], a[56:59], v[228:231]
    v_mfma_f32_16x16x32_bf16 a[132:135], a[60:63], a[8:11], a[132:135]
    buffer_load_dwordx4 v12, s[12:15], s25 offen offset:2048 lds
    ds_read_b128 a[92:95], v17 offset:14336
    v_mfma_f32_16x16x32_bf16 a[136:139], a[60:63], a[12:15], a[136:139]
    v_mfma_f32_16x16x32_bf16 v[232:235], a[12:15], a[56:59], v[232:235]
    ds_read_b128 a[96:99], v17 offset:16384
    v_mfma_f32_16x16x32_bf16 v[196:199], a[12:15], a[52:55], v[196:199]
    v_mfma_f32_16x16x32_bf16 v[140:143], a[48:51], a[12:15], v[140:143]
    ds_read_b64_tr_b16 a[100:101], v18 offset:14336
    v_mfma_f32_16x16x32_bf16 v[136:139], a[44:47], a[12:15], v[136:139]
    v_mfma_f32_16x16x32_bf16 v[68:71], a[40:43], a[12:15], v[68:71]
    s_mov_b64 exec, s[32:33]
    buffer_load_dwordx4 v13, s[16:19], s26 offen offset:3072 lds
    s_mov_b64 exec, -1
    v_mfma_f32_16x16x32_bf16 v[64:67], a[36:39], a[12:15], v[64:67]
    ds_read_b64_tr_b16 a[102:103], v18 offset:14848
    v_mfma_f32_16x16x32_bf16 v[72:75], a[36:39], a[16:19], v[72:75]
    v_mfma_f32_16x16x32_bf16 v[76:79], a[40:43], a[16:19], v[76:79]
    ds_read_b64_tr_b16 a[104:105], v19 offset:14336
    v_mfma_f32_16x16x32_bf16 v[144:147], a[44:47], a[16:19], v[144:147]
    v_mfma_f32_16x16x32_bf16 v[148:151], a[48:51], a[16:19], v[148:151]
    ds_read_b64_tr_b16 a[106:107], v19 offset:14848
    v_mfma_f32_16x16x32_bf16 v[200:203], a[16:19], a[52:55], v[200:203]
    s_add_u32 m0, s29, s27
    s_add_u32 m0, m0, 4096
    v_mfma_f32_16x16x32_bf16 v[236:239], a[16:19], a[56:59], v[236:239]
    buffer_load_dwordx4 v6, s[8:11], s24 offen offset:0 lds
    ds_read_b64_tr_b16 a[108:109], v18 offset:15360
    v_mfma_f32_16x16x32_bf16 a[140:143], a[60:63], a[16:19], a[140:143]
    v_mfma_f32_16x16x32_bf16 a[144:147], a[60:63], a[20:23], a[144:147]
    v_mfma_f32_16x16x32_bf16 v[240:243], a[20:23], a[56:59], v[240:243]
    ds_read_b64_tr_b16 a[110:111], v18 offset:15872
    v_mfma_f32_16x16x32_bf16 v[204:207], a[20:23], a[52:55], v[204:207]
    v_mfma_f32_16x16x32_bf16 v[156:159], a[48:51], a[20:23], v[156:159]
    ds_read_b64_tr_b16 a[112:113], v19 offset:15360
    v_mfma_f32_16x16x32_bf16 v[152:155], a[44:47], a[20:23], v[152:155]
    buffer_load_dwordx4 v7, s[8:11], s24 offen offset:1024 lds
    v_mfma_f32_16x16x32_bf16 v[84:87], a[40:43], a[20:23], v[84:87]
    ds_read_b64_tr_b16 a[114:115], v19 offset:15872
    v_mfma_f32_16x16x32_bf16 v[80:83], a[36:39], a[20:23], v[80:83]
    v_mfma_f32_16x16x32_bf16 v[88:91], a[36:39], a[24:27], v[88:91]
    v_mfma_f32_16x16x32_bf16 v[92:95], a[40:43], a[24:27], v[92:95]
    ds_read_b64_tr_b16 a[116:117], v18 offset:16384
    v_mfma_f32_16x16x32_bf16 v[160:163], a[44:47], a[24:27], v[160:163]
    v_mfma_f32_16x16x32_bf16 v[164:167], a[48:51], a[24:27], v[164:167]
    ds_read_b64_tr_b16 a[118:119], v18 offset:16896
    buffer_load_dwordx4 v8, s[8:11], s24 offen offset:2048 lds
    v_mfma_f32_16x16x32_bf16 v[208:211], a[24:27], a[52:55], v[208:211]
    v_mfma_f32_16x16x32_bf16 v[244:247], a[24:27], a[56:59], v[244:247]
    ds_read_b64_tr_b16 a[120:121], v19 offset:16384
    v_mfma_f32_16x16x32_bf16 a[148:151], a[60:63], a[24:27], a[148:151]
    v_mfma_f32_16x16x32_bf16 a[152:155], a[60:63], a[28:31], a[152:155]
    v_mfma_f32_16x16x32_bf16 v[248:251], a[28:31], a[56:59], v[248:251]
    ds_read_b64_tr_b16 a[122:123], v19 offset:16896
    v_mfma_f32_16x16x32_bf16 v[212:215], a[28:31], a[52:55], v[212:215]
    v_mfma_f32_16x16x32_bf16 v[172:175], a[48:51], a[28:31], v[172:175]
    buffer_load_dwordx4 v9, s[8:11], s24 offen offset:3072 lds
    ds_read_b64_tr_b16 a[124:125], v28 offset:14336
    v_mfma_f32_16x16x32_bf16 v[168:171], a[44:47], a[28:31], v[168:171]
    v_mfma_f32_16x16x32_bf16 v[100:103], a[40:43], a[28:31], v[100:103]
    ds_read_b64_tr_b16 a[126:127], v28 offset:14592
    v_mfma_f32_16x16x32_bf16 v[96:99], a[36:39], a[28:31], v[96:99]
    v_mfma_f32_16x16x32_bf16 v[104:107], a[36:39], a[32:35], v[104:107]
    v_mfma_f32_16x16x32_bf16 v[108:111], a[40:43], a[32:35], v[108:111]
    v_mfma_f32_16x16x32_bf16 v[176:179], a[44:47], a[32:35], v[176:179]
    s_add_u32 m0, s45, s27
    v_mfma_f32_16x16x32_bf16 v[180:183], a[48:51], a[32:35], v[180:183]
    s_mov_b64 exec, s[32:33]
    buffer_load_dwordx4 v1, s[8:11], s24 offen lds
    s_mov_b64 exec, -1
    v_mfma_f32_16x16x32_bf16 v[216:219], a[32:35], a[52:55], v[216:219]
    s_add_u32 s27, s27, 34816
    v_mfma_f32_16x16x32_bf16 v[252:255], a[32:35], a[56:59], v[252:255]
    s_cmp_eq_u32 s27, 104448
    s_cselect_b32 s27, 0, s27
    v_mfma_f32_16x16x32_bf16 a[156:159], a[60:63], a[32:35], a[156:159]
    s_waitcnt lgkmcnt(0)
    v_mfma_f32_16x16x32_bf16 v[112:115], a[108:111], a[64:67], v[112:115]
    s_waitcnt vmcnt(17)
    s_barrier
    v_mfma_f32_16x16x32_bf16 v[116:119], a[112:115], a[64:67], v[116:119]
    s_add_u32 s28, s28, 34816
    v_mfma_f32_16x16x32_bf16 v[184:187], a[64:67], a[116:119], v[184:187]
    s_cmp_eq_u32 s28, 104448
    s_cselect_b32 s28, 0, s28
    v_mfma_f32_16x16x32_bf16 v[220:223], a[64:67], a[120:123], v[220:223]
    s_add_u32 s25, s25, 196608
    s_add_u32 s26, s26, 229376
    v_mfma_f32_16x16x32_bf16 a[128:131], a[124:127], a[68:71], a[128:131]
    s_add_u32 m0, s30, 14336
    s_nop 0
    buffer_load_dwordx4 v10, s[12:15], s25 offen lds
    v_mfma_f32_16x16x32_bf16 v[224:227], a[68:71], a[120:123], v[224:227]
    v_add_u32 v16, s28, v14
    v_mfma_f32_16x16x32_bf16 v[188:191], a[68:71], a[116:119], v[188:191]
    ds_read_b64_tr_b16 a[36:37], v18 offset:28672
    v_mfma_f32_16x16x32_bf16 v[124:127], a[112:115], a[68:71], v[124:127]
    v_mfma_f32_16x16x32_bf16 v[120:123], a[108:111], a[68:71], v[120:123]
    ds_read_b64_tr_b16 a[38:39], v18 offset:29184
    v_mfma_f32_16x16x32_bf16 v[52:55], a[104:107], a[68:71], v[52:55]
    v_mfma_f32_16x16x32_bf16 v[48:51], a[100:103], a[68:71], v[48:51]
    ds_read_b64_tr_b16 a[40:41], v19 offset:28672
    v_mfma_f32_16x16x32_bf16 v[56:59], a[100:103], a[72:75], v[56:59]
    buffer_load_dwordx4 v11, s[12:15], s25 offen offset:1024 lds
    v_mfma_f32_16x16x32_bf16 v[60:63], a[104:107], a[72:75], v[60:63]
    ds_read_b64_tr_b16 a[42:43], v19 offset:29184
    v_mfma_f32_16x16x32_bf16 v[128:131], a[108:111], a[72:75], v[128:131]
    v_mfma_f32_16x16x32_bf16 v[132:135], a[112:115], a[72:75], v[132:135]
    ds_read_b64_tr_b16 a[44:45], v18 offset:29696
    v_mfma_f32_16x16x32_bf16 v[192:195], a[72:75], a[116:119], v[192:195]
    v_mfma_f32_16x16x32_bf16 v[228:231], a[72:75], a[120:123], v[228:231]
    ds_read_b64_tr_b16 a[46:47], v18 offset:30208
    v_mfma_f32_16x16x32_bf16 a[132:135], a[124:127], a[72:75], a[132:135]
    v_mfma_f32_16x16x32_bf16 a[136:139], a[124:127], a[76:79], a[136:139]
    ds_read_b64_tr_b16 a[48:49], v19 offset:29696
    v_mfma_f32_16x16x32_bf16 v[232:235], a[76:79], a[120:123], v[232:235]
    buffer_load_dwordx4 v12, s[12:15], s25 offen offset:2048 lds
    v_mfma_f32_16x16x32_bf16 v[196:199], a[76:79], a[116:119], v[196:199]
    ds_read_b64_tr_b16 a[50:51], v19 offset:30208
    v_mfma_f32_16x16x32_bf16 v[140:143], a[112:115], a[76:79], v[140:143]
    v_mfma_f32_16x16x32_bf16 v[136:139], a[108:111], a[76:79], v[136:139]
    ds_read_b64_tr_b16 a[52:53], v18 offset:30720
    v_mfma_f32_16x16x32_bf16 v[68:71], a[104:107], a[76:79], v[68:71]
    v_mfma_f32_16x16x32_bf16 v[64:67], a[100:103], a[76:79], v[64:67]
    ds_read_b64_tr_b16 a[54:55], v18 offset:31232
    v_mfma_f32_16x16x32_bf16 v[72:75], a[100:103], a[80:83], v[72:75]
    v_mfma_f32_16x16x32_bf16 v[76:79], a[104:107], a[80:83], v[76:79]
    s_mov_b64 exec, s[32:33]
    buffer_load_dwordx4 v13, s[16:19], s26 offen offset:3072 lds
    s_mov_b64 exec, -1
    v_mfma_f32_16x16x32_bf16 v[144:147], a[108:111], a[80:83], v[144:147]
    ds_read_b64_tr_b16 a[56:57], v19 offset:30720
    v_mfma_f32_16x16x32_bf16 v[148:151], a[112:115], a[80:83], v[148:151]
    ds_read_b64_tr_b16 a[58:59], v19 offset:31232
    v_mfma_f32_16x16x32_bf16 v[200:203], a[80:83], a[116:119], v[200:203]
    v_mfma_f32_16x16x32_bf16 v[236:239], a[80:83], a[120:123], v[236:239]
    ds_read_b64_tr_b16 a[60:61], v28 offset:28672
    v_mfma_f32_16x16x32_bf16 a[140:143], a[124:127], a[80:83], a[140:143]
    s_and_b32 s31, s36, 15
    v_mfma_f32_16x16x32_bf16 a[144:147], a[124:127], a[84:87], a[144:147]
    s_lshr_b64 s[36:37], s[36:37], 4
    ds_read_b64_tr_b16 a[62:63], v28 offset:28928
    v_mfma_f32_16x16x32_bf16 v[240:243], a[84:87], a[120:123], v[240:243]
    s_lshl_b32 s24, s31, 7
    s_add_u32 m0, s29, s27
    v_mfma_f32_16x16x32_bf16 v[204:207], a[84:87], a[116:119], v[204:207]
    buffer_load_dwordx4 v2, s[8:11], s24 offen offset:0 lds
    v_add_u32 v17, s28, v15
    v_mfma_f32_16x16x32_bf16 v[156:159], a[112:115], a[84:87], v[156:159]
    v_mfma_f32_16x16x32_bf16 v[152:155], a[108:111], a[84:87], v[152:155]
    ds_read_b128 a[0:3], v16 offset:0
    v_mfma_f32_16x16x32_bf16 v[84:87], a[104:107], a[84:87], v[84:87]
    v_mfma_f32_16x16x32_bf16 v[80:83], a[100:103], a[84:87], v[80:83]
    ds_read_b128 a[4:7], v16 offset:2048
    v_mfma_f32_16x16x32_bf16 v[88:91], a[100:103], a[88:91], v[88:91]
    v_mfma_f32_16x16x32_bf16 v[92:95], a[104:107], a[88:91], v[92:95]
    ds_read_b128 a[8:11], v16 offset:4096
    buffer_load_dwordx4 v3, s[8:11], s24 offen offset:1024 lds
    v_mfma_f32_16x16x32_bf16 v[160:163], a[108:111], a[88:91], v[160:163]
    v_mfma_f32_16x16x32_bf16 v[164:167], a[112:115], a[88:91], v[164:167]
    ds_read_b128 a[12:15], v16 offset:6144
    v_mfma_f32_16x16x32_bf16 v[208:211], a[88:91], a[116:119], v[208:211]
    v_mfma_f32_16x16x32_bf16 v[244:247], a[88:91], a[120:123], v[244:247]
    ds_read_b128 a[16:19], v16 offset:8192
    v_mfma_f32_16x16x32_bf16 a[148:151], a[124:127], a[88:91], a[148:151]
    v_mfma_f32_16x16x32_bf16 a[152:155], a[124:127], a[92:95], a[152:155]
    ds_read_b128 a[20:23], v16 offset:10240
    v_mfma_f32_16x16x32_bf16 v[248:251], a[92:95], a[120:123], v[248:251]
    v_mfma_f32_16x16x32_bf16 v[212:215], a[92:95], a[116:119], v[212:215]
    ds_read_b128 a[24:27], v16 offset:12288
    buffer_load_dwordx4 v4, s[8:11], s24 offen offset:2048 lds
    v_mfma_f32_16x16x32_bf16 v[172:175], a[112:115], a[92:95], v[172:175]
    v_mfma_f32_16x16x32_bf16 v[168:171], a[108:111], a[92:95], v[168:171]
    ds_read_b128 a[28:31], v16 offset:14336
    v_mfma_f32_16x16x32_bf16 v[100:103], a[104:107], a[92:95], v[100:103]
    v_mfma_f32_16x16x32_bf16 v[96:99], a[100:103], a[92:95], v[96:99]
    ds_read_b128 a[32:35], v16 offset:16384
    v_mfma_f32_16x16x32_bf16 v[104:107], a[100:103], a[96:99], v[104:107]
    v_mfma_f32_16x16x32_bf16 v[108:111], a[104:107], a[96:99], v[108:111]
    v_mfma_f32_16x16x32_bf16 v[176:179], a[108:111], a[96:99], v[176:179]
    buffer_load_dwordx4 v5, s[8:11], s24 offen offset:3072 lds
    v_mfma_f32_16x16x32_bf16 v[180:183], a[112:115], a[96:99], v[180:183]
    v_mfma_f32_16x16x32_bf16 v[216:219], a[96:99], a[116:119], v[216:219]
    v_mfma_f32_16x16x32_bf16 v[252:255], a[96:99], a[120:123], v[252:255]
    v_mfma_f32_16x16x32_bf16 a[156:159], a[124:127], a[96:99], a[156:159]
    s_waitcnt lgkmcnt(0)
    v_mfma_f32_16x16x32_bf16 v[112:115], a[44:47], a[0:3], v[112:115]
    s_waitcnt vmcnt(17)
    s_barrier
    v_mfma_f32_16x16x32_bf16 v[116:119], a[48:51], a[0:3], v[116:119]
    ds_read_b128 a[64:67], v17 offset:0
    v_mfma_f32_16x16x32_bf16 v[184:187], a[0:3], a[52:55], v[184:187]
    s_mul_i32 s25, s31, 393216
    v_mfma_f32_16x16x32_bf16 v[220:223], a[0:3], a[56:59], v[220:223]
    s_mul_i32 s26, s31, 458752
    ds_read_b128 a[68:71], v17 offset:2048
    v_mfma_f32_16x16x32_bf16 a[128:131], a[60:63], a[4:7], a[128:131]
    s_add_u32 m0, s30, 28672
    s_nop 0
    buffer_load_dwordx4 v10, s[12:15], s25 offen lds
    v_mfma_f32_16x16x32_bf16 v[224:227], a[4:7], a[56:59], v[224:227]
    ds_read_b128 a[72:75], v17 offset:4096
    v_mfma_f32_16x16x32_bf16 v[188:191], a[4:7], a[52:55], v[188:191]
    v_mfma_f32_16x16x32_bf16 v[124:127], a[48:51], a[4:7], v[124:127]
    ds_read_b128 a[76:79], v17 offset:6144
    v_mfma_f32_16x16x32_bf16 v[120:123], a[44:47], a[4:7], v[120:123]
    v_mfma_f32_16x16x32_bf16 v[52:55], a[40:43], a[4:7], v[52:55]
    v_mfma_f32_16x16x32_bf16 v[48:51], a[36:39], a[4:7], v[48:51]
    ds_read_b128 a[80:83], v17 offset:8192
    buffer_load_dwordx4 v11, s[12:15], s25 offen offset:1024 lds
    v_mfma_f32_16x16x32_bf16 v[56:59], a[36:39], a[8:11], v[56:59]
    v_mfma_f32_16x16x32_bf16 v[60:63], a[40:43], a[8:11], v[60:63]
    ds_read_b128 a[84:87], v17 offset:10240
    v_mfma_f32_16x16x32_bf16 v[128:131], a[44:47], a[8:11], v[128:131]
    v_mfma_f32_16x16x32_bf16 v[132:135], a[48:51], a[8:11], v[132:135]
    ds_read_b128 a[88:91], v17 offset:12288
    v_mfma_f32_16x16x32_bf16 v[192:195], a[8:11], a[52:55], v[192:195]
    v_mfma_f32_16x16x32_bf16 v[228:231], a[8:11], a[56:59], v[228:231]
    v_mfma_f32_16x16x32_bf16 a[132:135], a[60:63], a[8:11], a[132:135]
    buffer_load_dwordx4 v12, s[12:15], s25 offen offset:2048 lds
    ds_read_b128 a[92:95], v17 offset:14336
    v_mfma_f32_16x16x32_bf16 a[136:139], a[60:63], a[12:15], a[136:139]
    v_mfma_f32_16x16x32_bf16 v[232:235], a[12:15], a[56:59], v[232:235]
    ds_read_b128 a[96:99], v17 offset:16384
    v_mfma_f32_16x16x32_bf16 v[196:199], a[12:15], a[52:55], v[196:199]
    v_mfma_f32_16x16x32_bf16 v[140:143], a[48:51], a[12:15], v[140:143]
    ds_read_b64_tr_b16 a[100:101], v18 offset:43008
    v_mfma_f32_16x16x32_bf16 v[136:139], a[44:47], a[12:15], v[136:139]
    v_mfma_f32_16x16x32_bf16 v[68:71], a[40:43], a[12:15], v[68:71]
    s_mov_b64 exec, s[32:33]
    buffer_load_dwordx4 v13, s[16:19], s26 offen offset:3072 lds
    s_mov_b64 exec, -1
    v_mfma_f32_16x16x32_bf16 v[64:67], a[36:39], a[12:15], v[64:67]
    ds_read_b64_tr_b16 a[102:103], v18 offset:43520
    v_mfma_f32_16x16x32_bf16 v[72:75], a[36:39], a[16:19], v[72:75]
    v_mfma_f32_16x16x32_bf16 v[76:79], a[40:43], a[16:19], v[76:79]
    ds_read_b64_tr_b16 a[104:105], v19 offset:43008
    v_mfma_f32_16x16x32_bf16 v[144:147], a[44:47], a[16:19], v[144:147]
    v_mfma_f32_16x16x32_bf16 v[148:151], a[48:51], a[16:19], v[148:151]
    ds_read_b64_tr_b16 a[106:107], v19 offset:43520
    v_mfma_f32_16x16x32_bf16 v[200:203], a[16:19], a[52:55], v[200:203]
    s_add_u32 m0, s29, s27
    s_add_u32 m0, m0, 4096
    v_mfma_f32_16x16x32_bf16 v[236:239], a[16:19], a[56:59], v[236:239]
    buffer_load_dwordx4 v6, s[8:11], s24 offen offset:0 lds
    ds_read_b64_tr_b16 a[108:109], v18 offset:44032
    v_mfma_f32_16x16x32_bf16 a[140:143], a[60:63], a[16:19], a[140:143]
    v_mfma_f32_16x16x32_bf16 a[144:147], a[60:63], a[20:23], a[144:147]
    v_mfma_f32_16x16x32_bf16 v[240:243], a[20:23], a[56:59], v[240:243]
    ds_read_b64_tr_b16 a[110:111], v18 offset:44544
    v_mfma_f32_16x16x32_bf16 v[204:207], a[20:23], a[52:55], v[204:207]
    v_mfma_f32_16x16x32_bf16 v[156:159], a[48:51], a[20:23], v[156:159]
    ds_read_b64_tr_b16 a[112:113], v19 offset:44032
    v_mfma_f32_16x16x32_bf16 v[152:155], a[44:47], a[20:23], v[152:155]
    buffer_load_dwordx4 v7, s[8:11], s24 offen offset:1024 lds
    v_mfma_f32_16x16x32_bf16 v[84:87], a[40:43], a[20:23], v[84:87]
    ds_read_b64_tr_b16 a[114:115], v19 offset:44544
    v_mfma_f32_16x16x32_bf16 v[80:83], a[36:39], a[20:23], v[80:83]
    v_mfma_f32_16x16x32_bf16 v[88:91], a[36:39], a[24:27], v[88:91]
    v_mfma_f32_16x16x32_bf16 v[92:95], a[40:43], a[24:27], v[92:95]
    ds_read_b64_tr_b16 a[116:117], v18 offset:45056
    v_mfma_f32_16x16x32_bf16 v[160:163], a[44:47], a[24:27], v[160:163]
    v_mfma_f32_16x16x32_bf16 v[164:167], a[48:51], a[24:27], v[164:167]
    ds_read_b64_tr_b16 a[118:119], v18 offset:45568
    buffer_load_dwordx4 v8, s[8:11], s24 offen offset:2048 lds
    v_mfma_f32_16x16x32_bf16 v[208:211], a[24:27], a[52:55], v[208:211]
    v_mfma_f32_16x16x32_bf16 v[244:247], a[24:27], a[56:59], v[244:247]
    ds_read_b64_tr_b16 a[120:121], v19 offset:45056
    v_mfma_f32_16x16x32_bf16 a[148:151], a[60:63], a[24:27], a[148:151]
    v_mfma_f32_16x16x32_bf16 a[152:155], a[60:63], a[28:31], a[152:155]
    v_mfma_f32_16x16x32_bf16 v[248:251], a[28:31], a[56:59], v[248:251]
    ds_read_b64_tr_b16 a[122:123], v19 offset:45568
    v_mfma_f32_16x16x32_bf16 v[212:215], a[28:31], a[52:55], v[212:215]
    v_mfma_f32_16x16x32_bf16 v[172:175], a[48:51], a[28:31], v[172:175]
    buffer_load_dwordx4 v9, s[8:11], s24 offen offset:3072 lds
    ds_read_b64_tr_b16 a[124:125], v28 offset:43008
    v_mfma_f32_16x16x32_bf16 v[168:171], a[44:47], a[28:31], v[168:171]
    v_mfma_f32_16x16x32_bf16 v[100:103], a[40:43], a[28:31], v[100:103]
    ds_read_b64_tr_b16 a[126:127], v28 offset:43264
    v_mfma_f32_16x16x32_bf16 v[96:99], a[36:39], a[28:31], v[96:99]
    v_mfma_f32_16x16x32_bf16 v[104:107], a[36:39], a[32:35], v[104:107]
    v_mfma_f32_16x16x32_bf16 v[108:111], a[40:43], a[32:35], v[108:111]
    v_mfma_f32_16x16x32_bf16 v[176:179], a[44:47], a[32:35], v[176:179]
    s_add_u32 m0, s45, s27
    v_mfma_f32_16x16x32_bf16 v[180:183], a[48:51], a[32:35], v[180:183]
    s_mov_b64 exec, s[32:33]
    buffer_load_dwordx4 v1, s[8:11], s24 offen lds
    s_mov_b64 exec, -1
    v_mfma_f32_16x16x32_bf16 v[216:219], a[32:35], a[52:55], v[216:219]
    s_add_u32 s27, s27, 34816
    v_mfma_f32_16x16x32_bf16 v[252:255], a[32:35], a[56:59], v[252:255]
    s_cmp_eq_u32 s27, 104448
    s_cselect_b32 s27, 0, s27
    v_mfma_f32_16x16x32_bf16 a[156:159], a[60:63], a[32:35], a[156:159]
    s_waitcnt lgkmcnt(0)
    v_mfma_f32_16x16x32_bf16 v[112:115], a[108:111], a[64:67], v[112:115]
    s_waitcnt vmcnt(17)
    s_barrier
    v_mfma_f32_16x16x32_bf16 v[116:119], a[112:115], a[64:67], v[116:119]
    s_add_u32 s28, s28, 34816
    v_mfma_f32_16x16x32_bf16 v[184:187], a[64:67], a[116:119], v[184:187]
    s_cmp_eq_u32 s28, 104448
    s_cselect_b32 s28, 0, s28
    v_mfma_f32_16x16x32_bf16 v[220:223], a[64:67], a[120:123], v[220:223]
    s_add_u32 s25, s25, 196608
    s_add_u32 s26, s26, 229376
    v_mfma_f32_16x16x32_bf16 a[128:131], a[124:127], a[68:71], a[128:131]
    s_add_u32 m0, s30, 43008
    s_nop 0
    buffer_load_dwordx4 v10, s[12:15], s25 offen lds
    v_mfma_f32_16x16x32_bf16 v[224:227], a[68:71], a[120:123], v[224:227]
    v_add_u32 v16, s28, v14
    v_mfma_f32_16x16x32_bf16 v[188:191], a[68:71], a[116:119], v[188:191]
    ds_read_b64_tr_b16 a[36:37], v18 offset:0
    v_mfma_f32_16x16x32_bf16 v[124:127], a[112:115], a[68:71], v[124:127]
    v_mfma_f32_16x16x32_bf16 v[120:123], a[108:111], a[68:71], v[120:123]
    ds_read_b64_tr_b16 a[38:39], v18 offset:512
    v_mfma_f32_16x16x32_bf16 v[52:55], a[104:107], a[68:71], v[52:55]
    v_mfma_f32_16x16x32_bf16 v[48:51], a[100:103], a[68:71], v[48:51]
    ds_read_b64_tr_b16 a[40:41], v19 offset:0
    v_mfma_f32_16x16x32_bf16 v[56:59], a[100:103], a[72:75], v[56:59]
    buffer_load_dwordx4 v11, s[12:15], s25 offen offset:1024 lds
    v_mfma_f32_16x16x32_bf16 v[60:63], a[104:107], a[72:75], v[60:63]
    ds_read_b64_tr_b16 a[42:43], v19 offset:512
    v_mfma_f32_16x16x32_bf16 v[128:131], a[108:111], a[72:75], v[128:131]
    v_mfma_f32_16x16x32_bf16 v[132:135], a[112:115], a[72:75], v[132:135]
    ds_read_b64_tr_b16 a[44:45], v18 offset:1024
    v_mfma_f32_16x16x32_bf16 v[192:195], a[72:75], a[116:119], v[192:195]
    v_mfma_f32_16x16x32_bf16 v[228:231], a[72:75], a[120:123], v[228:231]
    ds_read_b64_tr_b16 a[46:47], v18 offset:1536
    v_mfma_f32_16x16x32_bf16 a[132:135], a[124:127], a[72:75], a[132:135]
    v_mfma_f32_16x16x32_bf16 a[136:139], a[124:127], a[76:79], a[136:139]
    ds_read_b64_tr_b16 a[48:49], v19 offset:1024
    v_mfma_f32_16x16x32_bf16 v[232:235], a[76:79], a[120:123], v[232:235]
    buffer_load_dwordx4 v12, s[12:15], s25 offen offset:2048 lds
    v_mfma_f32_16x16x32_bf16 v[196:199], a[76:79], a[116:119], v[196:199]
    ds_read_b64_tr_b16 a[50:51], v19 offset:1536
    v_mfma_f32_16x16x32_bf16 v[140:143], a[112:115], a[76:79], v[140:143]
    v_mfma_f32_16x16x32_bf16 v[136:139], a[108:111], a[76:79], v[136:139]
    ds_read_b64_tr_b16 a[52:53], v18 offset:2048
    v_mfma_f32_16x16x32_bf16 v[68:71], a[104:107], a[76:79], v[68:71]
    v_mfma_f32_16x16x32_bf16 v[64:67], a[100:103], a[76:79], v[64:67]
    ds_read_b64_tr_b16 a[54:55], v18 offset:2560
    v_mfma_f32_16x16x32_bf16 v[72:75], a[100:103], a[80:83], v[72:75]
    v_mfma_f32_16x16x32_bf16 v[76:79], a[104:107], a[80:83], v[76:79]
    s_mov_b64 exec, s[32:33]
    buffer_load_dwordx4 v13, s[16:19], s26 offen offset:3072 lds
    s_mov_b64 exec, -1
    v_mfma_f32_16x16x32_bf16 v[144:147], a[108:111], a[80:83], v[144:147]
    ds_read_b64_tr_b16 a[56:57], v19 offset:2048
    v_mfma_f32_16x16x32_bf16 v[148:151], a[112:115], a[80:83], v[148:151]
    ds_read_b64_tr_b16 a[58:59], v19 offset:2560
    v_mfma_f32_16x16x32_bf16 v[200:203], a[80:83], a[116:119], v[200:203]
    v_mfma_f32_16x16x32_bf16 v[236:239], a[80:83], a[120:123], v[236:239]
    ds_read_b64_tr_b16 a[60:61], v28 offset:0
    v_mfma_f32_16x16x32_bf16 a[140:143], a[124:127], a[80:83], a[140:143]
    s_and_b32 s31, s36, 15
    v_mfma_f32_16x16x32_bf16 a[144:147], a[124:127], a[84:87], a[144:147]
    s_lshr_b64 s[36:37], s[36:37], 4
    ds_read_b64_tr_b16 a[62:63], v28 offset:256
    v_mfma_f32_16x16x32_bf16 v[240:243], a[84:87], a[120:123], v[240:243]
    s_lshl_b32 s24, s31, 7
    s_add_u32 m0, s29, s27
    v_mfma_f32_16x16x32_bf16 v[204:207], a[84:87], a[116:119], v[204:207]
    buffer_load_dwordx4 v2, s[8:11], s24 offen offset:0 lds
    v_add_u32 v17, s28, v15
    v_mfma_f32_16x16x32_bf16 v[156:159], a[112:115], a[84:87], v[156:159]
    v_mfma_f32_16x16x32_bf16 v[152:155], a[108:111], a[84:87], v[152:155]
    ds_read_b128 a[0:3], v16 offset:0
    v_mfma_f32_16x16x32_bf16 v[84:87], a[104:107], a[84:87], v[84:87]
    v_mfma_f32_16x16x32_bf16 v[80:83], a[100:103], a[84:87], v[80:83]
    ds_read_b128 a[4:7], v16 offset:2048
    v_mfma_f32_16x16x32_bf16 v[88:91], a[100:103], a[88:91], v[88:91]
    v_mfma_f32_16x16x32_bf16 v[92:95], a[104:107], a[88:91], v[92:95]
    ds_read_b128 a[8:11], v16 offset:4096
    buffer_load_dwordx4 v3, s[8:11], s24 offen offset:1024 lds
    v_mfma_f32_16x16x32_bf16 v[160:163], a[108:111], a[88:91], v[160:163]
    v_mfma_f32_16x16x32_bf16 v[164:167], a[112:115], a[88:91], v[164:167]
    ds_read_b128 a[12:15], v16 offset:6144
    v_mfma_f32_16x16x32_bf16 v[208:211], a[88:91], a[116:119], v[208:211]
    v_mfma_f32_16x16x32_bf16 v[244:247], a[88:91], a[120:123], v[244:247]
    ds_read_b128 a[16:19], v16 offset:8192
    v_mfma_f32_16x16x32_bf16 a[148:151], a[124:127], a[88:91], a[148:151]
    v_mfma_f32_16x16x32_bf16 a[152:155], a[124:127], a[92:95], a[152:155]
    ds_read_b128 a[20:23], v16 offset:10240
    v_mfma_f32_16x16x32_bf16 v[248:251], a[92:95], a[120:123], v[248:251]
    v_mfma_f32_16x16x32_bf16 v[212:215], a[92:95], a[116:119], v[212:215]
    ds_read_b128 a[24:27], v16 offset:12288
    buffer_load_dwordx4 v4, s[8:11], s24 offen offset:2048 lds
    v_mfma_f32_16x16x32_bf16 v[172:175], a[112:115], a[92:95], v[172:175]
    v_mfma_f32_16x16x32_bf16 v[168:171], a[108:111], a[92:95], v[168:171]
    ds_read_b128 a[28:31], v16 offset:14336
    v_mfma_f32_16x16x32_bf16 v[100:103], a[104:107], a[92:95], v[100:103]
    v_mfma_f32_16x16x32_bf16 v[96:99], a[100:103], a[92:95], v[96:99]
    ds_read_b128 a[32:35], v16 offset:16384
    v_mfma_f32_16x16x32_bf16 v[104:107], a[100:103], a[96:99], v[104:107]
    v_mfma_f32_16x16x32_bf16 v[108:111], a[104:107], a[96:99], v[108:111]
    v_mfma_f32_16x16x32_bf16 v[176:179], a[108:111], a[96:99], v[176:179]
    buffer_load_dwordx4 v5, s[8:11], s24 offen offset:3072 lds
    v_mfma_f32_16x16x32_bf16 v[180:183], a[112:115], a[96:99], v[180:183]
    v_mfma_f32_16x16x32_bf16 v[216:219], a[96:99], a[116:119], v[216:219]
    v_mfma_f32_16x16x32_bf16 v[252:255], a[96:99], a[120:123], v[252:255]
    v_mfma_f32_16x16x32_bf16 a[156:159], a[124:127], a[96:99], a[156:159]
    s_lshr_b32 s47, 0x2, s34
    s_bitcmp1_b32 s47, 0
    s_cbranch_scc0 L_nt_1_5
    s_cmp_lg_u32 s34, 1
    s_cbranch_scc1 L_nk_1_6
    s_mov_b32 s4, s72
    s_mov_b32 s5, s73
    s_mov_b32 s6, 0x700000
    s_mov_b32 s7, 0x20000
    s_lshl_b32 s46, s2, 2
    s_add_u32 s46, s46, s3
    s_mul_i32 s46, s46, 14336
    s_add_u32 s46, s46, 0
    v_cmp_le_u32 vcc, 20, v0
    v_mov_b32 v47, 4608
    s_nop 0
    v_cndmask_b32 v47, 0, v47, vcc
    v_lshl_add_u32 v46, v0, 7, v47
    s_mov_b32 exec_hi, 0xff
    buffer_load_dword v47, v46, s[4:7], s46 offen
    s_mov_b64 exec, -1
L_nk_1_6:
L_nt_1_5:
    s_nop 1
    s_add_u32 s34, s34, 1
    s_cmp_lt_u32 s34, 5
    s_cbranch_scc1 L_loop_1_4
    s_waitcnt lgkmcnt(0)
    v_mfma_f32_16x16x32_bf16 v[112:115], a[44:47], a[0:3], v[112:115]
    s_waitcnt vmcnt(17)
    s_barrier
    v_mfma_f32_16x16x32_bf16 v[116:119], a[48:51], a[0:3], v[116:119]
    ds_read_b128 a[64:67], v17 offset:0
    v_mfma_f32_16x16x32_bf16 v[184:187], a[0:3], a[52:55], v[184:187]
    s_mul_i32 s25, s31, 393216
    v_mfma_f32_16x16x32_bf16 v[220:223], a[0:3], a[56:59], v[220:223]
    s_mul_i32 s26, s31, 458752
    ds_read_b128 a[68:71], v17 offset:2048
    v_mfma_f32_16x16x32_bf16 a[128:131], a[60:63], a[4:7], a[128:131]
    s_add_u32 m0, s30, 0
    s_nop 0
    buffer_load_dwordx4 v10, s[12:15], s25 offen lds
    v_mfma_f32_16x16x32_bf16 v[224:227], a[4:7], a[56:59], v[224:227]
    ds_read_b128 a[72:75], v17 offset:4096
    v_mfma_f32_16x16x32_bf16 v[188:191], a[4:7], a[52:55], v[188:191]
    v_mfma_f32_16x16x32_bf16 v[124:127], a[48:51], a[4:7], v[124:127]
    ds_read_b128 a[76:79], v17 offset:6144
    v_mfma_f32_16x16x32_bf16 v[120:123], a[44:47], a[4:7], v[120:123]
    v_mfma_f32_16x16x32_bf16 v[52:55], a[40:43], a[4:7], v[52:55]
    v_mfma_f32_16x16x32_bf16 v[48:51], a[36:39], a[4:7], v[48:51]
    ds_read_b128 a[80:83], v17 offset:8192
    buffer_load_dwordx4 v11, s[12:15], s25 offen offset:1024 lds
    v_mfma_f32_16x16x32_bf16 v[56:59], a[36:39], a[8:11], v[56:59]
    v_mfma_f32_16x16x32_bf16 v[60:63], a[40:43], a[8:11], v[60:63]
    ds_read_b128 a[84:87], v17 offset:10240
    v_mfma_f32_16x16x32_bf16 v[128:131], a[44:47], a[8:11], v[128:131]
    v_mfma_f32_16x16x32_bf16 v[132:135], a[48:51], a[8:11], v[132:135]
    ds_read_b128 a[88:91], v17 offset:12288
    v_mfma_f32_16x16x32_bf16 v[192:195], a[8:11], a[52:55], v[192:195]
    v_mfma_f32_16x16x32_bf16 v[228:231], a[8:11], a[56:59], v[228:231]
    v_mfma_f32_16x16x32_bf16 a[132:135], a[60:63], a[8:11], a[132:135]
    buffer_load_dwordx4 v12, s[12:15], s25 offen offset:2048 lds
    ds_read_b128 a[92:95], v17 offset:14336
    v_mfma_f32_16x16x32_bf16 a[136:139], a[60:63], a[12:15], a[136:139]
    v_mfma_f32_16x16x32_bf16 v[232:235], a[12:15], a[56:59], v[232:235]
    ds_read_b128 a[96:99], v17 offset:16384
    v_mfma_f32_16x16x32_bf16 v[196:199], a[12:15], a[52:55], v[196:199]
    v_mfma_f32_16x16x32_bf16 v[140:143], a[48:51], a[12:15], v[140:143]
    ds_read_b64_tr_b16 a[100:101], v18 offset:14336
    v_mfma_f32_16x16x32_bf16 v[136:139], a[44:47], a[12:15], v[136:139]
    v_mfma_f32_16x16x32_bf16 v[68:71], a[40:43], a[12:15], v[68:71]
    s_mov_b64 exec, s[32:33]
    buffer_load_dwordx4 v13, s[16:19], s26 offen offset:3072 lds
    s_mov_b64 exec, -1
    v_mfma_f32_16x16x32_bf16 v[64:67], a[36:39], a[12:15], v[64:67]
    ds_read_b64_tr_b16 a[102:103], v18 offset:14848
    v_mfma_f32_16x16x32_bf16 v[72:75], a[36:39], a[16:19], v[72:75]
    v_mfma_f32_16x16x32_bf16 v[76:79], a[40:43], a[16:19], v[76:79]
    ds_read_b64_tr_b16 a[104:105], v19 offset:14336
    v_mfma_f32_16x16x32_bf16 v[144:147], a[44:47], a[16:19], v[144:147]
    v_mfma_f32_16x16x32_bf16 v[148:151], a[48:51], a[16:19], v[148:151]
    ds_read_b64_tr_b16 a[106:107], v19 offset:14848
    v_mfma_f32_16x16x32_bf16 v[200:203], a[16:19], a[52:55], v[200:203]
    s_add_u32 m0, s29, s27
    s_add_u32 m0, m0, 4096
    v_mfma_f32_16x16x32_bf16 v[236:239], a[16:19], a[56:59], v[236:239]
    buffer_load_dwordx4 v6, s[8:11], s24 offen offset:0 lds
    ds_read_b64_tr_b16 a[108:109], v18 offset:15360
    v_mfma_f32_16x16x32_bf16 a[140:143], a[60:63], a[16:19], a[140:143]
    v_mfma_f32_16x16x32_bf16 a[144:147], a[60:63], a[20:23], a[144:147]
    v_mfma_f32_16x16x32_bf16 v[240:243], a[20:23], a[56:59], v[240:243]
    ds_read_b64_tr_b16 a[110:111], v18 offset:15872
    v_mfma_f32_16x16x32_bf16 v[204:207], a[20:23], a[52:55], v[204:207]
    v_mfma_f32_16x16x32_bf16 v[156:159], a[48:51], a[20:23], v[156:159]
    ds_read_b64_tr_b16 a[112:113], v19 offset:15360
    v_mfma_f32_16x16x32_bf16 v[152:155], a[44:47], a[20:23], v[152:155]
    buffer_load_dwordx4 v7, s[8:11], s24 offen offset:1024 lds
    v_mfma_f32_16x16x32_bf16 v[84:87], a[40:43], a[20:23], v[84:87]
    ds_read_b64_tr_b16 a[114:115], v19 offset:15872
    v_mfma_f32_16x16x32_bf16 v[80:83], a[36:39], a[20:23], v[80:83]
    v_mfma_f32_16x16x32_bf16 v[88:91], a[36:39], a[24:27], v[88:91]
    v_mfma_f32_16x16x32_bf16 v[92:95], a[40:43], a[24:27], v[92:95]
    ds_read_b64_tr_b16 a[116:117], v18 offset:16384
    v_mfma_f32_16x16x32_bf16 v[160:163], a[44:47], a[24:27], v[160:163]
    v_mfma_f32_16x16x32_bf16 v[164:167], a[48:51], a[24:27], v[164:167]
    ds_read_b64_tr_b16 a[118:119], v18 offset:16896
    buffer_load_dwordx4 v8, s[8:11], s24 offen offset:2048 lds
    v_mfma_f32_16x16x32_bf16 v[208:211], a[24:27], a[52:55], v[208:211]
    v_mfma_f32_16x16x32_bf16 v[244:247], a[24:27], a[56:59], v[244:247]
    ds_read_b64_tr_b16 a[120:121], v19 offset:16384
    v_mfma_f32_16x16x32_bf16 a[148:151], a[60:63], a[24:27], a[148:151]
    v_mfma_f32_16x16x32_bf16 a[152:155], a[60:63], a[28:31], a[152:155]
    v_mfma_f32_16x16x32_bf16 v[248:251], a[28:31], a[56:59], v[248:251]
    ds_read_b64_tr_b16 a[122:123], v19 offset:16896
    v_mfma_f32_16x16x32_bf16 v[212:215], a[28:31], a[52:55], v[212:215]
    v_mfma_f32_16x16x32_bf16 v[172:175], a[48:51], a[28:31], v[172:175]
    buffer_load_dwordx4 v9, s[8:11], s24 offen offset:3072 lds
    ds_read_b64_tr_b16 a[124:125], v28 offset:14336
    v_mfma_f32_16x16x32_bf16 v[168:171], a[44:47], a[28:31], v[168:171]
    v_mfma_f32_16x16x32_bf16 v[100:103], a[40:43], a[28:31], v[100:103]
    ds_read_b64_tr_b16 a[126:127], v28 offset:14592
    v_mfma_f32_16x16x32_bf16 v[96:99], a[36:39], a[28:31], v[96:99]
    v_mfma_f32_16x16x32_bf16 v[104:107], a[36:39], a[32:35], v[104:107]
    v_mfma_f32_16x16x32_bf16 v[108:111], a[40:43], a[32:35], v[108:111]
    v_mfma_f32_16x16x32_bf16 v[176:179], a[44:47], a[32:35], v[176:179]
    s_add_u32 m0, s45, s27
    v_mfma_f32_16x16x32_bf16 v[180:183], a[48:51], a[32:35], v[180:183]
    s_mov_b64 exec, s[32:33]
    buffer_load_dwordx4 v1, s[8:11], s24 offen lds
    s_mov_b64 exec, -1
    v_mfma_f32_16x16x32_bf16 v[216:219], a[32:35], a[52:55], v[216:219]
    s_add_u32 s27, s27, 34816
    v_mfma_f32_16x16x32_bf16 v[252:255], a[32:35], a[56:59], v[252:255]
    s_cmp_eq_u32 s27, 104448
    s_cselect_b32 s27, 0, s27
    v_mfma_f32_16x16x32_bf16 a[156:159], a[60:63], a[32:35], a[156:159]
    s_waitcnt lgkmcnt(0)
    v_mfma_f32_16x16x32_bf16 v[112:115], a[108:111], a[64:67], v[112:115]
    s_waitcnt vmcnt(17)
    s_barrier
    v_mfma_f32_16x16x32_bf16 v[116:119], a[112:115], a[64:67], v[116:119]
    s_add_u32 s28, s28, 34816
    v_mfma_f32_16x16x32_bf16 v[184:187], a[64:67], a[116:119], v[184:187]
    s_cmp_eq_u32 s28, 104448
    s_cselect_b32 s28, 0, s28
    v_mfma_f32_16x16x32_bf16 v[220:223], a[64:67], a[120:123], v[220:223]
    s_add_u32 s25, s25, 196608
    s_add_u32 s26, s26, 229376
    v_mfma_f32_16x16x32_bf16 a[128:131], a[124:127], a[68:71], a[128:131]
    s_add_u32 m0, s30, 14336
    s_nop 0
    buffer_load_dwordx4 v10, s[12:15], s25 offen lds
    v_mfma_f32_16x16x32_bf16 v[224:227], a[68:71], a[120:123], v[224:227]
    v_add_u32 v16, s28, v14
    v_mfma_f32_16x16x32_bf16 v[188:191], a[68:71], a[116:119], v[188:191]
    ds_read_b64_tr_b16 a[36:37], v18 offset:28672
    v_mfma_f32_16x16x32_bf16 v[124:127], a[112:115], a[68:71], v[124:127]
    v_mfma_f32_16x16x32_bf16 v[120:123], a[108:111], a[68:71], v[120:123]
    ds_read_b64_tr_b16 a[38:39], v18 offset:29184
    v_mfma_f32_16x16x32_bf16 v[52:55], a[104:107], a[68:71], v[52:55]
    v_mfma_f32_16x16x32_bf16 v[48:51], a[100:103], a[68:71], v[48:51]
    ds_read_b64_tr_b16 a[40:41], v19 offset:28672
    v_mfma_f32_16x16x32_bf16 v[56:59], a[100:103], a[72:75], v[56:59]
    buffer_load_dwordx4 v11, s[12:15], s25 offen offset:1024 lds
    v_mfma_f32_16x16x32_bf16 v[60:63], a[104:107], a[72:75], v[60:63]
    ds_read_b64_tr_b16 a[42:43], v19 offset:29184
    v_mfma_f32_16x16x32_bf16 v[128:131], a[108:111], a[72:75], v[128:131]
    v_mfma_f32_16x16x32_bf16 v[132:135], a[112:115], a[72:75], v[132:135]
    ds_read_b64_tr_b16 a[44:45], v18 offset:29696
    v_mfma_f32_16x16x32_bf16 v[192:195], a[72:75], a[116:119], v[192:195]
    v_mfma_f32_16x16x32_bf16 v[228:231], a[72:75], a[120:123], v[228:231]
    ds_read_b64_tr_b16 a[46:47], v18 offset:30208
    v_mfma_f32_16x16x32_bf16 a[132:135], a[124:127], a[72:75], a[132:135]
    v_mfma_f32_16x16x32_bf16 a[136:139], a[124:127], a[76:79], a[136:139]
    ds_read_b64_tr_b16 a[48:49], v19 offset:29696
    v_mfma_f32_16x16x32_bf16 v[232:235], a[76:79], a[120:123], v[232:235]
    buffer_load_dwordx4 v12, s[12:15], s25 offen offset:2048 lds
    v_mfma_f32_16x16x32_bf16 v[196:199], a[76:79], a[116:119], v[196:199]
    ds_read_b64_tr_b16 a[50:51], v19 offset:30208
    v_mfma_f32_16x16x32_bf16 v[140:143], a[112:115], a[76:79], v[140:143]
    v_mfma_f32_16x16x32_bf16 v[136:139], a[108:111], a[76:79], v[136:139]
    ds_read_b64_tr_b16 a[52:53], v18 offset:30720
    v_mfma_f32_16x16x32_bf16 v[68:71], a[104:107], a[76:79], v[68:71]
    v_mfma_f32_16x16x32_bf16 v[64:67], a[100:103], a[76:79], v[64:67]
    ds_read_b64_tr_b16 a[54:55], v18 offset:31232
    v_mfma_f32_16x16x32_bf16 v[72:75], a[100:103], a[80:83], v[72:75]
    v_mfma_f32_16x16x32_bf16 v[76:79], a[104:107], a[80:83], v[76:79]
    s_mov_b64 exec, s[32:33]
    buffer_load_dwordx4 v13, s[16:19], s26 offen offset:3072 lds
    s_mov_b64 exec, -1
    v_mfma_f32_16x16x32_bf16 v[144:147], a[108:111], a[80:83], v[144:147]
    ds_read_b64_tr_b16 a[56:57], v19 offset:30720
    v_mfma_f32_16x16x32_bf16 v[148:151], a[112:115], a[80:83], v[148:151]
    ds_read_b64_tr_b16 a[58:59], v19 offset:31232
    v_mfma_f32_16x16x32_bf16 v[200:203], a[80:83], a[116:119], v[200:203]
    v_mfma_f32_16x16x32_bf16 v[236:239], a[80:83], a[120:123], v[236:239]
    ds_read_b64_tr_b16 a[60:61], v28 offset:28672
    v_mfma_f32_16x16x32_bf16 a[140:143], a[124:127], a[80:83], a[140:143]
    s_and_b32 s31, s36, 15
    v_mfma_f32_16x16x32_bf16 a[144:147], a[124:127], a[84:87], a[144:147]
    s_lshr_b64 s[36:37], s[36:37], 4
    ds_read_b64_tr_b16 a[62:63], v28 offset:28928
    v_mfma_f32_16x16x32_bf16 v[240:243], a[84:87], a[120:123], v[240:243]
    s_lshl_b32 s24, s31, 7
    s_add_u32 m0, s29, s27
    v_mfma_f32_16x16x32_bf16 v[204:207], a[84:87], a[116:119], v[204:207]
    buffer_load_dwordx4 v2, s[8:11], s24 offen offset:0 lds
    v_add_u32 v17, s28, v15
    v_mfma_f32_16x16x32_bf16 v[156:159], a[112:115], a[84:87], v[156:159]
    v_mfma_f32_16x16x32_bf16 v[152:155], a[108:111], a[84:87], v[152:155]
    ds_read_b128 a[0:3], v16 offset:0
    v_mfma_f32_16x16x32_bf16 v[84:87], a[104:107], a[84:87], v[84:87]
    v_mfma_f32_16x16x32_bf16 v[80:83], a[100:103], a[84:87], v[80:83]
    ds_read_b128 a[4:7], v16 offset:2048
    v_mfma_f32_16x16x32_bf16 v[88:91], a[100:103], a[88:91], v[88:91]
    v_mfma_f32_16x16x32_bf16 v[92:95], a[104:107], a[88:91], v[92:95]
    ds_read_b128 a[8:11], v16 offset:4096
    buffer_load_dwordx4 v3, s[8:11], s24 offen offset:1024 lds
    v_mfma_f32_16x16x32_bf16 v[160:163], a[108:111], a[88:91], v[160:163]
    v_mfma_f32_16x16x32_bf16 v[164:167], a[112:115], a[88:91], v[164:167]
    ds_read_b128 a[12:15], v16 offset:6144
    v_mfma_f32_16x16x32_bf16 v[208:211], a[88:91], a[116:119], v[208:211]
    v_mfma_f32_16x16x32_bf16 v[244:247], a[88:91], a[120:123], v[244:247]
    ds_read_b128 a[16:19], v16 offset:8192
    v_mfma_f32_16x16x32_bf16 a[148:151], a[124:127], a[88:91], a[148:151]
    v_mfma_f32_16x16x32_bf16 a[152:155], a[124:127], a[92:95], a[152:155]
    ds_read_b128 a[20:23], v16 offset:10240
    v_mfma_f32_16x16x32_bf16 v[248:251], a[92:95], a[120:123], v[248:251]
    v_mfma_f32_16x16x32_bf16 v[212:215], a[92:95], a[116:119], v[212:215]
    ds_read_b128 a[24:27], v16 offset:12288
    buffer_load_dwordx4 v4, s[8:11], s24 offen offset:2048 lds
    v_mfma_f32_16x16x32_bf16 v[172:175], a[112:115], a[92:95], v[172:175]
    v_mfma_f32_16x16x32_bf16 v[168:171], a[108:111], a[92:95], v[168:171]
    ds_read_b128 a[28:31], v16 offset:14336
    v_mfma_f32_16x16x32_bf16 v[100:103], a[104:107], a[92:95], v[100:103]
    v_mfma_f32_16x16x32_bf16 v[96:99], a[100:103], a[92:95], v[96:99]
    ds_read_b128 a[32:35], v16 offset:16384
    v_mfma_f32_16x16x32_bf16 v[104:107], a[100:103], a[96:99], v[104:107]
    v_mfma_f32_16x16x32_bf16 v[108:111], a[104:107], a[96:99], v[108:111]
    v_mfma_f32_16x16x32_bf16 v[176:179], a[108:111], a[96:99], v[176:179]
    buffer_load_dwordx4 v5, s[8:11], s24 offen offset:3072 lds
    v_mfma_f32_16x16x32_bf16 v[180:183], a[112:115], a[96:99], v[180:183]
    v_mfma_f32_16x16x32_bf16 v[216:219], a[96:99], a[116:119], v[216:219]
    v_mfma_f32_16x16x32_bf16 v[252:255], a[96:99], a[120:123], v[252:255]
    v_mfma_f32_16x16x32_bf16 a[156:159], a[124:127], a[96:99], a[156:159]
    s_waitcnt lgkmcnt(0)
    v_mfma_f32_16x16x32_bf16 v[112:115], a[44:47], a[0:3], v[112:115]
    s_waitcnt vmcnt(17)
    s_barrier
    v_mfma_f32_16x16x32_bf16 v[116:119], a[48:51], a[0:3], v[116:119]
    ds_read_b128 a[64:67], v17 offset:0
    s_mul_i32 s25, s31, 393216
    v_mfma_f32_16x16x32_bf16 v[184:187], a[0:3], a[52:55], v[184:187]
    s_mul_i32 s26, s31, 458752
    s_add_u32 m0, s30, 28672
    v_mfma_f32_16x16x32_bf16 v[220:223], a[0:3], a[56:59], v[220:223]
    ds_read_b128 a[68:71], v17 offset:2048
    buffer_load_dwordx4 v10, s[12:15], s25 offen lds
    v_mfma_f32_16x16x32_bf16 a[128:131], a[60:63], a[4:7], a[128:131]
    v_mfma_f32_16x16x32_bf16 v[224:227], a[4:7], a[56:59], v[224:227]
    ds_read_b128 a[72:75], v17 offset:4096
    v_mfma_f32_16x16x32_bf16 v[188:191], a[4:7], a[52:55], v[188:191]
    v_mfma_f32_16x16x32_bf16 v[124:127], a[48:51], a[4:7], v[124:127]
    ds_read_b128 a[76:79], v17 offset:6144
    v_mfma_f32_16x16x32_bf16 v[120:123], a[44:47], a[4:7], v[120:123]
    buffer_load_dwordx4 v11, s[12:15], s25 offen offset:1024 lds
    v_mfma_f32_16x16x32_bf16 v[52:55], a[40:43], a[4:7], v[52:55]
    v_mfma_f32_16x16x32_bf16 v[48:51], a[36:39], a[4:7], v[48:51]
    ds_read_b128 a[80:83], v17 offset:8192
    v_mfma_f32_16x16x32_bf16 v[56:59], a[36:39], a[8:11], v[56:59]
    v_mfma_f32_16x16x32_bf16 v[60:63], a[40:43], a[8:11], v[60:63]
    ds_read_b128 a[84:87], v17 offset:10240
    buffer_load_dwordx4 v12, s[12:15], s25 offen offset:2048 lds
    v_mfma_f32_16x16x32_bf16 v[128:131], a[44:47], a[8:11], v[128:131]
    v_mfma_f32_16x16x32_bf16 v[132:135], a[48:51], a[8:11], v[132:135]
    ds_read_b128 a[88:91], v17 offset:12288
    v_mfma_f32_16x16x32_bf16 v[192:195], a[8:11], a[52:55], v[192:195]
    v_mfma_f32_16x16x32_bf16 v[228:231], a[8:11], a[56:59], v[228:231]
    v_mfma_f32_16x16x32_bf16 a[132:135], a[60:63], a[8:11], a[132:135]
    ds_read_b128 a[92:95], v17 offset:14336
    v_mfma_f32_16x16x32_bf16 a[136:139], a[60:63], a[12:15], a[136:139]
    s_mov_b64 exec, s[32:33]
    buffer_load_dwordx4 v13, s[16:19], s26 offen offset:3072 lds
    s_mov_b64 exec, -1
    v_mfma_f32_16x16x32_bf16 v[232:235], a[12:15], a[56:59], v[232:235]
    ds_read_b128 a[96:99], v17 offset:16384
    v_mfma_f32_16x16x32_bf16 v[196:199], a[12:15], a[52:55], v[196:199]
    v_mfma_f32_16x16x32_bf16 v[140:143], a[48:51], a[12:15], v[140:143]
    s_add_u32 m0, s29, s27
    s_add_u32 m0, m0, 4096
    v_mfma_f32_16x16x32_bf16 v[136:139], a[44:47], a[12:15], v[136:139]
    ds_read_b64_tr_b16 a[100:101], v18 offset:43008
    buffer_load_dwordx4 v6, s[8:11], s24 offen offset:0 lds
    v_mfma_f32_16x16x32_bf16 v[68:71], a[40:43], a[12:15], v[68:71]
    v_mfma_f32_16x16x32_bf16 v[64:67], a[36:39], a[12:15], v[64:67]
    ds_read_b64_tr_b16 a[102:103], v18 offset:43520
    v_mfma_f32_16x16x32_bf16 v[72:75], a[36:39], a[16:19], v[72:75]
    v_mfma_f32_16x16x32_bf16 v[76:79], a[40:43], a[16:19], v[76:79]
    ds_read_b64_tr_b16 a[104:105], v19 offset:43008
    buffer_load_dwordx4 v7, s[8:11], s24 offen offset:1024 lds
    v_mfma_f32_16x16x32_bf16 v[144:147], a[44:47], a[16:19], v[144:147]
    v_mfma_f32_16x16x32_bf16 v[148:151], a[48:51], a[16:19], v[148:151]
    ds_read_b64_tr_b16 a[106:107], v19 offset:43520
    v_mfma_f32_16x16x32_bf16 v[200:203], a[16:19], a[52:55], v[200:203]
    v_mfma_f32_16x16x32_bf16 v[236:239], a[16:19], a[56:59], v[236:239]
    ds_read_b64_tr_b16 a[108:109], v18 offset:44032
    v_mfma_f32_16x16x32_bf16 a[140:143], a[60:63], a[16:19], a[140:143]
    buffer_load_dwordx4 v8, s[8:11], s24 offen offset:2048 lds
    v_mfma_f32_16x16x32_bf16 a[144:147], a[60:63], a[20:23], a[144:147]
    v_mfma_f32_16x16x32_bf16 v[240:243], a[20:23], a[56:59], v[240:243]
    ds_read_b64_tr_b16 a[110:111], v18 offset:44544
    v_mfma_f32_16x16x32_bf16 v[204:207], a[20:23], a[52:55], v[204:207]
    v_mfma_f32_16x16x32_bf16 v[156:159], a[48:51], a[20:23], v[156:159]
    ds_read_b64_tr_b16 a[112:113], v19 offset:44032
    v_mfma_f32_16x16x32_bf16 v[152:155], a[44:47], a[20:23], v[152:155]
    buffer_load_dwordx4 v9, s[8:11], s24 offen offset:3072 lds
    v_mfma_f32_16x16x32_bf16 v[84:87], a[40:43], a[20:23], v[84:87]
    ds_read_b64_tr_b16 a[114:115], v19 offset:44544
    v_mfma_f32_16x16x32_bf16 v[80:83], a[36:39], a[20:23], v[80:83]
    v_mfma_f32_16x16x32_bf16 v[88:91], a[36:39], a[24:27], v[88:91]
    v_mfma_f32_16x16x32_bf16 v[92:95], a[40:43], a[24:27], v[92:95]
    s_add_u32 m0, s45, s27
    ds_read_b64_tr_b16 a[116:117], v18 offset:45056
    v_mfma_f32_16x16x32_bf16 v[160:163], a[44:47], a[24:27], v[160:163]
    s_mov_b64 exec, s[32:33]
    buffer_load_dwordx4 v1, s[8:11], s24 offen lds
    s_mov_b64 exec, -1
    v_mfma_f32_16x16x32_bf16 v[164:167], a[48:51], a[24:27], v[164:167]
    s_add_u32 s27, s27, 34816
    ds_read_b64_tr_b16 a[118:119], v18 offset:45568
    v_mfma_f32_16x16x32_bf16 v[208:211], a[24:27], a[52:55], v[208:211]
    s_cmp_eq_u32 s27, 104448
    s_cselect_b32 s27, 0, s27
    v_mfma_f32_16x16x32_bf16 v[244:247], a[24:27], a[56:59], v[244:247]
    ds_read_b64_tr_b16 a[120:121], v19 offset:45056
    v_mfma_f32_16x16x32_bf16 a[148:151], a[60:63], a[24:27], a[148:151]
    v_mfma_f32_16x16x32_bf16 a[152:155], a[60:63], a[28:31], a[152:155]
    v_mfma_f32_16x16x32_bf16 v[248:251], a[28:31], a[56:59], v[248:251]
    ds_read_b64_tr_b16 a[122:123], v19 offset:45568
    v_mfma_f32_16x16x32_bf16 v[212:215], a[28:31], a[52:55], v[212:215]
    s_mov_b32 s4, s74
    v_mfma_f32_16x16x32_bf16 v[172:175], a[48:51], a[28:31], v[172:175]
    s_mov_b32 s5, s75
    ds_read_b64_tr_b16 a[124:125], v28 offset:43008
    v_mfma_f32_16x16x32_bf16 v[168:171], a[44:47], a[28:31], v[168:171]
    s_mov_b32 s6, 0x800000
    s_mov_b32 s7, 0x20000
    v_mfma_f32_16x16x32_bf16 v[100:103], a[40:43], a[28:31], v[100:103]
    s_lshl_b32 s46, s2, 2
    s_add_u32 s46, s46, s3
    v_mfma_f32_16x16x32_bf16 v[96:99], a[36:39], a[28:31], v[96:99]
    s_mul_i32 s46, s46, 8192
    ds_read_b64_tr_b16 a[126:127], v28 offset:43264
    v_mfma_f32_16x16x32_bf16 v[104:107], a[36:39], a[32:35], v[104:107]
    v_lshlrev_b32 v46, 7, v0
    v_mfma_f32_16x16x32_bf16 v[108:111], a[40:43], a[32:35], v[108:111]
    s_mov_b32 exec_hi, 0x0
    buffer_load_dword v47, v46, s[4:7], s46 offen
    s_mov_b64 exec, -1
    v_mfma_f32_16x16x32_bf16 v[176:179], a[44:47], a[32:35], v[176:179]
    v_mfma_f32_16x16x32_bf16 v[180:183], a[48:51], a[32:35], v[180:183]
    v_mfma_f32_16x16x32_bf16 v[216:219], a[32:35], a[52:55], v[216:219]
    v_mfma_f32_16x16x32_bf16 v[252:255], a[32:35], a[56:59], v[252:255]
    v_mfma_f32_16x16x32_bf16 a[156:159], a[60:63], a[32:35], a[156:159]
    s_waitcnt lgkmcnt(0)
    v_mfma_f32_16x16x32_bf16 v[112:115], a[108:111], a[64:67], v[112:115]
    s_waitcnt vmcnt(18)
    s_barrier
    v_mfma_f32_16x16x32_bf16 v[116:119], a[112:115], a[64:67], v[116:119]
    s_add_u32 s28, s28, 34816
    v_mfma_f32_16x16x32_bf16 v[184:187], a[64:67], a[116:119], v[184:187]
    s_cmp_eq_u32 s28, 104448
    s_cselect_b32 s28, 0, s28
    v_mfma_f32_16x16x32_bf16 v[220:223], a[64:67], a[120:123], v[220:223]
    v_mfma_f32_16x16x32_bf16 a[128:131], a[124:127], a[68:71], a[128:131]
    v_add_u32 v16, s28, v14
    v_mfma_f32_16x16x32_bf16 v[224:227], a[68:71], a[120:123], v[224:227]
    v_mfma_f32_16x16x32_bf16 v[188:191], a[68:71], a[116:119], v[188:191]
    s_add_u32 s25, s25, 196608
    ds_read_b64_tr_b16 a[36:37], v18 offset:0
    v_mfma_f32_16x16x32_bf16 v[124:127], a[112:115], a[68:71], v[124:127]
    s_add_u32 s26, s26, 229376
    s_add_u32 m0, s30, 43008
    v_mfma_f32_16x16x32_bf16 v[120:123], a[108:111], a[68:71], v[120:123]
    buffer_load_dwordx4 v10, s[12:15], s25 offen lds
    ds_read_b64_tr_b16 a[38:39], v18 offset:512
    v_mfma_f32_16x16x32_bf16 v[52:55], a[104:107], a[68:71], v[52:55]
    v_mfma_f32_16x16x32_bf16 v[48:51], a[100:103], a[68:71], v[48:51]
    ds_read_b64_tr_b16 a[40:41], v19 offset:0
    v_mfma_f32_16x16x32_bf16 v[56:59], a[100:103], a[72:75], v[56:59]
    v_mfma_f32_16x16x32_bf16 v[60:63], a[104:107], a[72:75], v[60:63]
    ds_read_b64_tr_b16 a[42:43], v19 offset:512
    v_mfma_f32_16x16x32_bf16 v[128:131], a[108:111], a[72:75], v[128:131]
    v_mfma_f32_16x16x32_bf16 v[132:135], a[112:115], a[72:75], v[132:135]
    ds_read_b64_tr_b16 a[44:45], v18 offset:1024
    v_mfma_f32_16x16x32_bf16 v[192:195], a[72:75], a[116:119], v[192:195]
    v_mfma_f32_16x16x32_bf16 v[228:231], a[72:75], a[120:123], v[228:231]
    ds_read_b64_tr_b16 a[46:47], v18 offset:1536
    v_mfma_f32_16x16x32_bf16 a[132:135], a[124:127], a[72:75], a[132:135]
    v_mfma_f32_16x16x32_bf16 a[136:139], a[124:127], a[76:79], a[136:139]
    ds_read_b64_tr_b16 a[48:49], v19 offset:1024
    v_mfma_f32_16x16x32_bf16 v[232:235], a[76:79], a[120:123], v[232:235]
    v_mfma_f32_16x16x32_bf16 v[196:199], a[76:79], a[116:119], v[196:199]
    ds_read_b64_tr_b16 a[50:51], v19 offset:1536
    v_mfma_f32_16x16x32_bf16 v[140:143], a[112:115], a[76:79], v[140:143]
    v_mfma_f32_16x16x32_bf16 v[136:139], a[108:111], a[76:79], v[136:139]
    ds_read_b64_tr_b16 a[52:53], v18 offset:2048
    buffer_load_dwordx4 v11, s[12:15], s25 offen offset:1024 lds
    v_mfma_f32_16x16x32_bf16 v[68:71], a[104:107], a[76:79], v[68:71]
    v_mfma_f32_16x16x32_bf16 v[64:67], a[100:103], a[76:79], v[64:67]
    ds_read_b64_tr_b16 a[54:55], v18 offset:2560
    v_mfma_f32_16x16x32_bf16 v[72:75], a[100:103], a[80:83], v[72:75]
    v_mfma_f32_16x16x32_bf16 v[76:79], a[104:107], a[80:83], v[76:79]
    ds_read_b64_tr_b16 a[56:57], v19 offset:2048
    v_mfma_f32_16x16x32_bf16 v[144:147], a[108:111], a[80:83], v[144:147]
    v_mfma_f32_16x16x32_bf16 v[148:151], a[112:115], a[80:83], v[148:151]
    ds_read_b64_tr_b16 a[58:59], v19 offset:2560
    v_mfma_f32_16x16x32_bf16 v[200:203], a[80:83], a[116:119], v[200:203]
    v_mfma_f32_16x16x32_bf16 v[236:239], a[80:83], a[120:123], v[236:239]
    ds_read_b64_tr_b16 a[60:61], v28 offset:0
    v_mfma_f32_16x16x32_bf16 a[140:143], a[124:127], a[80:83], a[140:143]
    v_mfma_f32_16x16x32_bf16 a[144:147], a[124:127], a[84:87], a[144:147]
    ds_read_b64_tr_b16 a[62:63], v28 offset:256
    v_mfma_f32_16x16x32_bf16 v[240:243], a[84:87], a[120:123], v[240:243]
    v_mfma_f32_16x16x32_bf16 v[204:207], a[84:87], a[116:119], v[204:207]
    v_add_u32 v17, s28, v15
    v_mfma_f32_16x16x32_bf16 v[156:159], a[112:115], a[84:87], v[156:159]
    v_mfma_f32_16x16x32_bf16 v[152:155], a[108:111], a[84:87], v[152:155]
    ds_read_b128 a[0:3], v16 offset:0
    v_mfma_f32_16x16x32_bf16 v[84:87], a[104:107], a[84:87], v[84:87]
    buffer_load_dwordx4 v12, s[12:15], s25 offen offset:2048 lds
    v_mfma_f32_16x16x32_bf16 v[80:83], a[100:103], a[84:87], v[80:83]
    ds_read_b128 a[4:7], v16 offset:2048
    v_mfma_f32_16x16x32_bf16 v[88:91], a[100:103], a[88:91], v[88:91]
    v_mfma_f32_16x16x32_bf16 v[92:95], a[104:107], a[88:91], v[92:95]
    ds_read_b128 a[8:11], v16 offset:4096
    v_mfma_f32_16x16x32_bf16 v[160:163], a[108:111], a[88:91], v[160:163]
    v_mfma_f32_16x16x32_bf16 v[164:167], a[112:115], a[88:91], v[164:167]
    ds_read_b128 a[12:15], v16 offset:6144
    v_mfma_f32_16x16x32_bf16 v[208:211], a[88:91], a[116:119], v[208:211]
    v_mfma_f32_16x16x32_bf16 v[244:247], a[88:91], a[120:123], v[244:247]
    ds_read_b128 a[16:19], v16 offset:8192
    v_mfma_f32_16x16x32_bf16 a[148:151], a[124:127], a[88:91], a[148:151]
    v_mfma_f32_16x16x32_bf16 a[152:155], a[124:127], a[92:95], a[152:155]
    ds_read_b128 a[20:23], v16 offset:10240
    v_mfma_f32_16x16x32_bf16 v[248:251], a[92:95], a[120:123], v[248:251]
    v_mfma_f32_16x16x32_bf16 v[212:215], a[92:95], a[116:119], v[212:215]
    ds_read_b128 a[24:27], v16 offset:12288
    v_mfma_f32_16x16x32_bf16 v[172:175], a[112:115], a[92:95], v[172:175]
    v_mfma_f32_16x16x32_bf16 v[168:171], a[108:111], a[92:95], v[168:171]
    ds_read_b128 a[28:31], v16 offset:14336
    v_mfma_f32_16x16x32_bf16 v[100:103], a[104:107], a[92:95], v[100:103]
    s_mov_b64 exec, s[32:33]
    buffer_load_dwordx4 v13, s[16:19], s26 offen offset:3072 lds
    s_mov_b64 exec, -1
    v_mfma_f32_16x16x32_bf16 v[96:99], a[100:103], a[92:95], v[96:99]
    ds_read_b128 a[32:35], v16 offset:16384
    v_mfma_f32_16x16x32_bf16 v[104:107], a[100:103], a[96:99], v[104:107]
    v_mfma_f32_16x16x32_bf16 v[108:111], a[104:107], a[96:99], v[108:111]
    v_mfma_f32_16x16x32_bf16 v[176:179], a[108:111], a[96:99], v[176:179]
    v_mfma_f32_16x16x32_bf16 v[180:183], a[112:115], a[96:99], v[180:183]
    v_mfma_f32_16x16x32_bf16 v[216:219], a[96:99], a[116:119], v[216:219]
    v_mfma_f32_16x16x32_bf16 v[252:255], a[96:99], a[120:123], v[252:255]
    v_mfma_f32_16x16x32_bf16 a[156:159], a[124:127], a[96:99], a[156:159]
    s_waitcnt lgkmcnt(0)
    v_mfma_f32_16x16x32_bf16 v[112:115], a[44:47], a[0:3], v[112:115]
    s_waitcnt vmcnt(14)
    s_barrier
    v_mfma_f32_16x16x32_bf16 v[116:119], a[48:51], a[0:3], v[116:119]
    ds_read_b128 a[64:67], v17 offset:0
    v_mfma_f32_16x16x32_bf16 v[184:187], a[0:3], a[52:55], v[184:187]
    v_mfma_f32_16x16x32_bf16 v[220:223], a[0:3], a[56:59], v[220:223]
    ds_read_b128 a[68:71], v17 offset:2048
    v_mfma_f32_16x16x32_bf16 a[128:131], a[60:63], a[4:7], a[128:131]
    v_mfma_f32_16x16x32_bf16 v[224:227], a[4:7], a[56:59], v[224:227]
    ds_read_b128 a[72:75], v17 offset:4096
    v_mfma_f32_16x16x32_bf16 v[188:191], a[4:7], a[52:55], v[188:191]
    v_mfma_f32_16x16x32_bf16 v[124:127], a[48:51], a[4:7], v[124:127]
    ds_read_b128 a[76:79], v17 offset:6144
    v_mfma_f32_16x16x32_bf16 v[120:123], a[44:47], a[4:7], v[120:123]
    v_mfma_f32_16x16x32_bf16 v[52:55], a[40:43], a[4:7], v[52:55]
    v_mfma_f32_16x16x32_bf16 v[48:51], a[36:39], a[4:7], v[48:51]
    ds_read_b128 a[80:83], v17 offset:8192
    v_mfma_f32_16x16x32_bf16 v[56:59], a[36:39], a[8:11], v[56:59]
    v_mfma_f32_16x16x32_bf16 v[60:63], a[40:43], a[8:11], v[60:63]
    ds_read_b128 a[84:87], v17 offset:10240
    v_mfma_f32_16x16x32_bf16 v[128:131], a[44:47], a[8:11], v[128:131]
    v_mfma_f32_16x16x32_bf16 v[132:135], a[48:51], a[8:11], v[132:135]
    ds_read_b128 a[88:91], v17 offset:12288
    v_mfma_f32_16x16x32_bf16 v[192:195], a[8:11], a[52:55], v[192:195]
    v_mfma_f32_16x16x32_bf16 v[228:231], a[8:11], a[56:59], v[228:231]
    v_mfma_f32_16x16x32_bf16 a[132:135], a[60:63], a[8:11], a[132:135]
    ds_read_b128 a[92:95], v17 offset:14336
    v_mfma_f32_16x16x32_bf16 a[136:139], a[60:63], a[12:15], a[136:139]
    v_mfma_f32_16x16x32_bf16 v[232:235], a[12:15], a[56:59], v[232:235]
    ds_read_b128 a[96:99], v17 offset:16384
    v_mfma_f32_16x16x32_bf16 v[196:199], a[12:15], a[52:55], v[196:199]
    v_mfma_f32_16x16x32_bf16 v[140:143], a[48:51], a[12:15], v[140:143]
    ds_read_b64_tr_b16 a[100:101], v18 offset:14336
    v_mfma_f32_16x16x32_bf16 v[136:139], a[44:47], a[12:15], v[136:139]
    v_mfma_f32_16x16x32_bf16 v[68:71], a[40:43], a[12:15], v[68:71]
    v_mfma_f32_16x16x32_bf16 v[64:67], a[36:39], a[12:15], v[64:67]
    ds_read_b64_tr_b16 a[102:103], v18 offset:14848
    v_mfma_f32_16x16x32_bf16 v[72:75], a[36:39], a[16:19], v[72:75]
    s_mov_b32 s4, s74
    v_mfma_f32_16x16x32_bf16 v[76:79], a[40:43], a[16:19], v[76:79]
    s_mov_b32 s5, s75
    ds_read_b64_tr_b16 a[104:105], v19 offset:14336
    v_mfma_f32_16x16x32_bf16 v[144:147], a[44:47], a[16:19], v[144:147]
    s_mov_b32 s6, 0x800000
    s_mov_b32 s7, 0x20000
    v_mfma_f32_16x16x32_bf16 v[148:151], a[48:51], a[16:19], v[148:151]
    s_lshl_b32 s46, s2, 2
    s_add_u32 s46, s46, s3
    v_mfma_f32_16x16x32_bf16 v[200:203], a[16:19], a[52:55], v[200:203]
    s_mul_i32 s46, s46, 8192
    ds_read_b64_tr_b16 a[106:107], v19 offset:14848
    v_mfma_f32_16x16x32_bf16 v[236:239], a[16:19], a[56:59], v[236:239]
    s_add_u32 s46, s46, 4096
    v_lshlrev_b32 v46, 7, v0
    v_mfma_f32_16x16x32_bf16 a[140:143], a[60:63], a[16:19], a[140:143]
    s_mov_b32 exec_hi, 0x0
    buffer_load_dword v47, v46, s[4:7], s46 offen
    s_mov_b64 exec, -1
    v_mfma_f32_16x16x32_bf16 a[144:147], a[60:63], a[20:23], a[144:147]
    ds_read_b64_tr_b16 a[108:109], v18 offset:15360
    v_mfma_f32_16x16x32_bf16 v[240:243], a[20:23], a[56:59], v[240:243]
    ds_read_b64_tr_b16 a[110:111], v18 offset:15872
    v_mfma_f32_16x16x32_bf16 v[204:207], a[20:23], a[52:55], v[204:207]
    v_mfma_f32_16x16x32_bf16 v[156:159], a[48:51], a[20:23], v[156:159]
    ds_read_b64_tr_b16 a[112:113], v19 offset:15360
    v_mfma_f32_16x16x32_bf16 v[152:155], a[44:47], a[20:23], v[152:155]
    v_mfma_f32_16x16x32_bf16 v[84:87], a[40:43], a[20:23], v[84:87]
    ds_read_b64_tr_b16 a[114:115], v19 offset:15872
    v_mfma_f32_16x16x32_bf16 v[80:83], a[36:39], a[20:23], v[80:83]
    v_mfma_f32_16x16x32_bf16 v[88:91], a[36:39], a[24:27], v[88:91]
    v_mfma_f32_16x16x32_bf16 v[92:95], a[40:43], a[24:27], v[92:95]
    ds_read_b64_tr_b16 a[116:117], v18 offset:16384
    v_mfma_f32_16x16x32_bf16 v[160:163], a[44:47], a[24:27], v[160:163]
    v_mfma_f32_16x16x32_bf16 v[164:167], a[48:51], a[24:27], v[164:167]
    ds_read_b64_tr_b16 a[118:119], v18 offset:16896
    v_mfma_f32_16x16x32_bf16 v[208:211], a[24:27], a[52:55], v[208:211]
    v_mfma_f32_16x16x32_bf16 v[244:247], a[24:27], a[56:59], v[244:247]
    ds_read_b64_tr_b16 a[120:121], v19 offset:16384
    v_mfma_f32_16x16x32_bf16 a[148:151], a[60:63], a[24:27], a[148:151]
    v_mfma_f32_16x16x32_bf16 a[152:155], a[60:63], a[28:31], a[152:155]
    v_mfma_f32_16x16x32_bf16 v[248:251], a[28:31], a[56:59], v[248:251]
    ds_read_b64_tr_b16 a[122:123], v19 offset:16896
    v_mfma_f32_16x16x32_bf16 v[212:215], a[28:31], a[52:55], v[212:215]
    v_mfma_f32_16x16x32_bf16 v[172:175], a[48:51], a[28:31], v[172:175]
    ds_read_b64_tr_b16 a[124:125], v28 offset:14336
    v_mfma_f32_16x16x32_bf16 v[168:171], a[44:47], a[28:31], v[168:171]
    v_mfma_f32_16x16x32_bf16 v[100:103], a[40:43], a[28:31], v[100:103]
    ds_read_b64_tr_b16 a[126:127], v28 offset:14592
    v_mfma_f32_16x16x32_bf16 v[96:99], a[36:39], a[28:31], v[96:99]
    v_mfma_f32_16x16x32_bf16 v[104:107], a[36:39], a[32:35], v[104:107]
    v_mfma_f32_16x16x32_bf16 v[108:111], a[40:43], a[32:35], v[108:111]
    v_mfma_f32_16x16x32_bf16 v[176:179], a[44:47], a[32:35], v[176:179]
    v_mfma_f32_16x16x32_bf16 v[180:183], a[48:51], a[32:35], v[180:183]
    v_mfma_f32_16x16x32_bf16 v[216:219], a[32:35], a[52:55], v[216:219]
    v_mfma_f32_16x16x32_bf16 v[252:255], a[32:35], a[56:59], v[252:255]
    v_mfma_f32_16x16x32_bf16 a[156:159], a[60:63], a[32:35], a[156:159]
    s_waitcnt lgkmcnt(0)
    v_mfma_f32_16x16x32_bf16 v[112:115], a[108:111], a[64:67], v[112:115]
    s_waitcnt vmcnt(6)
    s_barrier
    v_mfma_f32_16x16x32_bf16 v[116:119], a[112:115], a[64:67], v[116:119]
    s_add_u32 s28, s28, 34816
    v_mfma_f32_16x16x32_bf16 v[184:187], a[64:67], a[116:119], v[184:187]
    s_cmp_eq_u32 s28, 104448
    s_cselect_b32 s28, 0, s28
    v_mfma_f32_16x16x32_bf16 v[220:223], a[64:67], a[120:123], v[220:223]
    v_mfma_f32_16x16x32_bf16 a[128:131], a[124:127], a[68:71], a[128:131]
    v_add_u32 v16, s28, v14
    v_mfma_f32_16x16x32_bf16 v[224:227], a[68:71], a[120:123], v[224:227]
    v_mfma_f32_16x16x32_bf16 v[188:191], a[68:71], a[116:119], v[188:191]
    ds_read_b64_tr_b16 a[36:37], v18 offset:28672
    v_mfma_f32_16x16x32_bf16 v[124:127], a[112:115], a[68:71], v[124:127]
    v_mfma_f32_16x16x32_bf16 v[120:123], a[108:111], a[68:71], v[120:123]
    ds_read_b64_tr_b16 a[38:39], v18 offset:29184
    v_mfma_f32_16x16x32_bf16 v[52:55], a[104:107], a[68:71], v[52:55]
    v_mfma_f32_16x16x32_bf16 v[48:51], a[100:103], a[68:71], v[48:51]
    ds_read_b64_tr_b16 a[40:41], v19 offset:28672
    v_mfma_f32_16x16x32_bf16 v[56:59], a[100:103], a[72:75], v[56:59]
    v_mfma_f32_16x16x32_bf16 v[60:63], a[104:107], a[72:75], v[60:63]
    ds_read_b64_tr_b16 a[42:43], v19 offset:29184
    v_mfma_f32_16x16x32_bf16 v[128:131], a[108:111], a[72:75], v[128:131]
    v_mfma_f32_16x16x32_bf16 v[132:135], a[112:115], a[72:75], v[132:135]
    ds_read_b64_tr_b16 a[44:45], v18 offset:29696
    v_mfma_f32_16x16x32_bf16 v[192:195], a[72:75], a[116:119], v[192:195]
    v_mfma_f32_16x16x32_bf16 v[228:231], a[72:75], a[120:123], v[228:231]
    ds_read_b64_tr_b16 a[46:47], v18 offset:30208
    v_mfma_f32_16x16x32_bf16 a[132:135], a[124:127], a[72:75], a[132:135]
    v_mfma_f32_16x16x32_bf16 a[136:139], a[124:127], a[76:79], a[136:139]
    ds_read_b64_tr_b16 a[48:49], v19 offset:29696
    v_mfma_f32_16x16x32_bf16 v[232:235], a[76:79], a[120:123], v[232:235]
    v_mfma_f32_16x16x32_bf16 v[196:199], a[76:79], a[116:119], v[196:199]
    ds_read_b64_tr_b16 a[50:51], v19 offset:30208
    v_mfma_f32_16x16x32_bf16 v[140:143], a[112:115], a[76:79], v[140:143]
    v_mfma_f32_16x16x32_bf16 v[136:139], a[108:111], a[76:79], v[136:139]
    ds_read_b64_tr_b16 a[52:53], v18 offset:30720
    v_mfma_f32_16x16x32_bf16 v[68:71], a[104:107], a[76:79], v[68:71]
    v_mfma_f32_16x16x32_bf16 v[64:67], a[100:103], a[76:79], v[64:67]
    ds_read_b64_tr_b16 a[54:55], v18 offset:31232
    v_mfma_f32_16x16x32_bf16 v[72:75], a[100:103], a[80:83], v[72:75]
    v_mfma_f32_16x16x32_bf16 v[76:79], a[104:107], a[80:83], v[76:79]
    ds_read_b64_tr_b16 a[56:57], v19 offset:30720
    v_mfma_f32_16x16x32_bf16 v[144:147], a[108:111], a[80:83], v[144:147]
    s_mov_b32 s4, s84
    v_mfma_f32_16x16x32_bf16 v[148:151], a[112:115], a[80:83], v[148:151]
    s_mov_b32 s5, s85
    ds_read_b64_tr_b16 a[58:59], v19 offset:31232
    v_mfma_f32_16x16x32_bf16 v[200:203], a[80:83], a[116:119], v[200:203]
    s_mov_b32 s6, 0x100
    s_mov_b32 s7, 0x20000
    v_mfma_f32_16x16x32_bf16 v[236:239], a[80:83], a[120:123], v[236:239]
    v_mov_b32 v43, 0
    buffer_load_dword v44, v43, s[4:7], 0 offen sc1
    v_mfma_f32_16x16x32_bf16 a[140:143], a[124:127], a[80:83], a[140:143]
    ds_read_b64_tr_b16 a[60:61], v28 offset:28672
    v_mfma_f32_16x16x32_bf16 a[144:147], a[124:127], a[84:87], a[144:147]
    ds_read_b64_tr_b16 a[62:63], v28 offset:28928
    v_mfma_f32_16x16x32_bf16 v[240:243], a[84:87], a[120:123], v[240:243]
    v_mfma_f32_16x16x32_bf16 v[204:207], a[84:87], a[116:119], v[204:207]
    v_add_u32 v17, s28, v15
    v_mfma_f32_16x16x32_bf16 v[156:159], a[112:115], a[84:87], v[156:159]
    v_mfma_f32_16x16x32_bf16 v[152:155], a[108:111], a[84:87], v[152:155]
    ds_read_b128 a[0:3], v16 offset:0
    v_mfma_f32_16x16x32_bf16 v[84:87], a[104:107], a[84:87], v[84:87]
    v_mfma_f32_16x16x32_bf16 v[80:83], a[100:103], a[84:87], v[80:83]
    ds_read_b128 a[4:7], v16 offset:2048
    v_mfma_f32_16x16x32_bf16 v[88:91], a[100:103], a[88:91], v[88:91]
    v_mfma_f32_16x16x32_bf16 v[92:95], a[104:107], a[88:91], v[92:95]
    ds_read_b128 a[8:11], v16 offset:4096
    v_mfma_f32_16x16x32_bf16 v[160:163], a[108:111], a[88:91], v[160:163]
    v_mfma_f32_16x16x32_bf16 v[164:167], a[112:115], a[88:91], v[164:167]
    ds_read_b128 a[12:15], v16 offset:6144
    v_mfma_f32_16x16x32_bf16 v[208:211], a[88:91], a[116:119], v[208:211]
    v_mfma_f32_16x16x32_bf16 v[244:247], a[88:91], a[120:123], v[244:247]
    ds_read_b128 a[16:19], v16 offset:8192
    v_mfma_f32_16x16x32_bf16 a[148:151], a[124:127], a[88:91], a[148:151]
    v_mfma_f32_16x16x32_bf16 a[152:155], a[124:127], a[92:95], a[152:155]
    ds_read_b128 a[20:23], v16 offset:10240
    v_mfma_f32_16x16x32_bf16 v[248:251], a[92:95], a[120:123], v[248:251]
    v_mfma_f32_16x16x32_bf16 v[212:215], a[92:95], a[116:119], v[212:215]
    ds_read_b128 a[24:27], v16 offset:12288
    v_mfma_f32_16x16x32_bf16 v[172:175], a[112:115], a[92:95], v[172:175]
    v_mfma_f32_16x16x32_bf16 v[168:171], a[108:111], a[92:95], v[168:171]
    ds_read_b128 a[28:31], v16 offset:14336
    v_mfma_f32_16x16x32_bf16 v[100:103], a[104:107], a[92:95], v[100:103]
    v_mfma_f32_16x16x32_bf16 v[96:99], a[100:103], a[92:95], v[96:99]
    ds_read_b128 a[32:35], v16 offset:16384
    v_mfma_f32_16x16x32_bf16 v[104:107], a[100:103], a[96:99], v[104:107]
    v_mfma_f32_16x16x32_bf16 v[108:111], a[104:107], a[96:99], v[108:111]
    v_mfma_f32_16x16x32_bf16 v[176:179], a[108:111], a[96:99], v[176:179]
    v_mfma_f32_16x16x32_bf16 v[180:183], a[112:115], a[96:99], v[180:183]
    v_mfma_f32_16x16x32_bf16 v[216:219], a[96:99], a[116:119], v[216:219]
    v_mfma_f32_16x16x32_bf16 v[252:255], a[96:99], a[120:123], v[252:255]
    v_mfma_f32_16x16x32_bf16 a[156:159], a[124:127], a[96:99], a[156:159]
    s_waitcnt lgkmcnt(0)
    v_mfma_f32_16x16x32_bf16 v[112:115], a[44:47], a[0:3], v[112:115]
    s_waitcnt vmcnt(2)
    s_barrier
    v_mfma_f32_16x16x32_bf16 v[116:119], a[48:51], a[0:3], v[116:119]
    ds_read_b128 a[64:67], v17 offset:0
    s_lshl_b32 s49, s43, 11
    v_mfma_f32_16x16x32_bf16 v[184:187], a[0:3], a[52:55], v[184:187]
    s_add_u32 s50, s49, 4096
    v_lshlrev_b32 v45, 4, v0
    v_mfma_f32_16x16x32_bf16 v[220:223], a[0:3], a[56:59], v[220:223]
    s_mov_b32 s4, s80
    s_mov_b32 s5, s81
    v_mfma_f32_16x16x32_bf16 a[128:131], a[60:63], a[4:7], a[128:131]
    s_mov_b32 s6, 0x800
    ds_read_b128 a[68:71], v17 offset:2048
    v_mfma_f32_16x16x32_bf16 v[224:227], a[4:7], a[56:59], v[224:227]
    s_mov_b32 s7, 0x20000
    buffer_load_dwordx4 a[160:163], v45, s[8:11], s49 offen offset:0
    v_mfma_f32_16x16x32_bf16 v[188:191], a[4:7], a[52:55], v[188:191]
    ds_read_b128 a[72:75], v17 offset:4096
    v_mfma_f32_16x16x32_bf16 v[124:127], a[48:51], a[4:7], v[124:127]
    ds_read_b128 a[76:79], v17 offset:6144
    v_mfma_f32_16x16x32_bf16 v[120:123], a[44:47], a[4:7], v[120:123]
    v_mfma_f32_16x16x32_bf16 v[52:55], a[40:43], a[4:7], v[52:55]
    buffer_load_dwordx4 a[164:167], v45, s[8:11], s49 offen offset:1024
    v_mfma_f32_16x16x32_bf16 v[48:51], a[36:39], a[4:7], v[48:51]
    ds_read_b128 a[80:83], v17 offset:8192
    v_mfma_f32_16x16x32_bf16 v[56:59], a[36:39], a[8:11], v[56:59]
    v_mfma_f32_16x16x32_bf16 v[60:63], a[40:43], a[8:11], v[60:63]
    ds_read_b128 a[84:87], v17 offset:10240
    v_mfma_f32_16x16x32_bf16 v[128:131], a[44:47], a[8:11], v[128:131]
    v_mfma_f32_16x16x32_bf16 v[132:135], a[48:51], a[8:11], v[132:135]
    ds_read_b128 a[88:91], v17 offset:12288
    v_mfma_f32_16x16x32_bf16 v[192:195], a[8:11], a[52:55], v[192:195]
    buffer_load_dwordx4 a[168:171], v45, s[8:11], s49 offen offset:2048
    v_mfma_f32_16x16x32_bf16 v[228:231], a[8:11], a[56:59], v[228:231]
    v_mfma_f32_16x16x32_bf16 a[132:135], a[60:63], a[8:11], a[132:135]
    ds_read_b128 a[92:95], v17 offset:14336
    v_mfma_f32_16x16x32_bf16 a[136:139], a[60:63], a[12:15], a[136:139]
    v_mfma_f32_16x16x32_bf16 v[232:235], a[12:15], a[56:59], v[232:235]
    ds_read_b128 a[96:99], v17 offset:16384
    v_mfma_f32_16x16x32_bf16 v[196:199], a[12:15], a[52:55], v[196:199]
    v_mfma_f32_16x16x32_bf16 v[140:143], a[48:51], a[12:15], v[140:143]
    buffer_load_dwordx4 a[172:175], v45, s[8:11], s49 offen offset:3072
    ds_read_b64_tr_b16 a[100:101], v18 offset:43008
    v_mfma_f32_16x16x32_bf16 v[136:139], a[44:47], a[12:15], v[136:139]
    v_mfma_f32_16x16x32_bf16 v[68:71], a[40:43], a[12:15], v[68:71]
    v_mfma_f32_16x16x32_bf16 v[64:67], a[36:39], a[12:15], v[64:67]
    ds_read_b64_tr_b16 a[102:103], v18 offset:43520
    v_mfma_f32_16x16x32_bf16 v[72:75], a[36:39], a[16:19], v[72:75]
    v_mfma_f32_16x16x32_bf16 v[76:79], a[40:43], a[16:19], v[76:79]
    ds_read_b64_tr_b16 a[104:105], v19 offset:43008
    v_mfma_f32_16x16x32_bf16 v[144:147], a[44:47], a[16:19], v[144:147]
    buffer_load_dwordx4 a[176:179], v45, s[8:11], s50 offen offset:0
    v_mfma_f32_16x16x32_bf16 v[148:151], a[48:51], a[16:19], v[148:151]
    ds_read_b64_tr_b16 a[106:107], v19 offset:43520
    v_mfma_f32_16x16x32_bf16 v[200:203], a[16:19], a[52:55], v[200:203]
    v_mfma_f32_16x16x32_bf16 v[236:239], a[16:19], a[56:59], v[236:239]
    ds_read_b64_tr_b16 a[108:109], v18 offset:44032
    v_mfma_f32_16x16x32_bf16 a[140:143], a[60:63], a[16:19], a[140:143]
    v_mfma_f32_16x16x32_bf16 a[144:147], a[60:63], a[20:23], a[144:147]
    buffer_load_dwordx4 a[180:183], v45, s[8:11], s50 offen offset:1024
    v_mfma_f32_16x16x32_bf16 v[240:243], a[20:23], a[56:59], v[240:243]
    ds_read_b64_tr_b16 a[110:111], v18 offset:44544
    v_mfma_f32_16x16x32_bf16 v[204:207], a[20:23], a[52:55], v[204:207]
    v_mfma_f32_16x16x32_bf16 v[156:159], a[48:51], a[20:23], v[156:159]
    ds_read_b64_tr_b16 a[112:113], v19 offset:44032
    v_mfma_f32_16x16x32_bf16 v[152:155], a[44:47], a[20:23], v[152:155]
    v_mfma_f32_16x16x32_bf16 v[84:87], a[40:43], a[20:23], v[84:87]
    ds_read_b64_tr_b16 a[114:115], v19 offset:44544
    v_mfma_f32_16x16x32_bf16 v[80:83], a[36:39], a[20:23], v[80:83]
    buffer_load_dwordx4 a[184:187], v45, s[8:11], s50 offen offset:2048
    v_mfma_f32_16x16x32_bf16 v[88:91], a[36:39], a[24:27], v[88:91]
    v_mfma_f32_16x16x32_bf16 v[92:95], a[40:43], a[24:27], v[92:95]
    ds_read_b64_tr_b16 a[116:117], v18 offset:45056
    v_mfma_f32_16x16x32_bf16 v[160:163], a[44:47], a[24:27], v[160:163]
    v_mfma_f32_16x16x32_bf16 v[164:167], a[48:51], a[24:27], v[164:167]
    ds_read_b64_tr_b16 a[118:119], v18 offset:45568
    v_mfma_f32_16x16x32_bf16 v[208:211], a[24:27], a[52:55], v[208:211]
    v_mfma_f32_16x16x32_bf16 v[244:247], a[24:27], a[56:59], v[244:247]
    buffer_load_dwordx4 a[188:191], v45, s[8:11], s50 offen offset:3072
    ds_read_b64_tr_b16 a[120:121], v19 offset:45056
    v_mfma_f32_16x16x32_bf16 a[148:151], a[60:63], a[24:27], a[148:151]
    v_mfma_f32_16x16x32_bf16 a[152:155], a[60:63], a[28:31], a[152:155]
    v_mfma_f32_16x16x32_bf16 v[248:251], a[28:31], a[56:59], v[248:251]
    ds_read_b64_tr_b16 a[122:123], v19 offset:45568
    v_mfma_f32_16x16x32_bf16 v[212:215], a[28:31], a[52:55], v[212:215]
    v_mfma_f32_16x16x32_bf16 v[172:175], a[48:51], a[28:31], v[172:175]
    ds_read_b64_tr_b16 a[124:125], v28 offset:43008
    v_mfma_f32_16x16x32_bf16 v[168:171], a[44:47], a[28:31], v[168:171]
    buffer_load_dwordx4 a[192:195], v45, s[4:7], 0 offen offset:0
    v_mfma_f32_16x16x32_bf16 v[100:103], a[40:43], a[28:31], v[100:103]
    ds_read_b64_tr_b16 a[126:127], v28 offset:43264
    v_mfma_f32_16x16x32_bf16 v[96:99], a[36:39], a[28:31], v[96:99]
    v_mfma_f32_16x16x32_bf16 v[104:107], a[36:39], a[32:35], v[104:107]
    v_mfma_f32_16x16x32_bf16 v[108:111], a[40:43], a[32:35], v[108:111]
    v_mfma_f32_16x16x32_bf16 v[176:179], a[44:47], a[32:35], v[176:179]
    v_mfma_f32_16x16x32_bf16 v[180:183], a[48:51], a[32:35], v[180:183]
    buffer_load_dwordx4 a[196:199], v45, s[4:7], 0 offen offset:1024
    v_mfma_f32_16x16x32_bf16 v[216:219], a[32:35], a[52:55], v[216:219]
    v_mfma_f32_16x16x32_bf16 v[252:255], a[32:35], a[56:59], v[252:255]
    v_mfma_f32_16x16x32_bf16 a[156:159], a[60:63], a[32:35], a[156:159]
    s_waitcnt lgkmcnt(0)
    v_mfma_f32_16x16x32_bf16 v[112:115], a[108:111], a[64:67], v[112:115]
    s_barrier
    v_mfma_f32_16x16x32_bf16 v[116:119], a[112:115], a[64:67], v[116:119]
    s_add_u32 s36, s38, s39
    s_and_b32 s36, s36, 3
    v_mfma_f32_16x16x32_bf16 v[184:187], a[64:67], a[116:119], v[184:187]
    s_lshl_b32 s36, s36, 3
    s_lshl_b32 s24, s3, 12
    v_mfma_f32_16x16x32_bf16 v[220:223], a[64:67], a[120:123], v[220:223]
    s_mov_b32 s8, s74
    s_mov_b32 s9, s75
    v_mfma_f32_16x16x32_bf16 a[128:131], a[124:127], a[68:71], a[128:131]
    s_mov_b32 s10, 0x800000
    s_mov_b32 s11, 0x20000
    v_mfma_f32_16x16x32_bf16 v[224:227], a[68:71], a[120:123], v[224:227]
    v_lshrrev_b32 v6, 3, v0
    v_and_b32 v7, 7, v0
    v_mfma_f32_16x16x32_bf16 v[188:191], a[68:71], a[116:119], v[188:191]
    v_lshrrev_b32 v8, 4, v0
    s_lshl_b32 s48, s38, 7
    v_mfma_f32_16x16x32_bf16 v[124:127], a[112:115], a[68:71], v[124:127]
    s_lshl_b32 s49, s3, 5
    s_add_u32 s48, s48, s49
    v_mfma_f32_16x16x32_bf16 v[120:123], a[108:111], a[68:71], v[120:123]
    v_add_u32 v9, s48, v6
    v_lshlrev_b32 v9, 12, v9
    v_mfma_f32_16x16x32_bf16 v[52:55], a[104:107], a[68:71], v[52:55]
    v_xor_b32 v10, v7, v8
    v_xor_b32 v11, 4, v10
    v_mfma_f32_16x16x32_bf16 v[48:51], a[100:103], a[68:71], v[48:51]
    v_lshl_add_u32 v10, v10, 4, v9
    v_lshl_add_u32 v11, v11, 4, v9
    v_mfma_f32_16x16x32_bf16 v[56:59], a[100:103], a[72:75], v[56:59]
    v_add_u32 v2, 0, v10
    v_add_u32 v3, 31744, v11
    v_mfma_f32_16x16x32_bf16 v[60:63], a[104:107], a[72:75], v[60:63]
    v_add_u32 v4, 63488, v10
    v_add_u32 v5, 95232, v11
    v_mfma_f32_16x16x32_bf16 v[128:131], a[108:111], a[72:75], v[128:131]
    s_lshr_b32 s37, 0x3, s36
    s_and_b32 s37, s37, 0xff
    v_mfma_f32_16x16x32_bf16 v[132:135], a[112:115], a[72:75], v[132:135]
    s_lshl_b32 s26, s37, 7
    s_add_u32 m0, s24, 0
    v_mfma_f32_16x16x32_bf16 v[192:195], a[72:75], a[116:119], v[192:195]
    buffer_load_dwordx4 v2, s[8:11], s26 offen lds
    buffer_load_dwordx4 v3, s[8:11], s26 offen offset:1024 lds
    v_mfma_f32_16x16x32_bf16 v[228:231], a[72:75], a[120:123], v[228:231]
    buffer_load_dwordx4 v4, s[8:11], s26 offen offset:2048 lds
    buffer_load_dwordx4 v5, s[8:11], s26 offen offset:3072 lds
    v_mfma_f32_16x16x32_bf16 a[132:135], a[124:127], a[72:75], a[132:135]
    s_lshr_b32 s37, 0x1010400, s36
    s_and_b32 s37, s37, 0xff
    v_mfma_f32_16x16x32_bf16 a[136:139], a[124:127], a[76:79], a[136:139]
    s_lshl_b32 s26, s37, 7
    s_add_u32 m0, s24, 16384
    v_mfma_f32_16x16x32_bf16 v[232:235], a[76:79], a[120:123], v[232:235]
    buffer_load_dwordx4 v2, s[8:11], s26 offen lds
    v_mfma_f32_16x16x32_bf16 v[196:199], a[76:79], a[116:119], v[196:199]
    buffer_load_dwordx4 v3, s[8:11], s26 offen offset:1024 lds
    v_mfma_f32_16x16x32_bf16 v[140:143], a[112:115], a[76:79], v[140:143]
    v_mfma_f32_16x16x32_bf16 v[136:139], a[108:111], a[76:79], v[136:139]
    v_mfma_f32_16x16x32_bf16 v[68:71], a[104:107], a[76:79], v[68:71]
    v_mfma_f32_16x16x32_bf16 v[64:67], a[100:103], a[76:79], v[64:67]
    buffer_load_dwordx4 v4, s[8:11], s26 offen offset:2048 lds
    v_mfma_f32_16x16x32_bf16 v[72:75], a[100:103], a[80:83], v[72:75]
    v_mfma_f32_16x16x32_bf16 v[76:79], a[104:107], a[80:83], v[76:79]
    v_mfma_f32_16x16x32_bf16 v[144:147], a[108:111], a[80:83], v[144:147]
    v_mfma_f32_16x16x32_bf16 v[148:151], a[112:115], a[80:83], v[148:151]
    buffer_load_dwordx4 v5, s[8:11], s26 offen offset:3072 lds
    v_mfma_f32_16x16x32_bf16 v[200:203], a[80:83], a[116:119], v[200:203]
    s_lshr_b32 s37, 0x2050101, s36
    v_mfma_f32_16x16x32_bf16 v[236:239], a[80:83], a[120:123], v[236:239]
    s_and_b32 s37, s37, 0xff
    s_lshl_b32 s26, s37, 7
    v_mfma_f32_16x16x32_bf16 a[140:143], a[124:127], a[80:83], a[140:143]
    s_add_u32 m0, s24, 32768
    s_nop 0
    buffer_load_dwordx4 v2, s[8:11], s26 offen lds
    v_mfma_f32_16x16x32_bf16 a[144:147], a[124:127], a[84:87], a[144:147]
    v_mfma_f32_16x16x32_bf16 v[240:243], a[84:87], a[120:123], v[240:243]
    v_mfma_f32_16x16x32_bf16 v[204:207], a[84:87], a[116:119], v[204:207]
    v_mfma_f32_16x16x32_bf16 v[156:159], a[112:115], a[84:87], v[156:159]
    buffer_load_dwordx4 v3, s[8:11], s26 offen offset:1024 lds
    v_mfma_f32_16x16x32_bf16 v[152:155], a[108:111], a[84:87], v[152:155]
    v_mfma_f32_16x16x32_bf16 v[84:87], a[104:107], a[84:87], v[84:87]
    v_mfma_f32_16x16x32_bf16 v[80:83], a[100:103], a[84:87], v[80:83]
    v_mfma_f32_16x16x32_bf16 v[88:91], a[100:103], a[88:91], v[88:91]
    buffer_load_dwordx4 v4, s[8:11], s26 offen offset:2048 lds
    v_mfma_f32_16x16x32_bf16 v[92:95], a[104:107], a[88:91], v[92:95]
    v_mfma_f32_16x16x32_bf16 v[160:163], a[108:111], a[88:91], v[160:163]
    v_mfma_f32_16x16x32_bf16 v[164:167], a[112:115], a[88:91], v[164:167]
    buffer_load_dwordx4 v5, s[8:11], s26 offen offset:3072 lds
    v_mfma_f32_16x16x32_bf16 v[208:211], a[88:91], a[116:119], v[208:211]
    v_mfma_f32_16x16x32_bf16 v[244:247], a[88:91], a[120:123], v[244:247]
    s_lshr_b32 s37, 0x6020202, s36
    s_and_b32 s37, s37, 0xff
    v_mfma_f32_16x16x32_bf16 a[148:151], a[124:127], a[88:91], a[148:151]
    s_lshl_b32 s26, s37, 7
    s_add_u32 m0, s24, 49152
    v_mfma_f32_16x16x32_bf16 a[152:155], a[124:127], a[92:95], a[152:155]
    buffer_load_dwordx4 v2, s[8:11], s26 offen lds
    v_mfma_f32_16x16x32_bf16 v[248:251], a[92:95], a[120:123], v[248:251]
    v_mfma_f32_16x16x32_bf16 v[212:215], a[92:95], a[116:119], v[212:215]
    v_mfma_f32_16x16x32_bf16 v[172:175], a[112:115], a[92:95], v[172:175]
    buffer_load_dwordx4 v3, s[8:11], s26 offen offset:1024 lds
    v_mfma_f32_16x16x32_bf16 v[168:171], a[108:111], a[92:95], v[168:171]
    v_mfma_f32_16x16x32_bf16 v[100:103], a[104:107], a[92:95], v[100:103]
    v_mfma_f32_16x16x32_bf16 v[96:99], a[100:103], a[92:95], v[96:99]
    v_mfma_f32_16x16x32_bf16 v[104:107], a[100:103], a[96:99], v[104:107]
    buffer_load_dwordx4 v4, s[8:11], s26 offen offset:2048 lds
    v_mfma_f32_16x16x32_bf16 v[108:111], a[104:107], a[96:99], v[108:111]
    v_mfma_f32_16x16x32_bf16 v[176:179], a[108:111], a[96:99], v[176:179]
    v_mfma_f32_16x16x32_bf16 v[180:183], a[112:115], a[96:99], v[180:183]
    v_mfma_f32_16x16x32_bf16 v[216:219], a[96:99], a[116:119], v[216:219]
    buffer_load_dwordx4 v5, s[8:11], s26 offen offset:3072 lds
    v_mfma_f32_16x16x32_bf16 v[252:255], a[96:99], a[120:123], v[252:255]
    v_mfma_f32_16x16x32_bf16 a[156:159], a[124:127], a[96:99], a[156:159]
    s_mov_b32 s4, s68
    s_mov_b32 s5, s69
    s_mov_b32 s6, 0x200000
    s_mov_b32 s7, 0x20000
    s_lshl_b32 s46, s2, 2
    s_add_u32 s46, s46, s3
    s_mul_i32 s46, s46, 2048
    v_lshlrev_b32 v46, 7, v0
    s_mov_b64 exec, 0xffff
    buffer_load_dword v47, v46, s[4:7], s46 offen
    s_mov_b64 exec, -1
    s_mov_b32 s4, s78
    s_mov_b32 s5, s79
    s_mov_b32 s6, 0x380000
    s_mov_b32 s7, 0x20000
    s_lshl_b32 s46, s2, 2
    s_add_u32 s46, s46, s3
    s_mul_i32 s46, s46, 3584
    v_lshlrev_b32 v46, 7, v0
    s_mov_b64 exec, 0xfffffff
    buffer_load_dword v47, v46, s[4:7], s46 offen
    s_mov_b64 exec, -1
    s_waitcnt vmcnt(28)
    s_mov_b32 s4, s84
    s_mov_b32 s5, s85
    s_mov_b32 s6, 0x100
    s_mov_b32 s7, 0x20000
    v_mov_b32 v43, 0
    s_mov_b32 s47, 0
    v_cmp_gt_u32 vcc, 160, v44
    s_nop 1
    s_cmp_eq_u64 vcc, 0
    s_cbranch_scc1 L_polled_1_8
L_poll_1_7:
    buffer_load_dword v44, v43, s[4:7], 0 offen sc1
    s_waitcnt vmcnt(0)
    v_cmp_gt_u32 vcc, 160, v44
    s_nop 1
    s_cmp_eq_u64 vcc, 0
    s_cbranch_scc1 L_polled_1_8
    s_add_u32 s47, s47, 1
    s_cmp_lt_u32 s47, 262144
    s_cbranch_scc1 L_poll_1_7
L_polled_1_8:
    s_nop 1
    v_and_b32 v2, 15, v0
    v_lshrrev_b32 v3, 4, v0
    v_and_b32 v4, 1, v0
    v_lshl_add_u32 v5, v3, 2, v4
    v_add_u32 v6, 2, v5
    v_cmp_eq_u32 s[50:51], 1, v4
    v_cmp_le_u32 s[52:53], v5, v2
    v_cmp_le_u32 s[54:55], v6, v2
    v_mov_b32 v7, 0x0c0c0100
    v_mov_b32 v8, 0x01000c0c
    v_mov_b32 v9, 0x0c0c0302
    v_mov_b32 v10, 0x03020c0c
    v_mov_b32 v11, 0x0c0c0c0c
    v_cndmask_b32 v7, v7, v8, s[50:51]
    v_cndmask_b32 v9, v9, v10, s[50:51]
    v_cndmask_b32 v12, v7, v11, s[52:53]
    v_cndmask_b32 v13, v9, v11, s[54:55]
    v_cndmask_b32 v14, v11, v7, s[52:53]
    v_cndmask_b32 v15, v11, v9, s[54:55]
    s_lshr_b32 s46, s3, 1
    s_or_b32 s46, s46, s35
    s_cmp_eq_u32 s46, 0
    s_cselect_b64 s[56:57], -1, 0
    v_mov_b32 v16, 0xff800000
    v_cvt_pk_bf16_f32 v112, v112, v113
    v_cvt_pk_bf16_f32 v113, v114, v115
    v_cvt_pk_bf16_f32 v114, v116, v117
    v_cvt_pk_bf16_f32 v115, v118, v119
    v_cvt_pk_bf16_f32 v120, v120, v121
    v_cvt_pk_bf16_f32 v121, v122, v123
    v_cvt_pk_bf16_f32 v122, v124, v125
    v_cvt_pk_bf16_f32 v123, v126, v127
    v_cvt_pk_bf16_f32 v128, v128, v129
    v_cvt_pk_bf16_f32 v129, v130, v131
    v_cvt_pk_bf16_f32 v130, v132, v133
    v_cvt_pk_bf16_f32 v131, v134, v135
    v_cvt_pk_bf16_f32 v136, v136, v137
    v_cvt_pk_bf16_f32 v137, v138, v139
    v_cvt_pk_bf16_f32 v138, v140, v141
    v_cvt_pk_bf16_f32 v139, v142, v143
    v_cvt_pk_bf16_f32 v144, v144, v145
    v_cvt_pk_bf16_f32 v145, v146, v147
    v_cvt_pk_bf16_f32 v146, v148, v149
    v_cvt_pk_bf16_f32 v147, v150, v151
    v_cvt_pk_bf16_f32 v152, v152, v153
    v_cvt_pk_bf16_f32 v153, v154, v155
    v_cvt_pk_bf16_f32 v154, v156, v157
    v_cvt_pk_bf16_f32 v155, v158, v159
    v_cvt_pk_bf16_f32 v160, v160, v161
    v_cvt_pk_bf16_f32 v161, v162, v163
    v_cvt_pk_bf16_f32 v162, v164, v165
    v_cvt_pk_bf16_f32 v163, v166, v167
    v_cvt_pk_bf16_f32 v168, v168, v169
    v_cvt_pk_bf16_f32 v169, v170, v171
    v_cvt_pk_bf16_f32 v170, v172, v173
    v_cvt_pk_bf16_f32 v171, v174, v175
    v_cvt_pk_bf16_f32 v176, v176, v177
    v_cvt_pk_bf16_f32 v177, v178, v179
    v_cvt_pk_bf16_f32 v178, v180, v181
    v_cvt_pk_bf16_f32 v179, v182, v183
    v_cvt_pk_bf16_f32 v48, v48, v49
    v_cvt_pk_bf16_f32 v49, v50, v51
    v_cvt_pk_bf16_f32 v50, v52, v53
    v_cvt_pk_bf16_f32 v51, v54, v55
    v_cvt_pk_bf16_f32 v56, v56, v57
    v_cvt_pk_bf16_f32 v57, v58, v59
    v_cvt_pk_bf16_f32 v58, v60, v61
    v_cvt_pk_bf16_f32 v59, v62, v63
    v_cvt_pk_bf16_f32 v64, v64, v65
    v_cvt_pk_bf16_f32 v65, v66, v67
    v_cvt_pk_bf16_f32 v66, v68, v69
    v_cvt_pk_bf16_f32 v67, v70, v71
    v_cvt_pk_bf16_f32 v72, v72, v73
    v_cvt_pk_bf16_f32 v73, v74, v75
    v_cvt_pk_bf16_f32 v74, v76, v77
    v_cvt_pk_bf16_f32 v75, v78, v79
    v_cvt_pk_bf16_f32 v80, v80, v81
    v_cvt_pk_bf16_f32 v81, v82, v83
    v_cvt_pk_bf16_f32 v82, v84, v85
    v_cvt_pk_bf16_f32 v83, v86, v87
    v_cvt_pk_bf16_f32 v88, v88, v89
    v_cvt_pk_bf16_f32 v89, v90, v91
    v_cvt_pk_bf16_f32 v90, v92, v93
    v_cvt_pk_bf16_f32 v91, v94, v95
    v_cvt_pk_bf16_f32 v96, v96, v97
    v_cvt_pk_bf16_f32 v97, v98, v99
    v_cvt_pk_bf16_f32 v98, v100, v101
    v_cvt_pk_bf16_f32 v99, v102, v103
    v_cvt_pk_bf16_f32 v104, v104, v105
    v_cvt_pk_bf16_f32 v105, v106, v107
    v_cvt_pk_bf16_f32 v106, v108, v109
    v_cvt_pk_bf16_f32 v107, v110, v111
    v_mfma_f32_16x16x32_bf16 v[52:55], v[112:115], v[48:51], 0
    v_mfma_f32_16x16x32_bf16 v[124:127], v[120:123], v[48:51], 0
    v_mfma_f32_16x16x32_bf16 v[60:63], v[120:123], v[56:59], 0
    v_mfma_f32_16x16x32_bf16 v[132:135], v[128:131], v[56:59], 0
    v_mfma_f32_16x16x32_bf16 v[68:71], v[128:131], v[64:67], 0
    v_mfma_f32_16x16x32_bf16 v[140:143], v[136:139], v[64:67], 0
    v_mfma_f32_16x16x32_bf16 v[76:79], v[136:139], v[72:75], 0
    v_mfma_f32_16x16x32_bf16 v[148:151], v[144:147], v[72:75], 0
    v_mfma_f32_16x16x32_bf16 v[84:87], v[144:147], v[80:83], 0
    v_mfma_f32_16x16x32_bf16 v[156:159], v[152:155], v[80:83], 0
    v_mfma_f32_16x16x32_bf16 v[92:95], v[152:155], v[88:91], 0
    v_mfma_f32_16x16x32_bf16 v[164:167], v[160:163], v[88:91], 0
    v_mfma_f32_16x16x32_bf16 v[100:103], v[160:163], v[96:99], 0
    v_mfma_f32_16x16x32_bf16 v[172:175], v[168:171], v[96:99], 0
    v_mfma_f32_16x16x32_bf16 v[108:111], v[168:171], v[104:107], 0
    v_mfma_f32_16x16x32_bf16 v[180:183], v[176:179], v[104:107], 0
    v_cvt_pk_bf16_f32 v184, v184, v185
    v_cvt_pk_bf16_f32 v185, v186, v187
    v_cvt_pk_bf16_f32 v186, v188, v189
    v_cvt_pk_bf16_f32 v187, v190, v191
    v_cvt_pk_bf16_f32 v188, v192, v193
    v_cvt_pk_bf16_f32 v189, v194, v195
    v_cvt_pk_bf16_f32 v190, v196, v197
    v_cvt_pk_bf16_f32 v191, v198, v199
    v_cvt_pk_bf16_f32 v192, v200, v201
    v_cvt_pk_bf16_f32 v193, v202, v203
    v_cvt_pk_bf16_f32 v194, v204, v205
    v_cvt_pk_bf16_f32 v195, v206, v207
    v_cvt_pk_bf16_f32 v196, v208, v209
    v_cvt_pk_bf16_f32 v197, v210, v211
    v_cvt_pk_bf16_f32 v198, v212, v213
    v_cvt_pk_bf16_f32 v199, v214, v215
    v_cvt_pk_bf16_f32 v200, v216, v217
    v_cvt_pk_bf16_f32 v201, v218, v219
    v_cvt_pk_bf16_f32 v220, v220, v221
    v_cvt_pk_bf16_f32 v221, v222, v223
    v_cvt_pk_bf16_f32 v222, v224, v225
    v_cvt_pk_bf16_f32 v223, v226, v227
    v_cvt_pk_bf16_f32 v224, v228, v229
    v_cvt_pk_bf16_f32 v225, v230, v231
    v_cvt_pk_bf16_f32 v226, v232, v233
    v_cvt_pk_bf16_f32 v227, v234, v235
    v_cvt_pk_bf16_f32 v228, v236, v237
    v_cvt_pk_bf16_f32 v229, v238, v239
    v_cvt_pk_bf16_f32 v230, v240, v241
    v_cvt_pk_bf16_f32 v231, v242, v243
    v_cvt_pk_bf16_f32 v232, v244, v245
    v_cvt_pk_bf16_f32 v233, v246, v247
    v_cvt_pk_bf16_f32 v234, v248, v249
    v_cvt_pk_bf16_f32 v235, v250, v251
    v_cvt_pk_bf16_f32 v236, v252, v253
    v_cvt_pk_bf16_f32 v237, v254, v255
    s_mov_b32 s46, 0x3e8293ee
    v_cndmask_b32 v52, v52, v53, s[50:51]
    v_cndmask_b32 v54, v54, v55, s[50:51]
    v_cndmask_b32 v60, v60, v61, s[50:51]
    v_cndmask_b32 v62, v62, v63, s[50:51]
    v_cndmask_b32 v68, v68, v69, s[50:51]
    v_cndmask_b32 v70, v70, v71, s[50:51]
    v_cndmask_b32 v76, v76, v77, s[50:51]
    v_cndmask_b32 v78, v78, v79, s[50:51]
    v_cndmask_b32 v84, v84, v85, s[50:51]
    v_cndmask_b32 v86, v86, v87, s[50:51]
    v_cndmask_b32 v92, v92, v93, s[50:51]
    v_cndmask_b32 v94, v94, v95, s[50:51]
    v_cndmask_b32 v100, v100, v101, s[50:51]
    v_cndmask_b32 v102, v102, v103, s[50:51]
    v_cndmask_b32 v108, v108, v109, s[50:51]
    v_cndmask_b32 v110, v110, v111, s[50:51]
    v_cndmask_b32 v52, v52, v16, s[56:57]
    v_cndmask_b32 v54, v54, v16, s[56:57]
    v_cndmask_b32 v124, v124, v125, s[50:51]
    v_cndmask_b32 v126, v126, v127, s[50:51]
    v_cndmask_b32 v132, v132, v133, s[50:51]
    v_cndmask_b32 v134, v134, v135, s[50:51]
    v_cndmask_b32 v140, v140, v141, s[50:51]
    v_cndmask_b32 v142, v142, v143, s[50:51]
    v_cndmask_b32 v148, v148, v149, s[50:51]
    v_cndmask_b32 v150, v150, v151, s[50:51]
    v_cndmask_b32 v156, v156, v157, s[50:51]
    v_cndmask_b32 v158, v158, v159, s[50:51]
    v_cndmask_b32 v164, v164, v165, s[50:51]
    v_cndmask_b32 v166, v166, v167, s[50:51]
    v_cndmask_b32 v172, v172, v173, s[50:51]
    v_cndmask_b32 v174, v174, v175, s[50:51]
    v_cndmask_b32 v180, v180, v181, s[50:51]
    v_cndmask_b32 v182, v182, v183, s[50:51]
    v_cndmask_b32 v52, v52, v124, s[52:53]
    v_cndmask_b32 v54, v54, v126, s[54:55]
    v_cndmask_b32 v60, v60, v132, s[52:53]
    v_cndmask_b32 v62, v62, v134, s[54:55]
    v_cndmask_b32 v68, v68, v140, s[52:53]
    v_cndmask_b32 v70, v70, v142, s[54:55]
    v_cndmask_b32 v76, v76, v148, s[52:53]
    v_cndmask_b32 v78, v78, v150, s[54:55]
    v_cndmask_b32 v84, v84, v156, s[52:53]
    v_cndmask_b32 v86, v86, v158, s[54:55]
    v_cndmask_b32 v92, v92, v164, s[52:53]
    v_cndmask_b32 v94, v94, v166, s[54:55]
    v_cndmask_b32 v100, v100, v172, s[52:53]
    v_cndmask_b32 v102, v102, v174, s[54:55]
    v_cndmask_b32 v108, v108, v180, s[52:53]
    v_cndmask_b32 v110, v110, v182, s[54:55]
    v_max_f32 v53, v52, v54
    v_max_f32 v61, v60, v62
    v_max_f32 v69, v68, v70
    v_max_f32 v77, v76, v78
    v_max_f32 v85, v84, v86
    v_max_f32 v93, v92, v94
    v_max_f32 v101, v100, v102
    v_max_f32 v109, v108, v110
    v_mov_b32 v55, v53
    v_mov_b32 v63, v61
    v_mov_b32 v71, v69
    v_mov_b32 v79, v77
    v_mov_b32 v87, v85
    v_mov_b32 v95, v93
    v_mov_b32 v103, v101
    v_mov_b32 v111, v109
    v_permlane32_swap_b32 v53, v55
    v_permlane32_swap_b32 v61, v63
    v_permlane32_swap_b32 v69, v71
    v_permlane32_swap_b32 v77, v79
    v_permlane32_swap_b32 v85, v87
    v_permlane32_swap_b32 v93, v95
    v_permlane32_swap_b32 v101, v103
    v_permlane32_swap_b32 v109, v111
    v_max_f32 v53, v53, v55
    v_max_f32 v61, v61, v63
    v_max_f32 v69, v69, v71
    v_max_f32 v77, v77, v79
    v_max_f32 v85, v85, v87
    v_max_f32 v93, v93, v95
    v_max_f32 v101, v101, v103
    v_max_f32 v109, v109, v111
    v_mov_b32 v55, v53
    v_mov_b32 v63, v61
    v_mov_b32 v71, v69
    v_mov_b32 v79, v77
    v_mov_b32 v87, v85
    v_mov_b32 v95, v93
    v_mov_b32 v103, v101
    v_mov_b32 v111, v109
    v_permlane16_swap_b32 v53, v55
    v_permlane16_swap_b32 v61, v63
    v_permlane16_swap_b32 v69, v71
    v_permlane16_swap_b32 v77, v79
    v_permlane16_swap_b32 v85, v87
    v_permlane16_swap_b32 v93, v95
    v_permlane16_swap_b32 v101, v103
    v_permlane16_swap_b32 v109, v111
    v_max_f32 v53, v53, v55
    v_max_f32 v61, v61, v63
    v_max_f32 v69, v69, v71
    v_max_f32 v77, v77, v79
    v_max_f32 v85, v85, v87
    v_max_f32 v93, v93, v95
    v_max_f32 v101, v101, v103
    v_max_f32 v109, v109, v111
    v_sub_f32 v52, v52, v53
    v_sub_f32 v54, v54, v53
    v_sub_f32 v60, v60, v61
    v_sub_f32 v62, v62, v61
    v_sub_f32 v68, v68, v69
    v_sub_f32 v70, v70, v69
    v_sub_f32 v76, v76, v77
    v_sub_f32 v78, v78, v77
    v_sub_f32 v84, v84, v85
    v_sub_f32 v86, v86, v85
    v_sub_f32 v92, v92, v93
    v_sub_f32 v94, v94, v93
    v_sub_f32 v100, v100, v101
    v_sub_f32 v102, v102, v101
    v_sub_f32 v108, v108, v109
    v_sub_f32 v110, v110, v109
    v_mul_f32 v52, s46, v52
    v_mul_f32 v54, s46, v54
    v_mul_f32 v60, s46, v60
    v_mul_f32 v62, s46, v62
    v_mul_f32 v68, s46, v68
    v_mul_f32 v70, s46, v70
    v_mul_f32 v76, s46, v76
    v_mul_f32 v78, s46, v78
    v_mul_f32 v84, s46, v84
    v_mul_f32 v86, s46, v86
    v_mul_f32 v92, s46, v92
    v_mul_f32 v94, s46, v94
    v_mul_f32 v100, s46, v100
    v_mul_f32 v102, s46, v102
    v_mul_f32 v108, s46, v108
    v_mul_f32 v110, s46, v110
    v_exp_f32 v52, v52
    v_exp_f32 v54, v54
    v_exp_f32 v60, v60
    v_exp_f32 v62, v62
    v_exp_f32 v68, v68
    v_exp_f32 v70, v70
    v_exp_f32 v76, v76
    v_exp_f32 v78, v78
    v_exp_f32 v84, v84
    v_exp_f32 v86, v86
    v_exp_f32 v92, v92
    v_exp_f32 v94, v94
    v_exp_f32 v100, v100
    v_exp_f32 v102, v102
    v_exp_f32 v108, v108
    v_exp_f32 v110, v110
    v_add_f32 v53, v52, v54
    v_add_f32 v61, v60, v62
    v_add_f32 v69, v68, v70
    v_add_f32 v77, v76, v78
    v_add_f32 v85, v84, v86
    v_add_f32 v93, v92, v94
    v_add_f32 v101, v100, v102
    v_add_f32 v109, v108, v110
    v_and_b32 v43, 7, v0
    v_lshlrev_b32 v43, 7, v43
    v_add_u32 v43, 26607616, v43
    buffer_load_dword v44, v43, s[20:23], 0 offen sc1
    v_mov_b32 v55, v53
    v_mov_b32 v63, v61
    v_mov_b32 v71, v69
    v_mov_b32 v79, v77
    v_mov_b32 v87, v85
    v_mov_b32 v95, v93
    v_mov_b32 v103, v101
    v_mov_b32 v111, v109
    v_permlane32_swap_b32 v53, v55
    v_permlane32_swap_b32 v61, v63
    v_permlane32_swap_b32 v69, v71
    v_permlane32_swap_b32 v77, v79
    v_permlane32_swap_b32 v85, v87
    v_permlane32_swap_b32 v93, v95
    v_permlane32_swap_b32 v101, v103
    v_permlane32_swap_b32 v109, v111
    v_add_f32 v53, v53, v55
    v_add_f32 v61, v61, v63
    v_add_f32 v69, v69, v71
    v_add_f32 v77, v77, v79
    v_add_f32 v85, v85, v87
    v_add_f32 v93, v93, v95
    v_add_f32 v101, v101, v103
    v_add_f32 v109, v109, v111
    v_mov_b32 v55, v53
    v_mov_b32 v63, v61
    v_mov_b32 v71, v69
    v_mov_b32 v79, v77
    v_mov_b32 v87, v85
    v_mov_b32 v95, v93
    v_mov_b32 v103, v101
    v_mov_b32 v111, v109
    v_permlane16_swap_b32 v53, v55
    v_permlane16_swap_b32 v61, v63
    v_permlane16_swap_b32 v69, v71
    v_permlane16_swap_b32 v77, v79
    v_permlane16_swap_b32 v85, v87
    v_permlane16_swap_b32 v93, v95
    v_permlane16_swap_b32 v101, v103
    v_permlane16_swap_b32 v109, v111
    v_add_f32 v53, v53, v55
    v_add_f32 v61, v61, v63
    v_add_f32 v69, v69, v71
    v_add_f32 v77, v77, v79
    v_add_f32 v85, v85, v87
    v_add_f32 v93, v93, v95
    v_add_f32 v101, v101, v103
    v_add_f32 v109, v109, v111
    v_rcp_f32 v53, v53
    v_rcp_f32 v61, v61
    v_rcp_f32 v69, v69
    v_rcp_f32 v77, v77
    v_rcp_f32 v85, v85
    v_rcp_f32 v93, v93
    v_rcp_f32 v101, v101
    v_rcp_f32 v109, v109
    v_mul_f32 v52, v52, v53
    v_mul_f32 v54, v54, v53
    v_mul_f32 v60, v60, v61
    v_mul_f32 v62, v62, v61
    v_mul_f32 v68, v68, v69
    v_mul_f32 v70, v70, v69
    v_mul_f32 v76, v76, v77
    v_mul_f32 v78, v78, v77
    v_mul_f32 v84, v84, v85
    v_mul_f32 v86, v86, v85
    v_mul_f32 v92, v92, v93
    v_mul_f32 v94, v94, v93
    v_mul_f32 v100, v100, v101
    v_mul_f32 v102, v102, v101
    v_mul_f32 v108, v108, v109
    v_mul_f32 v110, v110, v109
    v_cvt_pk_bf16_f32 v125, v52, v54
    v_cvt_pk_bf16_f32 v133, v60, v62
    v_cvt_pk_bf16_f32 v141, v68, v70
    v_cvt_pk_bf16_f32 v149, v76, v78
    v_cvt_pk_bf16_f32 v157, v84, v86
    v_cvt_pk_bf16_f32 v165, v92, v94
    v_cvt_pk_bf16_f32 v173, v100, v102
    v_cvt_pk_bf16_f32 v181, v108, v110
    v_perm_b32 v52, v125, v125, v12
    v_perm_b32 v53, v125, v125, v13
    v_perm_b32 v54, v125, v125, v14
    v_perm_b32 v55, v125, v125, v15
    v_perm_b32 v60, v133, v133, v12
    v_perm_b32 v61, v133, v133, v13
    v_perm_b32 v62, v133, v133, v14
    v_perm_b32 v63, v133, v133, v15
    v_perm_b32 v68, v141, v141, v12
    v_perm_b32 v69, v141, v141, v13
    v_perm_b32 v70, v141, v141, v14
    v_perm_b32 v71, v141, v141, v15
    v_perm_b32 v76, v149, v149, v12
    v_perm_b32 v77, v149, v149, v13
    v_perm_b32 v78, v149, v149, v14
    v_perm_b32 v79, v149, v149, v15
    v_perm_b32 v84, v157, v157, v12
    v_perm_b32 v85, v157, v157, v13
    v_perm_b32 v86, v157, v157, v14
    v_perm_b32 v87, v157, v157, v15
    v_perm_b32 v92, v165, v165, v12
    v_perm_b32 v93, v165, v165, v13
    v_perm_b32 v94, v165, v165, v14
    v_perm_b32 v95, v165, v165, v15
    v_perm_b32 v100, v173, v173, v12
    v_perm_b32 v101, v173, v173, v13
    v_perm_b32 v102, v173, v173, v14
    v_perm_b32 v103, v173, v173, v15
    v_perm_b32 v108, v181, v181, v12
    v_perm_b32 v109, v181, v181, v13
    v_perm_b32 v110, v181, v181, v14
    v_perm_b32 v111, v181, v181, v15
    v_mfma_f32_16x16x32_bf16 v[124:127], v[184:187], v[52:55], 0
    v_mfma_f32_16x16x32_bf16 v[48:51], v[220:223], v[52:55], 0
    v_mfma_f32_16x16x32_bf16 v[132:135], v[186:189], v[60:63], 0
    v_mfma_f32_16x16x32_bf16 v[56:59], v[222:225], v[60:63], 0
    v_mfma_f32_16x16x32_bf16 v[140:143], v[188:191], v[68:71], 0
    v_mfma_f32_16x16x32_bf16 v[64:67], v[224:227], v[68:71], 0
    v_mfma_f32_16x16x32_bf16 v[148:151], v[190:193], v[76:79], 0
    v_mfma_f32_16x16x32_bf16 v[72:75], v[226:229], v[76:79], 0
    v_mfma_f32_16x16x32_bf16 v[156:159], v[192:195], v[84:87], 0
    v_mfma_f32_16x16x32_bf16 v[80:83], v[228:231], v[84:87], 0
    v_mfma_f32_16x16x32_bf16 v[164:167], v[194:197], v[92:95], 0
    v_mfma_f32_16x16x32_bf16 v[88:91], v[230:233], v[92:95], 0
    v_mfma_f32_16x16x32_bf16 v[172:175], v[196:199], v[100:103], 0
    v_mfma_f32_16x16x32_bf16 v[96:99], v[232:235], v[100:103], 0
    v_mfma_f32_16x16x32_bf16 v[180:183], v[198:201], v[108:111], 0
    v_mfma_f32_16x16x32_bf16 v[104:107], v[234:237], v[108:111], 0
    s_mov_b32 s42, 0
    v_lshrrev_b32 v20, 3, v0
    v_and_b32 v21, 7, v0
    v_lshrrev_b32 v22, 4, v0
    s_lshl_b32 s48, s38, 7
    s_lshl_b32 s49, s3, 5
    s_add_u32 s48, s48, s49
    v_add_u32 v23, s48, v20
    v_lshlrev_b32 v23, 12, v23
    v_xor_b32 v24, v21, v22
    v_xor_b32 v25, 4, v24
    v_lshl_add_u32 v24, v24, 4, v23
    v_lshl_add_u32 v25, v25, 4, v23
    v_add_u32 v2, 0, v24
    v_add_u32 v3, 31744, v25
    v_add_u32 v4, 63488, v24
    v_add_u32 v5, 95232, v25
    s_mul_i32 s25, s3, 4096
    s_add_u32 s25, s25, 65536
    s_mul_i32 s50, s39, 7168
    s_lshr_b32 s51, s3, 1
    s_mul_i32 s51, s51, 114688
    s_and_b32 s48, s3, 1
    s_mul_i32 s48, s48, 3584
    s_add_u32 s51, s51, s50
    s_add_u32 s51, s51, s48
    s_add_u32 s51, s51, 0
    v_lshlrev_b32 v7, 4, v0
    v_add_u32 v6, s51, v7
    s_lshl_b32 s40, s38, 2
    s_add_u32 s40, s40, s3
    s_mul_i32 s48, s40, 114688
    s_add_u32 s50, s50, s48
    s_add_u32 s50, s50, 7340032
    s_add_u32 s51, s50, 4096
    v_and_b32 v20, 15, v0
    v_lshrrev_b32 v21, 4, v0
    v_lshrrev_b32 v22, 1, v20
    v_xor_b32 v22, v22, v21
    v_lshlrev_b32 v22, 4, v22
    v_lshl_add_u32 v22, v20, 7, v22
    v_add_u32 v8, s24, v22
    v_xor_b32 v9, 64, v8
    v_lshlrev_b32 v10, 3, v0
    v_and_b32 v10, 0xff, v10
    v_lshrrev_b32 v22, 5, v0
    v_lshl_or_b32 v10, v22, 9, v10
    v_add_u32 v10, 65536, v10
    v_lshl_add_u32 v14, v22, 9, v10
    v_lshl_add_u32 v15, v22, 30, v6
    s_mov_b32 s4, s76
    s_mov_b32 s5, s77
    s_mov_b32 s6, 0x1000
    s_mov_b32 s7, 0x20000
    s_lshl_b32 s48, s40, 6
    v_lshlrev_b32 v21, 1, v20
    v_add_u32 v21, s48, v21
    buffer_load_ushort v16, v21, s[4:7], 0 offen
    buffer_load_ushort v17, v21, s[4:7], 0 offen offset:32
    s_waitcnt vmcnt(2)
    s_mov_b32 s47, 0
    v_cmp_gt_u32 vcc, 16, v44
    s_nop 1
    s_cmp_eq_u64 vcc, 0
    s_cbranch_scc1 L_polled_1_10
L_poll_1_9:
    buffer_load_dword v44, v43, s[20:23], 0 offen sc1
    s_waitcnt vmcnt(0)
    v_cmp_gt_u32 vcc, 16, v44
    s_nop 1
    s_cmp_eq_u64 vcc, 0
    s_cbranch_scc1 L_polled_1_10
    s_add_u32 s47, s47, 1
    s_cmp_lt_u32 s47, 262144
    s_cbranch_scc1 L_poll_1_9
L_polled_1_10:
    s_nop 1
    v_lshlrev_b32 v11, 4, v0
    s_lshl_b32 s47, s44, 1
    s_and_b32 s48, s3, 1
    s_add_u32 s47, s47, s48
    s_lshl_b32 s46, s35, 4
    s_lshr_b32 s48, s3, 1
    s_lshl_b32 s48, s48, 3
    s_add_u32 s46, s46, s48
    s_lshl_b32 s46, s46, 5
    s_add_u32 s46, s46, s47
    s_lshl_b32 s46, s46, 10
    s_add_u32 s46, s46, 14680064
    s_mov_b32 s60, 0xbdd2d3e8
    s_mov_b32 s61, 0xbdd2d3e8
    s_mov_b32 s62, 1.0
    s_mov_b32 s63, 1.0
    v_mov_b32 v216, 0xc0135761
    v_mov_b32 v217, 0xc0135761
    s_lshl_b32 s48, s35, 3
    s_lshr_b32 s47, s3, 1
    s_lshl_b32 s47, s47, 2
    s_add_u32 s48, s48, s47
    s_mul_i32 s48, s48, 114688
    s_lshl_b32 s47, s44, 1
    s_and_b32 s49, s3, 1
    s_add_u32 s47, s47, s49
    s_add_u32 s49, s47, 80
    s_lshl_b32 s49, s49, 10
    s_add_u32 s48, s48, s49
    s_add_u32 s48, s48, 7340032
    v_accvgpr_read_b32 v184, a128
    s_lshr_b32 s37, 0x3, s36
    s_and_b32 s37, s37, 0xff
    s_mul_i32 s27, s37, 229376
    s_add_u32 m0, s25, 0
    s_nop 0
    buffer_load_dwordx4 v6, s[20:23], s27 offen sc1 lds
    v_accvgpr_read_b32 v185, a129
    v_accvgpr_read_b32 v186, a130
    v_accvgpr_read_b32 v187, a131
    v_accvgpr_read_b32 v188, a132
    v_accvgpr_read_b32 v189, a133
    v_accvgpr_read_b32 v190, a134
    v_accvgpr_read_b32 v191, a135
    v_accvgpr_read_b32 v192, a136
    v_accvgpr_read_b32 v193, a137
    buffer_load_dwordx4 v6, s[20:23], s27 offen offset:1024 sc1 lds
    v_accvgpr_read_b32 v194, a138
    v_accvgpr_read_b32 v195, a139
    v_accvgpr_read_b32 v196, a140
    v_accvgpr_read_b32 v197, a141
    v_accvgpr_read_b32 v198, a142
    v_accvgpr_read_b32 v199, a143
    v_accvgpr_read_b32 v200, a144
    v_accvgpr_read_b32 v201, a145
    v_accvgpr_read_b32 v202, a146
    v_accvgpr_read_b32 v203, a147
    buffer_load_dwordx4 v6, s[20:23], s27 offen offset:2048 sc1 lds
    v_accvgpr_read_b32 v204, a148
    v_accvgpr_read_b32 v205, a149
    v_accvgpr_read_b32 v206, a150
    v_accvgpr_read_b32 v207, a151
    v_accvgpr_read_b32 v208, a152
    v_accvgpr_read_b32 v209, a153
    v_accvgpr_read_b32 v210, a154
    v_accvgpr_read_b32 v211, a155
    v_accvgpr_read_b32 v212, a156
    v_accvgpr_read_b32 v213, a157
    buffer_load_dwordx4 v15, s[20:23], s27 offen offset:3072 sc1 lds
    v_accvgpr_read_b32 v214, a158
    v_accvgpr_read_b32 v215, a159
    v_pk_mul_f32 v[220:221], v[184:185], v[184:185]
    v_pk_mul_f32 v[222:223], v[186:187], v[186:187]
    v_pk_mul_f32 v[224:225], v[188:189], v[188:189]
    v_pk_mul_f32 v[226:227], v[190:191], v[190:191]
    v_pk_fma_f32 v[220:221], v[220:221], s[60:61], v[216:217]
    v_pk_fma_f32 v[222:223], v[222:223], s[60:61], v[216:217]
    v_pk_fma_f32 v[224:225], v[224:225], s[60:61], v[216:217]
    v_pk_fma_f32 v[226:227], v[226:227], s[60:61], v[216:217]
    s_lshr_b32 s37, 0x1010400, s36
    s_and_b32 s37, s37, 0xff
    s_mul_i32 s27, s37, 229376
    s_add_u32 m0, s25, 16384
    s_nop 0
    buffer_load_dwordx4 v6, s[20:23], s27 offen sc1 lds
    v_pk_mul_f32 v[220:221], v[220:221], v[184:185]
    v_pk_mul_f32 v[222:223], v[222:223], v[186:187]
    v_pk_mul_f32 v[224:225], v[224:225], v[188:189]
    v_pk_mul_f32 v[226:227], v[226:227], v[190:191]
    v_exp_f32 v220, v220
    v_pk_mul_f32 v[228:229], v[192:193], v[192:193]
    v_exp_f32 v221, v221
    v_pk_mul_f32 v[230:231], v[194:195], v[194:195]
    v_pk_mul_f32 v[232:233], v[196:197], v[196:197]
    v_exp_f32 v222, v222
    buffer_load_dwordx4 v6, s[20:23], s27 offen offset:1024 sc1 lds
    v_pk_mul_f32 v[234:235], v[198:199], v[198:199]
    v_exp_f32 v223, v223
    v_pk_fma_f32 v[228:229], v[228:229], s[60:61], v[216:217]
    v_pk_fma_f32 v[230:231], v[230:231], s[60:61], v[216:217]
    v_exp_f32 v224, v224
    v_pk_fma_f32 v[232:233], v[232:233], s[60:61], v[216:217]
    v_exp_f32 v225, v225
    v_pk_fma_f32 v[234:235], v[234:235], s[60:61], v[216:217]
    v_pk_mul_f32 v[228:229], v[228:229], v[192:193]
    v_exp_f32 v226, v226
    buffer_load_dwordx4 v6, s[20:23], s27 offen offset:2048 sc1 lds
    v_pk_mul_f32 v[230:231], v[230:231], v[194:195]
    v_exp_f32 v227, v227
    v_pk_mul_f32 v[232:233], v[232:233], v[196:197]
    v_pk_mul_f32 v[234:235], v[234:235], v[198:199]
    v_exp_f32 v228, v228
    v_pk_add_f32 v[220:221], v[220:221], s[62:63]
    v_exp_f32 v229, v229
    v_pk_add_f32 v[222:223], v[222:223], s[62:63]
    v_exp_f32 v230, v230
    v_pk_add_f32 v[224:225], v[224:225], s[62:63]
    buffer_load_dwordx4 v15, s[20:23], s27 offen offset:3072 sc1 lds
    v_exp_f32 v231, v231
    v_pk_add_f32 v[226:227], v[226:227], s[62:63]
    v_exp_f32 v232, v232
    v_pk_mul_f32 v[236:237], v[200:201], v[200:201]
    v_exp_f32 v233, v233
    v_pk_mul_f32 v[238:239], v[202:203], v[202:203]
    v_exp_f32 v234, v234
    v_pk_mul_f32 v[240:241], v[204:205], v[204:205]
    v_exp_f32 v235, v235
    v_pk_mul_f32 v[242:243], v[206:207], v[206:207]
    s_lshr_b32 s37, 0x2050101, s36
    s_and_b32 s37, s37, 0xff
    s_mul_i32 s27, s37, 229376
    s_add_u32 m0, s25, 32768
    s_nop 0
    buffer_load_dwordx4 v6, s[20:23], s27 offen sc1 lds
    v_rcp_f32 v220, v220
    v_pk_fma_f32 v[236:237], v[236:237], s[60:61], v[216:217]
    v_rcp_f32 v221, v221
    v_pk_fma_f32 v[238:239], v[238:239], s[60:61], v[216:217]
    v_rcp_f32 v222, v222
    v_pk_fma_f32 v[240:241], v[240:241], s[60:61], v[216:217]
    v_rcp_f32 v223, v223
    v_pk_fma_f32 v[242:243], v[242:243], s[60:61], v[216:217]
    v_rcp_f32 v224, v224
    buffer_load_dwordx4 v6, s[20:23], s27 offen offset:1024 sc1 lds
    v_pk_mul_f32 v[236:237], v[236:237], v[200:201]
    v_rcp_f32 v225, v225
    v_pk_mul_f32 v[238:239], v[238:239], v[202:203]
    v_rcp_f32 v226, v226
    v_pk_mul_f32 v[240:241], v[240:241], v[204:205]
    v_rcp_f32 v227, v227
    v_pk_mul_f32 v[242:243], v[242:243], v[206:207]
    v_exp_f32 v236, v236
    v_pk_add_f32 v[228:229], v[228:229], s[62:63]
    v_exp_f32 v237, v237
    buffer_load_dwordx4 v6, s[20:23], s27 offen offset:2048 sc1 lds
    v_pk_add_f32 v[230:231], v[230:231], s[62:63]
    v_exp_f32 v238, v238
    v_pk_add_f32 v[232:233], v[232:233], s[62:63]
    v_exp_f32 v239, v239
    v_pk_add_f32 v[234:235], v[234:235], s[62:63]
    v_pk_mul_f32 v[184:185], v[184:185], v[220:221]
    v_exp_f32 v240, v240
    v_pk_mul_f32 v[186:187], v[186:187], v[222:223]
    v_exp_f32 v241, v241
    v_pk_mul_f32 v[188:189], v[188:189], v[224:225]
    buffer_load_dwordx4 v15, s[20:23], s27 offen offset:3072 sc1 lds
    v_exp_f32 v242, v242
    v_pk_mul_f32 v[190:191], v[190:191], v[226:227]
    v_exp_f32 v243, v243
    v_pk_mul_f32 v[244:245], v[208:209], v[208:209]
    v_pk_mul_f32 v[246:247], v[210:211], v[210:211]
    v_rcp_f32 v228, v228
    v_pk_mul_f32 v[248:249], v[212:213], v[212:213]
    v_rcp_f32 v229, v229
    v_pk_mul_f32 v[250:251], v[214:215], v[214:215]
    v_rcp_f32 v230, v230
    s_lshr_b32 s37, 0x6020202, s36
    s_and_b32 s37, s37, 0xff
    s_mul_i32 s27, s37, 229376
    s_add_u32 m0, s25, 49152
    s_nop 0
    buffer_load_dwordx4 v6, s[20:23], s27 offen sc1 lds
    v_pk_fma_f32 v[244:245], v[244:245], s[60:61], v[216:217]
    v_rcp_f32 v231, v231
    v_pk_fma_f32 v[246:247], v[246:247], s[60:61], v[216:217]
    v_pk_fma_f32 v[248:249], v[248:249], s[60:61], v[216:217]
    v_rcp_f32 v232, v232
    v_pk_fma_f32 v[250:251], v[250:251], s[60:61], v[216:217]
    v_rcp_f32 v233, v233
    v_pk_mul_f32 v[244:245], v[244:245], v[208:209]
    v_rcp_f32 v234, v234
    v_pk_mul_f32 v[246:247], v[246:247], v[210:211]
    buffer_load_dwordx4 v6, s[20:23], s27 offen offset:1024 sc1 lds
    v_rcp_f32 v235, v235
    v_pk_mul_f32 v[248:249], v[248:249], v[212:213]
    v_pk_mul_f32 v[250:251], v[250:251], v[214:215]
    v_exp_f32 v244, v244
    v_exp_f32 v245, v245
    v_pk_add_f32 v[236:237], v[236:237], s[62:63]
    v_exp_f32 v246, v246
    v_exp_f32 v247, v247
    v_pk_add_f32 v[238:239], v[238:239], s[62:63]
    v_exp_f32 v248, v248
    buffer_load_dwordx4 v6, s[20:23], s27 offen offset:2048 sc1 lds
    v_exp_f32 v249, v249
    v_pk_add_f32 v[240:241], v[240:241], s[62:63]
    v_exp_f32 v250, v250
    v_exp_f32 v251, v251
    v_pk_add_f32 v[242:243], v[242:243], s[62:63]
    v_rcp_f32 v236, v236
    v_rcp_f32 v237, v237
    v_pk_mul_f32 v[192:193], v[192:193], v[228:229]
    v_rcp_f32 v238, v238
    v_rcp_f32 v239, v239
    buffer_load_dwordx4 v15, s[20:23], s27 offen offset:3072 sc1 lds
    v_pk_mul_f32 v[194:195], v[194:195], v[230:231]
    v_rcp_f32 v240, v240
    v_rcp_f32 v241, v241
    v_pk_mul_f32 v[196:197], v[196:197], v[232:233]
    v_rcp_f32 v242, v242
    v_rcp_f32 v243, v243
    v_pk_mul_f32 v[198:199], v[198:199], v[234:235]
    v_pk_add_f32 v[244:245], v[244:245], s[62:63]
    v_pk_add_f32 v[246:247], v[246:247], s[62:63]
    v_pk_add_f32 v[248:249], v[248:249], s[62:63]
    v_pk_add_f32 v[250:251], v[250:251], s[62:63]
    v_rcp_f32 v244, v244
    v_rcp_f32 v245, v245
    v_pk_mul_f32 v[200:201], v[200:201], v[236:237]
    v_rcp_f32 v246, v246
    v_rcp_f32 v247, v247
    v_pk_mul_f32 v[202:203], v[202:203], v[238:239]
    v_rcp_f32 v248, v248
    v_rcp_f32 v249, v249
    v_pk_mul_f32 v[204:205], v[204:205], v[240:241]
    v_rcp_f32 v250, v250
    v_rcp_f32 v251, v251
    v_pk_mul_f32 v[206:207], v[206:207], v[242:243]
    v_pk_mul_f32 v[208:209], v[208:209], v[244:245]
    v_pk_mul_f32 v[210:211], v[210:211], v[246:247]
    v_pk_mul_f32 v[212:213], v[212:213], v[248:249]
    v_pk_mul_f32 v[214:215], v[214:215], v[250:251]
    v_cvt_pk_bf16_f32 v184, v184, v185
    v_cvt_pk_bf16_f32 v185, v186, v187
    v_cvt_pk_bf16_f32 v186, v188, v189
    v_cvt_pk_bf16_f32 v187, v190, v191
    v_cvt_pk_bf16_f32 v192, v192, v193
    v_cvt_pk_bf16_f32 v193, v194, v195
    v_cvt_pk_bf16_f32 v194, v196, v197
    v_cvt_pk_bf16_f32 v195, v198, v199
    v_cvt_pk_bf16_f32 v200, v200, v201
    v_cvt_pk_bf16_f32 v201, v202, v203
    v_cvt_pk_bf16_f32 v202, v204, v205
    v_cvt_pk_bf16_f32 v203, v206, v207
    v_cvt_pk_bf16_f32 v208, v208, v209
    v_cvt_pk_bf16_f32 v209, v210, v211
    v_cvt_pk_bf16_f32 v210, v212, v213
    v_cvt_pk_bf16_f32 v211, v214, v215
    v_cvt_pk_bf16_f32 v176, v124, v125
    v_cvt_pk_bf16_f32 v177, v126, v127
    v_cvt_pk_bf16_f32 v178, v48, v49
    v_cvt_pk_bf16_f32 v179, v50, v51
    v_cvt_pk_bf16_f32 v216, v132, v133
    v_cvt_pk_bf16_f32 v217, v134, v135
    v_cvt_pk_bf16_f32 v218, v56, v57
    v_cvt_pk_bf16_f32 v219, v58, v59
    v_cvt_pk_bf16_f32 v224, v140, v141
    v_cvt_pk_bf16_f32 v225, v142, v143
    v_cvt_pk_bf16_f32 v226, v64, v65
    v_cvt_pk_bf16_f32 v227, v66, v67
    v_cvt_pk_bf16_f32 v232, v148, v149
    v_cvt_pk_bf16_f32 v233, v150, v151
    v_cvt_pk_bf16_f32 v234, v72, v73
    v_cvt_pk_bf16_f32 v235, v74, v75
    v_cvt_pk_bf16_f32 v240, v156, v157
    v_cvt_pk_bf16_f32 v241, v158, v159
    v_cvt_pk_bf16_f32 v242, v80, v81
    v_cvt_pk_bf16_f32 v243, v82, v83
    v_cvt_pk_bf16_f32 v248, v164, v165
    v_cvt_pk_bf16_f32 v249, v166, v167
    v_cvt_pk_bf16_f32 v250, v88, v89
    v_cvt_pk_bf16_f32 v251, v90, v91
    v_cvt_pk_bf16_f32 v188, v172, v173
    v_cvt_pk_bf16_f32 v189, v174, v175
    v_cvt_pk_bf16_f32 v190, v96, v97
    v_cvt_pk_bf16_f32 v191, v98, v99
    v_cvt_pk_bf16_f32 v180, v180, v181
    v_cvt_pk_bf16_f32 v181, v182, v183
    v_cvt_pk_bf16_f32 v182, v104, v105
    v_cvt_pk_bf16_f32 v183, v106, v107
    v_accvgpr_read_b32 v112, a160
    v_accvgpr_read_b32 v113, a161
    v_accvgpr_read_b32 v114, a162
    v_accvgpr_read_b32 v115, a163
    v_accvgpr_read_b32 v116, a164
    v_accvgpr_read_b32 v117, a165
    v_accvgpr_read_b32 v118, a166
    v_accvgpr_read_b32 v119, a167
    v_accvgpr_read_b32 v120, a168
    v_accvgpr_read_b32 v121, a169
    v_accvgpr_read_b32 v122, a170
    v_accvgpr_read_b32 v123, a171
    v_accvgpr_read_b32 v124, a172
    v_accvgpr_read_b32 v125, a173
    v_accvgpr_read_b32 v126, a174
    v_accvgpr_read_b32 v127, a175
    v_accvgpr_read_b32 v128, a176
    v_accvgpr_read_b32 v129, a177
    v_accvgpr_read_b32 v130, a178
    v_accvgpr_read_b32 v131, a179
    v_accvgpr_read_b32 v132, a180
    v_accvgpr_read_b32 v133, a181
    v_accvgpr_read_b32 v134, a182
    v_accvgpr_read_b32 v135, a183
    v_accvgpr_read_b32 v136, a184
    v_accvgpr_read_b32 v137, a185
    v_accvgpr_read_b32 v138, a186
    v_accvgpr_read_b32 v139, a187
    v_accvgpr_read_b32 v140, a188
    v_accvgpr_read_b32 v141, a189
    v_accvgpr_read_b32 v142, a190
    v_accvgpr_read_b32 v143, a191
    v_accvgpr_read_b32 v144, a192
    v_accvgpr_read_b32 v145, a193
    v_accvgpr_read_b32 v146, a194
    v_accvgpr_read_b32 v147, a195
    v_accvgpr_read_b32 v148, a196
    v_accvgpr_read_b32 v149, a197
    v_accvgpr_read_b32 v150, a198
    v_accvgpr_read_b32 v151, a199
    v_mov_b32 v152, 0
    v_mov_b32 v153, 0
    v_mov_b32 v154, 0
    v_mov_b32 v155, 0
    v_dot2c_f32_bf16 v152, v112, v144
    v_dot2c_f32_bf16 v153, v120, v144
    v_dot2c_f32_bf16 v154, v128, v144
    v_dot2c_f32_bf16 v155, v136, v144
    v_dot2c_f32_bf16 v152, v113, v145
    v_dot2c_f32_bf16 v153, v121, v145
    v_dot2c_f32_bf16 v154, v129, v145
    v_dot2c_f32_bf16 v155, v137, v145
    v_dot2c_f32_bf16 v152, v114, v146
    v_dot2c_f32_bf16 v153, v122, v146
    v_dot2c_f32_bf16 v154, v130, v146
    v_dot2c_f32_bf16 v155, v138, v146
    v_dot2c_f32_bf16 v152, v115, v147
    v_dot2c_f32_bf16 v153, v123, v147
    v_dot2c_f32_bf16 v154, v131, v147
    v_dot2c_f32_bf16 v155, v139, v147
    v_dot2c_f32_bf16 v152, v116, v148
    v_dot2c_f32_bf16 v153, v124, v148
    v_dot2c_f32_bf16 v154, v132, v148
    v_dot2c_f32_bf16 v155, v140, v148
    v_dot2c_f32_bf16 v152, v117, v149
    v_dot2c_f32_bf16 v153, v125, v149
    v_dot2c_f32_bf16 v154, v133, v149
    v_dot2c_f32_bf16 v155, v141, v149
    v_dot2c_f32_bf16 v152, v118, v150
    v_dot2c_f32_bf16 v153, v126, v150
    v_dot2c_f32_bf16 v154, v134, v150
    v_dot2c_f32_bf16 v155, v142, v150
    v_dot2c_f32_bf16 v152, v119, v151
    v_dot2c_f32_bf16 v153, v127, v151
    v_dot2c_f32_bf16 v154, v135, v151
    v_dot2c_f32_bf16 v155, v143, v151
    s_nop 2
    v_permlane32_swap_b32 v152, v154
    v_permlane32_swap_b32 v153, v155
    v_add_f32 v152, v152, v154
    v_add_f32 v153, v153, v155
    s_nop 1
    v_permlane16_swap_b32 v152, v153
    v_add_f32 v152, v152, v153
    s_nop 1
    v_add_f32_dpp v152, v152, v152 row_ror:8 row_mask:0xf bank_mask:0xf
    s_nop 1
    v_add_f32_dpp v152, v152, v152 row_ror:4 row_mask:0xf bank_mask:0xf
    s_nop 1
    v_add_f32_dpp v152, v152, v152 row_ror:2 row_mask:0xf bank_mask:0xf
    s_nop 1
    v_add_f32_dpp v152, v152, v152 row_ror:1 row_mask:0xf bank_mask:0xf
    v_mul_f32 v152, 0xbfb8aa3b, v152
    v_exp_f32 v152, v152
    s_nop 0
    v_add_f32 v152, 1.0, v152
    v_rcp_f32 v152, v152
    s_lshl_b32 s49, s43, 2
    s_add_u32 s49, s49, 26214400
    v_lshrrev_b32 v156, 2, v0
    v_and_b32 v157, 15, v0
    v_cmp_eq_u32 vcc, 0, v157
    s_nop 1
    s_and_saveexec_b64 s[54:55], vcc
    buffer_store_dword v152, v156, s[20:23], s49 offen sc1
    s_mov_b64 exec, s[54:55]
    v_mov_b32 v12, v11
    s_add_u32 s53, s48, 0
    s_add_u32 s54, s48, 114688
    s_add_u32 s55, s48, 229376
    s_add_u32 s56, s48, 344064
    s_add_u32 s52, s46, 0
    s_add_u32 s57, s46, 32768
    s_add_u32 s58, s46, 65536
    s_add_u32 s59, s46, 98304
    s_add_u32 s47, s46, 131072
    s_add_u32 s49, s46, 163840
    s_add_u32 s44, s46, 196608
    s_add_u32 s43, s46, 229376
    s_branch L_p3
L_z:
    s_mul_i32 s46, s44, 224
    s_and_b32 s46, s46, 0xffffffc0
    s_add_u32 s41, s46, 3584
    s_mul_i32 s53, s44, 160
    s_and_b32 s53, s53, 0xffffffc0
    v_cmp_gt_u32 s[42:43], 64, v25
    v_mul_u32_u24 v23, 7168, v23
    v_add_u32 v25, v25, v23
    v_add_u32 v10, 4096, v25
    v_add_u32 v11, -896, v10
    v_mov_b32 v12, 0x40000000
    v_cndmask_b32 v12, v12, v11, s[42:43]
    s_lshl_b32 s29, s3, 13
    s_lshl_b32 s30, s3, 11
    s_add_u32 s30, s30, 98304
    s_waitcnt lgkmcnt(0)
    s_mov_b32 s8, s64
    s_mov_b32 s9, s65
    s_mov_b32 s10, 0x400000
    s_mov_b32 s11, 0x20000
    s_sub_u32 s12, s72, 4096
    s_subb_u32 s13, s73, 0
    s_mov_b32 s14, 0x701000
    s_mov_b32 s15, 0x20000
    s_mov_b32 s20, s86
    s_mov_b32 s21, s87
    s_mov_b32 s22, 0x1a00000
    s_mov_b32 s23, 0x20000
    s_lshl_b32 s46, s35, 2
    s_add_u32 s46, s46, s3
    s_lshl_b32 s46, s46, 13
    s_add_u32 s58, s46, 26279936
    s_add_u32 s59, s58, 4096
    s_lshl_b32 s55, s44, 9
    s_add_u32 s55, s55, s58
    s_mov_b32 s56, s36
    s_mov_b32 s57, s37
    v_lshlrev_b32 v56, 3, v0
    v_mov_b32 v30, -1
    v_mov_b32 v31, -1
    buffer_store_dwordx2 v[30:31], v56, s[20:23], s55 offen sc1
    s_and_b32 s31, s36, 15
    s_lshr_b64 s[36:37], s[36:37], 4
    s_lshl_b32 s24, s31, 28
    s_or_b32 s37, s37, s24
    s_lshl_b32 s24, s31, 7
    s_add_u32 m0, s29, s27
    s_nop 0
    buffer_load_dwordx4 v2, s[8:11], s24 offen offset:0 lds
    buffer_load_dwordx4 v3, s[8:11], s24 offen offset:1024 lds
    buffer_load_dwordx4 v4, s[8:11], s24 offen offset:2048 lds
    buffer_load_dwordx4 v5, s[8:11], s24 offen offset:3072 lds
    s_add_u32 m0, s29, s27
    s_add_u32 m0, m0, 4096
    s_nop 0
    buffer_load_dwordx4 v6, s[8:11], s24 offen offset:0 lds
    buffer_load_dwordx4 v7, s[8:11], s24 offen offset:1024 lds
    buffer_load_dwordx4 v8, s[8:11], s24 offen offset:2048 lds
    buffer_load_dwordx4 v9, s[8:11], s24 offen offset:3072 lds
    s_add_u32 s27, s27, 32768
    s_cmp_eq_u32 s27, 98304
    s_cselect_b32 s27, 0, s27
    s_mul_i32 s25, s31, 458752
    s_add_u32 s25, s25, s41
    s_add_u32 m0, s30, 0
    s_nop 0
    buffer_load_dwordx4 v10, s[12:15], s25 offen lds
    buffer_load_dwordx4 v11, s[12:15], s25 offen offset:1024 lds
    s_add_u32 s25, s25, 229376
    s_add_u32 m0, s30, 8192
    s_nop 0
    buffer_load_dwordx4 v10, s[12:15], s25 offen lds
    buffer_load_dwordx4 v11, s[12:15], s25 offen offset:1024 lds
    v_and_b32 v20, 15, v0
    v_lshrrev_b32 v21, 4, v0
    v_lshrrev_b32 v22, 1, v20
    v_xor_b32 v22, v22, v21
    v_lshlrev_b32 v22, 4, v22
    v_lshl_add_u32 v22, v20, 7, v22
    s_lshl_b32 s49, s3, 13
    v_add_u32 v14, s49, v22
    v_xor_b32 v15, 64, v14
    v_mov_b32 v16, v14
    v_mov_b32 v17, v15
    v_lshrrev_b32 v20, 2, v0
    v_and_b32 v20, 3, v20
    v_and_b32 v22, 3, v0
    v_lshrrev_b32 v23, 1, v20
    v_and_b32 v24, 1, v21
    v_lshl_or_b32 v23, v24, 1, v23
    v_mul_u32_u24 v25, 2048, v21
    v_lshl_add_u32 v26, v20, 7, v25
    v_lshl_add_u32 v26, v22, 3, v26
    v_add_u32 v26, 98304, v26
    s_and_b32 s49, s44, 1
    s_add_u32 s49, s49, 0
    s_lshr_b32 s50, s49, 2
    s_lshl_b32 s50, s50, 10
    s_and_b32 s49, s49, 3
    v_xor_b32 v30, s49, v23
    v_lshl_add_u32 v18, v30, 5, v26
    v_add_u32 v18, s50, v18
    s_and_b32 s49, s44, 1
    s_add_u32 s49, s49, 1
    s_lshr_b32 s50, s49, 2
    s_lshl_b32 s50, s50, 10
    s_and_b32 s49, s49, 3
    v_xor_b32 v30, s49, v23
    v_lshl_add_u32 v19, v30, 5, v26
    v_add_u32 v19, s50, v19
    s_and_b32 s49, s44, 1
    s_add_u32 s49, s49, 2
    s_lshr_b32 s50, s49, 2
    s_lshl_b32 s50, s50, 10
    s_and_b32 s49, s49, 3
    v_xor_b32 v30, s49, v23
    v_lshl_add_u32 v13, v30, 5, v26
    v_add_u32 v13, s50, v13
    s_and_b32 s49, s44, 1
    s_add_u32 s49, s49, 3
    s_lshr_b32 s50, s49, 2
    s_lshl_b32 s50, s50, 10
    s_and_b32 s49, s49, 3
    v_xor_b32 v30, s49, v23
    v_lshl_add_u32 v58, v30, 5, v26
    v_add_u32 v58, s50, v58
    v_mov_b32 v64, 0
    v_mov_b32 v65, 0
    v_mov_b32 v66, 0
    v_mov_b32 v67, 0
    v_mov_b32 v68, 0
    v_mov_b32 v69, 0
    v_mov_b32 v70, 0
    v_mov_b32 v71, 0
    v_mov_b32 v72, 0
    v_mov_b32 v73, 0
    v_mov_b32 v74, 0
    v_mov_b32 v75, 0
    v_mov_b32 v76, 0
    v_mov_b32 v77, 0
    v_mov_b32 v78, 0
    v_mov_b32 v79, 0
    v_mov_b32 v80, 0
    v_mov_b32 v81, 0
    v_mov_b32 v82, 0
    v_mov_b32 v83, 0
    v_mov_b32 v84, 0
    v_mov_b32 v85, 0
    v_mov_b32 v86, 0
    v_mov_b32 v87, 0
    v_mov_b32 v88, 0
    v_mov_b32 v89, 0
    v_mov_b32 v90, 0
    v_mov_b32 v91, 0
    v_mov_b32 v92, 0
    v_mov_b32 v93, 0
    v_mov_b32 v94, 0
    v_mov_b32 v95, 0
    v_mov_b32 v96, 0
    v_mov_b32 v97, 0
    v_mov_b32 v98, 0
    v_mov_b32 v99, 0
    v_mov_b32 v100, 0
    v_mov_b32 v101, 0
    v_mov_b32 v102, 0
    v_mov_b32 v103, 0
    v_mov_b32 v104, 0
    v_mov_b32 v105, 0
    v_mov_b32 v106, 0
    v_mov_b32 v107, 0
    v_mov_b32 v108, 0
    v_mov_b32 v109, 0
    v_mov_b32 v110, 0
    v_mov_b32 v111, 0
    v_mov_b32 v112, 0
    v_mov_b32 v113, 0
    v_mov_b32 v114, 0
    v_mov_b32 v115, 0
    v_mov_b32 v116, 0
    v_mov_b32 v117, 0
    v_mov_b32 v118, 0
    v_mov_b32 v119, 0
    v_mov_b32 v120, 0
    v_mov_b32 v121, 0
    v_mov_b32 v122, 0
    v_mov_b32 v123, 0
    v_mov_b32 v124, 0
    v_mov_b32 v125, 0
    v_mov_b32 v126, 0
    v_mov_b32 v127, 0
    v_mov_b32 v128, 0
    v_mov_b32 v129, 0
    v_mov_b32 v130, 0
    v_mov_b32 v131, 0
    v_mov_b32 v132, 0
    v_mov_b32 v133, 0
    v_mov_b32 v134, 0
    v_mov_b32 v135, 0
    v_mov_b32 v136, 0
    v_mov_b32 v137, 0
    v_mov_b32 v138, 0
    v_mov_b32 v139, 0
    v_mov_b32 v140, 0
    v_mov_b32 v141, 0
    v_mov_b32 v142, 0
    v_mov_b32 v143, 0
    v_mov_b32 v144, 0
    v_mov_b32 v145, 0
    v_mov_b32 v146, 0
    v_mov_b32 v147, 0
    v_mov_b32 v148, 0
    v_mov_b32 v149, 0
    v_mov_b32 v150, 0
    v_mov_b32 v151, 0
    v_mov_b32 v152, 0
    v_mov_b32 v153, 0
    v_mov_b32 v154, 0
    v_mov_b32 v155, 0
    v_mov_b32 v156, 0
    v_mov_b32 v157, 0
    v_mov_b32 v158, 0
    v_mov_b32 v159, 0
    v_mov_b32 v160, 0
    v_mov_b32 v161, 0
    v_mov_b32 v162, 0
    v_mov_b32 v163, 0
    v_mov_b32 v164, 0
    v_mov_b32 v165, 0
    v_mov_b32 v166, 0
    v_mov_b32 v167, 0
    v_mov_b32 v168, 0
    v_mov_b32 v169, 0
    v_mov_b32 v170, 0
    v_mov_b32 v171, 0
    v_mov_b32 v172, 0
    v_mov_b32 v173, 0
    v_mov_b32 v174, 0
    v_mov_b32 v175, 0
    s_lshr_b32 s46, s2, 3
    s_lshl_b32 s46, s46, 2
    s_add_u32 s46, s46, s3
    s_lshl_b32 s46, s46, 10
    s_getpc_b64 s[4:5]
L_pc_1_11:
    s_sub_u32 s4, s4, L_pc_1_11-gated_mix__sliding_local_dilated__mixer_gmlp__prompt_kernel
    s_subb_u32 s5, s5, 0
    s_mov_b32 s6, L_codeend-gated_mix__sliding_local_dilated__mixer_gmlp__prompt_kernel
    s_mov_b32 s7, 0x20000
    v_lshlrev_b32 v62, 7, v0
    s_mov_b64 exec, 0xff
    buffer_load_dword v62, v62, s[4:7], s46 offen
    s_mov_b64 exec, -1
    v_lshlrev_b32 v57, 4, v0
    v_and_b32 v20, 3, v0
    v_bfe_u32 v21, v0, 2, 1
    v_lshl_or_b32 v20, v21, 3, v20
    v_bfe_u32 v21, v0, 3, 1
    v_lshl_or_b32 v20, v21, 2, v20
    v_bfe_u32 v21, v0, 4, 1
    v_lshl_or_b32 v20, v21, 4, v20
    v_lshlrev_b32 v20, 5, v20
    v_lshrrev_b32 v21, 5, v0
    v_lshl_or_b32 v1, v21, 4, v20
    s_and_b32 s31, s36, 15
    s_lshr_b64 s[36:37], s[36:37], 4
    s_lshl_b32 s24, s31, 28
    s_or_b32 s37, s37, s24
    s_lshl_b32 s24, s31, 7
    s_add_u32 m0, s29, s27
    s_nop 0
    buffer_load_dwordx4 v2, s[8:11], s24 offen offset:0 lds
    buffer_load_dwordx4 v3, s[8:11], s24 offen offset:1024 lds
    buffer_load_dwordx4 v4, s[8:11], s24 offen offset:2048 lds
    buffer_load_dwordx4 v5, s[8:11], s24 offen offset:3072 lds
    s_mul_i32 s25, s31, 458752
    s_add_u32 s25, s25, s41
    s_add_u32 m0, s30, 16384
    s_nop 0
    buffer_load_dwordx4 v10, s[12:15], s25 offen lds
    buffer_load_dwordx4 v11, s[12:15], s25 offen offset:1024 lds
    s_add_u32 m0, s29, s27
    s_add_u32 m0, m0, 4096
    s_nop 0
    buffer_load_dwordx4 v6, s[8:11], s24 offen offset:0 lds
    buffer_load_dwordx4 v7, s[8:11], s24 offen offset:1024 lds
    buffer_load_dwordx4 v8, s[8:11], s24 offen offset:2048 lds
    buffer_load_dwordx4 v9, s[8:11], s24 offen offset:3072 lds
    s_add_u32 s27, s27, 32768
    s_cmp_eq_u32 s27, 98304
    s_cselect_b32 s27, 0, s27
    s_add_u32 s25, s25, 229376
    s_add_u32 m0, s30, 24576
    s_nop 0
    buffer_load_dwordx4 v10, s[12:15], s25 offen lds
    buffer_load_dwordx4 v11, s[12:15], s25 offen offset:1024 lds
    s_and_b32 s31, s36, 15
    s_lshr_b64 s[36:37], s[36:37], 4
    s_lshl_b32 s24, s31, 28
    s_or_b32 s37, s37, s24
    s_lshl_b32 s24, s31, 7
    s_add_u32 m0, s29, s27
    s_nop 0
    buffer_load_dwordx4 v2, s[8:11], s24 offen offset:0 lds
    buffer_load_dwordx4 v3, s[8:11], s24 offen offset:1024 lds
    buffer_load_dwordx4 v4, s[8:11], s24 offen offset:2048 lds
    buffer_load_dwordx4 v5, s[8:11], s24 offen offset:3072 lds
    s_mul_i32 s25, s31, 458752
    s_add_u32 s25, s25, s41
    s_add_u32 m0, s30, 32768
    s_nop 0
    buffer_load_dwordx4 v10, s[12:15], s25 offen lds
    buffer_load_dwordx4 v11, s[12:15], s25 offen offset:1024 lds
    s_waitcnt vmcnt(18)
    s_barrier
    s_cmp_lg_u32 s3, 0
    s_cbranch_scc1 L_an_1_12
    s_mov_b32 s4, s84
    s_mov_b32 s5, s85
    s_mov_b32 s6, 0x100
    s_mov_b32 s7, 0x20000
    v_mov_b32 v30, 0
    v_mov_b32 v31, 1
    s_mov_b64 exec, 1
    buffer_atomic_add v31, v30, s[4:7], 0 offen
    s_mov_b64 exec, -1
L_an_1_12:
    s_nop 1
    ds_read_b128 a[0:3], v16 offset:0
    ds_read_b128 a[4:7], v16 offset:2048
    ds_read_b128 a[8:11], v16 offset:4096
    ds_read_b128 a[12:15], v16 offset:6144
    ds_read_b64_tr_b16 a[16:17], v18 offset:0
    ds_read_b64_tr_b16 a[18:19], v18 offset:512
    ds_read_b64_tr_b16 a[20:21], v19 offset:0
    ds_read_b64_tr_b16 a[22:23], v19 offset:512
    ds_read_b64_tr_b16 a[24:25], v13 offset:0
    ds_read_b64_tr_b16 a[26:27], v13 offset:512
    ds_read_b64_tr_b16 a[28:29], v58 offset:0
    ds_read_b64_tr_b16 a[30:31], v58 offset:512
    ds_read_b64_tr_b16 a[32:33], v18 offset:1024
    ds_read_b64_tr_b16 a[34:35], v18 offset:1536
    ds_read_b64_tr_b16 a[36:37], v19 offset:1024
    ds_read_b64_tr_b16 a[38:39], v19 offset:1536
    ds_read_b64_tr_b16 a[40:41], v13 offset:1024
    ds_read_b64_tr_b16 a[42:43], v13 offset:1536
    s_mov_b32 s34, 0
    s_nop 1
L_loop_1_13:
    s_waitcnt lgkmcnt(0)
    v_mfma_f32_16x16x32_bf16 v[64:67], a[16:19], a[0:3], v[64:67]
    ds_read_b128 a[64:67], v17 offset:0
    v_mfma_f32_16x16x32_bf16 v[68:71], a[16:19], a[4:7], v[68:71]
    ds_read_b128 a[68:71], v17 offset:2048
    s_add_u32 m0, s29, s27
    v_mfma_f32_16x16x32_bf16 v[72:75], a[16:19], a[8:11], v[72:75]
    s_add_u32 m0, m0, 4096
    s_nop 0
    buffer_load_dwordx4 v6, s[8:11], s24 offen offset:0 lds
    v_mfma_f32_16x16x32_bf16 v[76:79], a[16:19], a[12:15], v[76:79]
    ds_read_b128 a[72:75], v17 offset:4096
    ds_read_b128 a[76:79], v17 offset:6144
    v_mfma_f32_16x16x32_bf16 v[92:95], a[20:23], a[12:15], v[92:95]
    ds_read_b64_tr_b16 a[80:81], v18 offset:8192
    v_mfma_f32_16x16x32_bf16 v[88:91], a[20:23], a[8:11], v[88:91]
    v_mfma_f32_16x16x32_bf16 v[84:87], a[20:23], a[4:7], v[84:87]
    ds_read_b64_tr_b16 a[82:83], v18 offset:8704
    buffer_load_dwordx4 v7, s[8:11], s24 offen offset:1024 lds
    v_mfma_f32_16x16x32_bf16 v[80:83], a[20:23], a[0:3], v[80:83]
    ds_read_b64_tr_b16 a[84:85], v19 offset:8192
    v_mfma_f32_16x16x32_bf16 v[96:99], a[24:27], a[0:3], v[96:99]
    ds_read_b64_tr_b16 a[86:87], v19 offset:8704
    v_mfma_f32_16x16x32_bf16 v[100:103], a[24:27], a[4:7], v[100:103]
    ds_read_b64_tr_b16 a[88:89], v13 offset:8192
    v_mfma_f32_16x16x32_bf16 v[104:107], a[24:27], a[8:11], v[104:107]
    v_mfma_f32_16x16x32_bf16 v[108:111], a[24:27], a[12:15], v[108:111]
    ds_read_b64_tr_b16 a[90:91], v13 offset:8704
    buffer_load_dwordx4 v8, s[8:11], s24 offen offset:2048 lds
    v_mfma_f32_16x16x32_bf16 v[124:127], a[28:31], a[12:15], v[124:127]
    ds_read_b64_tr_b16 a[92:93], v58 offset:8192
    v_mfma_f32_16x16x32_bf16 v[120:123], a[28:31], a[8:11], v[120:123]
    ds_read_b64_tr_b16 a[94:95], v58 offset:8704
    v_mfma_f32_16x16x32_bf16 v[116:119], a[28:31], a[4:7], v[116:119]
    ds_read_b64_tr_b16 a[96:97], v18 offset:9216
    v_mfma_f32_16x16x32_bf16 v[112:115], a[28:31], a[0:3], v[112:115]
    buffer_load_dwordx4 v9, s[8:11], s24 offen offset:3072 lds
    ds_read_b64_tr_b16 a[98:99], v18 offset:9728
    v_mfma_f32_16x16x32_bf16 v[128:131], a[32:35], a[0:3], v[128:131]
    v_mfma_f32_16x16x32_bf16 v[132:135], a[32:35], a[4:7], v[132:135]
    ds_read_b64_tr_b16 a[100:101], v19 offset:9216
    v_mfma_f32_16x16x32_bf16 v[136:139], a[32:35], a[8:11], v[136:139]
    s_add_u32 s27, s27, 32768
    ds_read_b64_tr_b16 a[102:103], v19 offset:9728
    v_mfma_f32_16x16x32_bf16 v[140:143], a[32:35], a[12:15], v[140:143]
    s_cmp_eq_u32 s27, 98304
    s_cselect_b32 s27, 0, s27
    v_mfma_f32_16x16x32_bf16 v[156:159], a[36:39], a[12:15], v[156:159]
    s_add_u32 s25, s25, 229376
    ds_read_b64_tr_b16 a[104:105], v13 offset:9216
    v_mfma_f32_16x16x32_bf16 v[152:155], a[36:39], a[8:11], v[152:155]
    s_add_u32 m0, s30, 40960
    s_nop 0
    buffer_load_dwordx4 v10, s[12:15], s25 offen lds
    v_mfma_f32_16x16x32_bf16 v[148:151], a[36:39], a[4:7], v[148:151]
    ds_read_b64_tr_b16 a[106:107], v13 offset:9728
    v_mfma_f32_16x16x32_bf16 v[144:147], a[36:39], a[0:3], v[144:147]
    v_mfma_f32_16x16x32_bf16 v[160:163], a[40:43], a[0:3], v[160:163]
    buffer_load_dwordx4 v11, s[12:15], s25 offen offset:1024 lds
    v_mfma_f32_16x16x32_bf16 v[164:167], a[40:43], a[4:7], v[164:167]
    v_mfma_f32_16x16x32_bf16 v[168:171], a[40:43], a[8:11], v[168:171]
    v_mfma_f32_16x16x32_bf16 v[172:175], a[40:43], a[12:15], v[172:175]
    s_waitcnt lgkmcnt(0)
    v_mfma_f32_16x16x32_bf16 v[64:67], a[80:83], a[64:67], v[64:67]
    s_waitcnt vmcnt(12)
    s_barrier
    v_mfma_f32_16x16x32_bf16 v[68:71], a[80:83], a[68:71], v[68:71]
    s_add_u32 s28, s28, 32768
    s_and_b32 s31, s36, 15
    v_mfma_f32_16x16x32_bf16 v[72:75], a[80:83], a[72:75], v[72:75]
    s_lshr_b64 s[36:37], s[36:37], 4
    s_lshl_b32 s24, s31, 28
    v_mfma_f32_16x16x32_bf16 v[76:79], a[80:83], a[76:79], v[76:79]
    s_or_b32 s37, s37, s24
    s_lshl_b32 s24, s31, 7
    v_mfma_f32_16x16x32_bf16 v[92:95], a[84:87], a[76:79], v[92:95]
    s_cmp_eq_u32 s28, 98304
    s_cselect_b32 s28, 0, s28
    v_mfma_f32_16x16x32_bf16 v[88:91], a[84:87], a[72:75], v[88:91]
    s_add_u32 m0, s29, s27
    v_add_u32 v16, s28, v14
    v_mfma_f32_16x16x32_bf16 v[84:87], a[84:87], a[68:71], v[84:87]
    buffer_load_dwordx4 v2, s[8:11], s24 offen offset:0 lds
    ds_read_b64_tr_b16 a[16:17], v18 offset:16384
    v_mfma_f32_16x16x32_bf16 v[80:83], a[84:87], a[64:67], v[80:83]
    ds_read_b64_tr_b16 a[18:19], v18 offset:16896
    ds_read_b64_tr_b16 a[20:21], v19 offset:16384
    v_mfma_f32_16x16x32_bf16 v[96:99], a[88:91], a[64:67], v[96:99]
    ds_read_b64_tr_b16 a[22:23], v19 offset:16896
    buffer_load_dwordx4 v3, s[8:11], s24 offen offset:1024 lds
    v_mfma_f32_16x16x32_bf16 v[100:103], a[88:91], a[68:71], v[100:103]
    ds_read_b64_tr_b16 a[24:25], v13 offset:16384
    ds_read_b64_tr_b16 a[26:27], v13 offset:16896
    v_mfma_f32_16x16x32_bf16 v[104:107], a[88:91], a[72:75], v[104:107]
    ds_read_b64_tr_b16 a[28:29], v58 offset:16384
    ds_read_b64_tr_b16 a[30:31], v58 offset:16896
    v_mfma_f32_16x16x32_bf16 v[108:111], a[88:91], a[76:79], v[108:111]
    ds_read_b64_tr_b16 a[32:33], v18 offset:17408
    buffer_load_dwordx4 v4, s[8:11], s24 offen offset:2048 lds
    v_mfma_f32_16x16x32_bf16 v[124:127], a[92:95], a[76:79], v[124:127]
    ds_read_b64_tr_b16 a[34:35], v18 offset:17920
    v_mfma_f32_16x16x32_bf16 v[120:123], a[92:95], a[72:75], v[120:123]
    ds_read_b64_tr_b16 a[36:37], v19 offset:17408
    v_mfma_f32_16x16x32_bf16 v[116:119], a[92:95], a[68:71], v[116:119]
    ds_read_b64_tr_b16 a[38:39], v19 offset:17920
    v_mfma_f32_16x16x32_bf16 v[112:115], a[92:95], a[64:67], v[112:115]
    ds_read_b64_tr_b16 a[40:41], v13 offset:17408
    v_mfma_f32_16x16x32_bf16 v[128:131], a[96:99], a[64:67], v[128:131]
    buffer_load_dwordx4 v5, s[8:11], s24 offen offset:3072 lds
    ds_read_b64_tr_b16 a[42:43], v13 offset:17920
    v_mfma_f32_16x16x32_bf16 v[132:135], a[96:99], a[68:71], v[132:135]
    v_add_u32 v17, s28, v15
    v_mfma_f32_16x16x32_bf16 v[136:139], a[96:99], a[72:75], v[136:139]
    ds_read_b128 a[0:3], v16 offset:0
    v_mfma_f32_16x16x32_bf16 v[140:143], a[96:99], a[76:79], v[140:143]
    s_mul_i32 s25, s31, 458752
    ds_read_b128 a[4:7], v16 offset:2048
    v_mfma_f32_16x16x32_bf16 v[156:159], a[100:103], a[76:79], v[156:159]
    s_add_u32 s25, s25, s41
    s_add_u32 m0, s30, 0
    v_mfma_f32_16x16x32_bf16 v[152:155], a[100:103], a[72:75], v[152:155]
    ds_read_b128 a[8:11], v16 offset:4096
    buffer_load_dwordx4 v10, s[12:15], s25 offen lds
    v_mfma_f32_16x16x32_bf16 v[148:151], a[100:103], a[68:71], v[148:151]
    ds_read_b128 a[12:15], v16 offset:6144
    v_mfma_f32_16x16x32_bf16 v[144:147], a[100:103], a[64:67], v[144:147]
    v_mfma_f32_16x16x32_bf16 v[160:163], a[104:107], a[64:67], v[160:163]
    buffer_load_dwordx4 v11, s[12:15], s25 offen offset:1024 lds
    v_mfma_f32_16x16x32_bf16 v[164:167], a[104:107], a[68:71], v[164:167]
    v_mfma_f32_16x16x32_bf16 v[168:171], a[104:107], a[72:75], v[168:171]
    v_mfma_f32_16x16x32_bf16 v[172:175], a[104:107], a[76:79], v[172:175]
    s_waitcnt lgkmcnt(0)
    v_mfma_f32_16x16x32_bf16 v[64:67], a[16:19], a[0:3], v[64:67]
    ds_read_b128 a[64:67], v17 offset:0
    v_mfma_f32_16x16x32_bf16 v[68:71], a[16:19], a[4:7], v[68:71]
    ds_read_b128 a[68:71], v17 offset:2048
    s_add_u32 m0, s29, s27
    v_mfma_f32_16x16x32_bf16 v[72:75], a[16:19], a[8:11], v[72:75]
    s_add_u32 m0, m0, 4096
    s_nop 0
    buffer_load_dwordx4 v6, s[8:11], s24 offen offset:0 lds
    v_mfma_f32_16x16x32_bf16 v[76:79], a[16:19], a[12:15], v[76:79]
    ds_read_b128 a[72:75], v17 offset:4096
    ds_read_b128 a[76:79], v17 offset:6144
    v_mfma_f32_16x16x32_bf16 v[92:95], a[20:23], a[12:15], v[92:95]
    ds_read_b64_tr_b16 a[80:81], v18 offset:24576
    v_mfma_f32_16x16x32_bf16 v[88:91], a[20:23], a[8:11], v[88:91]
    v_mfma_f32_16x16x32_bf16 v[84:87], a[20:23], a[4:7], v[84:87]
    ds_read_b64_tr_b16 a[82:83], v18 offset:25088
    buffer_load_dwordx4 v7, s[8:11], s24 offen offset:1024 lds
    v_mfma_f32_16x16x32_bf16 v[80:83], a[20:23], a[0:3], v[80:83]
    ds_read_b64_tr_b16 a[84:85], v19 offset:24576
    v_mfma_f32_16x16x32_bf16 v[96:99], a[24:27], a[0:3], v[96:99]
    ds_read_b64_tr_b16 a[86:87], v19 offset:25088
    v_mfma_f32_16x16x32_bf16 v[100:103], a[24:27], a[4:7], v[100:103]
    ds_read_b64_tr_b16 a[88:89], v13 offset:24576
    v_mfma_f32_16x16x32_bf16 v[104:107], a[24:27], a[8:11], v[104:107]
    v_mfma_f32_16x16x32_bf16 v[108:111], a[24:27], a[12:15], v[108:111]
    ds_read_b64_tr_b16 a[90:91], v13 offset:25088
    buffer_load_dwordx4 v8, s[8:11], s24 offen offset:2048 lds
    v_mfma_f32_16x16x32_bf16 v[124:127], a[28:31], a[12:15], v[124:127]
    ds_read_b64_tr_b16 a[92:93], v58 offset:24576
    v_mfma_f32_16x16x32_bf16 v[120:123], a[28:31], a[8:11], v[120:123]
    ds_read_b64_tr_b16 a[94:95], v58 offset:25088
    v_mfma_f32_16x16x32_bf16 v[116:119], a[28:31], a[4:7], v[116:119]
    ds_read_b64_tr_b16 a[96:97], v18 offset:25600
    v_mfma_f32_16x16x32_bf16 v[112:115], a[28:31], a[0:3], v[112:115]
    buffer_load_dwordx4 v9, s[8:11], s24 offen offset:3072 lds
    ds_read_b64_tr_b16 a[98:99], v18 offset:26112
    v_mfma_f32_16x16x32_bf16 v[128:131], a[32:35], a[0:3], v[128:131]
    v_mfma_f32_16x16x32_bf16 v[132:135], a[32:35], a[4:7], v[132:135]
    ds_read_b64_tr_b16 a[100:101], v19 offset:25600
    v_mfma_f32_16x16x32_bf16 v[136:139], a[32:35], a[8:11], v[136:139]
    s_add_u32 s27, s27, 32768
    ds_read_b64_tr_b16 a[102:103], v19 offset:26112
    v_mfma_f32_16x16x32_bf16 v[140:143], a[32:35], a[12:15], v[140:143]
    s_cmp_eq_u32 s27, 98304
    s_cselect_b32 s27, 0, s27
    v_mfma_f32_16x16x32_bf16 v[156:159], a[36:39], a[12:15], v[156:159]
    s_add_u32 s25, s25, 229376
    ds_read_b64_tr_b16 a[104:105], v13 offset:25600
    v_mfma_f32_16x16x32_bf16 v[152:155], a[36:39], a[8:11], v[152:155]
    s_add_u32 m0, s30, 8192
    s_nop 0
    buffer_load_dwordx4 v10, s[12:15], s25 offen lds
    v_mfma_f32_16x16x32_bf16 v[148:151], a[36:39], a[4:7], v[148:151]
    ds_read_b64_tr_b16 a[106:107], v13 offset:26112
    v_mfma_f32_16x16x32_bf16 v[144:147], a[36:39], a[0:3], v[144:147]
    v_mfma_f32_16x16x32_bf16 v[160:163], a[40:43], a[0:3], v[160:163]
    buffer_load_dwordx4 v11, s[12:15], s25 offen offset:1024 lds
    v_mfma_f32_16x16x32_bf16 v[164:167], a[40:43], a[4:7], v[164:167]
    v_mfma_f32_16x16x32_bf16 v[168:171], a[40:43], a[8:11], v[168:171]
    v_mfma_f32_16x16x32_bf16 v[172:175], a[40:43], a[12:15], v[172:175]
    s_waitcnt lgkmcnt(0)
    v_mfma_f32_16x16x32_bf16 v[64:67], a[80:83], a[64:67], v[64:67]
    s_waitcnt vmcnt(12)
    s_barrier
    v_mfma_f32_16x16x32_bf16 v[68:71], a[80:83], a[68:71], v[68:71]
    s_add_u32 s28, s28, 32768
    s_and_b32 s31, s36, 15
    v_mfma_f32_16x16x32_bf16 v[72:75], a[80:83], a[72:75], v[72:75]
    s_lshr_b64 s[36:37], s[36:37], 4
    s_lshl_b32 s24, s31, 28
    v_mfma_f32_16x16x32_bf16 v[76:79], a[80:83], a[76:79], v[76:79]
    s_or_b32 s37, s37, s24
    s_lshl_b32 s24, s31, 7
    v_mfma_f32_16x16x32_bf16 v[92:95], a[84:87], a[76:79], v[92:95]
    s_cmp_eq_u32 s28, 98304
    s_cselect_b32 s28, 0, s28
    v_mfma_f32_16x16x32_bf16 v[88:91], a[84:87], a[72:75], v[88:91]
    s_add_u32 m0, s29, s27
    v_add_u32 v16, s28, v14
    v_mfma_f32_16x16x32_bf16 v[84:87], a[84:87], a[68:71], v[84:87]
    buffer_load_dwordx4 v2, s[8:11], s24 offen offset:0 lds
    ds_read_b64_tr_b16 a[16:17], v18 offset:32768
    v_mfma_f32_16x16x32_bf16 v[80:83], a[84:87], a[64:67], v[80:83]
    ds_read_b64_tr_b16 a[18:19], v18 offset:33280
    ds_read_b64_tr_b16 a[20:21], v19 offset:32768
    v_mfma_f32_16x16x32_bf16 v[96:99], a[88:91], a[64:67], v[96:99]
    ds_read_b64_tr_b16 a[22:23], v19 offset:33280
    buffer_load_dwordx4 v3, s[8:11], s24 offen offset:1024 lds
    v_mfma_f32_16x16x32_bf16 v[100:103], a[88:91], a[68:71], v[100:103]
    ds_read_b64_tr_b16 a[24:25], v13 offset:32768
    ds_read_b64_tr_b16 a[26:27], v13 offset:33280
    v_mfma_f32_16x16x32_bf16 v[104:107], a[88:91], a[72:75], v[104:107]
    ds_read_b64_tr_b16 a[28:29], v58 offset:32768
    ds_read_b64_tr_b16 a[30:31], v58 offset:33280
    v_mfma_f32_16x16x32_bf16 v[108:111], a[88:91], a[76:79], v[108:111]
    ds_read_b64_tr_b16 a[32:33], v18 offset:33792
    buffer_load_dwordx4 v4, s[8:11], s24 offen offset:2048 lds
    v_mfma_f32_16x16x32_bf16 v[124:127], a[92:95], a[76:79], v[124:127]
    ds_read_b64_tr_b16 a[34:35], v18 offset:34304
    v_mfma_f32_16x16x32_bf16 v[120:123], a[92:95], a[72:75], v[120:123]
    ds_read_b64_tr_b16 a[36:37], v19 offset:33792
    v_mfma_f32_16x16x32_bf16 v[116:119], a[92:95], a[68:71], v[116:119]
    ds_read_b64_tr_b16 a[38:39], v19 offset:34304
    v_mfma_f32_16x16x32_bf16 v[112:115], a[92:95], a[64:67], v[112:115]
    ds_read_b64_tr_b16 a[40:41], v13 offset:33792
    v_mfma_f32_16x16x32_bf16 v[128:131], a[96:99], a[64:67], v[128:131]
    buffer_load_dwordx4 v5, s[8:11], s24 offen offset:3072 lds
    ds_read_b64_tr_b16 a[42:43], v13 offset:34304
    v_mfma_f32_16x16x32_bf16 v[132:135], a[96:99], a[68:71], v[132:135]
    v_add_u32 v17, s28, v15
    v_mfma_f32_16x16x32_bf16 v[136:139], a[96:99], a[72:75], v[136:139]
    ds_read_b128 a[0:3], v16 offset:0
    v_mfma_f32_16x16x32_bf16 v[140:143], a[96:99], a[76:79], v[140:143]
    s_mul_i32 s25, s31, 458752
    ds_read_b128 a[4:7], v16 offset:2048
    v_mfma_f32_16x16x32_bf16 v[156:159], a[100:103], a[76:79], v[156:159]
    s_add_u32 s25, s25, s41
    s_add_u32 m0, s30, 16384
    v_mfma_f32_16x16x32_bf16 v[152:155], a[100:103], a[72:75], v[152:155]
    ds_read_b128 a[8:11], v16 offset:4096
    buffer_load_dwordx4 v10, s[12:15], s25 offen lds
    v_mfma_f32_16x16x32_bf16 v[148:151], a[100:103], a[68:71], v[148:151]
    ds_read_b128 a[12:15], v16 offset:6144
    v_mfma_f32_16x16x32_bf16 v[144:147], a[100:103], a[64:67], v[144:147]
    v_mfma_f32_16x16x32_bf16 v[160:163], a[104:107], a[64:67], v[160:163]
    buffer_load_dwordx4 v11, s[12:15], s25 offen offset:1024 lds
    v_mfma_f32_16x16x32_bf16 v[164:167], a[104:107], a[68:71], v[164:167]
    v_mfma_f32_16x16x32_bf16 v[168:171], a[104:107], a[72:75], v[168:171]
    v_mfma_f32_16x16x32_bf16 v[172:175], a[104:107], a[76:79], v[172:175]
    s_waitcnt lgkmcnt(0)
    v_mfma_f32_16x16x32_bf16 v[64:67], a[16:19], a[0:3], v[64:67]
    ds_read_b128 a[64:67], v17 offset:0
    v_mfma_f32_16x16x32_bf16 v[68:71], a[16:19], a[4:7], v[68:71]
    ds_read_b128 a[68:71], v17 offset:2048
    s_add_u32 m0, s29, s27
    v_mfma_f32_16x16x32_bf16 v[72:75], a[16:19], a[8:11], v[72:75]
    s_add_u32 m0, m0, 4096
    s_nop 0
    buffer_load_dwordx4 v6, s[8:11], s24 offen offset:0 lds
    v_mfma_f32_16x16x32_bf16 v[76:79], a[16:19], a[12:15], v[76:79]
    ds_read_b128 a[72:75], v17 offset:4096
    ds_read_b128 a[76:79], v17 offset:6144
    v_mfma_f32_16x16x32_bf16 v[92:95], a[20:23], a[12:15], v[92:95]
    ds_read_b64_tr_b16 a[80:81], v18 offset:40960
    v_mfma_f32_16x16x32_bf16 v[88:91], a[20:23], a[8:11], v[88:91]
    v_mfma_f32_16x16x32_bf16 v[84:87], a[20:23], a[4:7], v[84:87]
    ds_read_b64_tr_b16 a[82:83], v18 offset:41472
    buffer_load_dwordx4 v7, s[8:11], s24 offen offset:1024 lds
    v_mfma_f32_16x16x32_bf16 v[80:83], a[20:23], a[0:3], v[80:83]
    ds_read_b64_tr_b16 a[84:85], v19 offset:40960
    v_mfma_f32_16x16x32_bf16 v[96:99], a[24:27], a[0:3], v[96:99]
    ds_read_b64_tr_b16 a[86:87], v19 offset:41472
    v_mfma_f32_16x16x32_bf16 v[100:103], a[24:27], a[4:7], v[100:103]
    ds_read_b64_tr_b16 a[88:89], v13 offset:40960
    v_mfma_f32_16x16x32_bf16 v[104:107], a[24:27], a[8:11], v[104:107]
    v_mfma_f32_16x16x32_bf16 v[108:111], a[24:27], a[12:15], v[108:111]
    ds_read_b64_tr_b16 a[90:91], v13 offset:41472
    buffer_load_dwordx4 v8, s[8:11], s24 offen offset:2048 lds
    v_mfma_f32_16x16x32_bf16 v[124:127], a[28:31], a[12:15], v[124:127]
    ds_read_b64_tr_b16 a[92:93], v58 offset:40960
    v_mfma_f32_16x16x32_bf16 v[120:123], a[28:31], a[8:11], v[120:123]
    ds_read_b64_tr_b16 a[94:95], v58 offset:41472
    v_mfma_f32_16x16x32_bf16 v[116:119], a[28:31], a[4:7], v[116:119]
    ds_read_b64_tr_b16 a[96:97], v18 offset:41984
    v_mfma_f32_16x16x32_bf16 v[112:115], a[28:31], a[0:3], v[112:115]
    buffer_load_dwordx4 v9, s[8:11], s24 offen offset:3072 lds
    ds_read_b64_tr_b16 a[98:99], v18 offset:42496
    v_mfma_f32_16x16x32_bf16 v[128:131], a[32:35], a[0:3], v[128:131]
    v_mfma_f32_16x16x32_bf16 v[132:135], a[32:35], a[4:7], v[132:135]
    ds_read_b64_tr_b16 a[100:101], v19 offset:41984
    v_mfma_f32_16x16x32_bf16 v[136:139], a[32:35], a[8:11], v[136:139]
    s_add_u32 s27, s27, 32768
    ds_read_b64_tr_b16 a[102:103], v19 offset:42496
    v_mfma_f32_16x16x32_bf16 v[140:143], a[32:35], a[12:15], v[140:143]
    s_cmp_eq_u32 s27, 98304
    s_cselect_b32 s27, 0, s27
    v_mfma_f32_16x16x32_bf16 v[156:159], a[36:39], a[12:15], v[156:159]
    s_add_u32 s25, s25, 229376
    ds_read_b64_tr_b16 a[104:105], v13 offset:41984
    v_mfma_f32_16x16x32_bf16 v[152:155], a[36:39], a[8:11], v[152:155]
    s_add_u32 m0, s30, 24576
    s_nop 0
    buffer_load_dwordx4 v10, s[12:15], s25 offen lds
    v_mfma_f32_16x16x32_bf16 v[148:151], a[36:39], a[4:7], v[148:151]
    ds_read_b64_tr_b16 a[106:107], v13 offset:42496
    v_mfma_f32_16x16x32_bf16 v[144:147], a[36:39], a[0:3], v[144:147]
    v_mfma_f32_16x16x32_bf16 v[160:163], a[40:43], a[0:3], v[160:163]
    buffer_load_dwordx4 v11, s[12:15], s25 offen offset:1024 lds
    v_mfma_f32_16x16x32_bf16 v[164:167], a[40:43], a[4:7], v[164:167]
    v_mfma_f32_16x16x32_bf16 v[168:171], a[40:43], a[8:11], v[168:171]
    v_mfma_f32_16x16x32_bf16 v[172:175], a[40:43], a[12:15], v[172:175]
    s_waitcnt lgkmcnt(0)
    v_mfma_f32_16x16x32_bf16 v[64:67], a[80:83], a[64:67], v[64:67]
    s_waitcnt vmcnt(12)
    s_barrier
    v_mfma_f32_16x16x32_bf16 v[68:71], a[80:83], a[68:71], v[68:71]
    s_add_u32 s28, s28, 32768
    s_and_b32 s31, s36, 15
    v_mfma_f32_16x16x32_bf16 v[72:75], a[80:83], a[72:75], v[72:75]
    s_lshr_b64 s[36:37], s[36:37], 4
    s_lshl_b32 s24, s31, 28
    v_mfma_f32_16x16x32_bf16 v[76:79], a[80:83], a[76:79], v[76:79]
    s_or_b32 s37, s37, s24
    s_lshl_b32 s24, s31, 7
    v_mfma_f32_16x16x32_bf16 v[92:95], a[84:87], a[76:79], v[92:95]
    s_cmp_eq_u32 s28, 98304
    s_cselect_b32 s28, 0, s28
    v_mfma_f32_16x16x32_bf16 v[88:91], a[84:87], a[72:75], v[88:91]
    s_add_u32 m0, s29, s27
    v_add_u32 v16, s28, v14
    v_mfma_f32_16x16x32_bf16 v[84:87], a[84:87], a[68:71], v[84:87]
    buffer_load_dwordx4 v2, s[8:11], s24 offen offset:0 lds
    ds_read_b64_tr_b16 a[16:17], v18 offset:0
    v_mfma_f32_16x16x32_bf16 v[80:83], a[84:87], a[64:67], v[80:83]
    ds_read_b64_tr_b16 a[18:19], v18 offset:512
    ds_read_b64_tr_b16 a[20:21], v19 offset:0
    v_mfma_f32_16x16x32_bf16 v[96:99], a[88:91], a[64:67], v[96:99]
    ds_read_b64_tr_b16 a[22:23], v19 offset:512
    buffer_load_dwordx4 v3, s[8:11], s24 offen offset:1024 lds
    v_mfma_f32_16x16x32_bf16 v[100:103], a[88:91], a[68:71], v[100:103]
    ds_read_b64_tr_b16 a[24:25], v13 offset:0
    ds_read_b64_tr_b16 a[26:27], v13 offset:512
    v_mfma_f32_16x16x32_bf16 v[104:107], a[88:91], a[72:75], v[104:107]
    ds_read_b64_tr_b16 a[28:29], v58 offset:0
    ds_read_b64_tr_b16 a[30:31], v58 offset:512
    v_mfma_f32_16x16x32_bf16 v[108:111], a[88:91], a[76:79], v[108:111]
    ds_read_b64_tr_b16 a[32:33], v18 offset:1024
    buffer_load_dwordx4 v4, s[8:11], s24 offen offset:2048 lds
    v_mfma_f32_16x16x32_bf16 v[124:127], a[92:95], a[76:79], v[124:127]
    ds_read_b64_tr_b16 a[34:35], v18 offset:1536
    v_mfma_f32_16x16x32_bf16 v[120:123], a[92:95], a[72:75], v[120:123]
    ds_read_b64_tr_b16 a[36:37], v19 offset:1024
    v_mfma_f32_16x16x32_bf16 v[116:119], a[92:95], a[68:71], v[116:119]
    ds_read_b64_tr_b16 a[38:39], v19 offset:1536
    v_mfma_f32_16x16x32_bf16 v[112:115], a[92:95], a[64:67], v[112:115]
    ds_read_b64_tr_b16 a[40:41], v13 offset:1024
    v_mfma_f32_16x16x32_bf16 v[128:131], a[96:99], a[64:67], v[128:131]
    buffer_load_dwordx4 v5, s[8:11], s24 offen offset:3072 lds
    ds_read_b64_tr_b16 a[42:43], v13 offset:1536
    v_mfma_f32_16x16x32_bf16 v[132:135], a[96:99], a[68:71], v[132:135]
    v_add_u32 v17, s28, v15
    v_mfma_f32_16x16x32_bf16 v[136:139], a[96:99], a[72:75], v[136:139]
    ds_read_b128 a[0:3], v16 offset:0
    v_mfma_f32_16x16x32_bf16 v[140:143], a[96:99], a[76:79], v[140:143]
    s_mul_i32 s25, s31, 458752
    ds_read_b128 a[4:7], v16 offset:2048
    v_mfma_f32_16x16x32_bf16 v[156:159], a[100:103], a[76:79], v[156:159]
    s_add_u32 s25, s25, s41
    s_add_u32 m0, s30, 32768
    v_mfma_f32_16x16x32_bf16 v[152:155], a[100:103], a[72:75], v[152:155]
    ds_read_b128 a[8:11], v16 offset:4096
    buffer_load_dwordx4 v10, s[12:15], s25 offen lds
    v_mfma_f32_16x16x32_bf16 v[148:151], a[100:103], a[68:71], v[148:151]
    ds_read_b128 a[12:15], v16 offset:6144
    v_mfma_f32_16x16x32_bf16 v[144:147], a[100:103], a[64:67], v[144:147]
    v_mfma_f32_16x16x32_bf16 v[160:163], a[104:107], a[64:67], v[160:163]
    buffer_load_dwordx4 v11, s[12:15], s25 offen offset:1024 lds
    v_mfma_f32_16x16x32_bf16 v[164:167], a[104:107], a[68:71], v[164:167]
    v_mfma_f32_16x16x32_bf16 v[168:171], a[104:107], a[72:75], v[168:171]
    v_mfma_f32_16x16x32_bf16 v[172:175], a[104:107], a[76:79], v[172:175]
    s_add_u32 s34, s34, 1
    s_cmp_lt_u32 s34, 3
    s_cbranch_scc1 L_loop_1_13
    s_waitcnt lgkmcnt(0)
    v_mfma_f32_16x16x32_bf16 v[64:67], a[16:19], a[0:3], v[64:67]
    ds_read_b128 a[64:67], v17 offset:0
    v_mfma_f32_16x16x32_bf16 v[68:71], a[16:19], a[4:7], v[68:71]
    ds_read_b128 a[68:71], v17 offset:2048
    s_add_u32 m0, s29, s27
    v_mfma_f32_16x16x32_bf16 v[72:75], a[16:19], a[8:11], v[72:75]
    s_add_u32 m0, m0, 4096
    s_nop 0
    buffer_load_dwordx4 v6, s[8:11], s24 offen offset:0 lds
    v_mfma_f32_16x16x32_bf16 v[76:79], a[16:19], a[12:15], v[76:79]
    ds_read_b128 a[72:75], v17 offset:4096
    ds_read_b128 a[76:79], v17 offset:6144
    v_mfma_f32_16x16x32_bf16 v[92:95], a[20:23], a[12:15], v[92:95]
    ds_read_b64_tr_b16 a[80:81], v18 offset:8192
    v_mfma_f32_16x16x32_bf16 v[88:91], a[20:23], a[8:11], v[88:91]
    v_mfma_f32_16x16x32_bf16 v[84:87], a[20:23], a[4:7], v[84:87]
    ds_read_b64_tr_b16 a[82:83], v18 offset:8704
    buffer_load_dwordx4 v7, s[8:11], s24 offen offset:1024 lds
    v_mfma_f32_16x16x32_bf16 v[80:83], a[20:23], a[0:3], v[80:83]
    ds_read_b64_tr_b16 a[84:85], v19 offset:8192
    v_mfma_f32_16x16x32_bf16 v[96:99], a[24:27], a[0:3], v[96:99]
    ds_read_b64_tr_b16 a[86:87], v19 offset:8704
    v_mfma_f32_16x16x32_bf16 v[100:103], a[24:27], a[4:7], v[100:103]
    ds_read_b64_tr_b16 a[88:89], v13 offset:8192
    v_mfma_f32_16x16x32_bf16 v[104:107], a[24:27], a[8:11], v[104:107]
    v_mfma_f32_16x16x32_bf16 v[108:111], a[24:27], a[12:15], v[108:111]
    ds_read_b64_tr_b16 a[90:91], v13 offset:8704
    buffer_load_dwordx4 v8, s[8:11], s24 offen offset:2048 lds
    v_mfma_f32_16x16x32_bf16 v[124:127], a[28:31], a[12:15], v[124:127]
    ds_read_b64_tr_b16 a[92:93], v58 offset:8192
    v_mfma_f32_16x16x32_bf16 v[120:123], a[28:31], a[8:11], v[120:123]
    ds_read_b64_tr_b16 a[94:95], v58 offset:8704
    v_mfma_f32_16x16x32_bf16 v[116:119], a[28:31], a[4:7], v[116:119]
    ds_read_b64_tr_b16 a[96:97], v18 offset:9216
    v_mfma_f32_16x16x32_bf16 v[112:115], a[28:31], a[0:3], v[112:115]
    buffer_load_dwordx4 v9, s[8:11], s24 offen offset:3072 lds
    ds_read_b64_tr_b16 a[98:99], v18 offset:9728
    v_mfma_f32_16x16x32_bf16 v[128:131], a[32:35], a[0:3], v[128:131]
    v_mfma_f32_16x16x32_bf16 v[132:135], a[32:35], a[4:7], v[132:135]
    ds_read_b64_tr_b16 a[100:101], v19 offset:9216
    v_mfma_f32_16x16x32_bf16 v[136:139], a[32:35], a[8:11], v[136:139]
    s_add_u32 s27, s27, 32768
    ds_read_b64_tr_b16 a[102:103], v19 offset:9728
    v_mfma_f32_16x16x32_bf16 v[140:143], a[32:35], a[12:15], v[140:143]
    s_cmp_eq_u32 s27, 98304
    s_cselect_b32 s27, 0, s27
    v_mfma_f32_16x16x32_bf16 v[156:159], a[36:39], a[12:15], v[156:159]
    s_add_u32 s25, s25, 229376
    ds_read_b64_tr_b16 a[104:105], v13 offset:9216
    v_mfma_f32_16x16x32_bf16 v[152:155], a[36:39], a[8:11], v[152:155]
    s_add_u32 m0, s30, 40960
    s_nop 0
    buffer_load_dwordx4 v10, s[12:15], s25 offen lds
    v_mfma_f32_16x16x32_bf16 v[148:151], a[36:39], a[4:7], v[148:151]
    ds_read_b64_tr_b16 a[106:107], v13 offset:9728
    v_mfma_f32_16x16x32_bf16 v[144:147], a[36:39], a[0:3], v[144:147]
    v_mfma_f32_16x16x32_bf16 v[160:163], a[40:43], a[0:3], v[160:163]
    buffer_load_dwordx4 v11, s[12:15], s25 offen offset:1024 lds
    v_mfma_f32_16x16x32_bf16 v[164:167], a[40:43], a[4:7], v[164:167]
    v_mfma_f32_16x16x32_bf16 v[168:171], a[40:43], a[8:11], v[168:171]
    v_mfma_f32_16x16x32_bf16 v[172:175], a[40:43], a[12:15], v[172:175]
    s_waitcnt lgkmcnt(0)
    v_mfma_f32_16x16x32_bf16 v[64:67], a[80:83], a[64:67], v[64:67]
    s_waitcnt vmcnt(12)
    s_barrier
    v_mfma_f32_16x16x32_bf16 v[68:71], a[80:83], a[68:71], v[68:71]
    s_add_u32 s28, s28, 32768
    s_and_b32 s31, s36, 15
    v_mfma_f32_16x16x32_bf16 v[72:75], a[80:83], a[72:75], v[72:75]
    s_lshr_b64 s[36:37], s[36:37], 4
    s_lshl_b32 s24, s31, 28
    v_mfma_f32_16x16x32_bf16 v[76:79], a[80:83], a[76:79], v[76:79]
    s_or_b32 s37, s37, s24
    s_lshl_b32 s24, s31, 7
    v_mfma_f32_16x16x32_bf16 v[92:95], a[84:87], a[76:79], v[92:95]
    s_cmp_eq_u32 s28, 98304
    s_cselect_b32 s28, 0, s28
    v_mfma_f32_16x16x32_bf16 v[88:91], a[84:87], a[72:75], v[88:91]
    s_add_u32 m0, s29, s27
    v_add_u32 v16, s28, v14
    v_mfma_f32_16x16x32_bf16 v[84:87], a[84:87], a[68:71], v[84:87]
    buffer_load_dwordx4 v2, s[8:11], s24 offen offset:0 lds
    ds_read_b64_tr_b16 a[16:17], v18 offset:16384
    v_mfma_f32_16x16x32_bf16 v[80:83], a[84:87], a[64:67], v[80:83]
    ds_read_b64_tr_b16 a[18:19], v18 offset:16896
    ds_read_b64_tr_b16 a[20:21], v19 offset:16384
    v_mfma_f32_16x16x32_bf16 v[96:99], a[88:91], a[64:67], v[96:99]
    ds_read_b64_tr_b16 a[22:23], v19 offset:16896
    buffer_load_dwordx4 v3, s[8:11], s24 offen offset:1024 lds
    v_mfma_f32_16x16x32_bf16 v[100:103], a[88:91], a[68:71], v[100:103]
    ds_read_b64_tr_b16 a[24:25], v13 offset:16384
    ds_read_b64_tr_b16 a[26:27], v13 offset:16896
    v_mfma_f32_16x16x32_bf16 v[104:107], a[88:91], a[72:75], v[104:107]
    ds_read_b64_tr_b16 a[28:29], v58 offset:16384
    ds_read_b64_tr_b16 a[30:31], v58 offset:16896
    v_mfma_f32_16x16x32_bf16 v[108:111], a[88:91], a[76:79], v[108:111]
    ds_read_b64_tr_b16 a[32:33], v18 offset:17408
    buffer_load_dwordx4 v4, s[8:11], s24 offen offset:2048 lds
    v_mfma_f32_16x16x32_bf16 v[124:127], a[92:95], a[76:79], v[124:127]
    ds_read_b64_tr_b16 a[34:35], v18 offset:17920
    v_mfma_f32_16x16x32_bf16 v[120:123], a[92:95], a[72:75], v[120:123]
    ds_read_b64_tr_b16 a[36:37], v19 offset:17408
    v_mfma_f32_16x16x32_bf16 v[116:119], a[92:95], a[68:71], v[116:119]
    ds_read_b64_tr_b16 a[38:39], v19 offset:17920
    v_mfma_f32_16x16x32_bf16 v[112:115], a[92:95], a[64:67], v[112:115]
    ds_read_b64_tr_b16 a[40:41], v13 offset:17408
    v_mfma_f32_16x16x32_bf16 v[128:131], a[96:99], a[64:67], v[128:131]
    buffer_load_dwordx4 v5, s[8:11], s24 offen offset:3072 lds
    ds_read_b64_tr_b16 a[42:43], v13 offset:17920
    v_mfma_f32_16x16x32_bf16 v[132:135], a[96:99], a[68:71], v[132:135]
    v_add_u32 v17, s28, v15
    v_mfma_f32_16x16x32_bf16 v[136:139], a[96:99], a[72:75], v[136:139]
    ds_read_b128 a[0:3], v16 offset:0
    v_mfma_f32_16x16x32_bf16 v[140:143], a[96:99], a[76:79], v[140:143]
    s_mul_i32 s25, s31, 458752
    ds_read_b128 a[4:7], v16 offset:2048
    v_mfma_f32_16x16x32_bf16 v[156:159], a[100:103], a[76:79], v[156:159]
    s_add_u32 s25, s25, s41
    s_add_u32 m0, s30, 0
    v_mfma_f32_16x16x32_bf16 v[152:155], a[100:103], a[72:75], v[152:155]
    ds_read_b128 a[8:11], v16 offset:4096
    buffer_load_dwordx4 v10, s[12:15], s25 offen lds
    v_mfma_f32_16x16x32_bf16 v[148:151], a[100:103], a[68:71], v[148:151]
    ds_read_b128 a[12:15], v16 offset:6144
    v_mfma_f32_16x16x32_bf16 v[144:147], a[100:103], a[64:67], v[144:147]
    v_mfma_f32_16x16x32_bf16 v[160:163], a[104:107], a[64:67], v[160:163]
    buffer_load_dwordx4 v11, s[12:15], s25 offen offset:1024 lds
    v_mfma_f32_16x16x32_bf16 v[164:167], a[104:107], a[68:71], v[164:167]
    v_mfma_f32_16x16x32_bf16 v[168:171], a[104:107], a[72:75], v[168:171]
    v_mfma_f32_16x16x32_bf16 v[172:175], a[104:107], a[76:79], v[172:175]
    s_waitcnt lgkmcnt(0)
    v_mfma_f32_16x16x32_bf16 v[64:67], a[16:19], a[0:3], v[64:67]
    ds_read_b128 a[64:67], v17 offset:0
    v_mfma_f32_16x16x32_bf16 v[68:71], a[16:19], a[4:7], v[68:71]
    ds_read_b128 a[68:71], v17 offset:2048
    s_add_u32 m0, s29, s27
    v_mfma_f32_16x16x32_bf16 v[72:75], a[16:19], a[8:11], v[72:75]
    s_add_u32 m0, m0, 4096
    s_nop 0
    buffer_load_dwordx4 v6, s[8:11], s24 offen offset:0 lds
    v_mfma_f32_16x16x32_bf16 v[76:79], a[16:19], a[12:15], v[76:79]
    ds_read_b128 a[72:75], v17 offset:4096
    ds_read_b128 a[76:79], v17 offset:6144
    v_mfma_f32_16x16x32_bf16 v[92:95], a[20:23], a[12:15], v[92:95]
    ds_read_b64_tr_b16 a[80:81], v18 offset:24576
    v_mfma_f32_16x16x32_bf16 v[88:91], a[20:23], a[8:11], v[88:91]
    v_mfma_f32_16x16x32_bf16 v[84:87], a[20:23], a[4:7], v[84:87]
    ds_read_b64_tr_b16 a[82:83], v18 offset:25088
    buffer_load_dwordx4 v7, s[8:11], s24 offen offset:1024 lds
    v_mfma_f32_16x16x32_bf16 v[80:83], a[20:23], a[0:3], v[80:83]
    ds_read_b64_tr_b16 a[84:85], v19 offset:24576
    v_mfma_f32_16x16x32_bf16 v[96:99], a[24:27], a[0:3], v[96:99]
    ds_read_b64_tr_b16 a[86:87], v19 offset:25088
    v_mfma_f32_16x16x32_bf16 v[100:103], a[24:27], a[4:7], v[100:103]
    ds_read_b64_tr_b16 a[88:89], v13 offset:24576
    v_mfma_f32_16x16x32_bf16 v[104:107], a[24:27], a[8:11], v[104:107]
    v_mfma_f32_16x16x32_bf16 v[108:111], a[24:27], a[12:15], v[108:111]
    ds_read_b64_tr_b16 a[90:91], v13 offset:25088
    buffer_load_dwordx4 v8, s[8:11], s24 offen offset:2048 lds
    v_mfma_f32_16x16x32_bf16 v[124:127], a[28:31], a[12:15], v[124:127]
    ds_read_b64_tr_b16 a[92:93], v58 offset:24576
    v_mfma_f32_16x16x32_bf16 v[120:123], a[28:31], a[8:11], v[120:123]
    ds_read_b64_tr_b16 a[94:95], v58 offset:25088
    v_mfma_f32_16x16x32_bf16 v[116:119], a[28:31], a[4:7], v[116:119]
    ds_read_b64_tr_b16 a[96:97], v18 offset:25600
    v_mfma_f32_16x16x32_bf16 v[112:115], a[28:31], a[0:3], v[112:115]
    buffer_load_dwordx4 v9, s[8:11], s24 offen offset:3072 lds
    ds_read_b64_tr_b16 a[98:99], v18 offset:26112
    v_mfma_f32_16x16x32_bf16 v[128:131], a[32:35], a[0:3], v[128:131]
    v_mfma_f32_16x16x32_bf16 v[132:135], a[32:35], a[4:7], v[132:135]
    ds_read_b64_tr_b16 a[100:101], v19 offset:25600
    v_mfma_f32_16x16x32_bf16 v[136:139], a[32:35], a[8:11], v[136:139]
    s_add_u32 s27, s27, 32768
    ds_read_b64_tr_b16 a[102:103], v19 offset:26112
    v_mfma_f32_16x16x32_bf16 v[140:143], a[32:35], a[12:15], v[140:143]
    s_cmp_eq_u32 s27, 98304
    s_cselect_b32 s27, 0, s27
    v_mfma_f32_16x16x32_bf16 v[156:159], a[36:39], a[12:15], v[156:159]
    s_add_u32 s25, s25, 229376
    ds_read_b64_tr_b16 a[104:105], v13 offset:25600
    v_mfma_f32_16x16x32_bf16 v[152:155], a[36:39], a[8:11], v[152:155]
    s_add_u32 m0, s30, 8192
    s_nop 0
    buffer_load_dwordx4 v10, s[12:15], s25 offen lds
    v_mfma_f32_16x16x32_bf16 v[148:151], a[36:39], a[4:7], v[148:151]
    ds_read_b64_tr_b16 a[106:107], v13 offset:26112
    v_mfma_f32_16x16x32_bf16 v[144:147], a[36:39], a[0:3], v[144:147]
    v_mfma_f32_16x16x32_bf16 v[160:163], a[40:43], a[0:3], v[160:163]
    buffer_load_dwordx4 v11, s[12:15], s25 offen offset:1024 lds
    v_mfma_f32_16x16x32_bf16 v[164:167], a[40:43], a[4:7], v[164:167]
    v_mfma_f32_16x16x32_bf16 v[168:171], a[40:43], a[8:11], v[168:171]
    v_mfma_f32_16x16x32_bf16 v[172:175], a[40:43], a[12:15], v[172:175]
    s_waitcnt lgkmcnt(0)
    v_mfma_f32_16x16x32_bf16 v[64:67], a[80:83], a[64:67], v[64:67]
    s_waitcnt vmcnt(12)
    s_barrier
    v_mfma_f32_16x16x32_bf16 v[68:71], a[80:83], a[68:71], v[68:71]
    s_add_u32 s28, s28, 32768
    s_and_b32 s31, s36, 15
    v_mfma_f32_16x16x32_bf16 v[72:75], a[80:83], a[72:75], v[72:75]
    s_lshr_b64 s[36:37], s[36:37], 4
    s_lshl_b32 s24, s31, 28
    v_mfma_f32_16x16x32_bf16 v[76:79], a[80:83], a[76:79], v[76:79]
    s_or_b32 s37, s37, s24
    s_lshl_b32 s24, s31, 7
    v_mfma_f32_16x16x32_bf16 v[92:95], a[84:87], a[76:79], v[92:95]
    s_cmp_eq_u32 s28, 98304
    s_cselect_b32 s28, 0, s28
    v_mfma_f32_16x16x32_bf16 v[88:91], a[84:87], a[72:75], v[88:91]
    s_add_u32 m0, s29, s27
    v_add_u32 v16, s28, v14
    v_mfma_f32_16x16x32_bf16 v[84:87], a[84:87], a[68:71], v[84:87]
    buffer_load_dwordx4 v2, s[8:11], s24 offen offset:0 lds
    ds_read_b64_tr_b16 a[16:17], v18 offset:32768
    v_mfma_f32_16x16x32_bf16 v[80:83], a[84:87], a[64:67], v[80:83]
    ds_read_b64_tr_b16 a[18:19], v18 offset:33280
    ds_read_b64_tr_b16 a[20:21], v19 offset:32768
    v_mfma_f32_16x16x32_bf16 v[96:99], a[88:91], a[64:67], v[96:99]
    ds_read_b64_tr_b16 a[22:23], v19 offset:33280
    buffer_load_dwordx4 v3, s[8:11], s24 offen offset:1024 lds
    v_mfma_f32_16x16x32_bf16 v[100:103], a[88:91], a[68:71], v[100:103]
    ds_read_b64_tr_b16 a[24:25], v13 offset:32768
    ds_read_b64_tr_b16 a[26:27], v13 offset:33280
    v_mfma_f32_16x16x32_bf16 v[104:107], a[88:91], a[72:75], v[104:107]
    ds_read_b64_tr_b16 a[28:29], v58 offset:32768
    ds_read_b64_tr_b16 a[30:31], v58 offset:33280
    v_mfma_f32_16x16x32_bf16 v[108:111], a[88:91], a[76:79], v[108:111]
    ds_read_b64_tr_b16 a[32:33], v18 offset:33792
    buffer_load_dwordx4 v4, s[8:11], s24 offen offset:2048 lds
    v_mfma_f32_16x16x32_bf16 v[124:127], a[92:95], a[76:79], v[124:127]
    ds_read_b64_tr_b16 a[34:35], v18 offset:34304
    v_mfma_f32_16x16x32_bf16 v[120:123], a[92:95], a[72:75], v[120:123]
    ds_read_b64_tr_b16 a[36:37], v19 offset:33792
    v_mfma_f32_16x16x32_bf16 v[116:119], a[92:95], a[68:71], v[116:119]
    ds_read_b64_tr_b16 a[38:39], v19 offset:34304
    v_mfma_f32_16x16x32_bf16 v[112:115], a[92:95], a[64:67], v[112:115]
    ds_read_b64_tr_b16 a[40:41], v13 offset:33792
    v_mfma_f32_16x16x32_bf16 v[128:131], a[96:99], a[64:67], v[128:131]
    buffer_load_dwordx4 v5, s[8:11], s24 offen offset:3072 lds
    ds_read_b64_tr_b16 a[42:43], v13 offset:34304
    v_mfma_f32_16x16x32_bf16 v[132:135], a[96:99], a[68:71], v[132:135]
    v_add_u32 v17, s28, v15
    v_mfma_f32_16x16x32_bf16 v[136:139], a[96:99], a[72:75], v[136:139]
    ds_read_b128 a[0:3], v16 offset:0
    v_mfma_f32_16x16x32_bf16 v[140:143], a[96:99], a[76:79], v[140:143]
    s_mul_i32 s25, s31, 458752
    ds_read_b128 a[4:7], v16 offset:2048
    v_mfma_f32_16x16x32_bf16 v[156:159], a[100:103], a[76:79], v[156:159]
    s_add_u32 s25, s25, s41
    s_add_u32 m0, s30, 16384
    v_mfma_f32_16x16x32_bf16 v[152:155], a[100:103], a[72:75], v[152:155]
    ds_read_b128 a[8:11], v16 offset:4096
    buffer_load_dwordx4 v10, s[12:15], s25 offen lds
    v_mfma_f32_16x16x32_bf16 v[148:151], a[100:103], a[68:71], v[148:151]
    ds_read_b128 a[12:15], v16 offset:6144
    v_mfma_f32_16x16x32_bf16 v[144:147], a[100:103], a[64:67], v[144:147]
    v_mfma_f32_16x16x32_bf16 v[160:163], a[104:107], a[64:67], v[160:163]
    buffer_load_dwordx4 v11, s[12:15], s25 offen offset:1024 lds
    v_mfma_f32_16x16x32_bf16 v[164:167], a[104:107], a[68:71], v[164:167]
    v_mfma_f32_16x16x32_bf16 v[168:171], a[104:107], a[72:75], v[168:171]
    v_mfma_f32_16x16x32_bf16 v[172:175], a[104:107], a[76:79], v[172:175]
    s_waitcnt lgkmcnt(0)
    v_mfma_f32_16x16x32_bf16 v[64:67], a[16:19], a[0:3], v[64:67]
    ds_read_b128 a[64:67], v17 offset:0
    v_mfma_f32_16x16x32_bf16 v[68:71], a[16:19], a[4:7], v[68:71]
    ds_read_b128 a[68:71], v17 offset:2048
    s_add_u32 m0, s29, s27
    v_mfma_f32_16x16x32_bf16 v[72:75], a[16:19], a[8:11], v[72:75]
    s_add_u32 m0, m0, 4096
    s_nop 0
    buffer_load_dwordx4 v6, s[8:11], s24 offen offset:0 lds
    v_mfma_f32_16x16x32_bf16 v[76:79], a[16:19], a[12:15], v[76:79]
    ds_read_b128 a[72:75], v17 offset:4096
    ds_read_b128 a[76:79], v17 offset:6144
    v_mfma_f32_16x16x32_bf16 v[92:95], a[20:23], a[12:15], v[92:95]
    ds_read_b64_tr_b16 a[80:81], v18 offset:40960
    v_mfma_f32_16x16x32_bf16 v[88:91], a[20:23], a[8:11], v[88:91]
    v_mfma_f32_16x16x32_bf16 v[84:87], a[20:23], a[4:7], v[84:87]
    ds_read_b64_tr_b16 a[82:83], v18 offset:41472
    buffer_load_dwordx4 v7, s[8:11], s24 offen offset:1024 lds
    v_mfma_f32_16x16x32_bf16 v[80:83], a[20:23], a[0:3], v[80:83]
    ds_read_b64_tr_b16 a[84:85], v19 offset:40960
    v_mfma_f32_16x16x32_bf16 v[96:99], a[24:27], a[0:3], v[96:99]
    ds_read_b64_tr_b16 a[86:87], v19 offset:41472
    v_mfma_f32_16x16x32_bf16 v[100:103], a[24:27], a[4:7], v[100:103]
    ds_read_b64_tr_b16 a[88:89], v13 offset:40960
    v_mfma_f32_16x16x32_bf16 v[104:107], a[24:27], a[8:11], v[104:107]
    v_mfma_f32_16x16x32_bf16 v[108:111], a[24:27], a[12:15], v[108:111]
    ds_read_b64_tr_b16 a[90:91], v13 offset:41472
    buffer_load_dwordx4 v8, s[8:11], s24 offen offset:2048 lds
    v_mfma_f32_16x16x32_bf16 v[124:127], a[28:31], a[12:15], v[124:127]
    ds_read_b64_tr_b16 a[92:93], v58 offset:40960
    v_mfma_f32_16x16x32_bf16 v[120:123], a[28:31], a[8:11], v[120:123]
    ds_read_b64_tr_b16 a[94:95], v58 offset:41472
    v_mfma_f32_16x16x32_bf16 v[116:119], a[28:31], a[4:7], v[116:119]
    ds_read_b64_tr_b16 a[96:97], v18 offset:41984
    v_mfma_f32_16x16x32_bf16 v[112:115], a[28:31], a[0:3], v[112:115]
    buffer_load_dwordx4 v9, s[8:11], s24 offen offset:3072 lds
    ds_read_b64_tr_b16 a[98:99], v18 offset:42496
    v_mfma_f32_16x16x32_bf16 v[128:131], a[32:35], a[0:3], v[128:131]
    v_mfma_f32_16x16x32_bf16 v[132:135], a[32:35], a[4:7], v[132:135]
    ds_read_b64_tr_b16 a[100:101], v19 offset:41984
    v_mfma_f32_16x16x32_bf16 v[136:139], a[32:35], a[8:11], v[136:139]
    s_add_u32 s27, s27, 32768
    ds_read_b64_tr_b16 a[102:103], v19 offset:42496
    v_mfma_f32_16x16x32_bf16 v[140:143], a[32:35], a[12:15], v[140:143]
    s_cmp_eq_u32 s27, 98304
    s_cselect_b32 s27, 0, s27
    v_mfma_f32_16x16x32_bf16 v[156:159], a[36:39], a[12:15], v[156:159]
    s_add_u32 s25, s25, 229376
    ds_read_b64_tr_b16 a[104:105], v13 offset:41984
    v_mfma_f32_16x16x32_bf16 v[152:155], a[36:39], a[8:11], v[152:155]
    s_add_u32 m0, s30, 24576
    s_nop 0
    buffer_load_dwordx4 v10, s[12:15], s25 offen lds
    v_mfma_f32_16x16x32_bf16 v[148:151], a[36:39], a[4:7], v[148:151]
    ds_read_b64_tr_b16 a[106:107], v13 offset:42496
    v_mfma_f32_16x16x32_bf16 v[144:147], a[36:39], a[0:3], v[144:147]
    v_mfma_f32_16x16x32_bf16 v[160:163], a[40:43], a[0:3], v[160:163]
    buffer_load_dwordx4 v11, s[12:15], s25 offen offset:1024 lds
    v_mfma_f32_16x16x32_bf16 v[164:167], a[40:43], a[4:7], v[164:167]
    v_mfma_f32_16x16x32_bf16 v[168:171], a[40:43], a[8:11], v[168:171]
    v_mfma_f32_16x16x32_bf16 v[172:175], a[40:43], a[12:15], v[172:175]
    s_waitcnt lgkmcnt(0)
    v_mfma_f32_16x16x32_bf16 v[64:67], a[80:83], a[64:67], v[64:67]
    s_waitcnt vmcnt(12)
    s_barrier
    v_mfma_f32_16x16x32_bf16 v[68:71], a[80:83], a[68:71], v[68:71]
    s_add_u32 s28, s28, 32768
    s_and_b32 s31, s36, 15
    v_mfma_f32_16x16x32_bf16 v[72:75], a[80:83], a[72:75], v[72:75]
    s_lshr_b64 s[36:37], s[36:37], 4
    s_lshl_b32 s24, s31, 28
    v_mfma_f32_16x16x32_bf16 v[76:79], a[80:83], a[76:79], v[76:79]
    s_or_b32 s37, s37, s24
    s_lshl_b32 s24, s31, 7
    v_mfma_f32_16x16x32_bf16 v[92:95], a[84:87], a[76:79], v[92:95]
    s_cmp_eq_u32 s28, 98304
    s_cselect_b32 s28, 0, s28
    v_mfma_f32_16x16x32_bf16 v[88:91], a[84:87], a[72:75], v[88:91]
    s_add_u32 m0, s29, s27
    v_add_u32 v16, s28, v14
    v_mfma_f32_16x16x32_bf16 v[84:87], a[84:87], a[68:71], v[84:87]
    buffer_load_dwordx4 v2, s[8:11], s24 offen offset:0 lds
    ds_read_b64_tr_b16 a[16:17], v18 offset:0
    v_mfma_f32_16x16x32_bf16 v[80:83], a[84:87], a[64:67], v[80:83]
    ds_read_b64_tr_b16 a[18:19], v18 offset:512
    ds_read_b64_tr_b16 a[20:21], v19 offset:0
    v_mfma_f32_16x16x32_bf16 v[96:99], a[88:91], a[64:67], v[96:99]
    ds_read_b64_tr_b16 a[22:23], v19 offset:512
    buffer_load_dwordx4 v3, s[8:11], s24 offen offset:1024 lds
    v_mfma_f32_16x16x32_bf16 v[100:103], a[88:91], a[68:71], v[100:103]
    ds_read_b64_tr_b16 a[24:25], v13 offset:0
    ds_read_b64_tr_b16 a[26:27], v13 offset:512
    v_mfma_f32_16x16x32_bf16 v[104:107], a[88:91], a[72:75], v[104:107]
    ds_read_b64_tr_b16 a[28:29], v58 offset:0
    ds_read_b64_tr_b16 a[30:31], v58 offset:512
    v_mfma_f32_16x16x32_bf16 v[108:111], a[88:91], a[76:79], v[108:111]
    ds_read_b64_tr_b16 a[32:33], v18 offset:1024
    buffer_load_dwordx4 v4, s[8:11], s24 offen offset:2048 lds
    v_mfma_f32_16x16x32_bf16 v[124:127], a[92:95], a[76:79], v[124:127]
    ds_read_b64_tr_b16 a[34:35], v18 offset:1536
    v_mfma_f32_16x16x32_bf16 v[120:123], a[92:95], a[72:75], v[120:123]
    ds_read_b64_tr_b16 a[36:37], v19 offset:1024
    v_mfma_f32_16x16x32_bf16 v[116:119], a[92:95], a[68:71], v[116:119]
    ds_read_b64_tr_b16 a[38:39], v19 offset:1536
    v_mfma_f32_16x16x32_bf16 v[112:115], a[92:95], a[64:67], v[112:115]
    ds_read_b64_tr_b16 a[40:41], v13 offset:1024
    v_mfma_f32_16x16x32_bf16 v[128:131], a[96:99], a[64:67], v[128:131]
    buffer_load_dwordx4 v5, s[8:11], s24 offen offset:3072 lds
    ds_read_b64_tr_b16 a[42:43], v13 offset:1536
    v_mfma_f32_16x16x32_bf16 v[132:135], a[96:99], a[68:71], v[132:135]
    v_add_u32 v17, s28, v15
    v_mfma_f32_16x16x32_bf16 v[136:139], a[96:99], a[72:75], v[136:139]
    ds_read_b128 a[128:131], v16 offset:0
    v_mfma_f32_16x16x32_bf16 v[140:143], a[96:99], a[76:79], v[140:143]
    s_mul_i32 s25, s31, 458752
    ds_read_b128 a[132:135], v16 offset:2048
    v_mfma_f32_16x16x32_bf16 v[156:159], a[100:103], a[76:79], v[156:159]
    s_add_u32 s25, s25, s41
    s_add_u32 m0, s30, 32768
    v_mfma_f32_16x16x32_bf16 v[152:155], a[100:103], a[72:75], v[152:155]
    ds_read_b128 a[136:139], v16 offset:4096
    buffer_load_dwordx4 v10, s[12:15], s25 offen lds
    v_mfma_f32_16x16x32_bf16 v[148:151], a[100:103], a[68:71], v[148:151]
    ds_read_b128 a[140:143], v16 offset:6144
    v_mfma_f32_16x16x32_bf16 v[144:147], a[100:103], a[64:67], v[144:147]
    v_mfma_f32_16x16x32_bf16 v[160:163], a[104:107], a[64:67], v[160:163]
    buffer_load_dwordx4 v11, s[12:15], s25 offen offset:1024 lds
    v_mfma_f32_16x16x32_bf16 v[164:167], a[104:107], a[68:71], v[164:167]
    v_mfma_f32_16x16x32_bf16 v[168:171], a[104:107], a[72:75], v[168:171]
    v_mfma_f32_16x16x32_bf16 v[172:175], a[104:107], a[76:79], v[172:175]
    s_waitcnt lgkmcnt(0)
    v_mfma_f32_16x16x32_bf16 v[64:67], a[16:19], a[128:131], v[64:67]
    ds_read_b128 a[144:147], v17 offset:0
    v_mfma_f32_16x16x32_bf16 v[68:71], a[16:19], a[132:135], v[68:71]
    ds_read_b128 a[148:151], v17 offset:2048
    s_add_u32 m0, s29, s27
    v_mfma_f32_16x16x32_bf16 v[72:75], a[16:19], a[136:139], v[72:75]
    s_add_u32 m0, m0, 4096
    s_nop 0
    buffer_load_dwordx4 v6, s[8:11], s24 offen offset:0 lds
    v_mfma_f32_16x16x32_bf16 v[76:79], a[16:19], a[140:143], v[76:79]
    ds_read_b128 a[152:155], v17 offset:4096
    ds_read_b128 a[156:159], v17 offset:6144
    v_mfma_f32_16x16x32_bf16 v[92:95], a[20:23], a[140:143], v[92:95]
    ds_read_b64_tr_b16 a[80:81], v18 offset:8192
    v_mfma_f32_16x16x32_bf16 v[88:91], a[20:23], a[136:139], v[88:91]
    v_mfma_f32_16x16x32_bf16 v[84:87], a[20:23], a[132:135], v[84:87]
    ds_read_b64_tr_b16 a[82:83], v18 offset:8704
    buffer_load_dwordx4 v7, s[8:11], s24 offen offset:1024 lds
    v_mfma_f32_16x16x32_bf16 v[80:83], a[20:23], a[128:131], v[80:83]
    ds_read_b64_tr_b16 a[84:85], v19 offset:8192
    v_mfma_f32_16x16x32_bf16 v[96:99], a[24:27], a[128:131], v[96:99]
    ds_read_b64_tr_b16 a[86:87], v19 offset:8704
    v_mfma_f32_16x16x32_bf16 v[100:103], a[24:27], a[132:135], v[100:103]
    ds_read_b64_tr_b16 a[88:89], v13 offset:8192
    v_mfma_f32_16x16x32_bf16 v[104:107], a[24:27], a[136:139], v[104:107]
    v_mfma_f32_16x16x32_bf16 v[108:111], a[24:27], a[140:143], v[108:111]
    ds_read_b64_tr_b16 a[90:91], v13 offset:8704
    buffer_load_dwordx4 v8, s[8:11], s24 offen offset:2048 lds
    v_mfma_f32_16x16x32_bf16 v[124:127], a[28:31], a[140:143], v[124:127]
    ds_read_b64_tr_b16 a[92:93], v58 offset:8192
    v_mfma_f32_16x16x32_bf16 v[120:123], a[28:31], a[136:139], v[120:123]
    ds_read_b64_tr_b16 a[94:95], v58 offset:8704
    v_mfma_f32_16x16x32_bf16 v[116:119], a[28:31], a[132:135], v[116:119]
    ds_read_b64_tr_b16 a[96:97], v18 offset:9216
    v_mfma_f32_16x16x32_bf16 v[112:115], a[28:31], a[128:131], v[112:115]
    buffer_load_dwordx4 v9, s[8:11], s24 offen offset:3072 lds
    ds_read_b64_tr_b16 a[98:99], v18 offset:9728
    v_mfma_f32_16x16x32_bf16 v[128:131], a[32:35], a[128:131], v[128:131]
    v_mfma_f32_16x16x32_bf16 v[132:135], a[32:35], a[132:135], v[132:135]
    ds_read_b64_tr_b16 a[100:101], v19 offset:9216
    v_mfma_f32_16x16x32_bf16 v[136:139], a[32:35], a[136:139], v[136:139]
    s_add_u32 s27, s27, 32768
    ds_read_b64_tr_b16 a[102:103], v19 offset:9728
    v_mfma_f32_16x16x32_bf16 v[140:143], a[32:35], a[140:143], v[140:143]
    s_cmp_eq_u32 s27, 98304
    s_cselect_b32 s27, 0, s27
    v_mfma_f32_16x16x32_bf16 v[156:159], a[36:39], a[140:143], v[156:159]
    s_add_u32 s25, s25, 229376
    ds_read_b64_tr_b16 a[104:105], v13 offset:9216
    v_mfma_f32_16x16x32_bf16 v[152:155], a[36:39], a[136:139], v[152:155]
    s_add_u32 m0, s30, 40960
    s_nop 0
    buffer_load_dwordx4 v10, s[12:15], s25 offen lds
    v_mfma_f32_16x16x32_bf16 v[148:151], a[36:39], a[132:135], v[148:151]
    ds_read_b64_tr_b16 a[106:107], v13 offset:9728
    v_mfma_f32_16x16x32_bf16 v[144:147], a[36:39], a[128:131], v[144:147]
    v_mfma_f32_16x16x32_bf16 v[160:163], a[40:43], a[128:131], v[160:163]
    buffer_load_dwordx4 v11, s[12:15], s25 offen offset:1024 lds
    v_mfma_f32_16x16x32_bf16 v[164:167], a[40:43], a[132:135], v[164:167]
    v_mfma_f32_16x16x32_bf16 v[168:171], a[40:43], a[136:139], v[168:171]
    v_mfma_f32_16x16x32_bf16 v[172:175], a[40:43], a[140:143], v[172:175]
    s_waitcnt lgkmcnt(0)
    v_mfma_f32_16x16x32_bf16 v[64:67], a[80:83], a[144:147], v[64:67]
    s_waitcnt vmcnt(12)
    s_barrier
    v_mfma_f32_16x16x32_bf16 v[68:71], a[80:83], a[148:151], v[68:71]
    s_add_u32 s28, s28, 32768
    s_bfe_u32 s24, s57, 0x4001c
    v_mfma_f32_16x16x32_bf16 v[72:75], a[80:83], a[152:155], v[72:75]
    s_cmp_eq_u32 s28, 98304
    s_cselect_b32 s28, 0, s28
    v_mfma_f32_16x16x32_bf16 v[76:79], a[80:83], a[156:159], v[76:79]
    s_lshl_b32 s24, s24, 7
    s_add_u32 m0, s29, s27
    v_mfma_f32_16x16x32_bf16 v[92:95], a[84:87], a[156:159], v[92:95]
    v_add_u32 v16, s28, v14
    buffer_load_dwordx4 v2, s[8:11], s24 offen offset:0 lds
    v_mfma_f32_16x16x32_bf16 v[88:91], a[84:87], a[152:155], v[88:91]
    ds_read_b64_tr_b16 a[16:17], v18 offset:16384
    ds_read_b64_tr_b16 a[18:19], v18 offset:16896
    v_mfma_f32_16x16x32_bf16 v[84:87], a[84:87], a[148:151], v[84:87]
    ds_read_b64_tr_b16 a[20:21], v19 offset:16384
    ds_read_b64_tr_b16 a[22:23], v19 offset:16896
    v_mfma_f32_16x16x32_bf16 v[80:83], a[84:87], a[144:147], v[80:83]
    buffer_load_dwordx4 v3, s[8:11], s24 offen offset:1024 lds
    ds_read_b64_tr_b16 a[24:25], v13 offset:16384
    v_mfma_f32_16x16x32_bf16 v[96:99], a[88:91], a[144:147], v[96:99]
    ds_read_b64_tr_b16 a[26:27], v13 offset:16896
    v_mfma_f32_16x16x32_bf16 v[100:103], a[88:91], a[148:151], v[100:103]
    ds_read_b64_tr_b16 a[28:29], v58 offset:16384
    v_mfma_f32_16x16x32_bf16 v[104:107], a[88:91], a[152:155], v[104:107]
    ds_read_b64_tr_b16 a[30:31], v58 offset:16896
    v_mfma_f32_16x16x32_bf16 v[108:111], a[88:91], a[156:159], v[108:111]
    ds_read_b64_tr_b16 a[32:33], v18 offset:17408
    buffer_load_dwordx4 v4, s[8:11], s24 offen offset:2048 lds
    v_mfma_f32_16x16x32_bf16 v[124:127], a[92:95], a[156:159], v[124:127]
    ds_read_b64_tr_b16 a[34:35], v18 offset:17920
    v_mfma_f32_16x16x32_bf16 v[120:123], a[92:95], a[152:155], v[120:123]
    ds_read_b64_tr_b16 a[36:37], v19 offset:17408
    v_mfma_f32_16x16x32_bf16 v[116:119], a[92:95], a[148:151], v[116:119]
    ds_read_b64_tr_b16 a[38:39], v19 offset:17920
    v_mfma_f32_16x16x32_bf16 v[112:115], a[92:95], a[144:147], v[112:115]
    ds_read_b64_tr_b16 a[40:41], v13 offset:17408
    v_mfma_f32_16x16x32_bf16 v[128:131], a[96:99], a[144:147], v[128:131]
    buffer_load_dwordx4 v5, s[8:11], s24 offen offset:3072 lds
    ds_read_b64_tr_b16 a[42:43], v13 offset:17920
    v_mfma_f32_16x16x32_bf16 v[132:135], a[96:99], a[148:151], v[132:135]
    v_add_u32 v17, s28, v15
    v_mfma_f32_16x16x32_bf16 v[136:139], a[96:99], a[152:155], v[136:139]
    ds_read_b128 a[160:163], v16 offset:0
    s_bfe_u32 s31, s57, 0x4001c
    v_mfma_f32_16x16x32_bf16 v[140:143], a[96:99], a[156:159], v[140:143]
    s_mul_i32 s25, s31, 458752
    ds_read_b128 a[164:167], v16 offset:2048
    v_mfma_f32_16x16x32_bf16 v[156:159], a[100:103], a[156:159], v[156:159]
    s_add_u32 s25, s25, s41
    s_add_u32 m0, s30, 0
    v_mfma_f32_16x16x32_bf16 v[152:155], a[100:103], a[152:155], v[152:155]
    ds_read_b128 a[168:171], v16 offset:4096
    buffer_load_dwordx4 v10, s[12:15], s25 offen lds
    v_mfma_f32_16x16x32_bf16 v[148:151], a[100:103], a[148:151], v[148:151]
    ds_read_b128 a[172:175], v16 offset:6144
    v_mfma_f32_16x16x32_bf16 v[144:147], a[100:103], a[144:147], v[144:147]
    v_mfma_f32_16x16x32_bf16 v[160:163], a[104:107], a[144:147], v[160:163]
    buffer_load_dwordx4 v11, s[12:15], s25 offen offset:1024 lds
    v_mfma_f32_16x16x32_bf16 v[164:167], a[104:107], a[148:151], v[164:167]
    v_mfma_f32_16x16x32_bf16 v[168:171], a[104:107], a[152:155], v[168:171]
    v_mfma_f32_16x16x32_bf16 v[172:175], a[104:107], a[156:159], v[172:175]
    s_waitcnt lgkmcnt(0)
    v_mfma_f32_16x16x32_bf16 v[64:67], a[16:19], a[160:163], v[64:67]
    ds_read_b128 a[176:179], v17 offset:0
    v_mfma_f32_16x16x32_bf16 v[68:71], a[16:19], a[164:167], v[68:71]
    ds_read_b128 a[180:183], v17 offset:2048
    s_add_u32 m0, s29, s27
    v_mfma_f32_16x16x32_bf16 v[72:75], a[16:19], a[168:171], v[72:75]
    s_add_u32 m0, m0, 4096
    s_nop 0
    buffer_load_dwordx4 v6, s[8:11], s24 offen offset:0 lds
    v_mfma_f32_16x16x32_bf16 v[76:79], a[16:19], a[172:175], v[76:79]
    ds_read_b128 a[184:187], v17 offset:4096
    ds_read_b128 a[188:191], v17 offset:6144
    v_mfma_f32_16x16x32_bf16 v[92:95], a[20:23], a[172:175], v[92:95]
    ds_read_b64_tr_b16 a[80:81], v18 offset:24576
    v_mfma_f32_16x16x32_bf16 v[88:91], a[20:23], a[168:171], v[88:91]
    v_mfma_f32_16x16x32_bf16 v[84:87], a[20:23], a[164:167], v[84:87]
    ds_read_b64_tr_b16 a[82:83], v18 offset:25088
    buffer_load_dwordx4 v7, s[8:11], s24 offen offset:1024 lds
    v_mfma_f32_16x16x32_bf16 v[80:83], a[20:23], a[160:163], v[80:83]
    ds_read_b64_tr_b16 a[84:85], v19 offset:24576
    v_mfma_f32_16x16x32_bf16 v[96:99], a[24:27], a[160:163], v[96:99]
    ds_read_b64_tr_b16 a[86:87], v19 offset:25088
    v_mfma_f32_16x16x32_bf16 v[100:103], a[24:27], a[164:167], v[100:103]
    ds_read_b64_tr_b16 a[88:89], v13 offset:24576
    v_mfma_f32_16x16x32_bf16 v[104:107], a[24:27], a[168:171], v[104:107]
    v_mfma_f32_16x16x32_bf16 v[108:111], a[24:27], a[172:175], v[108:111]
    ds_read_b64_tr_b16 a[90:91], v13 offset:25088
    buffer_load_dwordx4 v8, s[8:11], s24 offen offset:2048 lds
    v_mfma_f32_16x16x32_bf16 v[124:127], a[28:31], a[172:175], v[124:127]
    ds_read_b64_tr_b16 a[92:93], v58 offset:24576
    v_mfma_f32_16x16x32_bf16 v[120:123], a[28:31], a[168:171], v[120:123]
    ds_read_b64_tr_b16 a[94:95], v58 offset:25088
    v_mfma_f32_16x16x32_bf16 v[116:119], a[28:31], a[164:167], v[116:119]
    ds_read_b64_tr_b16 a[96:97], v18 offset:25600
    v_mfma_f32_16x16x32_bf16 v[112:115], a[28:31], a[160:163], v[112:115]
    buffer_load_dwordx4 v9, s[8:11], s24 offen offset:3072 lds
    ds_read_b64_tr_b16 a[98:99], v18 offset:26112
    v_mfma_f32_16x16x32_bf16 v[128:131], a[32:35], a[160:163], v[128:131]
    v_mfma_f32_16x16x32_bf16 v[132:135], a[32:35], a[164:167], v[132:135]
    ds_read_b64_tr_b16 a[100:101], v19 offset:25600
    v_mfma_f32_16x16x32_bf16 v[136:139], a[32:35], a[168:171], v[136:139]
    s_add_u32 s27, s27, 32768
    ds_read_b64_tr_b16 a[102:103], v19 offset:26112
    v_mfma_f32_16x16x32_bf16 v[140:143], a[32:35], a[172:175], v[140:143]
    s_cmp_eq_u32 s27, 98304
    s_cselect_b32 s27, 0, s27
    v_mfma_f32_16x16x32_bf16 v[156:159], a[36:39], a[172:175], v[156:159]
    s_add_u32 s25, s25, 229376
    ds_read_b64_tr_b16 a[104:105], v13 offset:25600
    v_mfma_f32_16x16x32_bf16 v[152:155], a[36:39], a[168:171], v[152:155]
    s_add_u32 m0, s30, 8192
    s_nop 0
    buffer_load_dwordx4 v10, s[12:15], s25 offen lds
    v_mfma_f32_16x16x32_bf16 v[148:151], a[36:39], a[164:167], v[148:151]
    ds_read_b64_tr_b16 a[106:107], v13 offset:26112
    v_mfma_f32_16x16x32_bf16 v[144:147], a[36:39], a[160:163], v[144:147]
    v_mfma_f32_16x16x32_bf16 v[160:163], a[40:43], a[160:163], v[160:163]
    buffer_load_dwordx4 v11, s[12:15], s25 offen offset:1024 lds
    v_mfma_f32_16x16x32_bf16 v[164:167], a[40:43], a[164:167], v[164:167]
    v_mfma_f32_16x16x32_bf16 v[168:171], a[40:43], a[168:171], v[168:171]
    v_mfma_f32_16x16x32_bf16 v[172:175], a[40:43], a[172:175], v[172:175]
    s_mov_b32 s41, s53
    s_waitcnt lgkmcnt(0)
    v_mfma_f32_16x16x32_bf16 v[64:67], a[80:83], a[176:179], v[64:67]
    s_waitcnt vmcnt(12)
    s_barrier
    v_mfma_f32_16x16x32_bf16 v[68:71], a[80:83], a[180:183], v[68:71]
    s_add_u32 s28, s28, 32768
    s_bfe_u32 s24, s56, 0x40000
    v_mfma_f32_16x16x32_bf16 v[72:75], a[80:83], a[184:187], v[72:75]
    s_cmp_eq_u32 s28, 98304
    s_cselect_b32 s28, 0, s28
    v_mfma_f32_16x16x32_bf16 v[76:79], a[80:83], a[188:191], v[76:79]
    s_lshl_b32 s24, s24, 7
    s_add_u32 m0, s29, s27
    v_mfma_f32_16x16x32_bf16 v[92:95], a[84:87], a[188:191], v[92:95]
    v_add_u32 v16, s28, v14
    buffer_load_dwordx4 v2, s[8:11], s24 offen offset:0 lds
    v_mfma_f32_16x16x32_bf16 v[88:91], a[84:87], a[184:187], v[88:91]
    ds_read_b64_tr_b16 a[16:17], v18 offset:32768
    ds_read_b64_tr_b16 a[18:19], v18 offset:33280
    v_mfma_f32_16x16x32_bf16 v[84:87], a[84:87], a[180:183], v[84:87]
    ds_read_b64_tr_b16 a[20:21], v19 offset:32768
    ds_read_b64_tr_b16 a[22:23], v19 offset:33280
    v_mfma_f32_16x16x32_bf16 v[80:83], a[84:87], a[176:179], v[80:83]
    buffer_load_dwordx4 v3, s[8:11], s24 offen offset:1024 lds
    ds_read_b64_tr_b16 a[24:25], v13 offset:32768
    v_mfma_f32_16x16x32_bf16 v[96:99], a[88:91], a[176:179], v[96:99]
    ds_read_b64_tr_b16 a[26:27], v13 offset:33280
    v_mfma_f32_16x16x32_bf16 v[100:103], a[88:91], a[180:183], v[100:103]
    ds_read_b64_tr_b16 a[28:29], v58 offset:32768
    v_mfma_f32_16x16x32_bf16 v[104:107], a[88:91], a[184:187], v[104:107]
    ds_read_b64_tr_b16 a[30:31], v58 offset:33280
    v_mfma_f32_16x16x32_bf16 v[108:111], a[88:91], a[188:191], v[108:111]
    ds_read_b64_tr_b16 a[32:33], v18 offset:33792
    buffer_load_dwordx4 v4, s[8:11], s24 offen offset:2048 lds
    v_mfma_f32_16x16x32_bf16 v[124:127], a[92:95], a[188:191], v[124:127]
    ds_read_b64_tr_b16 a[34:35], v18 offset:34304
    v_mfma_f32_16x16x32_bf16 v[120:123], a[92:95], a[184:187], v[120:123]
    ds_read_b64_tr_b16 a[36:37], v19 offset:33792
    v_mfma_f32_16x16x32_bf16 v[116:119], a[92:95], a[180:183], v[116:119]
    ds_read_b64_tr_b16 a[38:39], v19 offset:34304
    v_mfma_f32_16x16x32_bf16 v[112:115], a[92:95], a[176:179], v[112:115]
    ds_read_b64_tr_b16 a[40:41], v13 offset:33792
    v_mfma_f32_16x16x32_bf16 v[128:131], a[96:99], a[176:179], v[128:131]
    buffer_load_dwordx4 v5, s[8:11], s24 offen offset:3072 lds
    ds_read_b64_tr_b16 a[42:43], v13 offset:34304
    v_mfma_f32_16x16x32_bf16 v[132:135], a[96:99], a[180:183], v[132:135]
    v_add_u32 v17, s28, v15
    v_mfma_f32_16x16x32_bf16 v[136:139], a[96:99], a[184:187], v[136:139]
    ds_read_b128 a[192:195], v16 offset:0
    s_bfe_u32 s31, s56, 0x40000
    v_mfma_f32_16x16x32_bf16 v[140:143], a[96:99], a[188:191], v[140:143]
    s_mul_i32 s25, s31, 458752
    ds_read_b128 a[196:199], v16 offset:2048
    v_mfma_f32_16x16x32_bf16 v[156:159], a[100:103], a[188:191], v[156:159]
    s_add_u32 s25, s25, s41
    s_add_u32 m0, s30, 16384
    v_mfma_f32_16x16x32_bf16 v[152:155], a[100:103], a[184:187], v[152:155]
    ds_read_b128 a[200:203], v16 offset:4096
    buffer_load_dwordx4 v10, s[12:15], s25 offen lds
    v_mfma_f32_16x16x32_bf16 v[148:151], a[100:103], a[180:183], v[148:151]
    ds_read_b128 a[204:207], v16 offset:6144
    v_mfma_f32_16x16x32_bf16 v[144:147], a[100:103], a[176:179], v[144:147]
    v_mfma_f32_16x16x32_bf16 v[160:163], a[104:107], a[176:179], v[160:163]
    s_mov_b64 exec, s[42:43]
    buffer_load_dwordx4 v11, s[12:15], s25 offen offset:1024 lds
    s_mov_b64 exec, -1
    v_mfma_f32_16x16x32_bf16 v[164:167], a[104:107], a[180:183], v[164:167]
    v_mfma_f32_16x16x32_bf16 v[168:171], a[104:107], a[184:187], v[168:171]
    v_mfma_f32_16x16x32_bf16 v[172:175], a[104:107], a[188:191], v[172:175]
    s_waitcnt lgkmcnt(0)
    v_mfma_f32_16x16x32_bf16 v[64:67], a[16:19], a[192:195], v[64:67]
    ds_read_b128 a[208:211], v17 offset:0
    v_mfma_f32_16x16x32_bf16 v[68:71], a[16:19], a[196:199], v[68:71]
    ds_read_b128 a[212:215], v17 offset:2048
    s_add_u32 m0, s29, s27
    v_mfma_f32_16x16x32_bf16 v[72:75], a[16:19], a[200:203], v[72:75]
    s_add_u32 m0, m0, 4096
    s_nop 0
    buffer_load_dwordx4 v6, s[8:11], s24 offen offset:0 lds
    v_mfma_f32_16x16x32_bf16 v[76:79], a[16:19], a[204:207], v[76:79]
    ds_read_b128 a[216:219], v17 offset:4096
    ds_read_b128 a[220:223], v17 offset:6144
    v_mfma_f32_16x16x32_bf16 v[92:95], a[20:23], a[204:207], v[92:95]
    ds_read_b64_tr_b16 a[80:81], v18 offset:40960
    v_mfma_f32_16x16x32_bf16 v[88:91], a[20:23], a[200:203], v[88:91]
    v_mfma_f32_16x16x32_bf16 v[84:87], a[20:23], a[196:199], v[84:87]
    ds_read_b64_tr_b16 a[82:83], v18 offset:41472
    buffer_load_dwordx4 v7, s[8:11], s24 offen offset:1024 lds
    v_mfma_f32_16x16x32_bf16 v[80:83], a[20:23], a[192:195], v[80:83]
    ds_read_b64_tr_b16 a[84:85], v19 offset:40960
    v_mfma_f32_16x16x32_bf16 v[96:99], a[24:27], a[192:195], v[96:99]
    ds_read_b64_tr_b16 a[86:87], v19 offset:41472
    v_mfma_f32_16x16x32_bf16 v[100:103], a[24:27], a[196:199], v[100:103]
    ds_read_b64_tr_b16 a[88:89], v13 offset:40960
    v_mfma_f32_16x16x32_bf16 v[104:107], a[24:27], a[200:203], v[104:107]
    v_mfma_f32_16x16x32_bf16 v[108:111], a[24:27], a[204:207], v[108:111]
    ds_read_b64_tr_b16 a[90:91], v13 offset:41472
    buffer_load_dwordx4 v8, s[8:11], s24 offen offset:2048 lds
    v_mfma_f32_16x16x32_bf16 v[124:127], a[28:31], a[204:207], v[124:127]
    ds_read_b64_tr_b16 a[92:93], v58 offset:40960
    v_mfma_f32_16x16x32_bf16 v[120:123], a[28:31], a[200:203], v[120:123]
    ds_read_b64_tr_b16 a[94:95], v58 offset:41472
    v_mfma_f32_16x16x32_bf16 v[116:119], a[28:31], a[196:199], v[116:119]
    ds_read_b64_tr_b16 a[96:97], v18 offset:41984
    v_mfma_f32_16x16x32_bf16 v[112:115], a[28:31], a[192:195], v[112:115]
    buffer_load_dwordx4 v9, s[8:11], s24 offen offset:3072 lds
    ds_read_b64_tr_b16 a[98:99], v18 offset:42496
    v_mfma_f32_16x16x32_bf16 v[128:131], a[32:35], a[192:195], v[128:131]
    v_mfma_f32_16x16x32_bf16 v[132:135], a[32:35], a[196:199], v[132:135]
    ds_read_b64_tr_b16 a[100:101], v19 offset:41984
    v_mfma_f32_16x16x32_bf16 v[136:139], a[32:35], a[200:203], v[136:139]
    s_add_u32 s27, s27, 32768
    ds_read_b64_tr_b16 a[102:103], v19 offset:42496
    v_mfma_f32_16x16x32_bf16 v[140:143], a[32:35], a[204:207], v[140:143]
    s_cmp_eq_u32 s27, 98304
    s_cselect_b32 s27, 0, s27
    v_mfma_f32_16x16x32_bf16 v[156:159], a[36:39], a[204:207], v[156:159]
    s_add_u32 s25, s25, 229376
    ds_read_b64_tr_b16 a[104:105], v13 offset:41984
    v_mfma_f32_16x16x32_bf16 v[152:155], a[36:39], a[200:203], v[152:155]
    s_add_u32 m0, s30, 24576
    s_nop 0
    buffer_load_dwordx4 v10, s[12:15], s25 offen lds
    v_mfma_f32_16x16x32_bf16 v[148:151], a[36:39], a[196:199], v[148:151]
    ds_read_b64_tr_b16 a[106:107], v13 offset:42496
    v_mfma_f32_16x16x32_bf16 v[144:147], a[36:39], a[192:195], v[144:147]
    v_mfma_f32_16x16x32_bf16 v[160:163], a[40:43], a[192:195], v[160:163]
    s_mov_b64 exec, s[42:43]
    buffer_load_dwordx4 v11, s[12:15], s25 offen offset:1024 lds
    s_mov_b64 exec, -1
    v_mfma_f32_16x16x32_bf16 v[164:167], a[40:43], a[196:199], v[164:167]
    v_mfma_f32_16x16x32_bf16 v[168:171], a[40:43], a[200:203], v[168:171]
    v_mfma_f32_16x16x32_bf16 v[172:175], a[40:43], a[204:207], v[172:175]
    s_waitcnt lgkmcnt(0)
    v_mfma_f32_16x16x32_bf16 v[64:67], a[80:83], a[208:211], v[64:67]
    s_waitcnt vmcnt(12)
    s_barrier
    v_mfma_f32_16x16x32_bf16 v[68:71], a[80:83], a[212:215], v[68:71]
    s_add_u32 s28, s28, 32768
    s_bfe_u32 s24, s56, 0x40004
    v_mfma_f32_16x16x32_bf16 v[72:75], a[80:83], a[216:219], v[72:75]
    s_lshl_b32 s24, s24, 7
    s_add_u32 m0, s29, s27
    v_mfma_f32_16x16x32_bf16 v[76:79], a[80:83], a[220:223], v[76:79]
    s_cmp_eq_u32 s28, 98304
    s_cselect_b32 s28, 0, s28
    v_mfma_f32_16x16x32_bf16 v[92:95], a[84:87], a[220:223], v[92:95]
    buffer_load_dwordx4 v2, s[8:11], s24 offen offset:0 lds
    v_add_u32 v16, s28, v14
    v_mfma_f32_16x16x32_bf16 v[88:91], a[84:87], a[216:219], v[88:91]
    ds_read_b64_tr_b16 a[16:17], v18 offset:0
    ds_read_b64_tr_b16 a[18:19], v18 offset:512
    v_mfma_f32_16x16x32_bf16 v[84:87], a[84:87], a[212:215], v[84:87]
    buffer_load_dwordx4 v3, s[8:11], s24 offen offset:1024 lds
    ds_read_b64_tr_b16 a[20:21], v19 offset:0
    v_mfma_f32_16x16x32_bf16 v[80:83], a[84:87], a[208:211], v[80:83]
    ds_read_b64_tr_b16 a[22:23], v19 offset:512
    ds_read_b64_tr_b16 a[24:25], v13 offset:0
    v_mfma_f32_16x16x32_bf16 v[96:99], a[88:91], a[208:211], v[96:99]
    ds_read_b64_tr_b16 a[26:27], v13 offset:512
    buffer_load_dwordx4 v4, s[8:11], s24 offen offset:2048 lds
    v_mfma_f32_16x16x32_bf16 v[100:103], a[88:91], a[212:215], v[100:103]
    ds_read_b64_tr_b16 a[28:29], v58 offset:0
    v_mfma_f32_16x16x32_bf16 v[104:107], a[88:91], a[216:219], v[104:107]
    ds_read_b64_tr_b16 a[30:31], v58 offset:512
    v_mfma_f32_16x16x32_bf16 v[108:111], a[88:91], a[220:223], v[108:111]
    ds_read_b64_tr_b16 a[32:33], v18 offset:1024
    v_mfma_f32_16x16x32_bf16 v[124:127], a[92:95], a[220:223], v[124:127]
    buffer_load_dwordx4 v5, s[8:11], s24 offen offset:3072 lds
    ds_read_b64_tr_b16 a[34:35], v18 offset:1536
    v_mfma_f32_16x16x32_bf16 v[120:123], a[92:95], a[216:219], v[120:123]
    s_bfe_u32 s31, s56, 0x40004
    ds_read_b64_tr_b16 a[36:37], v19 offset:1024
    v_mfma_f32_16x16x32_bf16 v[116:119], a[92:95], a[212:215], v[116:119]
    s_mul_i32 s25, s31, 458752
    s_add_u32 s25, s25, s41
    v_mfma_f32_16x16x32_bf16 v[112:115], a[92:95], a[208:211], v[112:115]
    ds_read_b64_tr_b16 a[38:39], v19 offset:1536
    s_add_u32 m0, s30, 32768
    v_mfma_f32_16x16x32_bf16 v[128:131], a[96:99], a[208:211], v[128:131]
    buffer_load_dwordx4 v10, s[12:15], s25 offen lds
    ds_read_b64_tr_b16 a[40:41], v13 offset:1024
    v_mfma_f32_16x16x32_bf16 v[132:135], a[96:99], a[212:215], v[132:135]
    ds_read_b64_tr_b16 a[42:43], v13 offset:1536
    v_add_u32 v17, s28, v15
    v_mfma_f32_16x16x32_bf16 v[136:139], a[96:99], a[216:219], v[136:139]
    ds_read_b128 a[224:227], v16 offset:0
    v_mfma_f32_16x16x32_bf16 v[140:143], a[96:99], a[220:223], v[140:143]
    s_mov_b64 exec, s[42:43]
    buffer_load_dwordx4 v11, s[12:15], s25 offen offset:1024 lds
    s_mov_b64 exec, -1
    v_mfma_f32_16x16x32_bf16 v[156:159], a[100:103], a[220:223], v[156:159]
    ds_read_b128 a[228:231], v16 offset:2048
    ds_read_b128 a[232:235], v16 offset:4096
    v_mfma_f32_16x16x32_bf16 v[152:155], a[100:103], a[216:219], v[152:155]
    ds_read_b128 a[236:239], v16 offset:6144
    v_mfma_f32_16x16x32_bf16 v[148:151], a[100:103], a[212:215], v[148:151]
    s_mov_b32 s4, s84
    s_mov_b32 s5, s85
    v_mfma_f32_16x16x32_bf16 v[144:147], a[100:103], a[208:211], v[144:147]
    s_mov_b32 s6, 0x100
    s_mov_b32 s7, 0x20000
    v_mfma_f32_16x16x32_bf16 v[160:163], a[104:107], a[208:211], v[160:163]
    v_mov_b32 v59, 0
    buffer_load_dword v60, v59, s[4:7], 0 offen sc1
    v_mfma_f32_16x16x32_bf16 v[164:167], a[104:107], a[212:215], v[164:167]
    v_mfma_f32_16x16x32_bf16 v[168:171], a[104:107], a[216:219], v[168:171]
    v_mfma_f32_16x16x32_bf16 v[172:175], a[104:107], a[220:223], v[172:175]
    s_waitcnt lgkmcnt(0)
    v_mfma_f32_16x16x32_bf16 v[64:67], a[16:19], a[224:227], v[64:67]
    ds_read_b128 a[240:243], v17 offset:0
    v_mfma_f32_16x16x32_bf16 v[68:71], a[16:19], a[228:231], v[68:71]
    ds_read_b128 a[244:247], v17 offset:2048
    s_add_u32 m0, s29, s27
    v_mfma_f32_16x16x32_bf16 v[72:75], a[16:19], a[232:235], v[72:75]
    s_add_u32 m0, m0, 4096
    s_nop 0
    buffer_load_dwordx4 v6, s[8:11], s24 offen offset:0 lds
    v_mfma_f32_16x16x32_bf16 v[76:79], a[16:19], a[236:239], v[76:79]
    ds_read_b128 a[248:251], v17 offset:4096
    ds_read_b128 a[252:255], v17 offset:6144
    v_mfma_f32_16x16x32_bf16 v[92:95], a[20:23], a[236:239], v[92:95]
    ds_read_b64_tr_b16 a[80:81], v18 offset:8192
    v_mfma_f32_16x16x32_bf16 v[88:91], a[20:23], a[232:235], v[88:91]
    v_mfma_f32_16x16x32_bf16 v[84:87], a[20:23], a[228:231], v[84:87]
    ds_read_b64_tr_b16 a[82:83], v18 offset:8704
    buffer_load_dwordx4 v7, s[8:11], s24 offen offset:1024 lds
    v_mfma_f32_16x16x32_bf16 v[80:83], a[20:23], a[224:227], v[80:83]
    ds_read_b64_tr_b16 a[84:85], v19 offset:8192
    v_mfma_f32_16x16x32_bf16 v[96:99], a[24:27], a[224:227], v[96:99]
    ds_read_b64_tr_b16 a[86:87], v19 offset:8704
    v_mfma_f32_16x16x32_bf16 v[100:103], a[24:27], a[228:231], v[100:103]
    ds_read_b64_tr_b16 a[88:89], v13 offset:8192
    v_mfma_f32_16x16x32_bf16 v[104:107], a[24:27], a[232:235], v[104:107]
    v_mfma_f32_16x16x32_bf16 v[108:111], a[24:27], a[236:239], v[108:111]
    ds_read_b64_tr_b16 a[90:91], v13 offset:8704
    buffer_load_dwordx4 v8, s[8:11], s24 offen offset:2048 lds
    v_mfma_f32_16x16x32_bf16 v[124:127], a[28:31], a[236:239], v[124:127]
    ds_read_b64_tr_b16 a[92:93], v58 offset:8192
    v_mfma_f32_16x16x32_bf16 v[120:123], a[28:31], a[232:235], v[120:123]
    ds_read_b64_tr_b16 a[94:95], v58 offset:8704
    v_mfma_f32_16x16x32_bf16 v[116:119], a[28:31], a[228:231], v[116:119]
    ds_read_b64_tr_b16 a[96:97], v18 offset:9216
    v_mfma_f32_16x16x32_bf16 v[112:115], a[28:31], a[224:227], v[112:115]
    buffer_load_dwordx4 v9, s[8:11], s24 offen offset:3072 lds
    ds_read_b64_tr_b16 a[98:99], v18 offset:9728
    v_mfma_f32_16x16x32_bf16 v[128:131], a[32:35], a[224:227], v[128:131]
    v_mfma_f32_16x16x32_bf16 v[132:135], a[32:35], a[228:231], v[132:135]
    ds_read_b64_tr_b16 a[100:101], v19 offset:9216
    v_mfma_f32_16x16x32_bf16 v[136:139], a[32:35], a[232:235], v[136:139]
    s_add_u32 s27, s27, 32768
    ds_read_b64_tr_b16 a[102:103], v19 offset:9728
    v_mfma_f32_16x16x32_bf16 v[140:143], a[32:35], a[236:239], v[140:143]
    s_cmp_eq_u32 s27, 98304
    s_cselect_b32 s27, 0, s27
    v_mfma_f32_16x16x32_bf16 v[156:159], a[36:39], a[236:239], v[156:159]
    s_add_u32 s25, s25, 229376
    ds_read_b64_tr_b16 a[104:105], v13 offset:9216
    v_mfma_f32_16x16x32_bf16 v[152:155], a[36:39], a[232:235], v[152:155]
    s_add_u32 m0, s30, 40960
    s_nop 0
    buffer_load_dwordx4 v10, s[12:15], s25 offen lds
    v_mfma_f32_16x16x32_bf16 v[148:151], a[36:39], a[228:231], v[148:151]
    ds_read_b64_tr_b16 a[106:107], v13 offset:9728
    v_mfma_f32_16x16x32_bf16 v[144:147], a[36:39], a[224:227], v[144:147]
    v_mfma_f32_16x16x32_bf16 v[160:163], a[40:43], a[224:227], v[160:163]
    s_mov_b64 exec, s[42:43]
    buffer_load_dwordx4 v11, s[12:15], s25 offen offset:1024 lds
    s_mov_b64 exec, -1
    v_mfma_f32_16x16x32_bf16 v[164:167], a[40:43], a[228:231], v[164:167]
    v_mfma_f32_16x16x32_bf16 v[168:171], a[40:43], a[232:235], v[168:171]
    v_mfma_f32_16x16x32_bf16 v[172:175], a[40:43], a[236:239], v[172:175]
    s_waitcnt lgkmcnt(0)
    v_mfma_f32_16x16x32_bf16 v[64:67], a[80:83], a[240:243], v[64:67]
    s_waitcnt vmcnt(13)
    s_barrier
    v_mfma_f32_16x16x32_bf16 v[68:71], a[80:83], a[244:247], v[68:71]
    s_add_u32 s28, s28, 32768
    s_bfe_u32 s24, s56, 0x40008
    v_mfma_f32_16x16x32_bf16 v[72:75], a[80:83], a[248:251], v[72:75]
    s_lshl_b32 s24, s24, 7
    s_add_u32 m0, s29, s27
    v_mfma_f32_16x16x32_bf16 v[76:79], a[80:83], a[252:255], v[76:79]
    s_cmp_eq_u32 s28, 98304
    s_cselect_b32 s28, 0, s28
    v_mfma_f32_16x16x32_bf16 v[92:95], a[84:87], a[252:255], v[92:95]
    buffer_load_dwordx4 v2, s[8:11], s24 offen offset:0 lds
    v_add_u32 v16, s28, v14
    v_mfma_f32_16x16x32_bf16 v[88:91], a[84:87], a[248:251], v[88:91]
    ds_read_b64_tr_b16 a[16:17], v18 offset:16384
    ds_read_b64_tr_b16 a[18:19], v18 offset:16896
    v_mfma_f32_16x16x32_bf16 v[84:87], a[84:87], a[244:247], v[84:87]
    ds_read_b64_tr_b16 a[20:21], v19 offset:16384
    v_mfma_f32_16x16x32_bf16 v[80:83], a[84:87], a[240:243], v[80:83]
    buffer_load_dwordx4 v3, s[8:11], s24 offen offset:1024 lds
    v_mfma_f32_16x16x32_bf16 v[96:99], a[88:91], a[240:243], v[96:99]
    ds_read_b64_tr_b16 a[22:23], v19 offset:16896
    v_mfma_f32_16x16x32_bf16 v[100:103], a[88:91], a[244:247], v[100:103]
    ds_read_b64_tr_b16 a[24:25], v13 offset:16384
    v_mfma_f32_16x16x32_bf16 v[104:107], a[88:91], a[248:251], v[104:107]
    ds_read_b64_tr_b16 a[26:27], v13 offset:16896
    v_mfma_f32_16x16x32_bf16 v[108:111], a[88:91], a[252:255], v[108:111]
    ds_read_b64_tr_b16 a[28:29], v58 offset:16384
    buffer_load_dwordx4 v4, s[8:11], s24 offen offset:2048 lds
    v_mfma_f32_16x16x32_bf16 v[124:127], a[92:95], a[252:255], v[124:127]
    ds_read_b64_tr_b16 a[30:31], v58 offset:16896
    v_mfma_f32_16x16x32_bf16 v[120:123], a[92:95], a[248:251], v[120:123]
    ds_read_b64_tr_b16 a[32:33], v18 offset:17408
    v_mfma_f32_16x16x32_bf16 v[116:119], a[92:95], a[244:247], v[116:119]
    v_mfma_f32_16x16x32_bf16 v[112:115], a[92:95], a[240:243], v[112:115]
    ds_read_b64_tr_b16 a[34:35], v18 offset:17920
    v_mfma_f32_16x16x32_bf16 v[128:131], a[96:99], a[240:243], v[128:131]
    v_add_u32 v17, s28, v15
    buffer_load_dwordx4 v5, s[8:11], s24 offen offset:3072 lds
    v_mfma_f32_16x16x32_bf16 v[132:135], a[96:99], a[244:247], v[132:135]
    ds_read_b128 a[0:3], v16 offset:0
    v_mfma_f32_16x16x32_bf16 v[136:139], a[96:99], a[248:251], v[136:139]
    ds_read_b128 a[4:7], v16 offset:2048
    s_bfe_u32 s31, s57, 0x40010
    v_mfma_f32_16x16x32_bf16 v[140:143], a[96:99], a[252:255], v[140:143]
    s_mul_i32 s25, s31, 458752
    s_add_u32 s25, s25, s41
    v_mfma_f32_16x16x32_bf16 v[156:159], a[100:103], a[252:255], v[156:159]
    ds_read_b128 a[8:11], v16 offset:4096
    s_add_u32 m0, s30, 0
    v_mfma_f32_16x16x32_bf16 v[152:155], a[100:103], a[248:251], v[152:155]
    buffer_load_dwordx4 v10, s[12:15], s25 offen lds
    ds_read_b128 a[12:15], v16 offset:6144
    v_mfma_f32_16x16x32_bf16 v[148:151], a[100:103], a[244:247], v[148:151]
    v_mfma_f32_16x16x32_bf16 v[144:147], a[100:103], a[240:243], v[144:147]
    v_mfma_f32_16x16x32_bf16 v[160:163], a[104:107], a[240:243], v[160:163]
    s_mov_b64 exec, s[42:43]
    buffer_load_dwordx4 v11, s[12:15], s25 offen offset:1024 lds
    s_mov_b64 exec, -1
    v_mfma_f32_16x16x32_bf16 v[164:167], a[104:107], a[244:247], v[164:167]
    v_mfma_f32_16x16x32_bf16 v[168:171], a[104:107], a[248:251], v[168:171]
    v_mfma_f32_16x16x32_bf16 v[172:175], a[104:107], a[252:255], v[172:175]
    s_mov_b32 s4, s74
    s_mov_b32 s5, s75
    s_mov_b32 s6, 0x800000
    s_mov_b32 s7, 0x20000
    s_lshl_b32 s46, s2, 2
    s_add_u32 s46, s46, s3
    s_mul_i32 s46, s46, 8192
    v_lshlrev_b32 v62, 7, v0
    s_mov_b32 exec_hi, 0x0
    buffer_load_dword v63, v62, s[4:7], s46 offen
    s_mov_b64 exec, -1
    s_mov_b32 s4, s74
    s_mov_b32 s5, s75
    s_mov_b32 s6, 0x800000
    s_mov_b32 s7, 0x20000
    s_lshl_b32 s46, s2, 2
    s_add_u32 s46, s46, s3
    s_mul_i32 s46, s46, 8192
    s_add_u32 s46, s46, 4096
    v_lshlrev_b32 v62, 7, v0
    s_mov_b32 exec_hi, 0x0
    buffer_load_dword v63, v62, s[4:7], s46 offen
    s_mov_b64 exec, -1
    s_mov_b32 s4, s68
    s_mov_b32 s5, s69
    s_mov_b32 s6, 0x200000
    s_mov_b32 s7, 0x20000
    s_lshl_b32 s46, s2, 2
    s_add_u32 s46, s46, s3
    s_mul_i32 s46, s46, 2048
    v_lshlrev_b32 v62, 7, v0
    s_mov_b64 exec, 0xffff
    buffer_load_dword v63, v62, s[4:7], s46 offen
    s_mov_b64 exec, -1
    s_mov_b32 s4, s78
    s_mov_b32 s5, s79
    s_mov_b32 s6, 0x380000
    s_mov_b32 s7, 0x20000
    s_lshl_b32 s46, s2, 2
    s_add_u32 s46, s46, s3
    s_mul_i32 s46, s46, 3584
    v_lshlrev_b32 v62, 7, v0
    s_mov_b64 exec, 0xfffffff
    buffer_load_dword v63, v62, s[4:7], s46 offen
    s_mov_b64 exec, -1
    s_waitcnt vmcnt(16)
    s_mov_b32 s4, s84
    s_mov_b32 s5, s85
    s_mov_b32 s6, 0x100
    s_mov_b32 s7, 0x20000
    v_mov_b32 v59, 0
    s_mov_b32 s47, 0
    v_cmp_gt_u32 vcc, 160, v60
    s_nop 1
    s_cmp_eq_u64 vcc, 0
    s_cbranch_scc1 L_polled_1_15
L_poll_1_14:
    buffer_load_dword v60, v59, s[4:7], 0 offen sc1
    s_waitcnt vmcnt(0)
    v_cmp_gt_u32 vcc, 160, v60
    s_nop 1
    s_cmp_eq_u64 vcc, 0
    s_cbranch_scc1 L_polled_1_15
    s_add_u32 s47, s47, 1
    s_cmp_lt_u32 s47, 262144
    s_cbranch_scc1 L_poll_1_14
L_polled_1_15:
    s_nop 1
    s_mov_b32 s60, 0xbdd2d3e8
    s_mov_b32 s61, 0xbdd2d3e8
    s_mov_b32 s62, 1.0
    s_mov_b32 s63, 1.0
    v_mov_b32 v176, 0xc0135761
    v_mov_b32 v177, 0xc0135761
    v_pk_mul_f32 v[200:201], v[64:65], v[64:65]
    v_pk_mul_f32 v[202:203], v[68:69], v[68:69]
    v_pk_mul_f32 v[204:205], v[72:73], v[72:73]
    v_pk_mul_f32 v[206:207], v[76:77], v[76:77]
    v_pk_fma_f32 v[200:201], v[200:201], s[60:61], v[176:177]
    v_pk_fma_f32 v[202:203], v[202:203], s[60:61], v[176:177]
    v_pk_fma_f32 v[204:205], v[204:205], s[60:61], v[176:177]
    v_pk_fma_f32 v[206:207], v[206:207], s[60:61], v[176:177]
    v_pk_mul_f32 v[200:201], v[200:201], v[64:65]
    v_pk_mul_f32 v[202:203], v[202:203], v[68:69]
    v_pk_mul_f32 v[204:205], v[204:205], v[72:73]
    v_pk_mul_f32 v[206:207], v[206:207], v[76:77]
    v_exp_f32 v200, v200
    v_pk_mul_f32 v[208:209], v[66:67], v[66:67]
    v_exp_f32 v201, v201
    v_pk_mul_f32 v[210:211], v[70:71], v[70:71]
    v_pk_mul_f32 v[212:213], v[74:75], v[74:75]
    v_exp_f32 v202, v202
    v_pk_mul_f32 v[214:215], v[78:79], v[78:79]
    v_exp_f32 v203, v203
    v_pk_fma_f32 v[208:209], v[208:209], s[60:61], v[176:177]
    v_pk_fma_f32 v[210:211], v[210:211], s[60:61], v[176:177]
    v_exp_f32 v204, v204
    v_pk_fma_f32 v[212:213], v[212:213], s[60:61], v[176:177]
    v_exp_f32 v205, v205
    v_pk_fma_f32 v[214:215], v[214:215], s[60:61], v[176:177]
    v_pk_mul_f32 v[208:209], v[208:209], v[66:67]
    v_exp_f32 v206, v206
    v_pk_mul_f32 v[210:211], v[210:211], v[70:71]
    v_exp_f32 v207, v207
    v_pk_mul_f32 v[212:213], v[212:213], v[74:75]
    v_pk_mul_f32 v[214:215], v[214:215], v[78:79]
    v_exp_f32 v208, v208
    v_pk_add_f32 v[200:201], v[200:201], s[62:63]
    v_exp_f32 v209, v209
    v_pk_add_f32 v[202:203], v[202:203], s[62:63]
    v_exp_f32 v210, v210
    v_pk_add_f32 v[204:205], v[204:205], s[62:63]
    v_exp_f32 v211, v211
    v_pk_add_f32 v[206:207], v[206:207], s[62:63]
    v_exp_f32 v212, v212
    v_pk_mul_f32 v[216:217], v[80:81], v[80:81]
    v_exp_f32 v213, v213
    v_pk_mul_f32 v[218:219], v[84:85], v[84:85]
    v_exp_f32 v214, v214
    v_pk_mul_f32 v[220:221], v[88:89], v[88:89]
    v_exp_f32 v215, v215
    v_pk_mul_f32 v[222:223], v[92:93], v[92:93]
    v_rcp_f32 v200, v200
    v_pk_fma_f32 v[216:217], v[216:217], s[60:61], v[176:177]
    v_rcp_f32 v201, v201
    v_pk_fma_f32 v[218:219], v[218:219], s[60:61], v[176:177]
    v_rcp_f32 v202, v202
    v_pk_fma_f32 v[220:221], v[220:221], s[60:61], v[176:177]
    v_rcp_f32 v203, v203
    v_pk_fma_f32 v[222:223], v[222:223], s[60:61], v[176:177]
    v_rcp_f32 v204, v204
    v_pk_mul_f32 v[216:217], v[216:217], v[80:81]
    v_rcp_f32 v205, v205
    v_pk_mul_f32 v[218:219], v[218:219], v[84:85]
    v_rcp_f32 v206, v206
    v_pk_mul_f32 v[220:221], v[220:221], v[88:89]
    v_rcp_f32 v207, v207
    v_pk_mul_f32 v[222:223], v[222:223], v[92:93]
    v_exp_f32 v216, v216
    v_pk_add_f32 v[208:209], v[208:209], s[62:63]
    v_exp_f32 v217, v217
    v_pk_add_f32 v[210:211], v[210:211], s[62:63]
    v_pk_add_f32 v[212:213], v[212:213], s[62:63]
    v_exp_f32 v218, v218
    v_pk_add_f32 v[214:215], v[214:215], s[62:63]
    v_pk_mul_f32 v[64:65], v[64:65], v[200:201]
    v_exp_f32 v219, v219
    v_pk_mul_f32 v[68:69], v[68:69], v[202:203]
    v_pk_mul_f32 v[72:73], v[72:73], v[204:205]
    v_exp_f32 v220, v220
    v_pk_mul_f32 v[76:77], v[76:77], v[206:207]
    v_exp_f32 v221, v221
    v_pk_mul_f32 v[182:183], v[64:65], v[64:65]
    v_pk_mul_f32 v[186:187], v[68:69], v[68:69]
    v_exp_f32 v222, v222
    v_pk_mul_f32 v[190:191], v[72:73], v[72:73]
    v_pk_mul_f32 v[194:195], v[76:77], v[76:77]
    v_exp_f32 v223, v223
    v_pk_mul_f32 v[180:181], v[64:65], s[62:63]
    v_pk_mul_f32 v[184:185], v[68:69], s[62:63]
    v_rcp_f32 v208, v208
    v_pk_mul_f32 v[188:189], v[72:73], s[62:63]
    v_rcp_f32 v209, v209
    v_pk_mul_f32 v[192:193], v[76:77], s[62:63]
    v_pk_mul_f32 v[224:225], v[82:83], v[82:83]
    v_rcp_f32 v210, v210
    v_pk_mul_f32 v[226:227], v[86:87], v[86:87]
    v_pk_mul_f32 v[228:229], v[90:91], v[90:91]
    v_rcp_f32 v211, v211
    v_pk_mul_f32 v[230:231], v[94:95], v[94:95]
    v_pk_fma_f32 v[224:225], v[224:225], s[60:61], v[176:177]
    v_rcp_f32 v212, v212
    v_pk_fma_f32 v[226:227], v[226:227], s[60:61], v[176:177]
    v_rcp_f32 v213, v213
    v_pk_fma_f32 v[228:229], v[228:229], s[60:61], v[176:177]
    v_pk_fma_f32 v[230:231], v[230:231], s[60:61], v[176:177]
    v_rcp_f32 v214, v214
    v_pk_mul_f32 v[224:225], v[224:225], v[82:83]
    v_pk_mul_f32 v[226:227], v[226:227], v[86:87]
    v_rcp_f32 v215, v215
    v_pk_mul_f32 v[228:229], v[228:229], v[90:91]
    v_pk_mul_f32 v[230:231], v[230:231], v[94:95]
    v_exp_f32 v224, v224
    v_pk_add_f32 v[216:217], v[216:217], s[62:63]
    v_exp_f32 v225, v225
    v_pk_add_f32 v[218:219], v[218:219], s[62:63]
    v_pk_add_f32 v[220:221], v[220:221], s[62:63]
    v_exp_f32 v226, v226
    v_pk_add_f32 v[222:223], v[222:223], s[62:63]
    v_pk_mul_f32 v[66:67], v[66:67], v[208:209]
    v_exp_f32 v227, v227
    v_pk_mul_f32 v[70:71], v[70:71], v[210:211]
    v_pk_mul_f32 v[74:75], v[74:75], v[212:213]
    v_exp_f32 v228, v228
    v_pk_mul_f32 v[78:79], v[78:79], v[214:215]
    v_exp_f32 v229, v229
    v_pk_fma_f32 v[182:183], v[66:67], v[66:67], v[182:183]
    v_pk_fma_f32 v[186:187], v[70:71], v[70:71], v[186:187]
    v_exp_f32 v230, v230
    v_pk_fma_f32 v[190:191], v[74:75], v[74:75], v[190:191]
    v_pk_fma_f32 v[194:195], v[78:79], v[78:79], v[194:195]
    v_exp_f32 v231, v231
    v_pk_add_f32 v[180:181], v[180:181], v[66:67]
    v_pk_add_f32 v[184:185], v[184:185], v[70:71]
    v_rcp_f32 v216, v216
    v_pk_add_f32 v[188:189], v[188:189], v[74:75]
    v_rcp_f32 v217, v217
    v_pk_add_f32 v[192:193], v[192:193], v[78:79]
    v_pk_mul_f32 v[200:201], v[96:97], v[96:97]
    v_rcp_f32 v218, v218
    v_pk_mul_f32 v[202:203], v[100:101], v[100:101]
    v_pk_mul_f32 v[204:205], v[104:105], v[104:105]
    v_rcp_f32 v219, v219
    v_pk_mul_f32 v[206:207], v[108:109], v[108:109]
    v_pk_fma_f32 v[200:201], v[200:201], s[60:61], v[176:177]
    v_rcp_f32 v220, v220
    v_pk_fma_f32 v[202:203], v[202:203], s[60:61], v[176:177]
    v_rcp_f32 v221, v221
    v_pk_fma_f32 v[204:205], v[204:205], s[60:61], v[176:177]
    v_pk_fma_f32 v[206:207], v[206:207], s[60:61], v[176:177]
    v_rcp_f32 v222, v222
    v_pk_mul_f32 v[200:201], v[200:201], v[96:97]
    v_pk_mul_f32 v[202:203], v[202:203], v[100:101]
    v_rcp_f32 v223, v223
    v_pk_mul_f32 v[204:205], v[204:205], v[104:105]
    v_pk_mul_f32 v[206:207], v[206:207], v[108:109]
    v_exp_f32 v200, v200
    v_pk_add_f32 v[224:225], v[224:225], s[62:63]
    v_exp_f32 v201, v201
    v_pk_add_f32 v[226:227], v[226:227], s[62:63]
    v_pk_add_f32 v[228:229], v[228:229], s[62:63]
    v_exp_f32 v202, v202
    v_pk_add_f32 v[230:231], v[230:231], s[62:63]
    v_pk_mul_f32 v[80:81], v[80:81], v[216:217]
    v_exp_f32 v203, v203
    v_pk_mul_f32 v[84:85], v[84:85], v[218:219]
    v_pk_mul_f32 v[88:89], v[88:89], v[220:221]
    v_exp_f32 v204, v204
    v_pk_mul_f32 v[92:93], v[92:93], v[222:223]
    v_exp_f32 v205, v205
    v_pk_fma_f32 v[182:183], v[80:81], v[80:81], v[182:183]
    v_pk_fma_f32 v[186:187], v[84:85], v[84:85], v[186:187]
    v_exp_f32 v206, v206
    v_pk_fma_f32 v[190:191], v[88:89], v[88:89], v[190:191]
    v_pk_fma_f32 v[194:195], v[92:93], v[92:93], v[194:195]
    v_exp_f32 v207, v207
    v_pk_add_f32 v[180:181], v[180:181], v[80:81]
    v_pk_add_f32 v[184:185], v[184:185], v[84:85]
    v_rcp_f32 v224, v224
    v_pk_add_f32 v[188:189], v[188:189], v[88:89]
    v_rcp_f32 v225, v225
    v_pk_add_f32 v[192:193], v[192:193], v[92:93]
    v_pk_mul_f32 v[208:209], v[98:99], v[98:99]
    v_rcp_f32 v226, v226
    v_pk_mul_f32 v[210:211], v[102:103], v[102:103]
    v_pk_mul_f32 v[212:213], v[106:107], v[106:107]
    v_rcp_f32 v227, v227
    v_pk_mul_f32 v[214:215], v[110:111], v[110:111]
    v_pk_fma_f32 v[208:209], v[208:209], s[60:61], v[176:177]
    v_rcp_f32 v228, v228
    v_pk_fma_f32 v[210:211], v[210:211], s[60:61], v[176:177]
    v_rcp_f32 v229, v229
    v_pk_fma_f32 v[212:213], v[212:213], s[60:61], v[176:177]
    v_pk_fma_f32 v[214:215], v[214:215], s[60:61], v[176:177]
    v_rcp_f32 v230, v230
    v_pk_mul_f32 v[208:209], v[208:209], v[98:99]
    v_pk_mul_f32 v[210:211], v[210:211], v[102:103]
    v_rcp_f32 v231, v231
    v_pk_mul_f32 v[212:213], v[212:213], v[106:107]
    v_pk_mul_f32 v[214:215], v[214:215], v[110:111]
    v_exp_f32 v208, v208
    v_pk_add_f32 v[200:201], v[200:201], s[62:63]
    v_exp_f32 v209, v209
    v_pk_add_f32 v[202:203], v[202:203], s[62:63]
    v_pk_add_f32 v[204:205], v[204:205], s[62:63]
    v_exp_f32 v210, v210
    v_pk_add_f32 v[206:207], v[206:207], s[62:63]
    v_pk_mul_f32 v[82:83], v[82:83], v[224:225]
    v_exp_f32 v211, v211
    v_pk_mul_f32 v[86:87], v[86:87], v[226:227]
    v_pk_mul_f32 v[90:91], v[90:91], v[228:229]
    v_exp_f32 v212, v212
    v_pk_mul_f32 v[94:95], v[94:95], v[230:231]
    v_exp_f32 v213, v213
    v_pk_fma_f32 v[182:183], v[82:83], v[82:83], v[182:183]
    v_pk_fma_f32 v[186:187], v[86:87], v[86:87], v[186:187]
    v_exp_f32 v214, v214
    v_pk_fma_f32 v[190:191], v[90:91], v[90:91], v[190:191]
    v_pk_fma_f32 v[194:195], v[94:95], v[94:95], v[194:195]
    v_exp_f32 v215, v215
    v_pk_add_f32 v[180:181], v[180:181], v[82:83]
    v_pk_add_f32 v[184:185], v[184:185], v[86:87]
    v_rcp_f32 v200, v200
    v_pk_add_f32 v[188:189], v[188:189], v[90:91]
    v_rcp_f32 v201, v201
    v_pk_add_f32 v[192:193], v[192:193], v[94:95]
    v_pk_mul_f32 v[216:217], v[112:113], v[112:113]
    v_rcp_f32 v202, v202
    v_pk_mul_f32 v[218:219], v[116:117], v[116:117]
    v_pk_mul_f32 v[220:221], v[120:121], v[120:121]
    v_rcp_f32 v203, v203
    v_pk_mul_f32 v[222:223], v[124:125], v[124:125]
    v_pk_fma_f32 v[216:217], v[216:217], s[60:61], v[176:177]
    v_rcp_f32 v204, v204
    v_pk_fma_f32 v[218:219], v[218:219], s[60:61], v[176:177]
    v_rcp_f32 v205, v205
    v_pk_fma_f32 v[220:221], v[220:221], s[60:61], v[176:177]
    v_pk_fma_f32 v[222:223], v[222:223], s[60:61], v[176:177]
    v_rcp_f32 v206, v206
    v_pk_mul_f32 v[216:217], v[216:217], v[112:113]
    v_pk_mul_f32 v[218:219], v[218:219], v[116:117]
    v_rcp_f32 v207, v207
    v_pk_mul_f32 v[220:221], v[220:221], v[120:121]
    v_pk_mul_f32 v[222:223], v[222:223], v[124:125]
    v_exp_f32 v216, v216
    v_pk_add_f32 v[208:209], v[208:209], s[62:63]
    v_exp_f32 v217, v217
    v_pk_add_f32 v[210:211], v[210:211], s[62:63]
    v_pk_add_f32 v[212:213], v[212:213], s[62:63]
    v_exp_f32 v218, v218
    v_pk_add_f32 v[214:215], v[214:215], s[62:63]
    v_pk_mul_f32 v[96:97], v[96:97], v[200:201]
    v_exp_f32 v219, v219
    v_pk_mul_f32 v[100:101], v[100:101], v[202:203]
    v_pk_mul_f32 v[104:105], v[104:105], v[204:205]
    v_exp_f32 v220, v220
    v_pk_mul_f32 v[108:109], v[108:109], v[206:207]
    v_exp_f32 v221, v221
    v_pk_fma_f32 v[182:183], v[96:97], v[96:97], v[182:183]
    v_pk_fma_f32 v[186:187], v[100:101], v[100:101], v[186:187]
    v_exp_f32 v222, v222
    v_pk_fma_f32 v[190:191], v[104:105], v[104:105], v[190:191]
    v_pk_fma_f32 v[194:195], v[108:109], v[108:109], v[194:195]
    v_exp_f32 v223, v223
    v_pk_add_f32 v[180:181], v[180:181], v[96:97]
    v_pk_add_f32 v[184:185], v[184:185], v[100:101]
    v_rcp_f32 v208, v208
    v_pk_add_f32 v[188:189], v[188:189], v[104:105]
    v_rcp_f32 v209, v209
    v_pk_add_f32 v[192:193], v[192:193], v[108:109]
    v_pk_mul_f32 v[224:225], v[114:115], v[114:115]
    v_rcp_f32 v210, v210
    v_pk_mul_f32 v[226:227], v[118:119], v[118:119]
    v_pk_mul_f32 v[228:229], v[122:123], v[122:123]
    v_rcp_f32 v211, v211
    v_pk_mul_f32 v[230:231], v[126:127], v[126:127]
    v_pk_fma_f32 v[224:225], v[224:225], s[60:61], v[176:177]
    v_rcp_f32 v212, v212
    v_pk_fma_f32 v[226:227], v[226:227], s[60:61], v[176:177]
    v_rcp_f32 v213, v213
    v_pk_fma_f32 v[228:229], v[228:229], s[60:61], v[176:177]
    v_pk_fma_f32 v[230:231], v[230:231], s[60:61], v[176:177]
    v_rcp_f32 v214, v214
    v_pk_mul_f32 v[224:225], v[224:225], v[114:115]
    v_pk_mul_f32 v[226:227], v[226:227], v[118:119]
    v_rcp_f32 v215, v215
    v_pk_mul_f32 v[228:229], v[228:229], v[122:123]
    v_pk_mul_f32 v[230:231], v[230:231], v[126:127]
    v_exp_f32 v224, v224
    v_pk_add_f32 v[216:217], v[216:217], s[62:63]
    v_exp_f32 v225, v225
    v_pk_add_f32 v[218:219], v[218:219], s[62:63]
    v_pk_add_f32 v[220:221], v[220:221], s[62:63]
    v_exp_f32 v226, v226
    v_pk_add_f32 v[222:223], v[222:223], s[62:63]
    v_pk_mul_f32 v[98:99], v[98:99], v[208:209]
    v_exp_f32 v227, v227
    v_pk_mul_f32 v[102:103], v[102:103], v[210:211]
    v_pk_mul_f32 v[106:107], v[106:107], v[212:213]
    v_exp_f32 v228, v228
    v_pk_mul_f32 v[110:111], v[110:111], v[214:215]
    v_exp_f32 v229, v229
    v_pk_fma_f32 v[182:183], v[98:99], v[98:99], v[182:183]
    v_pk_fma_f32 v[186:187], v[102:103], v[102:103], v[186:187]
    v_exp_f32 v230, v230
    v_pk_fma_f32 v[190:191], v[106:107], v[106:107], v[190:191]
    v_pk_fma_f32 v[194:195], v[110:111], v[110:111], v[194:195]
    v_exp_f32 v231, v231
    v_pk_add_f32 v[180:181], v[180:181], v[98:99]
    v_pk_add_f32 v[184:185], v[184:185], v[102:103]
    v_rcp_f32 v216, v216
    v_pk_add_f32 v[188:189], v[188:189], v[106:107]
    v_rcp_f32 v217, v217
    v_pk_add_f32 v[192:193], v[192:193], v[110:111]
    v_pk_mul_f32 v[200:201], v[128:129], v[128:129]
    v_rcp_f32 v218, v218
    v_pk_mul_f32 v[202:203], v[132:133], v[132:133]
    v_pk_mul_f32 v[204:205], v[136:137], v[136:137]
    v_rcp_f32 v219, v219
    v_pk_mul_f32 v[206:207], v[140:141], v[140:141]
    v_pk_fma_f32 v[200:201], v[200:201], s[60:61], v[176:177]
    v_rcp_f32 v220, v220
    v_pk_fma_f32 v[202:203], v[202:203], s[60:61], v[176:177]
    v_rcp_f32 v221, v221
    v_pk_fma_f32 v[204:205], v[204:205], s[60:61], v[176:177]
    v_pk_fma_f32 v[206:207], v[206:207], s[60:61], v[176:177]
    v_rcp_f32 v222, v222
    v_pk_mul_f32 v[200:201], v[200:201], v[128:129]
    v_pk_mul_f32 v[202:203], v[202:203], v[132:133]
    v_rcp_f32 v223, v223
    v_pk_mul_f32 v[204:205], v[204:205], v[136:137]
    v_pk_mul_f32 v[206:207], v[206:207], v[140:141]
    v_exp_f32 v200, v200
    v_pk_add_f32 v[224:225], v[224:225], s[62:63]
    v_exp_f32 v201, v201
    v_pk_add_f32 v[226:227], v[226:227], s[62:63]
    v_pk_add_f32 v[228:229], v[228:229], s[62:63]
    v_exp_f32 v202, v202
    v_pk_add_f32 v[230:231], v[230:231], s[62:63]
    v_pk_mul_f32 v[112:113], v[112:113], v[216:217]
    v_exp_f32 v203, v203
    v_pk_mul_f32 v[116:117], v[116:117], v[218:219]
    v_pk_mul_f32 v[120:121], v[120:121], v[220:221]
    v_exp_f32 v204, v204
    v_pk_mul_f32 v[124:125], v[124:125], v[222:223]
    v_exp_f32 v205, v205
    v_pk_fma_f32 v[182:183], v[112:113], v[112:113], v[182:183]
    v_pk_fma_f32 v[186:187], v[116:117], v[116:117], v[186:187]
    v_exp_f32 v206, v206
    v_pk_fma_f32 v[190:191], v[120:121], v[120:121], v[190:191]
    v_pk_fma_f32 v[194:195], v[124:125], v[124:125], v[194:195]
    v_exp_f32 v207, v207
    v_pk_add_f32 v[180:181], v[180:181], v[112:113]
    v_pk_add_f32 v[184:185], v[184:185], v[116:117]
    v_rcp_f32 v224, v224
    v_pk_add_f32 v[188:189], v[188:189], v[120:121]
    v_rcp_f32 v225, v225
    v_pk_add_f32 v[192:193], v[192:193], v[124:125]
    v_pk_mul_f32 v[208:209], v[130:131], v[130:131]
    v_rcp_f32 v226, v226
    v_pk_mul_f32 v[210:211], v[134:135], v[134:135]
    v_pk_mul_f32 v[212:213], v[138:139], v[138:139]
    v_rcp_f32 v227, v227
    v_pk_mul_f32 v[214:215], v[142:143], v[142:143]
    v_pk_fma_f32 v[208:209], v[208:209], s[60:61], v[176:177]
    v_rcp_f32 v228, v228
    v_pk_fma_f32 v[210:211], v[210:211], s[60:61], v[176:177]
    v_rcp_f32 v229, v229
    v_pk_fma_f32 v[212:213], v[212:213], s[60:61], v[176:177]
    v_pk_fma_f32 v[214:215], v[214:215], s[60:61], v[176:177]
    v_rcp_f32 v230, v230
    v_pk_mul_f32 v[208:209], v[208:209], v[130:131]
    v_pk_mul_f32 v[210:211], v[210:211], v[134:135]
    v_rcp_f32 v231, v231
    v_pk_mul_f32 v[212:213], v[212:213], v[138:139]
    v_pk_mul_f32 v[214:215], v[214:215], v[142:143]
    v_exp_f32 v208, v208
    v_pk_add_f32 v[200:201], v[200:201], s[62:63]
    v_exp_f32 v209, v209
    v_pk_add_f32 v[202:203], v[202:203], s[62:63]
    v_pk_add_f32 v[204:205], v[204:205], s[62:63]
    v_exp_f32 v210, v210
    v_pk_add_f32 v[206:207], v[206:207], s[62:63]
    v_pk_mul_f32 v[114:115], v[114:115], v[224:225]
    v_exp_f32 v211, v211
    v_pk_mul_f32 v[118:119], v[118:119], v[226:227]
    v_pk_mul_f32 v[122:123], v[122:123], v[228:229]
    v_exp_f32 v212, v212
    v_pk_mul_f32 v[126:127], v[126:127], v[230:231]
    v_exp_f32 v213, v213
    v_pk_fma_f32 v[182:183], v[114:115], v[114:115], v[182:183]
    v_pk_fma_f32 v[186:187], v[118:119], v[118:119], v[186:187]
    v_exp_f32 v214, v214
    v_pk_fma_f32 v[190:191], v[122:123], v[122:123], v[190:191]
    v_pk_fma_f32 v[194:195], v[126:127], v[126:127], v[194:195]
    v_exp_f32 v215, v215
    v_pk_add_f32 v[180:181], v[180:181], v[114:115]
    v_pk_add_f32 v[184:185], v[184:185], v[118:119]
    v_rcp_f32 v200, v200
    v_pk_add_f32 v[188:189], v[188:189], v[122:123]
    v_rcp_f32 v201, v201
    v_pk_add_f32 v[192:193], v[192:193], v[126:127]
    v_pk_mul_f32 v[216:217], v[144:145], v[144:145]
    v_rcp_f32 v202, v202
    v_pk_mul_f32 v[218:219], v[148:149], v[148:149]
    v_pk_mul_f32 v[220:221], v[152:153], v[152:153]
    v_rcp_f32 v203, v203
    v_pk_mul_f32 v[222:223], v[156:157], v[156:157]
    v_pk_fma_f32 v[216:217], v[216:217], s[60:61], v[176:177]
    v_rcp_f32 v204, v204
    v_pk_fma_f32 v[218:219], v[218:219], s[60:61], v[176:177]
    v_rcp_f32 v205, v205
    v_pk_fma_f32 v[220:221], v[220:221], s[60:61], v[176:177]
    v_pk_fma_f32 v[222:223], v[222:223], s[60:61], v[176:177]
    v_rcp_f32 v206, v206
    v_pk_mul_f32 v[216:217], v[216:217], v[144:145]
    v_pk_mul_f32 v[218:219], v[218:219], v[148:149]
    v_rcp_f32 v207, v207
    v_pk_mul_f32 v[220:221], v[220:221], v[152:153]
    v_pk_mul_f32 v[222:223], v[222:223], v[156:157]
    v_exp_f32 v216, v216
    v_pk_add_f32 v[208:209], v[208:209], s[62:63]
    v_exp_f32 v217, v217
    v_pk_add_f32 v[210:211], v[210:211], s[62:63]
    v_pk_add_f32 v[212:213], v[212:213], s[62:63]
    v_exp_f32 v218, v218
    v_pk_add_f32 v[214:215], v[214:215], s[62:63]
    v_pk_mul_f32 v[128:129], v[128:129], v[200:201]
    v_exp_f32 v219, v219
    v_pk_mul_f32 v[132:133], v[132:133], v[202:203]
    v_pk_mul_f32 v[136:137], v[136:137], v[204:205]
    v_exp_f32 v220, v220
    v_pk_mul_f32 v[140:141], v[140:141], v[206:207]
    v_exp_f32 v221, v221
    v_pk_fma_f32 v[182:183], v[128:129], v[128:129], v[182:183]
    v_pk_fma_f32 v[186:187], v[132:133], v[132:133], v[186:187]
    v_exp_f32 v222, v222
    v_pk_fma_f32 v[190:191], v[136:137], v[136:137], v[190:191]
    v_pk_fma_f32 v[194:195], v[140:141], v[140:141], v[194:195]
    v_exp_f32 v223, v223
    v_pk_add_f32 v[180:181], v[180:181], v[128:129]
    v_pk_add_f32 v[184:185], v[184:185], v[132:133]
    v_rcp_f32 v208, v208
    v_pk_add_f32 v[188:189], v[188:189], v[136:137]
    v_rcp_f32 v209, v209
    v_pk_add_f32 v[192:193], v[192:193], v[140:141]
    v_pk_mul_f32 v[224:225], v[146:147], v[146:147]
    v_rcp_f32 v210, v210
    v_pk_mul_f32 v[226:227], v[150:151], v[150:151]
    v_pk_mul_f32 v[228:229], v[154:155], v[154:155]
    v_rcp_f32 v211, v211
    v_pk_mul_f32 v[230:231], v[158:159], v[158:159]
    v_pk_fma_f32 v[224:225], v[224:225], s[60:61], v[176:177]
    v_rcp_f32 v212, v212
    v_pk_fma_f32 v[226:227], v[226:227], s[60:61], v[176:177]
    v_rcp_f32 v213, v213
    v_pk_fma_f32 v[228:229], v[228:229], s[60:61], v[176:177]
    v_pk_fma_f32 v[230:231], v[230:231], s[60:61], v[176:177]
    v_rcp_f32 v214, v214
    v_pk_mul_f32 v[224:225], v[224:225], v[146:147]
    v_pk_mul_f32 v[226:227], v[226:227], v[150:151]
    v_rcp_f32 v215, v215
    v_pk_mul_f32 v[228:229], v[228:229], v[154:155]
    v_pk_mul_f32 v[230:231], v[230:231], v[158:159]
    v_exp_f32 v224, v224
    v_pk_add_f32 v[216:217], v[216:217], s[62:63]
    v_exp_f32 v225, v225
    v_pk_add_f32 v[218:219], v[218:219], s[62:63]
    v_pk_add_f32 v[220:221], v[220:221], s[62:63]
    v_exp_f32 v226, v226
    v_pk_add_f32 v[222:223], v[222:223], s[62:63]
    v_pk_mul_f32 v[130:131], v[130:131], v[208:209]
    v_exp_f32 v227, v227
    v_pk_mul_f32 v[134:135], v[134:135], v[210:211]
    v_pk_mul_f32 v[138:139], v[138:139], v[212:213]
    v_exp_f32 v228, v228
    v_pk_mul_f32 v[142:143], v[142:143], v[214:215]
    v_exp_f32 v229, v229
    v_pk_fma_f32 v[182:183], v[130:131], v[130:131], v[182:183]
    v_pk_fma_f32 v[186:187], v[134:135], v[134:135], v[186:187]
    v_exp_f32 v230, v230
    v_pk_fma_f32 v[190:191], v[138:139], v[138:139], v[190:191]
    v_pk_fma_f32 v[194:195], v[142:143], v[142:143], v[194:195]
    v_exp_f32 v231, v231
    v_pk_add_f32 v[180:181], v[180:181], v[130:131]
    v_pk_add_f32 v[184:185], v[184:185], v[134:135]
    v_rcp_f32 v216, v216
    v_pk_add_f32 v[188:189], v[188:189], v[138:139]
    v_rcp_f32 v217, v217
    v_pk_add_f32 v[192:193], v[192:193], v[142:143]
    v_pk_mul_f32 v[200:201], v[160:161], v[160:161]
    v_rcp_f32 v218, v218
    v_pk_mul_f32 v[202:203], v[164:165], v[164:165]
    v_pk_mul_f32 v[204:205], v[168:169], v[168:169]
    v_rcp_f32 v219, v219
    v_pk_mul_f32 v[206:207], v[172:173], v[172:173]
    v_pk_fma_f32 v[200:201], v[200:201], s[60:61], v[176:177]
    v_rcp_f32 v220, v220
    v_pk_fma_f32 v[202:203], v[202:203], s[60:61], v[176:177]
    v_rcp_f32 v221, v221
    v_pk_fma_f32 v[204:205], v[204:205], s[60:61], v[176:177]
    v_pk_fma_f32 v[206:207], v[206:207], s[60:61], v[176:177]
    v_rcp_f32 v222, v222
    v_pk_mul_f32 v[200:201], v[200:201], v[160:161]
    v_pk_mul_f32 v[202:203], v[202:203], v[164:165]
    v_rcp_f32 v223, v223
    v_pk_mul_f32 v[204:205], v[204:205], v[168:169]
    v_pk_mul_f32 v[206:207], v[206:207], v[172:173]
    v_exp_f32 v200, v200
    v_pk_add_f32 v[224:225], v[224:225], s[62:63]
    v_exp_f32 v201, v201
    v_pk_add_f32 v[226:227], v[226:227], s[62:63]
    v_pk_add_f32 v[228:229], v[228:229], s[62:63]
    v_exp_f32 v202, v202
    v_pk_add_f32 v[230:231], v[230:231], s[62:63]
    v_pk_mul_f32 v[144:145], v[144:145], v[216:217]
    v_exp_f32 v203, v203
    v_pk_mul_f32 v[148:149], v[148:149], v[218:219]
    v_pk_mul_f32 v[152:153], v[152:153], v[220:221]
    v_exp_f32 v204, v204
    v_pk_mul_f32 v[156:157], v[156:157], v[222:223]
    v_exp_f32 v205, v205
    v_pk_fma_f32 v[182:183], v[144:145], v[144:145], v[182:183]
    v_pk_fma_f32 v[186:187], v[148:149], v[148:149], v[186:187]
    v_exp_f32 v206, v206
    v_pk_fma_f32 v[190:191], v[152:153], v[152:153], v[190:191]
    v_pk_fma_f32 v[194:195], v[156:157], v[156:157], v[194:195]
    v_exp_f32 v207, v207
    v_pk_add_f32 v[180:181], v[180:181], v[144:145]
    v_pk_add_f32 v[184:185], v[184:185], v[148:149]
    v_rcp_f32 v224, v224
    v_pk_add_f32 v[188:189], v[188:189], v[152:153]
    v_rcp_f32 v225, v225
    v_pk_add_f32 v[192:193], v[192:193], v[156:157]
    v_pk_mul_f32 v[208:209], v[162:163], v[162:163]
    v_rcp_f32 v226, v226
    v_pk_mul_f32 v[210:211], v[166:167], v[166:167]
    v_pk_mul_f32 v[212:213], v[170:171], v[170:171]
    v_rcp_f32 v227, v227
    v_pk_mul_f32 v[214:215], v[174:175], v[174:175]
    v_pk_fma_f32 v[208:209], v[208:209], s[60:61], v[176:177]
    v_rcp_f32 v228, v228
    v_pk_fma_f32 v[210:211], v[210:211], s[60:61], v[176:177]
    v_rcp_f32 v229, v229
    v_pk_fma_f32 v[212:213], v[212:213], s[60:61], v[176:177]
    v_pk_fma_f32 v[214:215], v[214:215], s[60:61], v[176:177]
    v_rcp_f32 v230, v230
    v_pk_mul_f32 v[208:209], v[208:209], v[162:163]
    v_pk_mul_f32 v[210:211], v[210:211], v[166:167]
    v_rcp_f32 v231, v231
    v_pk_mul_f32 v[212:213], v[212:213], v[170:171]
    v_pk_mul_f32 v[214:215], v[214:215], v[174:175]
    v_exp_f32 v208, v208
    v_pk_add_f32 v[200:201], v[200:201], s[62:63]
    v_exp_f32 v209, v209
    v_pk_add_f32 v[202:203], v[202:203], s[62:63]
    v_exp_f32 v210, v210
    v_pk_add_f32 v[204:205], v[204:205], s[62:63]
    v_exp_f32 v211, v211
    v_pk_add_f32 v[206:207], v[206:207], s[62:63]
    v_exp_f32 v212, v212
    v_pk_mul_f32 v[146:147], v[146:147], v[224:225]
    v_exp_f32 v213, v213
    v_pk_mul_f32 v[150:151], v[150:151], v[226:227]
    v_exp_f32 v214, v214
    v_pk_mul_f32 v[154:155], v[154:155], v[228:229]
    v_exp_f32 v215, v215
    v_pk_mul_f32 v[158:159], v[158:159], v[230:231]
    v_rcp_f32 v200, v200
    v_pk_fma_f32 v[182:183], v[146:147], v[146:147], v[182:183]
    v_rcp_f32 v201, v201
    v_pk_fma_f32 v[186:187], v[150:151], v[150:151], v[186:187]
    v_rcp_f32 v202, v202
    v_pk_fma_f32 v[190:191], v[154:155], v[154:155], v[190:191]
    v_rcp_f32 v203, v203
    v_pk_fma_f32 v[194:195], v[158:159], v[158:159], v[194:195]
    v_rcp_f32 v204, v204
    v_pk_add_f32 v[180:181], v[180:181], v[146:147]
    v_rcp_f32 v205, v205
    v_pk_add_f32 v[184:185], v[184:185], v[150:151]
    v_rcp_f32 v206, v206
    v_pk_add_f32 v[188:189], v[188:189], v[154:155]
    v_rcp_f32 v207, v207
    v_pk_add_f32 v[192:193], v[192:193], v[158:159]
    v_pk_add_f32 v[208:209], v[208:209], s[62:63]
    v_pk_add_f32 v[210:211], v[210:211], s[62:63]
    v_pk_add_f32 v[212:213], v[212:213], s[62:63]
    v_pk_add_f32 v[214:215], v[214:215], s[62:63]
    v_rcp_f32 v208, v208
    v_pk_mul_f32 v[160:161], v[160:161], v[200:201]
    v_rcp_f32 v209, v209
    v_pk_mul_f32 v[164:165], v[164:165], v[202:203]
    v_pk_mul_f32 v[168:169], v[168:169], v[204:205]
    v_rcp_f32 v210, v210
    v_pk_mul_f32 v[172:173], v[172:173], v[206:207]
    v_rcp_f32 v211, v211
    v_pk_fma_f32 v[182:183], v[160:161], v[160:161], v[182:183]
    v_pk_fma_f32 v[186:187], v[164:165], v[164:165], v[186:187]
    v_rcp_f32 v212, v212
    v_pk_fma_f32 v[190:191], v[168:169], v[168:169], v[190:191]
    v_rcp_f32 v213, v213
    v_pk_fma_f32 v[194:195], v[172:173], v[172:173], v[194:195]
    v_pk_add_f32 v[180:181], v[180:181], v[160:161]
    v_rcp_f32 v214, v214
    v_pk_add_f32 v[184:185], v[184:185], v[164:165]
    v_rcp_f32 v215, v215
    v_pk_add_f32 v[188:189], v[188:189], v[168:169]
    v_pk_add_f32 v[192:193], v[192:193], v[172:173]
    v_pk_mul_f32 v[162:163], v[162:163], v[208:209]
    v_pk_mul_f32 v[166:167], v[166:167], v[210:211]
    v_pk_mul_f32 v[170:171], v[170:171], v[212:213]
    v_pk_mul_f32 v[174:175], v[174:175], v[214:215]
    v_pk_fma_f32 v[182:183], v[162:163], v[162:163], v[182:183]
    v_pk_fma_f32 v[186:187], v[166:167], v[166:167], v[186:187]
    v_pk_fma_f32 v[190:191], v[170:171], v[170:171], v[190:191]
    v_pk_fma_f32 v[194:195], v[174:175], v[174:175], v[194:195]
    v_pk_add_f32 v[180:181], v[180:181], v[162:163]
    v_pk_add_f32 v[184:185], v[184:185], v[166:167]
    v_pk_add_f32 v[188:189], v[188:189], v[170:171]
    v_pk_add_f32 v[192:193], v[192:193], v[174:175]
    v_add_f32 v180, v180, v181
    v_add_f32 v182, v182, v183
    v_add_f32 v184, v184, v185
    v_add_f32 v186, v186, v187
    v_add_f32 v188, v188, v189
    v_add_f32 v190, v190, v191
    v_add_f32 v192, v192, v193
    v_add_f32 v194, v194, v195
    v_permlane32_swap_b32 v180, v182
    v_permlane32_swap_b32 v184, v186
    v_permlane32_swap_b32 v188, v190
    v_permlane32_swap_b32 v192, v194
    v_add_f32 v180, v180, v182
    v_add_f32 v184, v184, v186
    v_add_f32 v188, v188, v190
    v_add_f32 v192, v192, v194
    v_permlane16_swap_b32 v180, v184
    s_nop 0
    v_permlane16_swap_b32 v188, v192
    v_add_f32 v20, v180, v184
    v_add_f32 v21, v188, v192
    s_nop 1
    v_permlane32_swap_b32 v20, v21
    buffer_store_dwordx2 v[20:21], v56, s[20:23], s55 offen sc1
    s_waitcnt lgkmcnt(0)
    v_mfma_f32_16x16x32_bf16 v[176:179], a[16:19], a[0:3], 0
    ds_read_b128 a[64:67], v17 offset:0
    s_add_u32 m0, s29, s27
    v_mfma_f32_16x16x32_bf16 v[180:183], a[16:19], a[4:7], 0
    ds_read_b128 a[68:71], v17 offset:2048
    s_add_u32 m0, m0, 4096
    v_mfma_f32_16x16x32_bf16 v[184:187], a[16:19], a[8:11], 0
    buffer_load_dwordx4 v6, s[8:11], s24 offen offset:0 lds
    ds_read_b128 a[72:75], v17 offset:4096
    v_mfma_f32_16x16x32_bf16 v[188:191], a[16:19], a[12:15], 0
    ds_read_b128 a[76:79], v17 offset:6144
    v_mfma_f32_16x16x32_bf16 v[204:207], a[20:23], a[12:15], 0
    ds_read_b64_tr_b16 a[80:81], v18 offset:24576
    buffer_load_dwordx4 v7, s[8:11], s24 offen offset:1024 lds
    v_mfma_f32_16x16x32_bf16 v[200:203], a[20:23], a[8:11], 0
    ds_read_b64_tr_b16 a[82:83], v18 offset:25088
    v_mfma_f32_16x16x32_bf16 v[196:199], a[20:23], a[4:7], 0
    ds_read_b64_tr_b16 a[84:85], v19 offset:24576
    v_mfma_f32_16x16x32_bf16 v[192:195], a[20:23], a[0:3], 0
    ds_read_b64_tr_b16 a[86:87], v19 offset:25088
    buffer_load_dwordx4 v8, s[8:11], s24 offen offset:2048 lds
    v_mfma_f32_16x16x32_bf16 v[208:211], a[24:27], a[0:3], 0
    ds_read_b64_tr_b16 a[88:89], v13 offset:24576
    v_mfma_f32_16x16x32_bf16 v[212:215], a[24:27], a[4:7], 0
    ds_read_b64_tr_b16 a[90:91], v13 offset:25088
    v_mfma_f32_16x16x32_bf16 v[216:219], a[24:27], a[8:11], 0
    ds_read_b64_tr_b16 a[92:93], v58 offset:24576
    v_mfma_f32_16x16x32_bf16 v[220:223], a[24:27], a[12:15], 0
    ds_read_b64_tr_b16 a[94:95], v58 offset:25088
    buffer_load_dwordx4 v9, s[8:11], s24 offen offset:3072 lds
    v_mfma_f32_16x16x32_bf16 v[236:239], a[28:31], a[12:15], 0
    ds_read_b64_tr_b16 a[96:97], v18 offset:25600
    s_add_u32 s27, s27, 32768
    v_mfma_f32_16x16x32_bf16 v[232:235], a[28:31], a[8:11], 0
    s_cmp_eq_u32 s27, 98304
    s_cselect_b32 s27, 0, s27
    v_mfma_f32_16x16x32_bf16 v[228:231], a[28:31], a[4:7], 0
    ds_read_b64_tr_b16 a[98:99], v18 offset:26112
    s_add_u32 s25, s25, 229376
    v_mfma_f32_16x16x32_bf16 v[224:227], a[28:31], a[0:3], 0
    s_add_u32 m0, s30, 8192
    s_nop 0
    buffer_load_dwordx4 v10, s[12:15], s25 offen lds
    v_mfma_f32_16x16x32_bf16 v[240:243], a[32:35], a[0:3], 0
    v_mfma_f32_16x16x32_bf16 v[244:247], a[32:35], a[4:7], 0
    s_mov_b64 exec, s[42:43]
    buffer_load_dwordx4 v11, s[12:15], s25 offen offset:1024 lds
    s_mov_b64 exec, -1
    v_mfma_f32_16x16x32_bf16 v[248:251], a[32:35], a[8:11], 0
    v_mfma_f32_16x16x32_bf16 v[252:255], a[32:35], a[12:15], 0
    s_waitcnt lgkmcnt(0)
    v_mfma_f32_16x16x32_bf16 v[176:179], a[80:83], a[64:67], v[176:179]
    s_waitcnt vmcnt(17)
    s_barrier
    v_mfma_f32_16x16x32_bf16 v[180:183], a[80:83], a[68:71], v[180:183]
    s_add_u32 s28, s28, 32768
    s_bfe_u32 s24, s56, 0x4000c
    v_mfma_f32_16x16x32_bf16 v[184:187], a[80:83], a[72:75], v[184:187]
    s_lshl_b32 s24, s24, 7
    s_add_u32 m0, s29, s27
    v_mfma_f32_16x16x32_bf16 v[188:191], a[80:83], a[76:79], v[188:191]
    s_cmp_eq_u32 s28, 98304
    s_cselect_b32 s28, 0, s28
    v_mfma_f32_16x16x32_bf16 v[204:207], a[84:87], a[76:79], v[204:207]
    v_add_u32 v16, s28, v14
    buffer_load_dwordx4 v2, s[8:11], s24 offen offset:0 lds
    v_mfma_f32_16x16x32_bf16 v[200:203], a[84:87], a[72:75], v[200:203]
    ds_read_b64_tr_b16 a[16:17], v18 offset:32768
    ds_read_b64_tr_b16 a[18:19], v18 offset:33280
    v_mfma_f32_16x16x32_bf16 v[196:199], a[84:87], a[68:71], v[196:199]
    ds_read_b64_tr_b16 a[20:21], v19 offset:32768
    ds_read_b64_tr_b16 a[22:23], v19 offset:33280
    v_mfma_f32_16x16x32_bf16 v[192:195], a[84:87], a[64:67], v[192:195]
    buffer_load_dwordx4 v3, s[8:11], s24 offen offset:1024 lds
    ds_read_b64_tr_b16 a[24:25], v13 offset:32768
    v_mfma_f32_16x16x32_bf16 v[208:211], a[88:91], a[64:67], v[208:211]
    ds_read_b64_tr_b16 a[26:27], v13 offset:33280
    ds_read_b64_tr_b16 a[28:29], v58 offset:32768
    v_mfma_f32_16x16x32_bf16 v[212:215], a[88:91], a[68:71], v[212:215]
    ds_read_b64_tr_b16 a[30:31], v58 offset:33280
    buffer_load_dwordx4 v4, s[8:11], s24 offen offset:2048 lds
    v_mfma_f32_16x16x32_bf16 v[216:219], a[88:91], a[72:75], v[216:219]
    ds_read_b64_tr_b16 a[32:33], v18 offset:33792
    ds_read_b64_tr_b16 a[34:35], v18 offset:34304
    v_mfma_f32_16x16x32_bf16 v[220:223], a[88:91], a[76:79], v[220:223]
    v_add_u32 v17, s28, v15
    ds_read_b128 a[0:3], v16 offset:0
    v_mfma_f32_16x16x32_bf16 v[236:239], a[92:95], a[76:79], v[236:239]
    buffer_load_dwordx4 v5, s[8:11], s24 offen offset:3072 lds
    ds_read_b128 a[4:7], v16 offset:2048
    v_mfma_f32_16x16x32_bf16 v[232:235], a[92:95], a[72:75], v[232:235]
    s_bfe_u32 s31, s56, 0x40008
    ds_read_b128 a[8:11], v16 offset:4096
    v_mfma_f32_16x16x32_bf16 v[228:231], a[92:95], a[68:71], v[228:231]
    s_mul_i32 s25, s31, 458752
    ds_read_b128 a[12:15], v16 offset:6144
    v_mfma_f32_16x16x32_bf16 v[224:227], a[92:95], a[64:67], v[224:227]
    s_add_u32 s25, s25, s41
    s_add_u32 m0, s30, 16384
    v_mfma_f32_16x16x32_bf16 v[240:243], a[96:99], a[64:67], v[240:243]
    buffer_load_dwordx4 v10, s[12:15], s25 offen lds
    v_mfma_f32_16x16x32_bf16 v[244:247], a[96:99], a[68:71], v[244:247]
    s_mov_b64 exec, s[42:43]
    buffer_load_dwordx4 v11, s[12:15], s25 offen offset:1024 lds
    s_mov_b64 exec, -1
    v_mfma_f32_16x16x32_bf16 v[248:251], a[96:99], a[72:75], v[248:251]
    v_mfma_f32_16x16x32_bf16 v[252:255], a[96:99], a[76:79], v[252:255]
    s_waitcnt lgkmcnt(0)
    v_mfma_f32_16x16x32_bf16 v[176:179], a[16:19], a[0:3], v[176:179]
    ds_read_b128 a[64:67], v17 offset:0
    s_add_u32 m0, s29, s27
    v_mfma_f32_16x16x32_bf16 v[180:183], a[16:19], a[4:7], v[180:183]
    ds_read_b128 a[68:71], v17 offset:2048
    s_add_u32 m0, m0, 4096
    v_mfma_f32_16x16x32_bf16 v[184:187], a[16:19], a[8:11], v[184:187]
    buffer_load_dwordx4 v6, s[8:11], s24 offen offset:0 lds
    ds_read_b128 a[72:75], v17 offset:4096
    v_mfma_f32_16x16x32_bf16 v[188:191], a[16:19], a[12:15], v[188:191]
    ds_read_b128 a[76:79], v17 offset:6144
    v_mfma_f32_16x16x32_bf16 v[204:207], a[20:23], a[12:15], v[204:207]
    ds_read_b64_tr_b16 a[80:81], v18 offset:40960
    buffer_load_dwordx4 v7, s[8:11], s24 offen offset:1024 lds
    v_mfma_f32_16x16x32_bf16 v[200:203], a[20:23], a[8:11], v[200:203]
    ds_read_b64_tr_b16 a[82:83], v18 offset:41472
    v_mfma_f32_16x16x32_bf16 v[196:199], a[20:23], a[4:7], v[196:199]
    ds_read_b64_tr_b16 a[84:85], v19 offset:40960
    v_mfma_f32_16x16x32_bf16 v[192:195], a[20:23], a[0:3], v[192:195]
    ds_read_b64_tr_b16 a[86:87], v19 offset:41472
    buffer_load_dwordx4 v8, s[8:11], s24 offen offset:2048 lds
    v_mfma_f32_16x16x32_bf16 v[208:211], a[24:27], a[0:3], v[208:211]
    ds_read_b64_tr_b16 a[88:89], v13 offset:40960
    v_mfma_f32_16x16x32_bf16 v[212:215], a[24:27], a[4:7], v[212:215]
    ds_read_b64_tr_b16 a[90:91], v13 offset:41472
    v_mfma_f32_16x16x32_bf16 v[216:219], a[24:27], a[8:11], v[216:219]
    ds_read_b64_tr_b16 a[92:93], v58 offset:40960
    v_mfma_f32_16x16x32_bf16 v[220:223], a[24:27], a[12:15], v[220:223]
    ds_read_b64_tr_b16 a[94:95], v58 offset:41472
    buffer_load_dwordx4 v9, s[8:11], s24 offen offset:3072 lds
    v_mfma_f32_16x16x32_bf16 v[236:239], a[28:31], a[12:15], v[236:239]
    ds_read_b64_tr_b16 a[96:97], v18 offset:41984
    s_add_u32 s27, s27, 32768
    v_mfma_f32_16x16x32_bf16 v[232:235], a[28:31], a[8:11], v[232:235]
    s_cmp_eq_u32 s27, 98304
    s_cselect_b32 s27, 0, s27
    v_mfma_f32_16x16x32_bf16 v[228:231], a[28:31], a[4:7], v[228:231]
    ds_read_b64_tr_b16 a[98:99], v18 offset:42496
    s_add_u32 s25, s25, 229376
    v_mfma_f32_16x16x32_bf16 v[224:227], a[28:31], a[0:3], v[224:227]
    s_add_u32 m0, s30, 24576
    s_nop 0
    buffer_load_dwordx4 v10, s[12:15], s25 offen lds
    v_mfma_f32_16x16x32_bf16 v[240:243], a[32:35], a[0:3], v[240:243]
    v_mfma_f32_16x16x32_bf16 v[244:247], a[32:35], a[4:7], v[244:247]
    s_mov_b64 exec, s[42:43]
    buffer_load_dwordx4 v11, s[12:15], s25 offen offset:1024 lds
    s_mov_b64 exec, -1
    v_mfma_f32_16x16x32_bf16 v[248:251], a[32:35], a[8:11], v[248:251]
    v_mfma_f32_16x16x32_bf16 v[252:255], a[32:35], a[12:15], v[252:255]
    s_waitcnt lgkmcnt(0)
    v_mfma_f32_16x16x32_bf16 v[176:179], a[80:83], a[64:67], v[176:179]
    s_waitcnt vmcnt(12)
    s_barrier
    v_mfma_f32_16x16x32_bf16 v[180:183], a[80:83], a[68:71], v[180:183]
    ds_read_b64_tr_b16 a[16:17], v18 offset:0
    s_bfe_u32 s24, s56, 0x40010
    v_mfma_f32_16x16x32_bf16 v[184:187], a[80:83], a[72:75], v[184:187]
    s_lshl_b32 s24, s24, 7
    s_add_u32 m0, s29, s27
    v_mfma_f32_16x16x32_bf16 v[188:191], a[80:83], a[76:79], v[188:191]
    ds_read_b64_tr_b16 a[18:19], v18 offset:512
    buffer_load_dwordx4 v2, s[8:11], s24 offen offset:0 lds
    v_mfma_f32_16x16x32_bf16 v[204:207], a[84:87], a[76:79], v[204:207]
    ds_read_b64_tr_b16 a[20:21], v19 offset:0
    ds_read_b64_tr_b16 a[22:23], v19 offset:512
    v_mfma_f32_16x16x32_bf16 v[200:203], a[84:87], a[72:75], v[200:203]
    buffer_load_dwordx4 v3, s[8:11], s24 offen offset:1024 lds
    v_mfma_f32_16x16x32_bf16 v[196:199], a[84:87], a[68:71], v[196:199]
    ds_read_b64_tr_b16 a[24:25], v13 offset:0
    v_mfma_f32_16x16x32_bf16 v[192:195], a[84:87], a[64:67], v[192:195]
    ds_read_b64_tr_b16 a[26:27], v13 offset:512
    v_mfma_f32_16x16x32_bf16 v[208:211], a[88:91], a[64:67], v[208:211]
    buffer_load_dwordx4 v4, s[8:11], s24 offen offset:2048 lds
    ds_read_b64_tr_b16 a[28:29], v58 offset:0
    v_mfma_f32_16x16x32_bf16 v[212:215], a[88:91], a[68:71], v[212:215]
    v_mfma_f32_16x16x32_bf16 v[216:219], a[88:91], a[72:75], v[216:219]
    ds_read_b64_tr_b16 a[30:31], v58 offset:512
    v_mfma_f32_16x16x32_bf16 v[220:223], a[88:91], a[76:79], v[220:223]
    ds_read_b64_tr_b16 a[32:33], v18 offset:1024
    buffer_load_dwordx4 v5, s[8:11], s24 offen offset:3072 lds
    v_mfma_f32_16x16x32_bf16 v[236:239], a[92:95], a[76:79], v[236:239]
    s_bfe_u32 s31, s56, 0x4000c
    ds_read_b64_tr_b16 a[34:35], v18 offset:1536
    v_mfma_f32_16x16x32_bf16 v[232:235], a[92:95], a[72:75], v[232:235]
    s_mul_i32 s25, s31, 458752
    s_add_u32 s25, s25, s41
    v_mfma_f32_16x16x32_bf16 v[228:231], a[92:95], a[68:71], v[228:231]
    s_add_u32 m0, s30, 32768
    s_nop 0
    buffer_load_dwordx4 v10, s[12:15], s25 offen lds
    v_mfma_f32_16x16x32_bf16 v[224:227], a[92:95], a[64:67], v[224:227]
    v_mfma_f32_16x16x32_bf16 v[240:243], a[96:99], a[64:67], v[240:243]
    v_mfma_f32_16x16x32_bf16 v[244:247], a[96:99], a[68:71], v[244:247]
    s_mov_b64 exec, s[42:43]
    buffer_load_dwordx4 v11, s[12:15], s25 offen offset:1024 lds
    s_mov_b64 exec, -1
    v_mfma_f32_16x16x32_bf16 v[248:251], a[96:99], a[72:75], v[248:251]
    v_mfma_f32_16x16x32_bf16 v[252:255], a[96:99], a[76:79], v[252:255]
    s_waitcnt lgkmcnt(0)
    v_mfma_f32_16x16x32_bf16 v[176:179], a[16:19], a[128:131], v[176:179]
    ds_read_b64_tr_b16 a[80:81], v18 offset:8192
    s_add_u32 m0, s29, s27
    v_mfma_f32_16x16x32_bf16 v[180:183], a[16:19], a[132:135], v[180:183]
    s_add_u32 m0, m0, 4096
    ds_read_b64_tr_b16 a[82:83], v18 offset:8704
    v_mfma_f32_16x16x32_bf16 v[184:187], a[16:19], a[136:139], v[184:187]
    buffer_load_dwordx4 v6, s[8:11], s24 offen offset:0 lds
    ds_read_b64_tr_b16 a[84:85], v19 offset:8192
    v_mfma_f32_16x16x32_bf16 v[188:191], a[16:19], a[140:143], v[188:191]
    v_mfma_f32_16x16x32_bf16 v[204:207], a[20:23], a[140:143], v[204:207]
    ds_read_b64_tr_b16 a[86:87], v19 offset:8704
    buffer_load_dwordx4 v7, s[8:11], s24 offen offset:1024 lds
    v_mfma_f32_16x16x32_bf16 v[200:203], a[20:23], a[136:139], v[200:203]
    ds_read_b64_tr_b16 a[88:89], v13 offset:8192
    v_mfma_f32_16x16x32_bf16 v[196:199], a[20:23], a[132:135], v[196:199]
    v_mfma_f32_16x16x32_bf16 v[192:195], a[20:23], a[128:131], v[192:195]
    ds_read_b64_tr_b16 a[90:91], v13 offset:8704
    buffer_load_dwordx4 v8, s[8:11], s24 offen offset:2048 lds
    v_mfma_f32_16x16x32_bf16 v[208:211], a[24:27], a[128:131], v[208:211]
    ds_read_b64_tr_b16 a[92:93], v58 offset:8192
    v_mfma_f32_16x16x32_bf16 v[212:215], a[24:27], a[132:135], v[212:215]
    ds_read_b64_tr_b16 a[94:95], v58 offset:8704
    v_mfma_f32_16x16x32_bf16 v[216:219], a[24:27], a[136:139], v[216:219]
    v_mfma_f32_16x16x32_bf16 v[220:223], a[24:27], a[140:143], v[220:223]
    buffer_load_dwordx4 v9, s[8:11], s24 offen offset:3072 lds
    ds_read_b64_tr_b16 a[96:97], v18 offset:9216
    v_mfma_f32_16x16x32_bf16 v[236:239], a[28:31], a[140:143], v[236:239]
    s_add_u32 s27, s27, 32768
    ds_read_b64_tr_b16 a[98:99], v18 offset:9728
    v_mfma_f32_16x16x32_bf16 v[232:235], a[28:31], a[136:139], v[232:235]
    s_cmp_eq_u32 s27, 98304
    s_cselect_b32 s27, 0, s27
    v_mfma_f32_16x16x32_bf16 v[228:231], a[28:31], a[132:135], v[228:231]
    s_add_u32 s25, s25, 229376
    s_add_u32 m0, s30, 40960
    v_mfma_f32_16x16x32_bf16 v[224:227], a[28:31], a[128:131], v[224:227]
    buffer_load_dwordx4 v10, s[12:15], s25 offen lds
    v_mfma_f32_16x16x32_bf16 v[240:243], a[32:35], a[128:131], v[240:243]
    v_mfma_f32_16x16x32_bf16 v[244:247], a[32:35], a[132:135], v[244:247]
    s_mov_b64 exec, s[42:43]
    buffer_load_dwordx4 v11, s[12:15], s25 offen offset:1024 lds
    s_mov_b64 exec, -1
    v_mfma_f32_16x16x32_bf16 v[248:251], a[32:35], a[136:139], v[248:251]
    v_mfma_f32_16x16x32_bf16 v[252:255], a[32:35], a[140:143], v[252:255]
    s_waitcnt lgkmcnt(0)
    v_mfma_f32_16x16x32_bf16 v[176:179], a[80:83], a[144:147], v[176:179]
    s_waitcnt vmcnt(12)
    s_barrier
    v_mfma_f32_16x16x32_bf16 v[180:183], a[80:83], a[148:151], v[180:183]
    s_add_u32 s28, s28, 32768
    v_mfma_f32_16x16x32_bf16 v[184:187], a[80:83], a[152:155], v[184:187]
    s_cmp_eq_u32 s28, 98304
    s_cselect_b32 s28, 0, s28
    v_mfma_f32_16x16x32_bf16 v[188:191], a[80:83], a[156:159], v[188:191]
    v_add_u32 v16, s28, v14
    ds_read_b64_tr_b16 a[16:17], v18 offset:16384
    v_mfma_f32_16x16x32_bf16 v[204:207], a[84:87], a[156:159], v[204:207]
    s_bfe_u32 s31, s57, 0x40014
    ds_read_b64_tr_b16 a[18:19], v18 offset:16896
    v_mfma_f32_16x16x32_bf16 v[200:203], a[84:87], a[152:155], v[200:203]
    s_mul_i32 s25, s31, 458752
    s_add_u32 s25, s25, s41
    v_mfma_f32_16x16x32_bf16 v[196:199], a[84:87], a[148:151], v[196:199]
    ds_read_b64_tr_b16 a[20:21], v19 offset:16384
    s_add_u32 m0, s30, 0
    v_mfma_f32_16x16x32_bf16 v[192:195], a[84:87], a[144:147], v[192:195]
    ds_read_b64_tr_b16 a[22:23], v19 offset:16896
    buffer_load_dwordx4 v10, s[12:15], s25 offen lds
    v_mfma_f32_16x16x32_bf16 v[208:211], a[88:91], a[144:147], v[208:211]
    ds_read_b64_tr_b16 a[24:25], v13 offset:16384
    ds_read_b64_tr_b16 a[26:27], v13 offset:16896
    v_mfma_f32_16x16x32_bf16 v[212:215], a[88:91], a[148:151], v[212:215]
    ds_read_b64_tr_b16 a[28:29], v58 offset:16384
    ds_read_b64_tr_b16 a[30:31], v58 offset:16896
    v_mfma_f32_16x16x32_bf16 v[216:219], a[88:91], a[152:155], v[216:219]
    ds_read_b64_tr_b16 a[32:33], v18 offset:17408
    ds_read_b64_tr_b16 a[34:35], v18 offset:17920
    v_mfma_f32_16x16x32_bf16 v[220:223], a[88:91], a[156:159], v[220:223]
    v_add_u32 v17, s28, v15
    ds_read_b128 a[0:3], v16 offset:0
    v_mfma_f32_16x16x32_bf16 v[236:239], a[92:95], a[156:159], v[236:239]
    ds_read_b128 a[4:7], v16 offset:2048
    ds_read_b128 a[8:11], v16 offset:4096
    v_mfma_f32_16x16x32_bf16 v[232:235], a[92:95], a[152:155], v[232:235]
    ds_read_b128 a[12:15], v16 offset:6144
    v_mfma_f32_16x16x32_bf16 v[228:231], a[92:95], a[148:151], v[228:231]
    s_mov_b64 exec, s[42:43]
    buffer_load_dwordx4 v11, s[12:15], s25 offen offset:1024 lds
    s_mov_b64 exec, -1
    v_mfma_f32_16x16x32_bf16 v[224:227], a[92:95], a[144:147], v[224:227]
    v_mfma_f32_16x16x32_bf16 v[240:243], a[96:99], a[144:147], v[240:243]
    v_mfma_f32_16x16x32_bf16 v[244:247], a[96:99], a[148:151], v[244:247]
    v_mfma_f32_16x16x32_bf16 v[248:251], a[96:99], a[152:155], v[248:251]
    v_mfma_f32_16x16x32_bf16 v[252:255], a[96:99], a[156:159], v[252:255]
    s_waitcnt lgkmcnt(0)
    v_mfma_f32_16x16x32_bf16 v[176:179], a[16:19], a[0:3], v[176:179]
    ds_read_b128 a[64:67], v17 offset:0
    v_mfma_f32_16x16x32_bf16 v[180:183], a[16:19], a[4:7], v[180:183]
    ds_read_b128 a[68:71], v17 offset:2048
    v_mfma_f32_16x16x32_bf16 v[184:187], a[16:19], a[8:11], v[184:187]
    ds_read_b128 a[72:75], v17 offset:4096
    s_add_u32 s25, s25, 229376
    v_mfma_f32_16x16x32_bf16 v[188:191], a[16:19], a[12:15], v[188:191]
    ds_read_b128 a[76:79], v17 offset:6144
    s_add_u32 m0, s30, 8192
    v_mfma_f32_16x16x32_bf16 v[204:207], a[20:23], a[12:15], v[204:207]
    buffer_load_dwordx4 v10, s[12:15], s25 offen lds
    ds_read_b64_tr_b16 a[80:81], v18 offset:24576
    v_mfma_f32_16x16x32_bf16 v[200:203], a[20:23], a[8:11], v[200:203]
    ds_read_b64_tr_b16 a[82:83], v18 offset:25088
    v_mfma_f32_16x16x32_bf16 v[196:199], a[20:23], a[4:7], v[196:199]
    ds_read_b64_tr_b16 a[84:85], v19 offset:24576
    v_mfma_f32_16x16x32_bf16 v[192:195], a[20:23], a[0:3], v[192:195]
    ds_read_b64_tr_b16 a[86:87], v19 offset:25088
    v_mfma_f32_16x16x32_bf16 v[208:211], a[24:27], a[0:3], v[208:211]
    ds_read_b64_tr_b16 a[88:89], v13 offset:24576
    v_mfma_f32_16x16x32_bf16 v[212:215], a[24:27], a[4:7], v[212:215]
    ds_read_b64_tr_b16 a[90:91], v13 offset:25088
    v_mfma_f32_16x16x32_bf16 v[216:219], a[24:27], a[8:11], v[216:219]
    ds_read_b64_tr_b16 a[92:93], v58 offset:24576
    v_mfma_f32_16x16x32_bf16 v[220:223], a[24:27], a[12:15], v[220:223]
    ds_read_b64_tr_b16 a[94:95], v58 offset:25088
    v_mfma_f32_16x16x32_bf16 v[236:239], a[28:31], a[12:15], v[236:239]
    s_mov_b64 exec, s[42:43]
    buffer_load_dwordx4 v11, s[12:15], s25 offen offset:1024 lds
    s_mov_b64 exec, -1
    v_mfma_f32_16x16x32_bf16 v[232:235], a[28:31], a[8:11], v[232:235]
    ds_read_b64_tr_b16 a[96:97], v18 offset:25600
    ds_read_b64_tr_b16 a[98:99], v18 offset:26112
    v_mfma_f32_16x16x32_bf16 v[228:231], a[28:31], a[4:7], v[228:231]
    v_mfma_f32_16x16x32_bf16 v[224:227], a[28:31], a[0:3], v[224:227]
    buffer_load_dwordx2 v[24:25], v56, s[20:23], s58 offen offset:0 sc1
    buffer_load_dwordx2 v[26:27], v56, s[20:23], s58 offen offset:512 sc1
    v_mfma_f32_16x16x32_bf16 v[240:243], a[32:35], a[0:3], v[240:243]
    buffer_load_dwordx2 v[28:29], v56, s[20:23], s58 offen offset:1024 sc1
    buffer_load_dwordx2 v[30:31], v56, s[20:23], s58 offen offset:1536 sc1
    v_mfma_f32_16x16x32_bf16 v[244:247], a[32:35], a[4:7], v[244:247]
    buffer_load_dwordx2 v[32:33], v56, s[20:23], s58 offen offset:2048 sc1
    buffer_load_dwordx2 v[34:35], v56, s[20:23], s58 offen offset:2560 sc1
    v_mfma_f32_16x16x32_bf16 v[248:251], a[32:35], a[8:11], v[248:251]
    buffer_load_dwordx2 v[36:37], v56, s[20:23], s58 offen offset:3072 sc1
    buffer_load_dwordx2 v[38:39], v56, s[20:23], s58 offen offset:3584 sc1
    v_mfma_f32_16x16x32_bf16 v[252:255], a[32:35], a[12:15], v[252:255]
    buffer_load_dwordx2 v[40:41], v56, s[20:23], s59 offen offset:0 sc1
    buffer_load_dwordx2 v[42:43], v56, s[20:23], s59 offen offset:512 sc1
    buffer_load_dwordx2 v[44:45], v56, s[20:23], s59 offen offset:1024 sc1
    buffer_load_dwordx2 v[46:47], v56, s[20:23], s59 offen offset:1536 sc1
    buffer_load_dwordx2 v[48:49], v56, s[20:23], s59 offen offset:2048 sc1
    buffer_load_dwordx2 v[50:51], v56, s[20:23], s59 offen offset:2560 sc1
    buffer_load_dwordx2 v[52:53], v56, s[20:23], s59 offen offset:3072 sc1
    buffer_load_dwordx2 v[54:55], v56, s[20:23], s59 offen offset:3584 sc1
    s_waitcnt lgkmcnt(0)
    v_mfma_f32_16x16x32_bf16 v[176:179], a[80:83], a[64:67], v[176:179]
    s_waitcnt vmcnt(20)
    s_barrier
    v_mfma_f32_16x16x32_bf16 v[180:183], a[80:83], a[68:71], v[180:183]
    s_add_u32 s28, s28, 32768
    s_bfe_u32 s24, s56, 0x40014
    v_mfma_f32_16x16x32_bf16 v[184:187], a[80:83], a[72:75], v[184:187]
    s_lshl_b32 s24, s24, 7
    s_add_u32 m0, s29, s27
    v_mfma_f32_16x16x32_bf16 v[188:191], a[80:83], a[76:79], v[188:191]
    s_cmp_eq_u32 s28, 98304
    s_cselect_b32 s28, 0, s28
    v_mfma_f32_16x16x32_bf16 v[204:207], a[84:87], a[76:79], v[204:207]
    v_add_u32 v16, s28, v14
    buffer_load_dwordx4 v2, s[8:11], s24 offen offset:0 lds
    v_mfma_f32_16x16x32_bf16 v[200:203], a[84:87], a[72:75], v[200:203]
    ds_read_b64_tr_b16 a[16:17], v18 offset:32768
    ds_read_b64_tr_b16 a[18:19], v18 offset:33280
    v_mfma_f32_16x16x32_bf16 v[196:199], a[84:87], a[68:71], v[196:199]
    ds_read_b64_tr_b16 a[20:21], v19 offset:32768
    ds_read_b64_tr_b16 a[22:23], v19 offset:33280
    v_mfma_f32_16x16x32_bf16 v[192:195], a[84:87], a[64:67], v[192:195]
    buffer_load_dwordx4 v3, s[8:11], s24 offen offset:1024 lds
    ds_read_b64_tr_b16 a[24:25], v13 offset:32768
    v_mfma_f32_16x16x32_bf16 v[208:211], a[88:91], a[64:67], v[208:211]
    ds_read_b64_tr_b16 a[26:27], v13 offset:33280
    ds_read_b64_tr_b16 a[28:29], v58 offset:32768
    v_mfma_f32_16x16x32_bf16 v[212:215], a[88:91], a[68:71], v[212:215]
    ds_read_b64_tr_b16 a[30:31], v58 offset:33280
    buffer_load_dwordx4 v4, s[8:11], s24 offen offset:2048 lds
    v_mfma_f32_16x16x32_bf16 v[216:219], a[88:91], a[72:75], v[216:219]
    ds_read_b64_tr_b16 a[32:33], v18 offset:33792
    ds_read_b64_tr_b16 a[34:35], v18 offset:34304
    v_mfma_f32_16x16x32_bf16 v[220:223], a[88:91], a[76:79], v[220:223]
    v_add_u32 v17, s28, v15
    ds_read_b128 a[0:3], v16 offset:0
    v_mfma_f32_16x16x32_bf16 v[236:239], a[92:95], a[76:79], v[236:239]
    buffer_load_dwordx4 v5, s[8:11], s24 offen offset:3072 lds
    ds_read_b128 a[4:7], v16 offset:2048
    v_mfma_f32_16x16x32_bf16 v[232:235], a[92:95], a[72:75], v[232:235]
    s_bfe_u32 s31, s56, 0x40010
    ds_read_b128 a[8:11], v16 offset:4096
    v_mfma_f32_16x16x32_bf16 v[228:231], a[92:95], a[68:71], v[228:231]
    s_mul_i32 s25, s31, 458752
    ds_read_b128 a[12:15], v16 offset:6144
    v_mfma_f32_16x16x32_bf16 v[224:227], a[92:95], a[64:67], v[224:227]
    s_add_u32 s25, s25, s41
    s_add_u32 m0, s30, 16384
    v_mfma_f32_16x16x32_bf16 v[240:243], a[96:99], a[64:67], v[240:243]
    buffer_load_dwordx4 v10, s[12:15], s25 offen lds
    v_mfma_f32_16x16x32_bf16 v[244:247], a[96:99], a[68:71], v[244:247]
    s_mov_b64 exec, s[42:43]
    buffer_load_dwordx4 v11, s[12:15], s25 offen offset:1024 lds
    s_mov_b64 exec, -1
    v_mfma_f32_16x16x32_bf16 v[248:251], a[96:99], a[72:75], v[248:251]
    v_mfma_f32_16x16x32_bf16 v[252:255], a[96:99], a[76:79], v[252:255]
    s_waitcnt vmcnt(6)
    s_mov_b32 s47, 0
L_mb_1_16:
    v_max3_u32 v20, v25, v27, v29
    v_max3_u32 v21, v31, v33, v35
    v_max3_u32 v22, v37, v39, v41
    v_max3_u32 v23, v43, v45, v47
    v_max3_u32 v20, v20, v49, v51
    v_max3_u32 v21, v21, v53, v55
    v_max3_u32 v20, v20, v22, v23
    v_max_u32 v20, v20, v21
    v_cmp_eq_u32 vcc, -1, v20
    s_nop 1
    s_cmp_eq_u64 vcc, 0
    s_cbranch_scc1 L_mbd_1_17
    s_add_u32 s47, s47, 1
    s_cmp_ge_u32 s47, 262144
    s_cbranch_scc1 L_mbd_1_17
    buffer_load_dwordx2 v[24:25], v56, s[20:23], s58 offen offset:0 sc1
    buffer_load_dwordx2 v[26:27], v56, s[20:23], s58 offen offset:512 sc1
    buffer_load_dwordx2 v[28:29], v56, s[20:23], s58 offen offset:1024 sc1
    buffer_load_dwordx2 v[30:31], v56, s[20:23], s58 offen offset:1536 sc1
    buffer_load_dwordx2 v[32:33], v56, s[20:23], s58 offen offset:2048 sc1
    buffer_load_dwordx2 v[34:35], v56, s[20:23], s58 offen offset:2560 sc1
    buffer_load_dwordx2 v[36:37], v56, s[20:23], s58 offen offset:3072 sc1
    buffer_load_dwordx2 v[38:39], v56, s[20:23], s58 offen offset:3584 sc1
    buffer_load_dwordx2 v[40:41], v56, s[20:23], s59 offen offset:0 sc1
    buffer_load_dwordx2 v[42:43], v56, s[20:23], s59 offen offset:512 sc1
    buffer_load_dwordx2 v[44:45], v56, s[20:23], s59 offen offset:1024 sc1
    buffer_load_dwordx2 v[46:47], v56, s[20:23], s59 offen offset:1536 sc1
    buffer_load_dwordx2 v[48:49], v56, s[20:23], s59 offen offset:2048 sc1
    buffer_load_dwordx2 v[50:51], v56, s[20:23], s59 offen offset:2560 sc1
    buffer_load_dwordx2 v[52:53], v56, s[20:23], s59 offen offset:3072 sc1
    buffer_load_dwordx2 v[54:55], v56, s[20:23], s59 offen offset:3584 sc1
    s_waitcnt vmcnt(0)
    s_branch L_mb_1_16
L_mbd_1_17:
    s_nop 1
    v_pk_add_f32 v[24:25], v[24:25], v[40:41]
    v_pk_add_f32 v[26:27], v[26:27], v[42:43]
    v_pk_add_f32 v[28:29], v[28:29], v[44:45]
    v_pk_add_f32 v[30:31], v[30:31], v[46:47]
    v_pk_add_f32 v[32:33], v[32:33], v[48:49]
    v_pk_add_f32 v[34:35], v[34:35], v[50:51]
    v_pk_add_f32 v[36:37], v[36:37], v[52:53]
    v_pk_add_f32 v[38:39], v[38:39], v[54:55]
    v_pk_add_f32 v[24:25], v[24:25], v[32:33]
    v_pk_add_f32 v[26:27], v[26:27], v[34:35]
    v_pk_add_f32 v[28:29], v[28:29], v[36:37]
    v_pk_add_f32 v[30:31], v[30:31], v[38:39]
    v_pk_add_f32 v[24:25], v[24:25], v[28:29]
    v_pk_add_f32 v[26:27], v[26:27], v[30:31]
    v_pk_add_f32 v[24:25], v[24:25], v[26:27]
    v_mul_f32 v24, 0x3a124925, v24
    v_mul_f32 v25, 0x3a124925, v25
    v_fma_f32 v25, -v24, v24, v25
    v_add_f32 v25, 0x3727c5ac, v25
    v_rsq_f32 v28, v25
    s_nop 0
    v_mul_f32 v29, -v24, v28
    v_mov_b32 v32, v28
    v_mov_b32 v33, v29
    s_nop 0
    v_permlane32_swap_b32 v28, v32
    v_permlane32_swap_b32 v29, v33
    v_mov_b32 v30, v28
    v_mov_b32 v31, v29
    v_mov_b32 v34, v32
    v_mov_b32 v35, v33
    v_permlane16_swap_b32 v28, v30
    v_permlane16_swap_b32 v29, v31
    v_permlane16_swap_b32 v32, v34
    v_permlane16_swap_b32 v33, v35
    s_lshl_b32 s46, s35, 3
    s_lshl_b32 s47, s3, 1
    s_add_u32 s46, s46, s47
    s_mul_i32 s46, s46, 114688
    s_mul_i32 s47, s44, 7168
    s_add_u32 s46, s46, s47
    s_add_u32 s47, s46, 4096
    s_add_u32 s48, s46, 114688
    s_add_u32 s49, s48, 4096
    v_pk_fma_f32 v[64:65], v[64:65], v[28:29], v[28:29] op_sel:[0,0,1] op_sel_hi:[1,0,1]
    v_pk_fma_f32 v[66:67], v[66:67], v[28:29], v[28:29] op_sel:[0,0,1] op_sel_hi:[1,0,1]
    v_pk_fma_f32 v[68:69], v[68:69], v[30:31], v[30:31] op_sel:[0,0,1] op_sel_hi:[1,0,1]
    v_pk_fma_f32 v[70:71], v[70:71], v[30:31], v[30:31] op_sel:[0,0,1] op_sel_hi:[1,0,1]
    v_pk_fma_f32 v[72:73], v[72:73], v[32:33], v[32:33] op_sel:[0,0,1] op_sel_hi:[1,0,1]
    v_pk_fma_f32 v[74:75], v[74:75], v[32:33], v[32:33] op_sel:[0,0,1] op_sel_hi:[1,0,1]
    v_pk_fma_f32 v[76:77], v[76:77], v[34:35], v[34:35] op_sel:[0,0,1] op_sel_hi:[1,0,1]
    v_pk_fma_f32 v[78:79], v[78:79], v[34:35], v[34:35] op_sel:[0,0,1] op_sel_hi:[1,0,1]
    v_cvt_pk_bf16_f32 v64, v64, v65
    v_cvt_pk_bf16_f32 v65, v66, v67
    v_cvt_pk_bf16_f32 v66, v68, v69
    v_cvt_pk_bf16_f32 v67, v70, v71
    v_cvt_pk_bf16_f32 v72, v72, v73
    v_cvt_pk_bf16_f32 v73, v74, v75
    v_cvt_pk_bf16_f32 v74, v76, v77
    v_cvt_pk_bf16_f32 v75, v78, v79
    v_permlane16_swap_b32 v64, v66
    v_permlane16_swap_b32 v65, v67
    v_permlane16_swap_b32 v72, v74
    v_permlane16_swap_b32 v73, v75
    v_pk_fma_f32 v[80:81], v[80:81], v[28:29], v[28:29] op_sel:[0,0,1] op_sel_hi:[1,0,1]
    v_pk_fma_f32 v[82:83], v[82:83], v[28:29], v[28:29] op_sel:[0,0,1] op_sel_hi:[1,0,1]
    v_pk_fma_f32 v[84:85], v[84:85], v[30:31], v[30:31] op_sel:[0,0,1] op_sel_hi:[1,0,1]
    v_pk_fma_f32 v[86:87], v[86:87], v[30:31], v[30:31] op_sel:[0,0,1] op_sel_hi:[1,0,1]
    v_pk_fma_f32 v[88:89], v[88:89], v[32:33], v[32:33] op_sel:[0,0,1] op_sel_hi:[1,0,1]
    v_pk_fma_f32 v[90:91], v[90:91], v[32:33], v[32:33] op_sel:[0,0,1] op_sel_hi:[1,0,1]
    v_pk_fma_f32 v[92:93], v[92:93], v[34:35], v[34:35] op_sel:[0,0,1] op_sel_hi:[1,0,1]
    v_pk_fma_f32 v[94:95], v[94:95], v[34:35], v[34:35] op_sel:[0,0,1] op_sel_hi:[1,0,1]
    v_cvt_pk_bf16_f32 v80, v80, v81
    v_cvt_pk_bf16_f32 v81, v82, v83
    v_cvt_pk_bf16_f32 v82, v84, v85
    v_cvt_pk_bf16_f32 v83, v86, v87
    v_cvt_pk_bf16_f32 v88, v88, v89
    v_cvt_pk_bf16_f32 v89, v90, v91
    v_cvt_pk_bf16_f32 v90, v92, v93
    v_cvt_pk_bf16_f32 v91, v94, v95
    v_permlane16_swap_b32 v80, v82
    v_permlane16_swap_b32 v81, v83
    v_permlane16_swap_b32 v88, v90
    v_permlane16_swap_b32 v89, v91
    v_pk_fma_f32 v[96:97], v[96:97], v[28:29], v[28:29] op_sel:[0,0,1] op_sel_hi:[1,0,1]
    v_pk_fma_f32 v[98:99], v[98:99], v[28:29], v[28:29] op_sel:[0,0,1] op_sel_hi:[1,0,1]
    v_pk_fma_f32 v[100:101], v[100:101], v[30:31], v[30:31] op_sel:[0,0,1] op_sel_hi:[1,0,1]
    v_pk_fma_f32 v[102:103], v[102:103], v[30:31], v[30:31] op_sel:[0,0,1] op_sel_hi:[1,0,1]
    v_pk_fma_f32 v[104:105], v[104:105], v[32:33], v[32:33] op_sel:[0,0,1] op_sel_hi:[1,0,1]
    v_pk_fma_f32 v[106:107], v[106:107], v[32:33], v[32:33] op_sel:[0,0,1] op_sel_hi:[1,0,1]
    v_pk_fma_f32 v[108:109], v[108:109], v[34:35], v[34:35] op_sel:[0,0,1] op_sel_hi:[1,0,1]
    v_pk_fma_f32 v[110:111], v[110:111], v[34:35], v[34:35] op_sel:[0,0,1] op_sel_hi:[1,0,1]
    v_cvt_pk_bf16_f32 v96, v96, v97
    v_cvt_pk_bf16_f32 v97, v98, v99
    v_cvt_pk_bf16_f32 v98, v100, v101
    v_cvt_pk_bf16_f32 v99, v102, v103
    v_cvt_pk_bf16_f32 v104, v104, v105
    v_cvt_pk_bf16_f32 v105, v106, v107
    v_cvt_pk_bf16_f32 v106, v108, v109
    v_cvt_pk_bf16_f32 v107, v110, v111
    v_permlane16_swap_b32 v96, v98
    v_permlane16_swap_b32 v97, v99
    v_permlane16_swap_b32 v104, v106
    v_permlane16_swap_b32 v105, v107
    v_pk_fma_f32 v[112:113], v[112:113], v[28:29], v[28:29] op_sel:[0,0,1] op_sel_hi:[1,0,1]
    v_pk_fma_f32 v[114:115], v[114:115], v[28:29], v[28:29] op_sel:[0,0,1] op_sel_hi:[1,0,1]
    v_pk_fma_f32 v[116:117], v[116:117], v[30:31], v[30:31] op_sel:[0,0,1] op_sel_hi:[1,0,1]
    v_pk_fma_f32 v[118:119], v[118:119], v[30:31], v[30:31] op_sel:[0,0,1] op_sel_hi:[1,0,1]
    v_pk_fma_f32 v[120:121], v[120:121], v[32:33], v[32:33] op_sel:[0,0,1] op_sel_hi:[1,0,1]
    v_pk_fma_f32 v[122:123], v[122:123], v[32:33], v[32:33] op_sel:[0,0,1] op_sel_hi:[1,0,1]
    v_pk_fma_f32 v[124:125], v[124:125], v[34:35], v[34:35] op_sel:[0,0,1] op_sel_hi:[1,0,1]
    v_pk_fma_f32 v[126:127], v[126:127], v[34:35], v[34:35] op_sel:[0,0,1] op_sel_hi:[1,0,1]
    v_cvt_pk_bf16_f32 v112, v112, v113
    v_cvt_pk_bf16_f32 v113, v114, v115
    v_cvt_pk_bf16_f32 v114, v116, v117
    v_cvt_pk_bf16_f32 v115, v118, v119
    v_cvt_pk_bf16_f32 v120, v120, v121
    v_cvt_pk_bf16_f32 v121, v122, v123
    v_cvt_pk_bf16_f32 v122, v124, v125
    v_cvt_pk_bf16_f32 v123, v126, v127
    v_permlane16_swap_b32 v112, v114
    v_permlane16_swap_b32 v113, v115
    v_permlane16_swap_b32 v120, v122
    v_permlane16_swap_b32 v121, v123
    v_pk_fma_f32 v[128:129], v[128:129], v[28:29], v[28:29] op_sel:[0,0,1] op_sel_hi:[1,0,1]
    v_pk_fma_f32 v[130:131], v[130:131], v[28:29], v[28:29] op_sel:[0,0,1] op_sel_hi:[1,0,1]
    v_pk_fma_f32 v[132:133], v[132:133], v[30:31], v[30:31] op_sel:[0,0,1] op_sel_hi:[1,0,1]
    v_pk_fma_f32 v[134:135], v[134:135], v[30:31], v[30:31] op_sel:[0,0,1] op_sel_hi:[1,0,1]
    v_pk_fma_f32 v[136:137], v[136:137], v[32:33], v[32:33] op_sel:[0,0,1] op_sel_hi:[1,0,1]
    v_pk_fma_f32 v[138:139], v[138:139], v[32:33], v[32:33] op_sel:[0,0,1] op_sel_hi:[1,0,1]
    v_pk_fma_f32 v[140:141], v[140:141], v[34:35], v[34:35] op_sel:[0,0,1] op_sel_hi:[1,0,1]
    v_pk_fma_f32 v[142:143], v[142:143], v[34:35], v[34:35] op_sel:[0,0,1] op_sel_hi:[1,0,1]
    v_cvt_pk_bf16_f32 v128, v128, v129
    v_cvt_pk_bf16_f32 v129, v130, v131
    v_cvt_pk_bf16_f32 v130, v132, v133
    v_cvt_pk_bf16_f32 v131, v134, v135
    v_cvt_pk_bf16_f32 v136, v136, v137
    v_cvt_pk_bf16_f32 v137, v138, v139
    v_cvt_pk_bf16_f32 v138, v140, v141
    v_cvt_pk_bf16_f32 v139, v142, v143
    v_permlane16_swap_b32 v128, v130
    v_permlane16_swap_b32 v129, v131
    v_permlane16_swap_b32 v136, v138
    v_permlane16_swap_b32 v137, v139
    v_pk_fma_f32 v[144:145], v[144:145], v[28:29], v[28:29] op_sel:[0,0,1] op_sel_hi:[1,0,1]
    v_pk_fma_f32 v[146:147], v[146:147], v[28:29], v[28:29] op_sel:[0,0,1] op_sel_hi:[1,0,1]
    v_pk_fma_f32 v[148:149], v[148:149], v[30:31], v[30:31] op_sel:[0,0,1] op_sel_hi:[1,0,1]
    v_pk_fma_f32 v[150:151], v[150:151], v[30:31], v[30:31] op_sel:[0,0,1] op_sel_hi:[1,0,1]
    v_pk_fma_f32 v[152:153], v[152:153], v[32:33], v[32:33] op_sel:[0,0,1] op_sel_hi:[1,0,1]
    v_pk_fma_f32 v[154:155], v[154:155], v[32:33], v[32:33] op_sel:[0,0,1] op_sel_hi:[1,0,1]
    v_pk_fma_f32 v[156:157], v[156:157], v[34:35], v[34:35] op_sel:[0,0,1] op_sel_hi:[1,0,1]
    v_pk_fma_f32 v[158:159], v[158:159], v[34:35], v[34:35] op_sel:[0,0,1] op_sel_hi:[1,0,1]
    v_cvt_pk_bf16_f32 v144, v144, v145
    v_cvt_pk_bf16_f32 v145, v146, v147
    v_cvt_pk_bf16_f32 v146, v148, v149
    v_cvt_pk_bf16_f32 v147, v150, v151
    v_cvt_pk_bf16_f32 v152, v152, v153
    v_cvt_pk_bf16_f32 v153, v154, v155
    v_cvt_pk_bf16_f32 v154, v156, v157
    v_cvt_pk_bf16_f32 v155, v158, v159
    v_permlane16_swap_b32 v144, v146
    v_permlane16_swap_b32 v145, v147
    v_permlane16_swap_b32 v152, v154
    v_permlane16_swap_b32 v153, v155
    v_pk_fma_f32 v[160:161], v[160:161], v[28:29], v[28:29] op_sel:[0,0,1] op_sel_hi:[1,0,1]
    v_pk_fma_f32 v[162:163], v[162:163], v[28:29], v[28:29] op_sel:[0,0,1] op_sel_hi:[1,0,1]
    v_pk_fma_f32 v[164:165], v[164:165], v[30:31], v[30:31] op_sel:[0,0,1] op_sel_hi:[1,0,1]
    v_pk_fma_f32 v[166:167], v[166:167], v[30:31], v[30:31] op_sel:[0,0,1] op_sel_hi:[1,0,1]
    v_pk_fma_f32 v[168:169], v[168:169], v[32:33], v[32:33] op_sel:[0,0,1] op_sel_hi:[1,0,1]
    v_pk_fma_f32 v[170:171], v[170:171], v[32:33], v[32:33] op_sel:[0,0,1] op_sel_hi:[1,0,1]
    v_pk_fma_f32 v[172:173], v[172:173], v[34:35], v[34:35] op_sel:[0,0,1] op_sel_hi:[1,0,1]
    v_pk_fma_f32 v[174:175], v[174:175], v[34:35], v[34:35] op_sel:[0,0,1] op_sel_hi:[1,0,1]
    v_cvt_pk_bf16_f32 v160, v160, v161
    v_cvt_pk_bf16_f32 v161, v162, v163
    v_cvt_pk_bf16_f32 v162, v164, v165
    v_cvt_pk_bf16_f32 v163, v166, v167
    v_cvt_pk_bf16_f32 v168, v168, v169
    v_cvt_pk_bf16_f32 v169, v170, v171
    v_cvt_pk_bf16_f32 v170, v172, v173
    v_cvt_pk_bf16_f32 v171, v174, v175
    v_permlane16_swap_b32 v160, v162
    v_permlane16_swap_b32 v161, v163
    v_permlane16_swap_b32 v168, v170
    v_permlane16_swap_b32 v169, v171
    s_waitcnt lgkmcnt(0)
    v_mfma_f32_16x16x32_bf16 v[176:179], a[16:19], a[0:3], v[176:179]
    ds_read_b128 a[64:67], v17 offset:0
    s_add_u32 m0, s29, s27
    v_mfma_f32_16x16x32_bf16 v[180:183], a[16:19], a[4:7], v[180:183]
    s_add_u32 m0, m0, 4096
    ds_read_b128 a[68:71], v17 offset:2048
    v_mfma_f32_16x16x32_bf16 v[184:187], a[16:19], a[8:11], v[184:187]
    buffer_load_dwordx4 v6, s[8:11], s24 offen offset:0 lds
    ds_read_b128 a[72:75], v17 offset:4096
    v_mfma_f32_16x16x32_bf16 v[188:191], a[16:19], a[12:15], v[188:191]
    ds_read_b128 a[76:79], v17 offset:6144
    buffer_load_dwordx4 v7, s[8:11], s24 offen offset:1024 lds
    v_mfma_f32_16x16x32_bf16 v[204:207], a[20:23], a[12:15], v[204:207]
    ds_read_b64_tr_b16 a[80:81], v18 offset:40960
    v_mfma_f32_16x16x32_bf16 v[200:203], a[20:23], a[8:11], v[200:203]
    ds_read_b64_tr_b16 a[82:83], v18 offset:41472
    v_mfma_f32_16x16x32_bf16 v[196:199], a[20:23], a[4:7], v[196:199]
    ds_read_b64_tr_b16 a[84:85], v19 offset:40960
    buffer_load_dwordx4 v8, s[8:11], s24 offen offset:2048 lds
    v_mfma_f32_16x16x32_bf16 v[192:195], a[20:23], a[0:3], v[192:195]
    ds_read_b64_tr_b16 a[86:87], v19 offset:41472
    v_mfma_f32_16x16x32_bf16 v[208:211], a[24:27], a[0:3], v[208:211]
    ds_read_b64_tr_b16 a[88:89], v13 offset:40960
    buffer_load_dwordx4 v9, s[8:11], s24 offen offset:3072 lds
    v_mfma_f32_16x16x32_bf16 v[212:215], a[24:27], a[4:7], v[212:215]
    ds_read_b64_tr_b16 a[90:91], v13 offset:41472
    s_add_u32 s27, s27, 32768
    v_mfma_f32_16x16x32_bf16 v[216:219], a[24:27], a[8:11], v[216:219]
    s_cmp_eq_u32 s27, 98304
    s_cselect_b32 s27, 0, s27
    v_mfma_f32_16x16x32_bf16 v[220:223], a[24:27], a[12:15], v[220:223]
    ds_read_b64_tr_b16 a[92:93], v58 offset:40960
    s_add_u32 s25, s25, 229376
    v_mfma_f32_16x16x32_bf16 v[236:239], a[28:31], a[12:15], v[236:239]
    s_add_u32 m0, s30, 24576
    ds_read_b64_tr_b16 a[94:95], v58 offset:41472
    v_mfma_f32_16x16x32_bf16 v[232:235], a[28:31], a[8:11], v[232:235]
    buffer_load_dwordx4 v10, s[12:15], s25 offen lds
    ds_read_b64_tr_b16 a[96:97], v18 offset:41984
    v_mfma_f32_16x16x32_bf16 v[228:231], a[28:31], a[4:7], v[228:231]
    ds_read_b64_tr_b16 a[98:99], v18 offset:42496
    v_mfma_f32_16x16x32_bf16 v[224:227], a[28:31], a[0:3], v[224:227]
    s_mov_b64 exec, s[42:43]
    buffer_load_dwordx4 v11, s[12:15], s25 offen offset:1024 lds
    s_mov_b64 exec, -1
    v_mfma_f32_16x16x32_bf16 v[240:243], a[32:35], a[0:3], v[240:243]
    buffer_store_dwordx4 v[64:67], v1, s[20:23], s46 offen offset:0 sc1
    v_mfma_f32_16x16x32_bf16 v[244:247], a[32:35], a[4:7], v[244:247]
    buffer_store_dwordx4 v[72:75], v1, s[20:23], s48 offen offset:0 sc1
    v_mfma_f32_16x16x32_bf16 v[248:251], a[32:35], a[8:11], v[248:251]
    v_mfma_f32_16x16x32_bf16 v[252:255], a[32:35], a[12:15], v[252:255]
    buffer_store_dwordx4 v[80:83], v1, s[20:23], s46 offen offset:1024 sc1
    s_waitcnt lgkmcnt(0)
    v_mfma_f32_16x16x32_bf16 v[176:179], a[80:83], a[64:67], v[176:179]
    s_waitcnt vmcnt(31)
    s_barrier
    v_mfma_f32_16x16x32_bf16 v[180:183], a[80:83], a[68:71], v[180:183]
    ds_read_b64_tr_b16 a[16:17], v18 offset:0
    s_bfe_u32 s24, s56, 0x40018
    v_mfma_f32_16x16x32_bf16 v[184:187], a[80:83], a[72:75], v[184:187]
    s_lshl_b32 s24, s24, 7
    s_add_u32 m0, s29, s27
    v_mfma_f32_16x16x32_bf16 v[188:191], a[80:83], a[76:79], v[188:191]
    buffer_load_dwordx4 v2, s[8:11], s24 offen offset:0 lds
    ds_read_b64_tr_b16 a[18:19], v18 offset:512
    v_mfma_f32_16x16x32_bf16 v[204:207], a[84:87], a[76:79], v[204:207]
    ds_read_b64_tr_b16 a[20:21], v19 offset:0
    buffer_load_dwordx4 v3, s[8:11], s24 offen offset:1024 lds
    v_mfma_f32_16x16x32_bf16 v[200:203], a[84:87], a[72:75], v[200:203]
    ds_read_b64_tr_b16 a[22:23], v19 offset:512
    v_mfma_f32_16x16x32_bf16 v[196:199], a[84:87], a[68:71], v[196:199]
    ds_read_b64_tr_b16 a[24:25], v13 offset:0
    buffer_load_dwordx4 v4, s[8:11], s24 offen offset:2048 lds
    v_mfma_f32_16x16x32_bf16 v[192:195], a[84:87], a[64:67], v[192:195]
    ds_read_b64_tr_b16 a[26:27], v13 offset:512
    v_mfma_f32_16x16x32_bf16 v[208:211], a[88:91], a[64:67], v[208:211]
    ds_read_b64_tr_b16 a[28:29], v58 offset:0
    v_mfma_f32_16x16x32_bf16 v[212:215], a[88:91], a[68:71], v[212:215]
    buffer_load_dwordx4 v5, s[8:11], s24 offen offset:3072 lds
    s_bfe_u32 s31, s56, 0x40014
    v_mfma_f32_16x16x32_bf16 v[216:219], a[88:91], a[72:75], v[216:219]
    s_mul_i32 s25, s31, 458752
    ds_read_b64_tr_b16 a[30:31], v58 offset:512
    v_mfma_f32_16x16x32_bf16 v[220:223], a[88:91], a[76:79], v[220:223]
    s_add_u32 s25, s25, s41
    s_add_u32 m0, s30, 32768
    v_mfma_f32_16x16x32_bf16 v[236:239], a[92:95], a[76:79], v[236:239]
    ds_read_b64_tr_b16 a[32:33], v18 offset:1024
    buffer_load_dwordx4 v10, s[12:15], s25 offen lds
    v_mfma_f32_16x16x32_bf16 v[232:235], a[92:95], a[72:75], v[232:235]
    ds_read_b64_tr_b16 a[34:35], v18 offset:1536
    v_mfma_f32_16x16x32_bf16 v[228:231], a[92:95], a[68:71], v[228:231]
    s_mov_b64 exec, s[42:43]
    buffer_load_dwordx4 v11, s[12:15], s25 offen offset:1024 lds
    s_mov_b64 exec, -1
    v_mfma_f32_16x16x32_bf16 v[224:227], a[92:95], a[64:67], v[224:227]
    buffer_store_dwordx4 v[88:91], v1, s[20:23], s48 offen offset:1024 sc1
    v_mfma_f32_16x16x32_bf16 v[240:243], a[96:99], a[64:67], v[240:243]
    buffer_store_dwordx4 v[96:99], v1, s[20:23], s46 offen offset:2048 sc1
    v_mfma_f32_16x16x32_bf16 v[244:247], a[96:99], a[68:71], v[244:247]
    v_mfma_f32_16x16x32_bf16 v[248:251], a[96:99], a[72:75], v[248:251]
    buffer_store_dwordx4 v[104:107], v1, s[20:23], s48 offen offset:2048 sc1
    v_mfma_f32_16x16x32_bf16 v[252:255], a[96:99], a[76:79], v[252:255]
    buffer_store_dwordx4 v[112:115], v1, s[20:23], s46 offen offset:3072 sc1
    s_waitcnt lgkmcnt(0)
    v_mfma_f32_16x16x32_bf16 v[176:179], a[16:19], a[160:163], v[176:179]
    ds_read_b64_tr_b16 a[80:81], v18 offset:8192
    s_add_u32 m0, s29, s27
    v_mfma_f32_16x16x32_bf16 v[180:183], a[16:19], a[164:167], v[180:183]
    s_add_u32 m0, m0, 4096
    s_nop 0
    buffer_load_dwordx4 v6, s[8:11], s24 offen offset:0 lds
    v_mfma_f32_16x16x32_bf16 v[184:187], a[16:19], a[168:171], v[184:187]
    ds_read_b64_tr_b16 a[82:83], v18 offset:8704
    ds_read_b64_tr_b16 a[84:85], v19 offset:8192
    v_mfma_f32_16x16x32_bf16 v[188:191], a[16:19], a[172:175], v[188:191]
    buffer_load_dwordx4 v7, s[8:11], s24 offen offset:1024 lds
    v_mfma_f32_16x16x32_bf16 v[204:207], a[20:23], a[172:175], v[204:207]
    ds_read_b64_tr_b16 a[86:87], v19 offset:8704
    v_mfma_f32_16x16x32_bf16 v[200:203], a[20:23], a[168:171], v[200:203]
    ds_read_b64_tr_b16 a[88:89], v13 offset:8192
    v_mfma_f32_16x16x32_bf16 v[196:199], a[20:23], a[164:167], v[196:199]
    buffer_load_dwordx4 v8, s[8:11], s24 offen offset:2048 lds
    v_mfma_f32_16x16x32_bf16 v[192:195], a[20:23], a[160:163], v[192:195]
    ds_read_b64_tr_b16 a[90:91], v13 offset:8704
    v_mfma_f32_16x16x32_bf16 v[208:211], a[24:27], a[160:163], v[208:211]
    ds_read_b64_tr_b16 a[92:93], v58 offset:8192
    buffer_load_dwordx4 v9, s[8:11], s24 offen offset:3072 lds
    v_mfma_f32_16x16x32_bf16 v[212:215], a[24:27], a[164:167], v[212:215]
    s_add_u32 s27, s27, 32768
    ds_read_b64_tr_b16 a[94:95], v58 offset:8704
    v_mfma_f32_16x16x32_bf16 v[216:219], a[24:27], a[168:171], v[216:219]
    s_cmp_eq_u32 s27, 98304
    s_cselect_b32 s27, 0, s27
    v_mfma_f32_16x16x32_bf16 v[220:223], a[24:27], a[172:175], v[220:223]
    s_add_u32 s25, s25, 229376
    s_add_u32 m0, s30, 40960
    v_mfma_f32_16x16x32_bf16 v[236:239], a[28:31], a[172:175], v[236:239]
    ds_read_b64_tr_b16 a[96:97], v18 offset:9216
    buffer_load_dwordx4 v10, s[12:15], s25 offen lds
    v_mfma_f32_16x16x32_bf16 v[232:235], a[28:31], a[168:171], v[232:235]
    ds_read_b64_tr_b16 a[98:99], v18 offset:9728
    v_mfma_f32_16x16x32_bf16 v[228:231], a[28:31], a[164:167], v[228:231]
    s_mov_b64 exec, s[42:43]
    buffer_load_dwordx4 v11, s[12:15], s25 offen offset:1024 lds
    s_mov_b64 exec, -1
    v_mfma_f32_16x16x32_bf16 v[224:227], a[28:31], a[160:163], v[224:227]
    buffer_store_dwordx4 v[120:123], v1, s[20:23], s48 offen offset:3072 sc1
    v_mfma_f32_16x16x32_bf16 v[240:243], a[32:35], a[160:163], v[240:243]
    v_mfma_f32_16x16x32_bf16 v[244:247], a[32:35], a[164:167], v[244:247]
    buffer_store_dwordx4 v[128:131], v1, s[20:23], s47 offen offset:0 sc1
    v_mfma_f32_16x16x32_bf16 v[248:251], a[32:35], a[168:171], v[248:251]
    v_mfma_f32_16x16x32_bf16 v[252:255], a[32:35], a[172:175], v[252:255]
    buffer_store_dwordx4 v[136:139], v1, s[20:23], s49 offen offset:0 sc1
    s_waitcnt lgkmcnt(0)
    v_mfma_f32_16x16x32_bf16 v[176:179], a[80:83], a[176:179], v[176:179]
    s_waitcnt vmcnt(22)
    s_barrier
    v_mfma_f32_16x16x32_bf16 v[180:183], a[80:83], a[180:183], v[180:183]
    s_add_u32 s28, s28, 32768
    v_mfma_f32_16x16x32_bf16 v[184:187], a[80:83], a[184:187], v[184:187]
    s_cmp_eq_u32 s28, 98304
    s_cselect_b32 s28, 0, s28
    v_mfma_f32_16x16x32_bf16 v[188:191], a[80:83], a[188:191], v[188:191]
    v_add_u32 v16, s28, v14
    s_bfe_u32 s31, s57, 0x40018
    v_mfma_f32_16x16x32_bf16 v[204:207], a[84:87], a[188:191], v[204:207]
    s_mul_i32 s25, s31, 458752
    ds_read_b64_tr_b16 a[16:17], v18 offset:16384
    v_mfma_f32_16x16x32_bf16 v[200:203], a[84:87], a[184:187], v[200:203]
    s_add_u32 s25, s25, s41
    ds_read_b64_tr_b16 a[18:19], v18 offset:16896
    v_mfma_f32_16x16x32_bf16 v[196:199], a[84:87], a[180:183], v[196:199]
    s_add_u32 m0, s30, 0
    s_nop 0
    buffer_load_dwordx4 v10, s[12:15], s25 offen lds
    v_mfma_f32_16x16x32_bf16 v[192:195], a[84:87], a[176:179], v[192:195]
    ds_read_b64_tr_b16 a[20:21], v19 offset:16384
    ds_read_b64_tr_b16 a[22:23], v19 offset:16896
    v_mfma_f32_16x16x32_bf16 v[208:211], a[88:91], a[176:179], v[208:211]
    ds_read_b64_tr_b16 a[24:25], v13 offset:16384
    ds_read_b64_tr_b16 a[26:27], v13 offset:16896
    v_mfma_f32_16x16x32_bf16 v[212:215], a[88:91], a[180:183], v[212:215]
    ds_read_b64_tr_b16 a[28:29], v58 offset:16384
    ds_read_b64_tr_b16 a[30:31], v58 offset:16896
    v_mfma_f32_16x16x32_bf16 v[216:219], a[88:91], a[184:187], v[216:219]
    ds_read_b64_tr_b16 a[32:33], v18 offset:17408
    ds_read_b64_tr_b16 a[34:35], v18 offset:17920
    v_mfma_f32_16x16x32_bf16 v[220:223], a[88:91], a[188:191], v[220:223]
    v_add_u32 v17, s28, v15
    ds_read_b128 a[0:3], v16 offset:0
    v_mfma_f32_16x16x32_bf16 v[236:239], a[92:95], a[188:191], v[236:239]
    s_mov_b64 exec, s[42:43]
    buffer_load_dwordx4 v11, s[12:15], s25 offen offset:1024 lds
    s_mov_b64 exec, -1
    v_mfma_f32_16x16x32_bf16 v[232:235], a[92:95], a[184:187], v[232:235]
    ds_read_b128 a[4:7], v16 offset:2048
    ds_read_b128 a[8:11], v16 offset:4096
    v_mfma_f32_16x16x32_bf16 v[228:231], a[92:95], a[180:183], v[228:231]
    ds_read_b128 a[12:15], v16 offset:6144
    v_mfma_f32_16x16x32_bf16 v[224:227], a[92:95], a[176:179], v[224:227]
    buffer_store_dwordx4 v[144:147], v1, s[20:23], s47 offen offset:1024 sc1
    v_mfma_f32_16x16x32_bf16 v[240:243], a[96:99], a[176:179], v[240:243]
    buffer_store_dwordx4 v[152:155], v1, s[20:23], s49 offen offset:1024 sc1
    v_mfma_f32_16x16x32_bf16 v[244:247], a[96:99], a[180:183], v[244:247]
    v_mfma_f32_16x16x32_bf16 v[248:251], a[96:99], a[184:187], v[248:251]
    buffer_store_dwordx4 v[160:163], v1, s[20:23], s47 offen offset:2048 sc1
    v_mfma_f32_16x16x32_bf16 v[252:255], a[96:99], a[188:191], v[252:255]
    buffer_store_dwordx4 v[168:171], v1, s[20:23], s49 offen offset:2048 sc1
    s_waitcnt lgkmcnt(0)
    v_mfma_f32_16x16x32_bf16 v[176:179], a[16:19], a[0:3], v[176:179]
    ds_read_b128 a[64:67], v17 offset:0
    v_mfma_f32_16x16x32_bf16 v[180:183], a[16:19], a[4:7], v[180:183]
    ds_read_b128 a[68:71], v17 offset:2048
    v_mfma_f32_16x16x32_bf16 v[184:187], a[16:19], a[8:11], v[184:187]
    ds_read_b128 a[72:75], v17 offset:4096
    v_mfma_f32_16x16x32_bf16 v[188:191], a[16:19], a[12:15], v[188:191]
    ds_read_b128 a[76:79], v17 offset:6144
    s_add_u32 s25, s25, 229376
    v_mfma_f32_16x16x32_bf16 v[204:207], a[20:23], a[12:15], v[204:207]
    ds_read_b64_tr_b16 a[80:81], v18 offset:24576
    s_add_u32 m0, s30, 8192
    v_mfma_f32_16x16x32_bf16 v[200:203], a[20:23], a[8:11], v[200:203]
    buffer_load_dwordx4 v10, s[12:15], s25 offen lds
    ds_read_b64_tr_b16 a[82:83], v18 offset:25088
    v_mfma_f32_16x16x32_bf16 v[196:199], a[20:23], a[4:7], v[196:199]
    ds_read_b64_tr_b16 a[84:85], v19 offset:24576
    v_mfma_f32_16x16x32_bf16 v[192:195], a[20:23], a[0:3], v[192:195]
    ds_read_b64_tr_b16 a[86:87], v19 offset:25088
    v_mfma_f32_16x16x32_bf16 v[208:211], a[24:27], a[0:3], v[208:211]
    ds_read_b64_tr_b16 a[88:89], v13 offset:24576
    v_mfma_f32_16x16x32_bf16 v[212:215], a[24:27], a[4:7], v[212:215]
    ds_read_b64_tr_b16 a[90:91], v13 offset:25088
    v_mfma_f32_16x16x32_bf16 v[216:219], a[24:27], a[8:11], v[216:219]
    ds_read_b64_tr_b16 a[92:93], v58 offset:24576
    v_mfma_f32_16x16x32_bf16 v[220:223], a[24:27], a[12:15], v[220:223]
    ds_read_b64_tr_b16 a[94:95], v58 offset:25088
    v_mfma_f32_16x16x32_bf16 v[236:239], a[28:31], a[12:15], v[236:239]
    ds_read_b64_tr_b16 a[96:97], v18 offset:25600
    v_mfma_f32_16x16x32_bf16 v[232:235], a[28:31], a[8:11], v[232:235]
    ds_read_b64_tr_b16 a[98:99], v18 offset:26112
    v_mfma_f32_16x16x32_bf16 v[228:231], a[28:31], a[4:7], v[228:231]
    s_mov_b64 exec, s[42:43]
    buffer_load_dwordx4 v11, s[12:15], s25 offen offset:1024 lds
    s_mov_b64 exec, -1
    v_mfma_f32_16x16x32_bf16 v[224:227], a[28:31], a[0:3], v[224:227]
    v_mfma_f32_16x16x32_bf16 v[240:243], a[32:35], a[0:3], v[240:243]
    v_mfma_f32_16x16x32_bf16 v[244:247], a[32:35], a[4:7], v[244:247]
    v_mfma_f32_16x16x32_bf16 v[248:251], a[32:35], a[8:11], v[248:251]
    v_mfma_f32_16x16x32_bf16 v[252:255], a[32:35], a[12:15], v[252:255]
    s_waitcnt lgkmcnt(0)
    v_mfma_f32_16x16x32_bf16 v[176:179], a[80:83], a[64:67], v[176:179]
    s_waitcnt vmcnt(11)
    s_barrier
    v_mfma_f32_16x16x32_bf16 v[180:183], a[80:83], a[68:71], v[180:183]
    s_add_u32 s28, s28, 32768
    s_bfe_u32 s24, s56, 0x4001c
    v_mfma_f32_16x16x32_bf16 v[184:187], a[80:83], a[72:75], v[184:187]
    s_lshl_b32 s24, s24, 7
    s_add_u32 m0, s29, s27
    v_mfma_f32_16x16x32_bf16 v[188:191], a[80:83], a[76:79], v[188:191]
    s_cmp_eq_u32 s28, 98304
    s_cselect_b32 s28, 0, s28
    v_mfma_f32_16x16x32_bf16 v[204:207], a[84:87], a[76:79], v[204:207]
    v_add_u32 v16, s28, v14
    buffer_load_dwordx4 v2, s[8:11], s24 offen offset:0 lds
    v_mfma_f32_16x16x32_bf16 v[200:203], a[84:87], a[72:75], v[200:203]
    ds_read_b64_tr_b16 a[16:17], v18 offset:32768
    ds_read_b64_tr_b16 a[18:19], v18 offset:33280
    v_mfma_f32_16x16x32_bf16 v[196:199], a[84:87], a[68:71], v[196:199]
    ds_read_b64_tr_b16 a[20:21], v19 offset:32768
    ds_read_b64_tr_b16 a[22:23], v19 offset:33280
    v_mfma_f32_16x16x32_bf16 v[192:195], a[84:87], a[64:67], v[192:195]
    buffer_load_dwordx4 v3, s[8:11], s24 offen offset:1024 lds
    ds_read_b64_tr_b16 a[24:25], v13 offset:32768
    v_mfma_f32_16x16x32_bf16 v[208:211], a[88:91], a[64:67], v[208:211]
    ds_read_b64_tr_b16 a[26:27], v13 offset:33280
    ds_read_b64_tr_b16 a[28:29], v58 offset:32768
    v_mfma_f32_16x16x32_bf16 v[212:215], a[88:91], a[68:71], v[212:215]
    ds_read_b64_tr_b16 a[30:31], v58 offset:33280
    buffer_load_dwordx4 v4, s[8:11], s24 offen offset:2048 lds
    v_mfma_f32_16x16x32_bf16 v[216:219], a[88:91], a[72:75], v[216:219]
    ds_read_b64_tr_b16 a[32:33], v18 offset:33792
    ds_read_b64_tr_b16 a[34:35], v18 offset:34304
    v_mfma_f32_16x16x32_bf16 v[220:223], a[88:91], a[76:79], v[220:223]
    v_add_u32 v17, s28, v15
    ds_read_b128 a[0:3], v16 offset:0
    v_mfma_f32_16x16x32_bf16 v[236:239], a[92:95], a[76:79], v[236:239]
    buffer_load_dwordx4 v5, s[8:11], s24 offen offset:3072 lds
    ds_read_b128 a[4:7], v16 offset:2048
    v_mfma_f32_16x16x32_bf16 v[232:235], a[92:95], a[72:75], v[232:235]
    s_bfe_u32 s31, s56, 0x40018
    ds_read_b128 a[8:11], v16 offset:4096
    v_mfma_f32_16x16x32_bf16 v[228:231], a[92:95], a[68:71], v[228:231]
    s_mul_i32 s25, s31, 458752
    ds_read_b128 a[12:15], v16 offset:6144
    v_mfma_f32_16x16x32_bf16 v[224:227], a[92:95], a[64:67], v[224:227]
    s_add_u32 s25, s25, s41
    s_add_u32 m0, s30, 16384
    v_mfma_f32_16x16x32_bf16 v[240:243], a[96:99], a[64:67], v[240:243]
    buffer_load_dwordx4 v10, s[12:15], s25 offen lds
    v_mfma_f32_16x16x32_bf16 v[244:247], a[96:99], a[68:71], v[244:247]
    s_mov_b64 exec, s[42:43]
    buffer_load_dwordx4 v11, s[12:15], s25 offen offset:1024 lds
    s_mov_b64 exec, -1
    v_mfma_f32_16x16x32_bf16 v[248:251], a[96:99], a[72:75], v[248:251]
    v_mfma_f32_16x16x32_bf16 v[252:255], a[96:99], a[76:79], v[252:255]
    s_waitcnt lgkmcnt(0)
    v_mfma_f32_16x16x32_bf16 v[176:179], a[16:19], a[0:3], v[176:179]
    ds_read_b128 a[64:67], v17 offset:0
    s_add_u32 m0, s29, s27
    v_mfma_f32_16x16x32_bf16 v[180:183], a[16:19], a[4:7], v[180:183]
    ds_read_b128 a[68:71], v17 offset:2048
    s_add_u32 m0, m0, 4096
    v_mfma_f32_16x16x32_bf16 v[184:187], a[16:19], a[8:11], v[184:187]
    buffer_load_dwordx4 v6, s[8:11], s24 offen offset:0 lds
    ds_read_b128 a[72:75], v17 offset:4096
    v_mfma_f32_16x16x32_bf16 v[188:191], a[16:19], a[12:15], v[188:191]
    ds_read_b128 a[76:79], v17 offset:6144
    v_mfma_f32_16x16x32_bf16 v[204:207], a[20:23], a[12:15], v[204:207]
    ds_read_b64_tr_b16 a[80:81], v18 offset:40960
    buffer_load_dwordx4 v7, s[8:11], s24 offen offset:1024 lds
    v_mfma_f32_16x16x32_bf16 v[200:203], a[20:23], a[8:11], v[200:203]
    ds_read_b64_tr_b16 a[82:83], v18 offset:41472
    v_mfma_f32_16x16x32_bf16 v[196:199], a[20:23], a[4:7], v[196:199]
    ds_read_b64_tr_b16 a[84:85], v19 offset:40960
    v_mfma_f32_16x16x32_bf16 v[192:195], a[20:23], a[0:3], v[192:195]
    ds_read_b64_tr_b16 a[86:87], v19 offset:41472
    buffer_load_dwordx4 v8, s[8:11], s24 offen offset:2048 lds
    v_mfma_f32_16x16x32_bf16 v[208:211], a[24:27], a[0:3], v[208:211]
    ds_read_b64_tr_b16 a[88:89], v13 offset:40960
    v_mfma_f32_16x16x32_bf16 v[212:215], a[24:27], a[4:7], v[212:215]
    ds_read_b64_tr_b16 a[90:91], v13 offset:41472
    v_mfma_f32_16x16x32_bf16 v[216:219], a[24:27], a[8:11], v[216:219]
    ds_read_b64_tr_b16 a[92:93], v58 offset:40960
    v_mfma_f32_16x16x32_bf16 v[220:223], a[24:27], a[12:15], v[220:223]
    ds_read_b64_tr_b16 a[94:95], v58 offset:41472
    buffer_load_dwordx4 v9, s[8:11], s24 offen offset:3072 lds
    v_mfma_f32_16x16x32_bf16 v[236:239], a[28:31], a[12:15], v[236:239]
    ds_read_b64_tr_b16 a[96:97], v18 offset:41984
    s_add_u32 s27, s27, 32768
    v_mfma_f32_16x16x32_bf16 v[232:235], a[28:31], a[8:11], v[232:235]
    s_cmp_eq_u32 s27, 98304
    s_cselect_b32 s27, 0, s27
    v_mfma_f32_16x16x32_bf16 v[228:231], a[28:31], a[4:7], v[228:231]
    ds_read_b64_tr_b16 a[98:99], v18 offset:42496
    s_add_u32 s25, s25, 229376
    v_mfma_f32_16x16x32_bf16 v[224:227], a[28:31], a[0:3], v[224:227]
    s_add_u32 m0, s30, 24576
    s_nop 0
    buffer_load_dwordx4 v10, s[12:15], s25 offen lds
    v_mfma_f32_16x16x32_bf16 v[240:243], a[32:35], a[0:3], v[240:243]
    v_mfma_f32_16x16x32_bf16 v[244:247], a[32:35], a[4:7], v[244:247]
    s_mov_b64 exec, s[42:43]
    buffer_load_dwordx4 v11, s[12:15], s25 offen offset:1024 lds
    s_mov_b64 exec, -1
    v_mfma_f32_16x16x32_bf16 v[248:251], a[32:35], a[8:11], v[248:251]
    v_mfma_f32_16x16x32_bf16 v[252:255], a[32:35], a[12:15], v[252:255]
    s_waitcnt lgkmcnt(0)
    v_mfma_f32_16x16x32_bf16 v[176:179], a[80:83], a[64:67], v[176:179]
    s_waitcnt vmcnt(12)
    s_barrier
    s_cmp_lg_u32 s3, 0
    s_cbranch_scc1 L_sig_1_18
    s_add_u32 s46, s35, 0
    s_lshl_b32 s46, s46, 7
    s_add_u32 s46, s46, 26607616
    v_mov_b32 v20, 0
    v_mov_b32 v21, 1
    s_mov_b64 exec, 1
    buffer_atomic_add v21, v20, s[20:23], s46 offen
    s_mov_b64 exec, -1
L_sig_1_18:
    s_nop 1
    v_mfma_f32_16x16x32_bf16 v[180:183], a[80:83], a[68:71], v[180:183]
    ds_read_b64_tr_b16 a[16:17], v18 offset:0
    s_bfe_u32 s24, s57, 0x40000
    v_mfma_f32_16x16x32_bf16 v[184:187], a[80:83], a[72:75], v[184:187]
    s_lshl_b32 s24, s24, 7
    s_add_u32 m0, s29, s27
    v_mfma_f32_16x16x32_bf16 v[188:191], a[80:83], a[76:79], v[188:191]
    ds_read_b64_tr_b16 a[18:19], v18 offset:512
    buffer_load_dwordx4 v2, s[8:11], s24 offen offset:0 lds
    v_mfma_f32_16x16x32_bf16 v[204:207], a[84:87], a[76:79], v[204:207]
    ds_read_b64_tr_b16 a[20:21], v19 offset:0
    ds_read_b64_tr_b16 a[22:23], v19 offset:512
    v_mfma_f32_16x16x32_bf16 v[200:203], a[84:87], a[72:75], v[200:203]
    buffer_load_dwordx4 v3, s[8:11], s24 offen offset:1024 lds
    v_mfma_f32_16x16x32_bf16 v[196:199], a[84:87], a[68:71], v[196:199]
    ds_read_b64_tr_b16 a[24:25], v13 offset:0
    v_mfma_f32_16x16x32_bf16 v[192:195], a[84:87], a[64:67], v[192:195]
    ds_read_b64_tr_b16 a[26:27], v13 offset:512
    v_mfma_f32_16x16x32_bf16 v[208:211], a[88:91], a[64:67], v[208:211]
    buffer_load_dwordx4 v4, s[8:11], s24 offen offset:2048 lds
    ds_read_b64_tr_b16 a[28:29], v58 offset:0
    v_mfma_f32_16x16x32_bf16 v[212:215], a[88:91], a[68:71], v[212:215]
    v_mfma_f32_16x16x32_bf16 v[216:219], a[88:91], a[72:75], v[216:219]
    ds_read_b64_tr_b16 a[30:31], v58 offset:512
    v_mfma_f32_16x16x32_bf16 v[220:223], a[88:91], a[76:79], v[220:223]
    ds_read_b64_tr_b16 a[32:33], v18 offset:1024
    buffer_load_dwordx4 v5, s[8:11], s24 offen offset:3072 lds
    v_mfma_f32_16x16x32_bf16 v[236:239], a[92:95], a[76:79], v[236:239]
    s_bfe_u32 s31, s56, 0x4001c
    ds_read_b64_tr_b16 a[34:35], v18 offset:1536
    v_mfma_f32_16x16x32_bf16 v[232:235], a[92:95], a[72:75], v[232:235]
    s_mul_i32 s25, s31, 458752
    s_add_u32 s25, s25, s41
    v_mfma_f32_16x16x32_bf16 v[228:231], a[92:95], a[68:71], v[228:231]
    s_add_u32 m0, s30, 32768
    s_nop 0
    buffer_load_dwordx4 v10, s[12:15], s25 offen lds
    v_mfma_f32_16x16x32_bf16 v[224:227], a[92:95], a[64:67], v[224:227]
    v_mfma_f32_16x16x32_bf16 v[240:243], a[96:99], a[64:67], v[240:243]
    v_mfma_f32_16x16x32_bf16 v[244:247], a[96:99], a[68:71], v[244:247]
    s_mov_b64 exec, s[42:43]
    buffer_load_dwordx4 v11, s[12:15], s25 offen offset:1024 lds
    s_mov_b64 exec, -1
    v_mfma_f32_16x16x32_bf16 v[248:251], a[96:99], a[72:75], v[248:251]
    v_mfma_f32_16x16x32_bf16 v[252:255], a[96:99], a[76:79], v[252:255]
    s_waitcnt lgkmcnt(0)
    v_mfma_f32_16x16x32_bf16 v[176:179], a[16:19], a[192:195], v[176:179]
    ds_read_b64_tr_b16 a[80:81], v18 offset:8192
    s_add_u32 m0, s29, s27
    v_mfma_f32_16x16x32_bf16 v[180:183], a[16:19], a[196:199], v[180:183]
    s_add_u32 m0, m0, 4096
    ds_read_b64_tr_b16 a[82:83], v18 offset:8704
    v_mfma_f32_16x16x32_bf16 v[184:187], a[16:19], a[200:203], v[184:187]
    buffer_load_dwordx4 v6, s[8:11], s24 offen offset:0 lds
    ds_read_b64_tr_b16 a[84:85], v19 offset:8192
    v_mfma_f32_16x16x32_bf16 v[188:191], a[16:19], a[204:207], v[188:191]
    v_mfma_f32_16x16x32_bf16 v[204:207], a[20:23], a[204:207], v[204:207]
    ds_read_b64_tr_b16 a[86:87], v19 offset:8704
    buffer_load_dwordx4 v7, s[8:11], s24 offen offset:1024 lds
    v_mfma_f32_16x16x32_bf16 v[200:203], a[20:23], a[200:203], v[200:203]
    ds_read_b64_tr_b16 a[88:89], v13 offset:8192
    v_mfma_f32_16x16x32_bf16 v[196:199], a[20:23], a[196:199], v[196:199]
    v_mfma_f32_16x16x32_bf16 v[192:195], a[20:23], a[192:195], v[192:195]
    ds_read_b64_tr_b16 a[90:91], v13 offset:8704
    buffer_load_dwordx4 v8, s[8:11], s24 offen offset:2048 lds
    v_mfma_f32_16x16x32_bf16 v[208:211], a[24:27], a[192:195], v[208:211]
    ds_read_b64_tr_b16 a[92:93], v58 offset:8192
    v_mfma_f32_16x16x32_bf16 v[212:215], a[24:27], a[196:199], v[212:215]
    ds_read_b64_tr_b16 a[94:95], v58 offset:8704
    v_mfma_f32_16x16x32_bf16 v[216:219], a[24:27], a[200:203], v[216:219]
    v_mfma_f32_16x16x32_bf16 v[220:223], a[24:27], a[204:207], v[220:223]
    buffer_load_dwordx4 v9, s[8:11], s24 offen offset:3072 lds
    ds_read_b64_tr_b16 a[96:97], v18 offset:9216
    v_mfma_f32_16x16x32_bf16 v[236:239], a[28:31], a[204:207], v[236:239]
    s_add_u32 s27, s27, 32768
    ds_read_b64_tr_b16 a[98:99], v18 offset:9728
    v_mfma_f32_16x16x32_bf16 v[232:235], a[28:31], a[200:203], v[232:235]
    s_cmp_eq_u32 s27, 98304
    s_cselect_b32 s27, 0, s27
    v_mfma_f32_16x16x32_bf16 v[228:231], a[28:31], a[196:199], v[228:231]
    s_add_u32 s25, s25, 229376
    s_add_u32 m0, s30, 40960
    v_mfma_f32_16x16x32_bf16 v[224:227], a[28:31], a[192:195], v[224:227]
    buffer_load_dwordx4 v10, s[12:15], s25 offen lds
    v_mfma_f32_16x16x32_bf16 v[240:243], a[32:35], a[192:195], v[240:243]
    v_mfma_f32_16x16x32_bf16 v[244:247], a[32:35], a[196:199], v[244:247]
    s_mov_b64 exec, s[42:43]
    buffer_load_dwordx4 v11, s[12:15], s25 offen offset:1024 lds
    s_mov_b64 exec, -1
    v_mfma_f32_16x16x32_bf16 v[248:251], a[32:35], a[200:203], v[248:251]
    v_mfma_f32_16x16x32_bf16 v[252:255], a[32:35], a[204:207], v[252:255]
    s_waitcnt lgkmcnt(0)
    v_mfma_f32_16x16x32_bf16 v[176:179], a[80:83], a[208:211], v[176:179]
    s_waitcnt vmcnt(12)
    s_barrier
    v_mfma_f32_16x16x32_bf16 v[180:183], a[80:83], a[212:215], v[180:183]
    s_add_u32 s28, s28, 32768
    v_mfma_f32_16x16x32_bf16 v[184:187], a[80:83], a[216:219], v[184:187]
    s_cmp_eq_u32 s28, 98304
    s_cselect_b32 s28, 0, s28
    v_mfma_f32_16x16x32_bf16 v[188:191], a[80:83], a[220:223], v[188:191]
    v_add_u32 v16, s28, v14
    ds_read_b64_tr_b16 a[16:17], v18 offset:16384
    v_mfma_f32_16x16x32_bf16 v[204:207], a[84:87], a[220:223], v[204:207]
    s_bfe_u32 s31, s57, 0x4001c
    ds_read_b64_tr_b16 a[18:19], v18 offset:16896
    v_mfma_f32_16x16x32_bf16 v[200:203], a[84:87], a[216:219], v[200:203]
    s_mul_i32 s25, s31, 458752
    s_add_u32 s25, s25, s41
    v_mfma_f32_16x16x32_bf16 v[196:199], a[84:87], a[212:215], v[196:199]
    ds_read_b64_tr_b16 a[20:21], v19 offset:16384
    s_add_u32 m0, s30, 0
    v_mfma_f32_16x16x32_bf16 v[192:195], a[84:87], a[208:211], v[192:195]
    ds_read_b64_tr_b16 a[22:23], v19 offset:16896
    buffer_load_dwordx4 v10, s[12:15], s25 offen lds
    v_mfma_f32_16x16x32_bf16 v[208:211], a[88:91], a[208:211], v[208:211]
    ds_read_b64_tr_b16 a[24:25], v13 offset:16384
    ds_read_b64_tr_b16 a[26:27], v13 offset:16896
    v_mfma_f32_16x16x32_bf16 v[212:215], a[88:91], a[212:215], v[212:215]
    ds_read_b64_tr_b16 a[28:29], v58 offset:16384
    ds_read_b64_tr_b16 a[30:31], v58 offset:16896
    v_mfma_f32_16x16x32_bf16 v[216:219], a[88:91], a[216:219], v[216:219]
    ds_read_b64_tr_b16 a[32:33], v18 offset:17408
    ds_read_b64_tr_b16 a[34:35], v18 offset:17920
    v_mfma_f32_16x16x32_bf16 v[220:223], a[88:91], a[220:223], v[220:223]
    v_add_u32 v17, s28, v15
    ds_read_b128 a[0:3], v16 offset:0
    v_mfma_f32_16x16x32_bf16 v[236:239], a[92:95], a[220:223], v[236:239]
    ds_read_b128 a[4:7], v16 offset:2048
    ds_read_b128 a[8:11], v16 offset:4096
    v_mfma_f32_16x16x32_bf16 v[232:235], a[92:95], a[216:219], v[232:235]
    ds_read_b128 a[12:15], v16 offset:6144
    v_mfma_f32_16x16x32_bf16 v[228:231], a[92:95], a[212:215], v[228:231]
    s_mov_b64 exec, s[42:43]
    buffer_load_dwordx4 v11, s[12:15], s25 offen offset:1024 lds
    s_mov_b64 exec, -1
    v_mfma_f32_16x16x32_bf16 v[224:227], a[92:95], a[208:211], v[224:227]
    v_mfma_f32_16x16x32_bf16 v[240:243], a[96:99], a[208:211], v[240:243]
    v_mfma_f32_16x16x32_bf16 v[244:247], a[96:99], a[212:215], v[244:247]
    v_mfma_f32_16x16x32_bf16 v[248:251], a[96:99], a[216:219], v[248:251]
    v_mfma_f32_16x16x32_bf16 v[252:255], a[96:99], a[220:223], v[252:255]
    s_waitcnt lgkmcnt(0)
    v_mfma_f32_16x16x32_bf16 v[176:179], a[16:19], a[0:3], v[176:179]
    ds_read_b128 a[64:67], v17 offset:0
    v_mfma_f32_16x16x32_bf16 v[180:183], a[16:19], a[4:7], v[180:183]
    ds_read_b128 a[68:71], v17 offset:2048
    v_mfma_f32_16x16x32_bf16 v[184:187], a[16:19], a[8:11], v[184:187]
    ds_read_b128 a[72:75], v17 offset:4096
    v_mfma_f32_16x16x32_bf16 v[188:191], a[16:19], a[12:15], v[188:191]
    ds_read_b128 a[76:79], v17 offset:6144
    s_add_u32 s25, s25, 229376
    v_mfma_f32_16x16x32_bf16 v[204:207], a[20:23], a[12:15], v[204:207]
    ds_read_b64_tr_b16 a[80:81], v18 offset:24576
    s_add_u32 m0, s30, 8192
    v_mfma_f32_16x16x32_bf16 v[200:203], a[20:23], a[8:11], v[200:203]
    buffer_load_dwordx4 v10, s[12:15], s25 offen lds
    ds_read_b64_tr_b16 a[82:83], v18 offset:25088
    v_mfma_f32_16x16x32_bf16 v[196:199], a[20:23], a[4:7], v[196:199]
    ds_read_b64_tr_b16 a[84:85], v19 offset:24576
    v_mfma_f32_16x16x32_bf16 v[192:195], a[20:23], a[0:3], v[192:195]
    ds_read_b64_tr_b16 a[86:87], v19 offset:25088
    v_mfma_f32_16x16x32_bf16 v[208:211], a[24:27], a[0:3], v[208:211]
    ds_read_b64_tr_b16 a[88:89], v13 offset:24576
    v_mfma_f32_16x16x32_bf16 v[212:215], a[24:27], a[4:7], v[212:215]
    ds_read_b64_tr_b16 a[90:91], v13 offset:25088
    v_mfma_f32_16x16x32_bf16 v[216:219], a[24:27], a[8:11], v[216:219]
    ds_read_b64_tr_b16 a[92:93], v58 offset:24576
    v_mfma_f32_16x16x32_bf16 v[220:223], a[24:27], a[12:15], v[220:223]
    ds_read_b64_tr_b16 a[94:95], v58 offset:25088
    v_mfma_f32_16x16x32_bf16 v[236:239], a[28:31], a[12:15], v[236:239]
    ds_read_b64_tr_b16 a[96:97], v18 offset:25600
    v_mfma_f32_16x16x32_bf16 v[232:235], a[28:31], a[8:11], v[232:235]
    ds_read_b64_tr_b16 a[98:99], v18 offset:26112
    v_mfma_f32_16x16x32_bf16 v[228:231], a[28:31], a[4:7], v[228:231]
    s_mov_b64 exec, s[42:43]
    buffer_load_dwordx4 v11, s[12:15], s25 offen offset:1024 lds
    s_mov_b64 exec, -1
    v_mfma_f32_16x16x32_bf16 v[224:227], a[28:31], a[0:3], v[224:227]
    v_mfma_f32_16x16x32_bf16 v[240:243], a[32:35], a[0:3], v[240:243]
    v_mfma_f32_16x16x32_bf16 v[244:247], a[32:35], a[4:7], v[244:247]
    v_mfma_f32_16x16x32_bf16 v[248:251], a[32:35], a[8:11], v[248:251]
    v_mfma_f32_16x16x32_bf16 v[252:255], a[32:35], a[12:15], v[252:255]
    s_waitcnt lgkmcnt(0)
    v_mfma_f32_16x16x32_bf16 v[176:179], a[80:83], a[64:67], v[176:179]
    s_waitcnt vmcnt(4)
    s_barrier
    v_mfma_f32_16x16x32_bf16 v[180:183], a[80:83], a[68:71], v[180:183]
    s_add_u32 s28, s28, 32768
    s_bfe_u32 s24, s57, 0x40004
    v_mfma_f32_16x16x32_bf16 v[184:187], a[80:83], a[72:75], v[184:187]
    s_lshl_b32 s24, s24, 7
    s_add_u32 m0, s29, s27
    v_mfma_f32_16x16x32_bf16 v[188:191], a[80:83], a[76:79], v[188:191]
    s_cmp_eq_u32 s28, 98304
    s_cselect_b32 s28, 0, s28
    v_mfma_f32_16x16x32_bf16 v[204:207], a[84:87], a[76:79], v[204:207]
    v_add_u32 v16, s28, v14
    buffer_load_dwordx4 v2, s[8:11], s24 offen offset:0 lds
    v_mfma_f32_16x16x32_bf16 v[200:203], a[84:87], a[72:75], v[200:203]
    ds_read_b64_tr_b16 a[16:17], v18 offset:32768
    ds_read_b64_tr_b16 a[18:19], v18 offset:33280
    v_mfma_f32_16x16x32_bf16 v[196:199], a[84:87], a[68:71], v[196:199]
    ds_read_b64_tr_b16 a[20:21], v19 offset:32768
    ds_read_b64_tr_b16 a[22:23], v19 offset:33280
    v_mfma_f32_16x16x32_bf16 v[192:195], a[84:87], a[64:67], v[192:195]
    buffer_load_dwordx4 v3, s[8:11], s24 offen offset:1024 lds
    ds_read_b64_tr_b16 a[24:25], v13 offset:32768
    v_mfma_f32_16x16x32_bf16 v[208:211], a[88:91], a[64:67], v[208:211]
    ds_read_b64_tr_b16 a[26:27], v13 offset:33280
    ds_read_b64_tr_b16 a[28:29], v58 offset:32768
    v_mfma_f32_16x16x32_bf16 v[212:215], a[88:91], a[68:71], v[212:215]
    ds_read_b64_tr_b16 a[30:31], v58 offset:33280
    buffer_load_dwordx4 v4, s[8:11], s24 offen offset:2048 lds
    v_mfma_f32_16x16x32_bf16 v[216:219], a[88:91], a[72:75], v[216:219]
    ds_read_b64_tr_b16 a[32:33], v18 offset:33792
    ds_read_b64_tr_b16 a[34:35], v18 offset:34304
    v_mfma_f32_16x16x32_bf16 v[220:223], a[88:91], a[76:79], v[220:223]
    v_add_u32 v17, s28, v15
    ds_read_b128 a[0:3], v16 offset:0
    v_mfma_f32_16x16x32_bf16 v[236:239], a[92:95], a[76:79], v[236:239]
    buffer_load_dwordx4 v5, s[8:11], s24 offen offset:3072 lds
    ds_read_b128 a[4:7], v16 offset:2048
    v_mfma_f32_16x16x32_bf16 v[232:235], a[92:95], a[72:75], v[232:235]
    s_bfe_u32 s31, s57, 0x40000
    ds_read_b128 a[8:11], v16 offset:4096
    v_mfma_f32_16x16x32_bf16 v[228:231], a[92:95], a[68:71], v[228:231]
    s_mul_i32 s25, s31, 458752
    ds_read_b128 a[12:15], v16 offset:6144
    v_mfma_f32_16x16x32_bf16 v[224:227], a[92:95], a[64:67], v[224:227]
    s_add_u32 s25, s25, s41
    s_add_u32 m0, s30, 16384
    v_mfma_f32_16x16x32_bf16 v[240:243], a[96:99], a[64:67], v[240:243]
    buffer_load_dwordx4 v10, s[12:15], s25 offen lds
    v_mfma_f32_16x16x32_bf16 v[244:247], a[96:99], a[68:71], v[244:247]
    s_mov_b64 exec, s[42:43]
    buffer_load_dwordx4 v11, s[12:15], s25 offen offset:1024 lds
    s_mov_b64 exec, -1
    v_mfma_f32_16x16x32_bf16 v[248:251], a[96:99], a[72:75], v[248:251]
    v_mfma_f32_16x16x32_bf16 v[252:255], a[96:99], a[76:79], v[252:255]
    s_waitcnt lgkmcnt(0)
    v_mfma_f32_16x16x32_bf16 v[176:179], a[16:19], a[0:3], v[176:179]
    ds_read_b128 a[64:67], v17 offset:0
    s_add_u32 m0, s29, s27
    v_mfma_f32_16x16x32_bf16 v[180:183], a[16:19], a[4:7], v[180:183]
    ds_read_b128 a[68:71], v17 offset:2048
    s_add_u32 m0, m0, 4096
    v_mfma_f32_16x16x32_bf16 v[184:187], a[16:19], a[8:11], v[184:187]
    buffer_load_dwordx4 v6, s[8:11], s24 offen offset:0 lds
    ds_read_b128 a[72:75], v17 offset:4096
    v_mfma_f32_16x16x32_bf16 v[188:191], a[16:19], a[12:15], v[188:191]
    ds_read_b128 a[76:79], v17 offset:6144
    v_mfma_f32_16x16x32_bf16 v[204:207], a[20:23], a[12:15], v[204:207]
    ds_read_b64_tr_b16 a[80:81], v18 offset:40960
    buffer_load_dwordx4 v7, s[8:11], s24 offen offset:1024 lds
    v_mfma_f32_16x16x32_bf16 v[200:203], a[20:23], a[8:11], v[200:203]
    ds_read_b64_tr_b16 a[82:83], v18 offset:41472
    v_mfma_f32_16x16x32_bf16 v[196:199], a[20:23], a[4:7], v[196:199]
    ds_read_b64_tr_b16 a[84:85], v19 offset:40960
    v_mfma_f32_16x16x32_bf16 v[192:195], a[20:23], a[0:3], v[192:195]
    ds_read_b64_tr_b16 a[86:87], v19 offset:41472
    buffer_load_dwordx4 v8, s[8:11], s24 offen offset:2048 lds
    v_mfma_f32_16x16x32_bf16 v[208:211], a[24:27], a[0:3], v[208:211]
    ds_read_b64_tr_b16 a[88:89], v13 offset:40960
    v_mfma_f32_16x16x32_bf16 v[212:215], a[24:27], a[4:7], v[212:215]
    ds_read_b64_tr_b16 a[90:91], v13 offset:41472
    v_mfma_f32_16x16x32_bf16 v[216:219], a[24:27], a[8:11], v[216:219]
    ds_read_b64_tr_b16 a[92:93], v58 offset:40960
    v_mfma_f32_16x16x32_bf16 v[220:223], a[24:27], a[12:15], v[220:223]
    ds_read_b64_tr_b16 a[94:95], v58 offset:41472
    buffer_load_dwordx4 v9, s[8:11], s24 offen offset:3072 lds
    v_mfma_f32_16x16x32_bf16 v[236:239], a[28:31], a[12:15], v[236:239]
    ds_read_b64_tr_b16 a[96:97], v18 offset:41984
    s_add_u32 s27, s27, 32768
    v_mfma_f32_16x16x32_bf16 v[232:235], a[28:31], a[8:11], v[232:235]
    s_cmp_eq_u32 s27, 98304
    s_cselect_b32 s27, 0, s27
    v_mfma_f32_16x16x32_bf16 v[228:231], a[28:31], a[4:7], v[228:231]
    ds_read_b64_tr_b16 a[98:99], v18 offset:42496
    s_add_u32 s25, s25, 229376
    v_mfma_f32_16x16x32_bf16 v[224:227], a[28:31], a[0:3], v[224:227]
    s_add_u32 m0, s30, 24576
    s_nop 0
    buffer_load_dwordx4 v10, s[12:15], s25 offen lds
    v_mfma_f32_16x16x32_bf16 v[240:243], a[32:35], a[0:3], v[240:243]
    v_mfma_f32_16x16x32_bf16 v[244:247], a[32:35], a[4:7], v[244:247]
    s_mov_b64 exec, s[42:43]
    buffer_load_dwordx4 v11, s[12:15], s25 offen offset:1024 lds
    s_mov_b64 exec, -1
    v_mfma_f32_16x16x32_bf16 v[248:251], a[32:35], a[8:11], v[248:251]
    v_mfma_f32_16x16x32_bf16 v[252:255], a[32:35], a[12:15], v[252:255]
    s_waitcnt lgkmcnt(0)
    v_mfma_f32_16x16x32_bf16 v[176:179], a[80:83], a[64:67], v[176:179]
    s_waitcnt vmcnt(12)
    s_barrier
    v_mfma_f32_16x16x32_bf16 v[180:183], a[80:83], a[68:71], v[180:183]
    ds_read_b64_tr_b16 a[16:17], v18 offset:0
    s_bfe_u32 s24, s57, 0x40008
    v_mfma_f32_16x16x32_bf16 v[184:187], a[80:83], a[72:75], v[184:187]
    s_lshl_b32 s24, s24, 7
    s_add_u32 m0, s29, s27
    v_mfma_f32_16x16x32_bf16 v[188:191], a[80:83], a[76:79], v[188:191]
    ds_read_b64_tr_b16 a[18:19], v18 offset:512
    buffer_load_dwordx4 v2, s[8:11], s24 offen offset:0 lds
    v_mfma_f32_16x16x32_bf16 v[204:207], a[84:87], a[76:79], v[204:207]
    ds_read_b64_tr_b16 a[20:21], v19 offset:0
    ds_read_b64_tr_b16 a[22:23], v19 offset:512
    v_mfma_f32_16x16x32_bf16 v[200:203], a[84:87], a[72:75], v[200:203]
    buffer_load_dwordx4 v3, s[8:11], s24 offen offset:1024 lds
    v_mfma_f32_16x16x32_bf16 v[196:199], a[84:87], a[68:71], v[196:199]
    ds_read_b64_tr_b16 a[24:25], v13 offset:0
    v_mfma_f32_16x16x32_bf16 v[192:195], a[84:87], a[64:67], v[192:195]
    ds_read_b64_tr_b16 a[26:27], v13 offset:512
    v_mfma_f32_16x16x32_bf16 v[208:211], a[88:91], a[64:67], v[208:211]
    buffer_load_dwordx4 v4, s[8:11], s24 offen offset:2048 lds
    ds_read_b64_tr_b16 a[28:29], v58 offset:0
    v_mfma_f32_16x16x32_bf16 v[212:215], a[88:91], a[68:71], v[212:215]
    v_mfma_f32_16x16x32_bf16 v[216:219], a[88:91], a[72:75], v[216:219]
    ds_read_b64_tr_b16 a[30:31], v58 offset:512
    v_mfma_f32_16x16x32_bf16 v[220:223], a[88:91], a[76:79], v[220:223]
    ds_read_b64_tr_b16 a[32:33], v18 offset:1024
    buffer_load_dwordx4 v5, s[8:11], s24 offen offset:3072 lds
    v_mfma_f32_16x16x32_bf16 v[236:239], a[92:95], a[76:79], v[236:239]
    s_bfe_u32 s31, s57, 0x40004
    ds_read_b64_tr_b16 a[34:35], v18 offset:1536
    v_mfma_f32_16x16x32_bf16 v[232:235], a[92:95], a[72:75], v[232:235]
    s_mul_i32 s25, s31, 458752
    s_add_u32 s25, s25, s41
    v_mfma_f32_16x16x32_bf16 v[228:231], a[92:95], a[68:71], v[228:231]
    s_add_u32 m0, s30, 32768
    s_nop 0
    buffer_load_dwordx4 v10, s[12:15], s25 offen lds
    v_mfma_f32_16x16x32_bf16 v[224:227], a[92:95], a[64:67], v[224:227]
    v_mfma_f32_16x16x32_bf16 v[240:243], a[96:99], a[64:67], v[240:243]
    v_mfma_f32_16x16x32_bf16 v[244:247], a[96:99], a[68:71], v[244:247]
    s_mov_b64 exec, s[42:43]
    buffer_load_dwordx4 v11, s[12:15], s25 offen offset:1024 lds
    s_mov_b64 exec, -1
    v_mfma_f32_16x16x32_bf16 v[248:251], a[96:99], a[72:75], v[248:251]
    v_mfma_f32_16x16x32_bf16 v[252:255], a[96:99], a[76:79], v[252:255]
    s_waitcnt lgkmcnt(0)
    v_mfma_f32_16x16x32_bf16 v[176:179], a[16:19], a[224:227], v[176:179]
    ds_read_b64_tr_b16 a[80:81], v18 offset:8192
    s_add_u32 m0, s29, s27
    v_mfma_f32_16x16x32_bf16 v[180:183], a[16:19], a[228:231], v[180:183]
    s_add_u32 m0, m0, 4096
    ds_read_b64_tr_b16 a[82:83], v18 offset:8704
    v_mfma_f32_16x16x32_bf16 v[184:187], a[16:19], a[232:235], v[184:187]
    buffer_load_dwordx4 v6, s[8:11], s24 offen offset:0 lds
    ds_read_b64_tr_b16 a[84:85], v19 offset:8192
    v_mfma_f32_16x16x32_bf16 v[188:191], a[16:19], a[236:239], v[188:191]
    v_mfma_f32_16x16x32_bf16 v[204:207], a[20:23], a[236:239], v[204:207]
    ds_read_b64_tr_b16 a[86:87], v19 offset:8704
    buffer_load_dwordx4 v7, s[8:11], s24 offen offset:1024 lds
    v_mfma_f32_16x16x32_bf16 v[200:203], a[20:23], a[232:235], v[200:203]
    ds_read_b64_tr_b16 a[88:89], v13 offset:8192
    v_mfma_f32_16x16x32_bf16 v[196:199], a[20:23], a[228:231], v[196:199]
    v_mfma_f32_16x16x32_bf16 v[192:195], a[20:23], a[224:227], v[192:195]
    ds_read_b64_tr_b16 a[90:91], v13 offset:8704
    buffer_load_dwordx4 v8, s[8:11], s24 offen offset:2048 lds
    v_mfma_f32_16x16x32_bf16 v[208:211], a[24:27], a[224:227], v[208:211]
    ds_read_b64_tr_b16 a[92:93], v58 offset:8192
    v_mfma_f32_16x16x32_bf16 v[212:215], a[24:27], a[228:231], v[212:215]
    ds_read_b64_tr_b16 a[94:95], v58 offset:8704
    v_mfma_f32_16x16x32_bf16 v[216:219], a[24:27], a[232:235], v[216:219]
    v_mfma_f32_16x16x32_bf16 v[220:223], a[24:27], a[236:239], v[220:223]
    buffer_load_dwordx4 v9, s[8:11], s24 offen offset:3072 lds
    ds_read_b64_tr_b16 a[96:97], v18 offset:9216
    v_mfma_f32_16x16x32_bf16 v[236:239], a[28:31], a[236:239], v[236:239]
    s_add_u32 s27, s27, 32768
    ds_read_b64_tr_b16 a[98:99], v18 offset:9728
    v_mfma_f32_16x16x32_bf16 v[232:235], a[28:31], a[232:235], v[232:235]
    s_cmp_eq_u32 s27, 98304
    s_cselect_b32 s27, 0, s27
    v_mfma_f32_16x16x32_bf16 v[228:231], a[28:31], a[228:231], v[228:231]
    s_add_u32 s25, s25, 229376
    s_add_u32 m0, s30, 40960
    v_mfma_f32_16x16x32_bf16 v[224:227], a[28:31], a[224:227], v[224:227]
    buffer_load_dwordx4 v10, s[12:15], s25 offen lds
    v_mfma_f32_16x16x32_bf16 v[240:243], a[32:35], a[224:227], v[240:243]
    v_mfma_f32_16x16x32_bf16 v[244:247], a[32:35], a[228:231], v[244:247]
    s_mov_b64 exec, s[42:43]
    buffer_load_dwordx4 v11, s[12:15], s25 offen offset:1024 lds
    s_mov_b64 exec, -1
    v_mfma_f32_16x16x32_bf16 v[248:251], a[32:35], a[232:235], v[248:251]
    v_mfma_f32_16x16x32_bf16 v[252:255], a[32:35], a[236:239], v[252:255]
    s_waitcnt lgkmcnt(0)
    v_mfma_f32_16x16x32_bf16 v[176:179], a[80:83], a[240:243], v[176:179]
    s_waitcnt vmcnt(12)
    s_barrier
    v_mfma_f32_16x16x32_bf16 v[180:183], a[80:83], a[244:247], v[180:183]
    s_add_u32 s28, s28, 32768
    v_mfma_f32_16x16x32_bf16 v[184:187], a[80:83], a[248:251], v[184:187]
    s_cmp_eq_u32 s28, 98304
    s_cselect_b32 s28, 0, s28
    v_mfma_f32_16x16x32_bf16 v[188:191], a[80:83], a[252:255], v[188:191]
    v_add_u32 v16, s28, v14
    ds_read_b64_tr_b16 a[16:17], v18 offset:16384
    v_mfma_f32_16x16x32_bf16 v[204:207], a[84:87], a[252:255], v[204:207]
    s_bfe_u32 s31, s57, 0x40008
    ds_read_b64_tr_b16 a[18:19], v18 offset:16896
    v_mfma_f32_16x16x32_bf16 v[200:203], a[84:87], a[248:251], v[200:203]
    s_mul_i32 s25, s31, 458752
    s_add_u32 s25, s25, s41
    v_mfma_f32_16x16x32_bf16 v[196:199], a[84:87], a[244:247], v[196:199]
    ds_read_b64_tr_b16 a[20:21], v19 offset:16384
    s_add_u32 m0, s30, 0
    v_mfma_f32_16x16x32_bf16 v[192:195], a[84:87], a[240:243], v[192:195]
    ds_read_b64_tr_b16 a[22:23], v19 offset:16896
    buffer_load_dwordx4 v10, s[12:15], s25 offen lds
    v_mfma_f32_16x16x32_bf16 v[208:211], a[88:91], a[240:243], v[208:211]
    ds_read_b64_tr_b16 a[24:25], v13 offset:16384
    ds_read_b64_tr_b16 a[26:27], v13 offset:16896
    v_mfma_f32_16x16x32_bf16 v[212:215], a[88:91], a[244:247], v[212:215]
    ds_read_b64_tr_b16 a[28:29], v58 offset:16384
    ds_read_b64_tr_b16 a[30:31], v58 offset:16896
    v_mfma_f32_16x16x32_bf16 v[216:219], a[88:91], a[248:251], v[216:219]
    ds_read_b64_tr_b16 a[32:33], v18 offset:17408
    ds_read_b64_tr_b16 a[34:35], v18 offset:17920
    v_mfma_f32_16x16x32_bf16 v[220:223], a[88:91], a[252:255], v[220:223]
    v_add_u32 v17, s28, v15
    ds_read_b128 a[0:3], v16 offset:0
    v_mfma_f32_16x16x32_bf16 v[236:239], a[92:95], a[252:255], v[236:239]
    ds_read_b128 a[4:7], v16 offset:2048
    ds_read_b128 a[8:11], v16 offset:4096
    v_mfma_f32_16x16x32_bf16 v[232:235], a[92:95], a[248:251], v[232:235]
    ds_read_b128 a[12:15], v16 offset:6144
    v_mfma_f32_16x16x32_bf16 v[228:231], a[92:95], a[244:247], v[228:231]
    s_mov_b64 exec, s[42:43]
    buffer_load_dwordx4 v11, s[12:15], s25 offen offset:1024 lds
    s_mov_b64 exec, -1
    v_mfma_f32_16x16x32_bf16 v[224:227], a[92:95], a[240:243], v[224:227]
    v_mfma_f32_16x16x32_bf16 v[240:243], a[96:99], a[240:243], v[240:243]
    v_mfma_f32_16x16x32_bf16 v[244:247], a[96:99], a[244:247], v[244:247]
    v_mfma_f32_16x16x32_bf16 v[248:251], a[96:99], a[248:251], v[248:251]
    v_mfma_f32_16x16x32_bf16 v[252:255], a[96:99], a[252:255], v[252:255]
    s_waitcnt lgkmcnt(0)
    v_mfma_f32_16x16x32_bf16 v[176:179], a[16:19], a[0:3], v[176:179]
    ds_read_b128 a[64:67], v17 offset:0
    v_mfma_f32_16x16x32_bf16 v[180:183], a[16:19], a[4:7], v[180:183]
    ds_read_b128 a[68:71], v17 offset:2048
    v_mfma_f32_16x16x32_bf16 v[184:187], a[16:19], a[8:11], v[184:187]
    ds_read_b128 a[72:75], v17 offset:4096
    v_mfma_f32_16x16x32_bf16 v[188:191], a[16:19], a[12:15], v[188:191]
    ds_read_b128 a[76:79], v17 offset:6144
    s_add_u32 s25, s25, 229376
    v_mfma_f32_16x16x32_bf16 v[204:207], a[20:23], a[12:15], v[204:207]
    ds_read_b64_tr_b16 a[80:81], v18 offset:24576
    s_add_u32 m0, s30, 8192
    v_mfma_f32_16x16x32_bf16 v[200:203], a[20:23], a[8:11], v[200:203]
    buffer_load_dwordx4 v10, s[12:15], s25 offen lds
    ds_read_b64_tr_b16 a[82:83], v18 offset:25088
    v_mfma_f32_16x16x32_bf16 v[196:199], a[20:23], a[4:7], v[196:199]
    ds_read_b64_tr_b16 a[84:85], v19 offset:24576
    v_mfma_f32_16x16x32_bf16 v[192:195], a[20:23], a[0:3], v[192:195]
    ds_read_b64_tr_b16 a[86:87], v19 offset:25088
    v_mfma_f32_16x16x32_bf16 v[208:211], a[24:27], a[0:3], v[208:211]
    ds_read_b64_tr_b16 a[88:89], v13 offset:24576
    v_mfma_f32_16x16x32_bf16 v[212:215], a[24:27], a[4:7], v[212:215]
    ds_read_b64_tr_b16 a[90:91], v13 offset:25088
    v_mfma_f32_16x16x32_bf16 v[216:219], a[24:27], a[8:11], v[216:219]
    ds_read_b64_tr_b16 a[92:93], v58 offset:24576
    v_mfma_f32_16x16x32_bf16 v[220:223], a[24:27], a[12:15], v[220:223]
    ds_read_b64_tr_b16 a[94:95], v58 offset:25088
    v_mfma_f32_16x16x32_bf16 v[236:239], a[28:31], a[12:15], v[236:239]
    ds_read_b64_tr_b16 a[96:97], v18 offset:25600
    v_mfma_f32_16x16x32_bf16 v[232:235], a[28:31], a[8:11], v[232:235]
    ds_read_b64_tr_b16 a[98:99], v18 offset:26112
    v_mfma_f32_16x16x32_bf16 v[228:231], a[28:31], a[4:7], v[228:231]
    s_mov_b64 exec, s[42:43]
    buffer_load_dwordx4 v11, s[12:15], s25 offen offset:1024 lds
    s_mov_b64 exec, -1
    v_mfma_f32_16x16x32_bf16 v[224:227], a[28:31], a[0:3], v[224:227]
    v_mfma_f32_16x16x32_bf16 v[240:243], a[32:35], a[0:3], v[240:243]
    v_mfma_f32_16x16x32_bf16 v[244:247], a[32:35], a[4:7], v[244:247]
    v_mfma_f32_16x16x32_bf16 v[248:251], a[32:35], a[8:11], v[248:251]
    v_mfma_f32_16x16x32_bf16 v[252:255], a[32:35], a[12:15], v[252:255]
    s_waitcnt lgkmcnt(0)
    v_mfma_f32_16x16x32_bf16 v[176:179], a[80:83], a[64:67], v[176:179]
    s_waitcnt vmcnt(4)
    s_barrier
    v_mfma_f32_16x16x32_bf16 v[180:183], a[80:83], a[68:71], v[180:183]
    s_add_u32 s28, s28, 32768
    s_bfe_u32 s24, s57, 0x4000c
    v_mfma_f32_16x16x32_bf16 v[184:187], a[80:83], a[72:75], v[184:187]
    s_lshl_b32 s24, s24, 7
    s_add_u32 m0, s29, s27
    v_mfma_f32_16x16x32_bf16 v[188:191], a[80:83], a[76:79], v[188:191]
    s_cmp_eq_u32 s28, 98304
    s_cselect_b32 s28, 0, s28
    v_mfma_f32_16x16x32_bf16 v[204:207], a[84:87], a[76:79], v[204:207]
    v_add_u32 v16, s28, v14
    buffer_load_dwordx4 v2, s[8:11], s24 offen offset:0 lds
    v_mfma_f32_16x16x32_bf16 v[200:203], a[84:87], a[72:75], v[200:203]
    ds_read_b64_tr_b16 a[16:17], v18 offset:32768
    ds_read_b64_tr_b16 a[18:19], v18 offset:33280
    v_mfma_f32_16x16x32_bf16 v[196:199], a[84:87], a[68:71], v[196:199]
    ds_read_b64_tr_b16 a[20:21], v19 offset:32768
    ds_read_b64_tr_b16 a[22:23], v19 offset:33280
    v_mfma_f32_16x16x32_bf16 v[192:195], a[84:87], a[64:67], v[192:195]
    buffer_load_dwordx4 v3, s[8:11], s24 offen offset:1024 lds
    ds_read_b64_tr_b16 a[24:25], v13 offset:32768
    v_mfma_f32_16x16x32_bf16 v[208:211], a[88:91], a[64:67], v[208:211]
    ds_read_b64_tr_b16 a[26:27], v13 offset:33280
    ds_read_b64_tr_b16 a[28:29], v58 offset:32768
    v_mfma_f32_16x16x32_bf16 v[212:215], a[88:91], a[68:71], v[212:215]
    ds_read_b64_tr_b16 a[30:31], v58 offset:33280
    buffer_load_dwordx4 v4, s[8:11], s24 offen offset:2048 lds
    v_mfma_f32_16x16x32_bf16 v[216:219], a[88:91], a[72:75], v[216:219]
    ds_read_b64_tr_b16 a[32:33], v18 offset:33792
    ds_read_b64_tr_b16 a[34:35], v18 offset:34304
    v_mfma_f32_16x16x32_bf16 v[220:223], a[88:91], a[76:79], v[220:223]
    v_add_u32 v17, s28, v15
    ds_read_b128 a[0:3], v16 offset:0
    v_mfma_f32_16x16x32_bf16 v[236:239], a[92:95], a[76:79], v[236:239]
    buffer_load_dwordx4 v5, s[8:11], s24 offen offset:3072 lds
    ds_read_b128 a[4:7], v16 offset:2048
    v_mfma_f32_16x16x32_bf16 v[232:235], a[92:95], a[72:75], v[232:235]
    s_bfe_u32 s31, s57, 0x4000c
    ds_read_b128 a[8:11], v16 offset:4096
    v_mfma_f32_16x16x32_bf16 v[228:231], a[92:95], a[68:71], v[228:231]
    s_mul_i32 s25, s31, 458752
    ds_read_b128 a[12:15], v16 offset:6144
    v_mfma_f32_16x16x32_bf16 v[224:227], a[92:95], a[64:67], v[224:227]
    s_add_u32 s25, s25, s41
    s_add_u32 m0, s30, 16384
    v_mfma_f32_16x16x32_bf16 v[240:243], a[96:99], a[64:67], v[240:243]
    buffer_load_dwordx4 v10, s[12:15], s25 offen lds
    v_mfma_f32_16x16x32_bf16 v[244:247], a[96:99], a[68:71], v[244:247]
    s_mov_b64 exec, s[42:43]
    buffer_load_dwordx4 v11, s[12:15], s25 offen offset:1024 lds
    s_mov_b64 exec, -1
    v_mfma_f32_16x16x32_bf16 v[248:251], a[96:99], a[72:75], v[248:251]
    v_mfma_f32_16x16x32_bf16 v[252:255], a[96:99], a[76:79], v[252:255]
    s_waitcnt lgkmcnt(0)
    v_mfma_f32_16x16x32_bf16 v[176:179], a[16:19], a[0:3], v[176:179]
    ds_read_b128 a[64:67], v17 offset:0
    s_add_u32 m0, s29, s27
    v_mfma_f32_16x16x32_bf16 v[180:183], a[16:19], a[4:7], v[180:183]
    ds_read_b128 a[68:71], v17 offset:2048
    s_add_u32 m0, m0, 4096
    v_mfma_f32_16x16x32_bf16 v[184:187], a[16:19], a[8:11], v[184:187]
    buffer_load_dwordx4 v6, s[8:11], s24 offen offset:0 lds
    ds_read_b128 a[72:75], v17 offset:4096
    v_mfma_f32_16x16x32_bf16 v[188:191], a[16:19], a[12:15], v[188:191]
    ds_read_b128 a[76:79], v17 offset:6144
    v_mfma_f32_16x16x32_bf16 v[204:207], a[20:23], a[12:15], v[204:207]
    ds_read_b64_tr_b16 a[80:81], v18 offset:40960
    buffer_load_dwordx4 v7, s[8:11], s24 offen offset:1024 lds
    v_mfma_f32_16x16x32_bf16 v[200:203], a[20:23], a[8:11], v[200:203]
    ds_read_b64_tr_b16 a[82:83], v18 offset:41472
    v_mfma_f32_16x16x32_bf16 v[196:199], a[20:23], a[4:7], v[196:199]
    ds_read_b64_tr_b16 a[84:85], v19 offset:40960
    v_mfma_f32_16x16x32_bf16 v[192:195], a[20:23], a[0:3], v[192:195]
    ds_read_b64_tr_b16 a[86:87], v19 offset:41472
    buffer_load_dwordx4 v8, s[8:11], s24 offen offset:2048 lds
    v_mfma_f32_16x16x32_bf16 v[208:211], a[24:27], a[0:3], v[208:211]
    ds_read_b64_tr_b16 a[88:89], v13 offset:40960
    v_mfma_f32_16x16x32_bf16 v[212:215], a[24:27], a[4:7], v[212:215]
    ds_read_b64_tr_b16 a[90:91], v13 offset:41472
    v_mfma_f32_16x16x32_bf16 v[216:219], a[24:27], a[8:11], v[216:219]
    ds_read_b64_tr_b16 a[92:93], v58 offset:40960
    v_mfma_f32_16x16x32_bf16 v[220:223], a[24:27], a[12:15], v[220:223]
    ds_read_b64_tr_b16 a[94:95], v58 offset:41472
    buffer_load_dwordx4 v9, s[8:11], s24 offen offset:3072 lds
    v_mfma_f32_16x16x32_bf16 v[236:239], a[28:31], a[12:15], v[236:239]
    ds_read_b64_tr_b16 a[96:97], v18 offset:41984
    s_add_u32 s27, s27, 32768
    v_mfma_f32_16x16x32_bf16 v[232:235], a[28:31], a[8:11], v[232:235]
    s_cmp_eq_u32 s27, 98304
    s_cselect_b32 s27, 0, s27
    v_mfma_f32_16x16x32_bf16 v[228:231], a[28:31], a[4:7], v[228:231]
    ds_read_b64_tr_b16 a[98:99], v18 offset:42496
    s_add_u32 s25, s25, 229376
    v_mfma_f32_16x16x32_bf16 v[224:227], a[28:31], a[0:3], v[224:227]
    s_add_u32 m0, s30, 24576
    s_nop 0
    buffer_load_dwordx4 v10, s[12:15], s25 offen lds
    v_mfma_f32_16x16x32_bf16 v[240:243], a[32:35], a[0:3], v[240:243]
    v_mfma_f32_16x16x32_bf16 v[244:247], a[32:35], a[4:7], v[244:247]
    s_mov_b64 exec, s[42:43]
    buffer_load_dwordx4 v11, s[12:15], s25 offen offset:1024 lds
    s_mov_b64 exec, -1
    v_mfma_f32_16x16x32_bf16 v[248:251], a[32:35], a[8:11], v[248:251]
    v_mfma_f32_16x16x32_bf16 v[252:255], a[32:35], a[12:15], v[252:255]
    s_waitcnt lgkmcnt(0)
    v_mfma_f32_16x16x32_bf16 v[176:179], a[80:83], a[64:67], v[176:179]
    s_waitcnt vmcnt(12)
    s_barrier
    v_mfma_f32_16x16x32_bf16 v[180:183], a[80:83], a[68:71], v[180:183]
    s_add_u32 s28, s28, 32768
    v_mfma_f32_16x16x32_bf16 v[184:187], a[80:83], a[72:75], v[184:187]
    s_cmp_eq_u32 s28, 98304
    s_cselect_b32 s28, 0, s28
    v_mfma_f32_16x16x32_bf16 v[188:191], a[80:83], a[76:79], v[188:191]
    v_add_u32 v16, s28, v14
    ds_read_b64_tr_b16 a[16:17], v18 offset:0
    v_mfma_f32_16x16x32_bf16 v[204:207], a[84:87], a[76:79], v[204:207]
    ds_read_b64_tr_b16 a[18:19], v18 offset:512
    ds_read_b64_tr_b16 a[20:21], v19 offset:0
    v_mfma_f32_16x16x32_bf16 v[200:203], a[84:87], a[72:75], v[200:203]
    ds_read_b64_tr_b16 a[22:23], v19 offset:512
    v_mfma_f32_16x16x32_bf16 v[196:199], a[84:87], a[68:71], v[196:199]
    ds_read_b64_tr_b16 a[24:25], v13 offset:0
    ds_read_b64_tr_b16 a[26:27], v13 offset:512
    v_mfma_f32_16x16x32_bf16 v[192:195], a[84:87], a[64:67], v[192:195]
    ds_read_b64_tr_b16 a[28:29], v58 offset:0
    v_mfma_f32_16x16x32_bf16 v[208:211], a[88:91], a[64:67], v[208:211]
    ds_read_b64_tr_b16 a[30:31], v58 offset:512
    ds_read_b64_tr_b16 a[32:33], v18 offset:1024
    v_mfma_f32_16x16x32_bf16 v[212:215], a[88:91], a[68:71], v[212:215]
    ds_read_b64_tr_b16 a[34:35], v18 offset:1536
    v_mfma_f32_16x16x32_bf16 v[216:219], a[88:91], a[72:75], v[216:219]
    v_add_u32 v17, s28, v15
    v_mfma_f32_16x16x32_bf16 v[220:223], a[88:91], a[76:79], v[220:223]
    ds_read_b128 a[0:3], v16 offset:0
    ds_read_b128 a[4:7], v16 offset:2048
    v_mfma_f32_16x16x32_bf16 v[236:239], a[92:95], a[76:79], v[236:239]
    ds_read_b128 a[8:11], v16 offset:4096
    v_mfma_f32_16x16x32_bf16 v[232:235], a[92:95], a[72:75], v[232:235]
    ds_read_b128 a[12:15], v16 offset:6144
    v_mfma_f32_16x16x32_bf16 v[228:231], a[92:95], a[68:71], v[228:231]
    v_mfma_f32_16x16x32_bf16 v[224:227], a[92:95], a[64:67], v[224:227]
    v_mfma_f32_16x16x32_bf16 v[240:243], a[96:99], a[64:67], v[240:243]
    v_mfma_f32_16x16x32_bf16 v[244:247], a[96:99], a[68:71], v[244:247]
    v_mfma_f32_16x16x32_bf16 v[248:251], a[96:99], a[72:75], v[248:251]
    v_mfma_f32_16x16x32_bf16 v[252:255], a[96:99], a[76:79], v[252:255]
    s_waitcnt lgkmcnt(0)
    v_mfma_f32_16x16x32_bf16 v[176:179], a[16:19], a[0:3], v[176:179]
    ds_read_b128 a[64:67], v17 offset:0
    v_mfma_f32_16x16x32_bf16 v[180:183], a[16:19], a[4:7], v[180:183]
    ds_read_b128 a[68:71], v17 offset:2048
    v_mfma_f32_16x16x32_bf16 v[184:187], a[16:19], a[8:11], v[184:187]
    ds_read_b128 a[72:75], v17 offset:4096
    v_mfma_f32_16x16x32_bf16 v[188:191], a[16:19], a[12:15], v[188:191]
    ds_read_b128 a[76:79], v17 offset:6144
    v_mfma_f32_16x16x32_bf16 v[204:207], a[20:23], a[12:15], v[204:207]
    ds_read_b64_tr_b16 a[80:81], v18 offset:8192
    v_mfma_f32_16x16x32_bf16 v[200:203], a[20:23], a[8:11], v[200:203]
    ds_read_b64_tr_b16 a[82:83], v18 offset:8704
    v_mfma_f32_16x16x32_bf16 v[196:199], a[20:23], a[4:7], v[196:199]
    ds_read_b64_tr_b16 a[84:85], v19 offset:8192
    v_mfma_f32_16x16x32_bf16 v[192:195], a[20:23], a[0:3], v[192:195]
    ds_read_b64_tr_b16 a[86:87], v19 offset:8704
    v_mfma_f32_16x16x32_bf16 v[208:211], a[24:27], a[0:3], v[208:211]
    ds_read_b64_tr_b16 a[88:89], v13 offset:8192
    v_and_b32 v59, 7, v0
    v_mfma_f32_16x16x32_bf16 v[212:215], a[24:27], a[4:7], v[212:215]
    v_lshlrev_b32 v59, 7, v59
    ds_read_b64_tr_b16 a[90:91], v13 offset:8704
    v_mfma_f32_16x16x32_bf16 v[216:219], a[24:27], a[8:11], v[216:219]
    s_mov_b32 s52, 26607616
    buffer_load_dword v60, v59, s[20:23], s52 offen sc1
    v_mfma_f32_16x16x32_bf16 v[220:223], a[24:27], a[12:15], v[220:223]
    ds_read_b64_tr_b16 a[92:93], v58 offset:8192
    ds_read_b64_tr_b16 a[94:95], v58 offset:8704
    v_mfma_f32_16x16x32_bf16 v[236:239], a[28:31], a[12:15], v[236:239]
    ds_read_b64_tr_b16 a[96:97], v18 offset:9216
    v_mfma_f32_16x16x32_bf16 v[232:235], a[28:31], a[8:11], v[232:235]
    ds_read_b64_tr_b16 a[98:99], v18 offset:9728
    v_mfma_f32_16x16x32_bf16 v[228:231], a[28:31], a[4:7], v[228:231]
    v_mfma_f32_16x16x32_bf16 v[224:227], a[28:31], a[0:3], v[224:227]
    v_mfma_f32_16x16x32_bf16 v[240:243], a[32:35], a[0:3], v[240:243]
    v_mfma_f32_16x16x32_bf16 v[244:247], a[32:35], a[4:7], v[244:247]
    v_mfma_f32_16x16x32_bf16 v[248:251], a[32:35], a[8:11], v[248:251]
    v_mfma_f32_16x16x32_bf16 v[252:255], a[32:35], a[12:15], v[252:255]
    s_waitcnt lgkmcnt(0)
    v_mfma_f32_16x16x32_bf16 v[176:179], a[80:83], a[64:67], v[176:179]
    s_waitcnt vmcnt(1)
    s_barrier
    v_mfma_f32_16x16x32_bf16 v[180:183], a[80:83], a[68:71], v[180:183]
    s_add_u32 s28, s28, 32768
    v_mfma_f32_16x16x32_bf16 v[184:187], a[80:83], a[72:75], v[184:187]
    s_cmp_eq_u32 s28, 98304
    s_cselect_b32 s28, 0, s28
    v_mfma_f32_16x16x32_bf16 v[188:191], a[80:83], a[76:79], v[188:191]
    v_add_u32 v16, s28, v14
    ds_read_b64_tr_b16 a[16:17], v18 offset:16384
    v_mfma_f32_16x16x32_bf16 v[204:207], a[84:87], a[76:79], v[204:207]
    ds_read_b64_tr_b16 a[18:19], v18 offset:16896
    ds_read_b64_tr_b16 a[20:21], v19 offset:16384
    v_mfma_f32_16x16x32_bf16 v[200:203], a[84:87], a[72:75], v[200:203]
    ds_read_b64_tr_b16 a[22:23], v19 offset:16896
    v_mfma_f32_16x16x32_bf16 v[196:199], a[84:87], a[68:71], v[196:199]
    ds_read_b64_tr_b16 a[24:25], v13 offset:16384
    ds_read_b64_tr_b16 a[26:27], v13 offset:16896
    v_mfma_f32_16x16x32_bf16 v[192:195], a[84:87], a[64:67], v[192:195]
    ds_read_b64_tr_b16 a[28:29], v58 offset:16384
    v_mfma_f32_16x16x32_bf16 v[208:211], a[88:91], a[64:67], v[208:211]
    ds_read_b64_tr_b16 a[30:31], v58 offset:16896
    ds_read_b64_tr_b16 a[32:33], v18 offset:17408
    v_mfma_f32_16x16x32_bf16 v[212:215], a[88:91], a[68:71], v[212:215]
    ds_read_b64_tr_b16 a[34:35], v18 offset:17920
    v_mfma_f32_16x16x32_bf16 v[216:219], a[88:91], a[72:75], v[216:219]
    v_add_u32 v17, s28, v15
    v_mfma_f32_16x16x32_bf16 v[220:223], a[88:91], a[76:79], v[220:223]
    ds_read_b128 a[0:3], v16 offset:0
    ds_read_b128 a[4:7], v16 offset:2048
    v_mfma_f32_16x16x32_bf16 v[236:239], a[92:95], a[76:79], v[236:239]
    ds_read_b128 a[8:11], v16 offset:4096
    v_mfma_f32_16x16x32_bf16 v[232:235], a[92:95], a[72:75], v[232:235]
    ds_read_b128 a[12:15], v16 offset:6144
    v_mfma_f32_16x16x32_bf16 v[228:231], a[92:95], a[68:71], v[228:231]
    v_mfma_f32_16x16x32_bf16 v[224:227], a[92:95], a[64:67], v[224:227]
    v_mfma_f32_16x16x32_bf16 v[240:243], a[96:99], a[64:67], v[240:243]
    v_mfma_f32_16x16x32_bf16 v[244:247], a[96:99], a[68:71], v[244:247]
    v_mfma_f32_16x16x32_bf16 v[248:251], a[96:99], a[72:75], v[248:251]
    v_mfma_f32_16x16x32_bf16 v[252:255], a[96:99], a[76:79], v[252:255]
    s_waitcnt lgkmcnt(0)
    v_mfma_f32_16x16x32_bf16 v[176:179], a[16:19], a[0:3], v[176:179]
    ds_read_b128 a[64:67], v17 offset:0
    v_mfma_f32_16x16x32_bf16 v[180:183], a[16:19], a[4:7], v[180:183]
    ds_read_b128 a[68:71], v17 offset:2048
    v_mfma_f32_16x16x32_bf16 v[184:187], a[16:19], a[8:11], v[184:187]
    ds_read_b128 a[72:75], v17 offset:4096
    v_mfma_f32_16x16x32_bf16 v[188:191], a[16:19], a[12:15], v[188:191]
    ds_read_b128 a[76:79], v17 offset:6144
    v_mfma_f32_16x16x32_bf16 v[204:207], a[20:23], a[12:15], v[204:207]
    ds_read_b64_tr_b16 a[80:81], v18 offset:24576
    v_mfma_f32_16x16x32_bf16 v[200:203], a[20:23], a[8:11], v[200:203]
    ds_read_b64_tr_b16 a[82:83], v18 offset:25088
    v_mfma_f32_16x16x32_bf16 v[196:199], a[20:23], a[4:7], v[196:199]
    ds_read_b64_tr_b16 a[84:85], v19 offset:24576
    v_mfma_f32_16x16x32_bf16 v[192:195], a[20:23], a[0:3], v[192:195]
    ds_read_b64_tr_b16 a[86:87], v19 offset:25088
    v_mfma_f32_16x16x32_bf16 v[208:211], a[24:27], a[0:3], v[208:211]
    ds_read_b64_tr_b16 a[88:89], v13 offset:24576
    v_mfma_f32_16x16x32_bf16 v[212:215], a[24:27], a[4:7], v[212:215]
    ds_read_b64_tr_b16 a[90:91], v13 offset:25088
    v_mfma_f32_16x16x32_bf16 v[216:219], a[24:27], a[8:11], v[216:219]
    ds_read_b64_tr_b16 a[92:93], v58 offset:24576
    v_mfma_f32_16x16x32_bf16 v[220:223], a[24:27], a[12:15], v[220:223]
    ds_read_b64_tr_b16 a[94:95], v58 offset:25088
    v_mfma_f32_16x16x32_bf16 v[236:239], a[28:31], a[12:15], v[236:239]
    ds_read_b64_tr_b16 a[96:97], v18 offset:25600
    v_mfma_f32_16x16x32_bf16 v[232:235], a[28:31], a[8:11], v[232:235]
    ds_read_b64_tr_b16 a[98:99], v18 offset:26112
    v_mfma_f32_16x16x32_bf16 v[228:231], a[28:31], a[4:7], v[228:231]
    v_mfma_f32_16x16x32_bf16 v[224:227], a[28:31], a[0:3], v[224:227]
    v_mfma_f32_16x16x32_bf16 v[240:243], a[32:35], a[0:3], v[240:243]
    v_mfma_f32_16x16x32_bf16 v[244:247], a[32:35], a[4:7], v[244:247]
    v_mfma_f32_16x16x32_bf16 v[248:251], a[32:35], a[8:11], v[248:251]
    v_mfma_f32_16x16x32_bf16 v[252:255], a[32:35], a[12:15], v[252:255]
    s_waitcnt lgkmcnt(0)
    v_mfma_f32_16x16x32_bf16 v[176:179], a[80:83], a[64:67], v[176:179]
    s_waitcnt vmcnt(45)
    s_barrier
    v_mfma_f32_16x16x32_bf16 v[180:183], a[80:83], a[68:71], v[180:183]
    s_add_u32 s36, s38, s39
    s_and_b32 s36, s36, 3
    v_mfma_f32_16x16x32_bf16 v[184:187], a[80:83], a[72:75], v[184:187]
    s_lshl_b32 s36, s36, 3
    s_lshl_b32 s24, s3, 12
    v_mfma_f32_16x16x32_bf16 v[188:191], a[80:83], a[76:79], v[188:191]
    s_mov_b32 s8, s74
    s_mov_b32 s9, s75
    v_mfma_f32_16x16x32_bf16 v[204:207], a[84:87], a[76:79], v[204:207]
    s_mov_b32 s10, 0x800000
    s_mov_b32 s11, 0x20000
    v_mfma_f32_16x16x32_bf16 v[200:203], a[84:87], a[72:75], v[200:203]
    v_lshrrev_b32 v6, 3, v0
    v_and_b32 v7, 7, v0
    v_mfma_f32_16x16x32_bf16 v[196:199], a[84:87], a[68:71], v[196:199]
    v_lshrrev_b32 v8, 4, v0
    s_lshl_b32 s48, s38, 7
    v_mfma_f32_16x16x32_bf16 v[192:195], a[84:87], a[64:67], v[192:195]
    s_lshl_b32 s49, s3, 5
    s_add_u32 s48, s48, s49
    v_mfma_f32_16x16x32_bf16 v[208:211], a[88:91], a[64:67], v[208:211]
    v_add_u32 v9, s48, v6
    v_lshlrev_b32 v9, 12, v9
    v_mfma_f32_16x16x32_bf16 v[212:215], a[88:91], a[68:71], v[212:215]
    v_xor_b32 v10, v7, v8
    v_xor_b32 v11, 4, v10
    v_mfma_f32_16x16x32_bf16 v[216:219], a[88:91], a[72:75], v[216:219]
    v_lshl_add_u32 v10, v10, 4, v9
    v_lshl_add_u32 v11, v11, 4, v9
    v_mfma_f32_16x16x32_bf16 v[220:223], a[88:91], a[76:79], v[220:223]
    v_add_u32 v2, 0, v10
    v_add_u32 v3, 31744, v11
    v_mfma_f32_16x16x32_bf16 v[236:239], a[92:95], a[76:79], v[236:239]
    v_add_u32 v4, 63488, v10
    v_add_u32 v5, 95232, v11
    v_mfma_f32_16x16x32_bf16 v[232:235], a[92:95], a[72:75], v[232:235]
    s_lshr_b32 s37, 0x3, s36
    s_and_b32 s37, s37, 0xff
    v_mfma_f32_16x16x32_bf16 v[228:231], a[92:95], a[68:71], v[228:231]
    s_lshl_b32 s26, s37, 7
    s_add_u32 m0, s24, 0
    v_mfma_f32_16x16x32_bf16 v[224:227], a[92:95], a[64:67], v[224:227]
    buffer_load_dwordx4 v2, s[8:11], s26 offen lds
    buffer_load_dwordx4 v3, s[8:11], s26 offen offset:1024 lds
    v_mfma_f32_16x16x32_bf16 v[240:243], a[96:99], a[64:67], v[240:243]
    buffer_load_dwordx4 v4, s[8:11], s26 offen offset:2048 lds
    buffer_load_dwordx4 v5, s[8:11], s26 offen offset:3072 lds
    v_mfma_f32_16x16x32_bf16 v[244:247], a[96:99], a[68:71], v[244:247]
    s_lshr_b32 s37, 0x1010400, s36
    s_and_b32 s37, s37, 0xff
    v_mfma_f32_16x16x32_bf16 v[248:251], a[96:99], a[72:75], v[248:251]
    s_lshl_b32 s26, s37, 7
    s_add_u32 m0, s24, 16384
    v_mfma_f32_16x16x32_bf16 v[252:255], a[96:99], a[76:79], v[252:255]
    buffer_load_dwordx4 v2, s[8:11], s26 offen lds
    buffer_load_dwordx4 v3, s[8:11], s26 offen offset:1024 lds
    buffer_load_dwordx4 v4, s[8:11], s26 offen offset:2048 lds
    buffer_load_dwordx4 v5, s[8:11], s26 offen offset:3072 lds
    s_lshr_b32 s37, 0x2050101, s36
    s_and_b32 s37, s37, 0xff
    s_lshl_b32 s26, s37, 7
    s_add_u32 m0, s24, 32768
    s_nop 0
    buffer_load_dwordx4 v2, s[8:11], s26 offen lds
    buffer_load_dwordx4 v3, s[8:11], s26 offen offset:1024 lds
    buffer_load_dwordx4 v4, s[8:11], s26 offen offset:2048 lds
    buffer_load_dwordx4 v5, s[8:11], s26 offen offset:3072 lds
    s_lshr_b32 s37, 0x6020202, s36
    s_and_b32 s37, s37, 0xff
    s_lshl_b32 s26, s37, 7
    s_add_u32 m0, s24, 49152
    s_nop 0
    buffer_load_dwordx4 v2, s[8:11], s26 offen lds
    buffer_load_dwordx4 v3, s[8:11], s26 offen offset:1024 lds
    buffer_load_dwordx4 v4, s[8:11], s26 offen offset:2048 lds
    buffer_load_dwordx4 v5, s[8:11], s26 offen offset:3072 lds
    s_mov_b32 s42, 1
    v_lshrrev_b32 v20, 3, v0
    v_and_b32 v21, 7, v0
    v_lshrrev_b32 v22, 4, v0
    s_lshl_b32 s48, s38, 7
    s_lshl_b32 s49, s3, 5
    s_add_u32 s48, s48, s49
    v_add_u32 v23, s48, v20
    v_lshlrev_b32 v23, 12, v23
    v_xor_b32 v24, v21, v22
    v_xor_b32 v25, 4, v24
    v_lshl_add_u32 v24, v24, 4, v23
    v_lshl_add_u32 v25, v25, 4, v23
    v_add_u32 v2, 0, v24
    v_add_u32 v3, 31744, v25
    v_add_u32 v4, 63488, v24
    v_add_u32 v5, 95232, v25
    s_mul_i32 s25, s3, 4096
    s_add_u32 s25, s25, 65536
    s_mul_i32 s50, s39, 7168
    s_lshr_b32 s51, s3, 1
    s_mul_i32 s51, s51, 114688
    s_and_b32 s48, s3, 1
    s_mul_i32 s48, s48, 3584
    s_add_u32 s51, s51, s50
    s_add_u32 s51, s51, s48
    s_add_u32 s51, s51, 0
    v_lshlrev_b32 v7, 4, v0
    v_add_u32 v6, s51, v7
    s_lshl_b32 s40, s38, 2
    s_add_u32 s40, s40, s3
    s_mul_i32 s48, s40, 114688
    s_add_u32 s50, s50, s48
    s_add_u32 s50, s50, 7340032
    s_add_u32 s51, s50, 4096
    v_and_b32 v20, 15, v0
    v_lshrrev_b32 v21, 4, v0
    v_lshrrev_b32 v22, 1, v20
    v_xor_b32 v22, v22, v21
    v_lshlrev_b32 v22, 4, v22
    v_lshl_add_u32 v22, v20, 7, v22
    v_add_u32 v8, s24, v22
    v_xor_b32 v9, 64, v8
    v_lshlrev_b32 v10, 3, v0
    v_and_b32 v10, 0xff, v10
    v_lshrrev_b32 v22, 5, v0
    v_lshl_or_b32 v10, v22, 9, v10
    v_add_u32 v10, 65536, v10
    v_lshl_add_u32 v14, v22, 9, v10
    v_lshl_add_u32 v15, v22, 30, v6
    s_mov_b32 s4, s76
    s_mov_b32 s5, s77
    s_mov_b32 s6, 0x1000
    s_mov_b32 s7, 0x20000
    s_lshl_b32 s48, s40, 6
    v_lshlrev_b32 v21, 1, v20
    v_add_u32 v21, s48, v21
    buffer_load_ushort v16, v21, s[4:7], 0 offen
    buffer_load_ushort v17, v21, s[4:7], 0 offen offset:32
    s_waitcnt vmcnt(18)
    s_mov_b32 s47, 0
    v_cmp_gt_u32 vcc, 16, v60
    s_nop 1
    s_cmp_eq_u64 vcc, 0
    s_cbranch_scc1 L_polled_1_20
L_poll_1_19:
    buffer_load_dword v60, v59, s[20:23], s52 offen sc1
    s_waitcnt vmcnt(0)
    v_cmp_gt_u32 vcc, 16, v60
    s_nop 1
    s_cmp_eq_u64 vcc, 0
    s_cbranch_scc1 L_polled_1_20
    s_add_u32 s47, s47, 1
    s_cmp_lt_u32 s47, 262144
    s_cbranch_scc1 L_poll_1_19
L_polled_1_20:
    s_nop 1
    s_mov_b32 s60, 0xbdd2d3e8
    s_mov_b32 s61, 0xbdd2d3e8
    s_mov_b32 s62, 1.0
    s_mov_b32 s63, 1.0
    v_mov_b32 v12, 0xc0135761
    v_mov_b32 v13, 0xc0135761
    s_lshl_b32 s46, s35, 3
    s_lshl_b32 s47, s3, 1
    s_add_u32 s46, s46, s47
    s_mul_i32 s46, s46, 114688
    s_mul_i32 s47, s44, 5120
    s_add_u32 s46, s46, s47
    s_add_u32 s46, s46, 7340032
    s_add_u32 s47, s46, 4096
    s_add_u32 s48, s46, 114688
    s_add_u32 s49, s48, 4096
    v_pk_mul_f32 v[20:21], v[176:177], v[176:177]
    s_lshr_b32 s37, 0x3, s36
    s_and_b32 s37, s37, 0xff
    s_mul_i32 s27, s37, 229376
    s_add_u32 m0, s25, 0
    s_nop 0
    buffer_load_dwordx4 v6, s[20:23], s27 offen sc1 lds
    v_pk_mul_f32 v[22:23], v[180:181], v[180:181]
    v_pk_mul_f32 v[24:25], v[184:185], v[184:185]
    v_pk_mul_f32 v[26:27], v[188:189], v[188:189]
    v_pk_fma_f32 v[20:21], v[20:21], s[60:61], v[12:13]
    v_pk_fma_f32 v[22:23], v[22:23], s[60:61], v[12:13]
    v_pk_fma_f32 v[24:25], v[24:25], s[60:61], v[12:13]
    v_pk_fma_f32 v[26:27], v[26:27], s[60:61], v[12:13]
    v_pk_mul_f32 v[20:21], v[20:21], v[176:177]
    v_pk_mul_f32 v[22:23], v[22:23], v[180:181]
    v_pk_mul_f32 v[24:25], v[24:25], v[184:185]
    v_pk_mul_f32 v[26:27], v[26:27], v[188:189]
    v_exp_f32 v20, v20
    buffer_load_dwordx4 v6, s[20:23], s27 offen offset:1024 sc1 lds
    v_pk_mul_f32 v[28:29], v[178:179], v[178:179]
    v_exp_f32 v21, v21
    v_pk_mul_f32 v[30:31], v[182:183], v[182:183]
    v_pk_mul_f32 v[32:33], v[186:187], v[186:187]
    v_exp_f32 v22, v22
    v_pk_mul_f32 v[34:35], v[190:191], v[190:191]
    v_exp_f32 v23, v23
    v_pk_fma_f32 v[28:29], v[28:29], s[60:61], v[12:13]
    v_pk_fma_f32 v[30:31], v[30:31], s[60:61], v[12:13]
    v_exp_f32 v24, v24
    v_pk_fma_f32 v[32:33], v[32:33], s[60:61], v[12:13]
    v_exp_f32 v25, v25
    v_pk_fma_f32 v[34:35], v[34:35], s[60:61], v[12:13]
    buffer_load_dwordx4 v6, s[20:23], s27 offen offset:2048 sc1 lds
    v_pk_mul_f32 v[28:29], v[28:29], v[178:179]
    v_exp_f32 v26, v26
    v_pk_mul_f32 v[30:31], v[30:31], v[182:183]
    v_exp_f32 v27, v27
    v_pk_mul_f32 v[32:33], v[32:33], v[186:187]
    v_pk_mul_f32 v[34:35], v[34:35], v[190:191]
    v_exp_f32 v28, v28
    v_pk_add_f32 v[20:21], v[20:21], s[62:63]
    v_exp_f32 v29, v29
    v_pk_add_f32 v[22:23], v[22:23], s[62:63]
    v_exp_f32 v30, v30
    v_pk_add_f32 v[24:25], v[24:25], s[62:63]
    buffer_load_dwordx4 v15, s[20:23], s27 offen offset:3072 sc1 lds
    v_exp_f32 v31, v31
    v_pk_add_f32 v[26:27], v[26:27], s[62:63]
    v_exp_f32 v32, v32
    v_pk_mul_f32 v[36:37], v[192:193], v[192:193]
    v_exp_f32 v33, v33
    v_pk_mul_f32 v[38:39], v[196:197], v[196:197]
    v_exp_f32 v34, v34
    v_pk_mul_f32 v[40:41], v[200:201], v[200:201]
    v_exp_f32 v35, v35
    v_pk_mul_f32 v[42:43], v[204:205], v[204:205]
    v_rcp_f32 v20, v20
    v_pk_fma_f32 v[36:37], v[36:37], s[60:61], v[12:13]
    v_rcp_f32 v21, v21
    s_lshr_b32 s37, 0x1010400, s36
    s_and_b32 s37, s37, 0xff
    s_mul_i32 s27, s37, 229376
    s_add_u32 m0, s25, 16384
    s_nop 0
    buffer_load_dwordx4 v6, s[20:23], s27 offen sc1 lds
    v_pk_fma_f32 v[38:39], v[38:39], s[60:61], v[12:13]
    v_rcp_f32 v22, v22
    v_pk_fma_f32 v[40:41], v[40:41], s[60:61], v[12:13]
    v_rcp_f32 v23, v23
    v_pk_fma_f32 v[42:43], v[42:43], s[60:61], v[12:13]
    v_rcp_f32 v24, v24
    v_pk_mul_f32 v[36:37], v[36:37], v[192:193]
    v_rcp_f32 v25, v25
    v_pk_mul_f32 v[38:39], v[38:39], v[196:197]
    v_rcp_f32 v26, v26
    v_pk_mul_f32 v[40:41], v[40:41], v[200:201]
    v_rcp_f32 v27, v27
    buffer_load_dwordx4 v6, s[20:23], s27 offen offset:1024 sc1 lds
    v_pk_mul_f32 v[42:43], v[42:43], v[204:205]
    v_exp_f32 v36, v36
    v_pk_add_f32 v[28:29], v[28:29], s[62:63]
    v_exp_f32 v37, v37
    v_pk_add_f32 v[30:31], v[30:31], s[62:63]
    v_exp_f32 v38, v38
    v_pk_add_f32 v[32:33], v[32:33], s[62:63]
    v_exp_f32 v39, v39
    v_pk_add_f32 v[34:35], v[34:35], s[62:63]
    v_pk_mul_f32 v[176:177], v[176:177], v[20:21]
    v_exp_f32 v40, v40
    v_pk_mul_f32 v[180:181], v[180:181], v[22:23]
    v_exp_f32 v41, v41
    buffer_load_dwordx4 v6, s[20:23], s27 offen offset:2048 sc1 lds
    v_pk_mul_f32 v[184:185], v[184:185], v[24:25]
    v_exp_f32 v42, v42
    v_pk_mul_f32 v[188:189], v[188:189], v[26:27]
    v_exp_f32 v43, v43
    v_pk_mul_f32 v[44:45], v[194:195], v[194:195]
    v_pk_mul_f32 v[46:47], v[198:199], v[198:199]
    v_rcp_f32 v28, v28
    v_pk_mul_f32 v[48:49], v[202:203], v[202:203]
    v_rcp_f32 v29, v29
    v_pk_mul_f32 v[50:51], v[206:207], v[206:207]
    v_rcp_f32 v30, v30
    v_pk_fma_f32 v[44:45], v[44:45], s[60:61], v[12:13]
    buffer_load_dwordx4 v15, s[20:23], s27 offen offset:3072 sc1 lds
    v_rcp_f32 v31, v31
    v_pk_fma_f32 v[46:47], v[46:47], s[60:61], v[12:13]
    v_pk_fma_f32 v[48:49], v[48:49], s[60:61], v[12:13]
    v_rcp_f32 v32, v32
    v_pk_fma_f32 v[50:51], v[50:51], s[60:61], v[12:13]
    v_rcp_f32 v33, v33
    v_pk_mul_f32 v[44:45], v[44:45], v[194:195]
    v_rcp_f32 v34, v34
    v_pk_mul_f32 v[46:47], v[46:47], v[198:199]
    v_rcp_f32 v35, v35
    v_pk_mul_f32 v[48:49], v[48:49], v[202:203]
    v_pk_mul_f32 v[50:51], v[50:51], v[206:207]
    v_exp_f32 v44, v44
    s_lshr_b32 s37, 0x2050101, s36
    s_and_b32 s37, s37, 0xff
    s_mul_i32 s27, s37, 229376
    s_add_u32 m0, s25, 32768
    s_nop 0
    buffer_load_dwordx4 v6, s[20:23], s27 offen sc1 lds
    v_pk_add_f32 v[36:37], v[36:37], s[62:63]
    v_exp_f32 v45, v45
    v_pk_add_f32 v[38:39], v[38:39], s[62:63]
    v_exp_f32 v46, v46
    v_pk_add_f32 v[40:41], v[40:41], s[62:63]
    v_exp_f32 v47, v47
    v_pk_add_f32 v[42:43], v[42:43], s[62:63]
    v_pk_mul_f32 v[178:179], v[178:179], v[28:29]
    v_exp_f32 v48, v48
    v_pk_mul_f32 v[182:183], v[182:183], v[30:31]
    v_exp_f32 v49, v49
    v_pk_mul_f32 v[186:187], v[186:187], v[32:33]
    v_exp_f32 v50, v50
    buffer_load_dwordx4 v6, s[20:23], s27 offen offset:1024 sc1 lds
    v_pk_mul_f32 v[190:191], v[190:191], v[34:35]
    v_exp_f32 v51, v51
    v_pk_mul_f32 v[20:21], v[208:209], v[208:209]
    v_pk_mul_f32 v[22:23], v[212:213], v[212:213]
    v_rcp_f32 v36, v36
    v_pk_mul_f32 v[24:25], v[216:217], v[216:217]
    v_rcp_f32 v37, v37
    v_pk_mul_f32 v[26:27], v[220:221], v[220:221]
    v_rcp_f32 v38, v38
    v_pk_fma_f32 v[20:21], v[20:21], s[60:61], v[12:13]
    v_rcp_f32 v39, v39
    v_pk_fma_f32 v[22:23], v[22:23], s[60:61], v[12:13]
    buffer_load_dwordx4 v6, s[20:23], s27 offen offset:2048 sc1 lds
    v_pk_fma_f32 v[24:25], v[24:25], s[60:61], v[12:13]
    v_rcp_f32 v40, v40
    v_pk_fma_f32 v[26:27], v[26:27], s[60:61], v[12:13]
    v_rcp_f32 v41, v41
    v_pk_mul_f32 v[20:21], v[20:21], v[208:209]
    v_rcp_f32 v42, v42
    v_pk_mul_f32 v[22:23], v[22:23], v[212:213]
    v_rcp_f32 v43, v43
    v_pk_mul_f32 v[24:25], v[24:25], v[216:217]
    v_pk_mul_f32 v[26:27], v[26:27], v[220:221]
    v_exp_f32 v20, v20
    v_pk_add_f32 v[44:45], v[44:45], s[62:63]
    v_exp_f32 v21, v21
    buffer_load_dwordx4 v15, s[20:23], s27 offen offset:3072 sc1 lds
    v_pk_add_f32 v[46:47], v[46:47], s[62:63]
    v_exp_f32 v22, v22
    v_pk_add_f32 v[48:49], v[48:49], s[62:63]
    v_exp_f32 v23, v23
    v_pk_add_f32 v[50:51], v[50:51], s[62:63]
    v_pk_mul_f32 v[192:193], v[192:193], v[36:37]
    v_exp_f32 v24, v24
    v_pk_mul_f32 v[196:197], v[196:197], v[38:39]
    v_exp_f32 v25, v25
    v_pk_mul_f32 v[200:201], v[200:201], v[40:41]
    v_exp_f32 v26, v26
    v_pk_mul_f32 v[204:205], v[204:205], v[42:43]
    s_lshr_b32 s37, 0x6020202, s36
    s_and_b32 s37, s37, 0xff
    s_mul_i32 s27, s37, 229376
    s_add_u32 m0, s25, 49152
    s_nop 0
    buffer_load_dwordx4 v6, s[20:23], s27 offen sc1 lds
    v_exp_f32 v27, v27
    v_pk_mul_f32 v[28:29], v[210:211], v[210:211]
    v_pk_mul_f32 v[30:31], v[214:215], v[214:215]
    v_rcp_f32 v44, v44
    v_pk_mul_f32 v[32:33], v[218:219], v[218:219]
    v_rcp_f32 v45, v45
    v_pk_mul_f32 v[34:35], v[222:223], v[222:223]
    v_rcp_f32 v46, v46
    v_pk_fma_f32 v[28:29], v[28:29], s[60:61], v[12:13]
    v_rcp_f32 v47, v47
    v_pk_fma_f32 v[30:31], v[30:31], s[60:61], v[12:13]
    v_pk_fma_f32 v[32:33], v[32:33], s[60:61], v[12:13]
    v_rcp_f32 v48, v48
    buffer_load_dwordx4 v6, s[20:23], s27 offen offset:1024 sc1 lds
    v_pk_fma_f32 v[34:35], v[34:35], s[60:61], v[12:13]
    v_rcp_f32 v49, v49
    v_pk_mul_f32 v[28:29], v[28:29], v[210:211]
    v_rcp_f32 v50, v50
    v_pk_mul_f32 v[30:31], v[30:31], v[214:215]
    v_rcp_f32 v51, v51
    v_pk_mul_f32 v[32:33], v[32:33], v[218:219]
    v_pk_mul_f32 v[34:35], v[34:35], v[222:223]
    v_exp_f32 v28, v28
    v_pk_add_f32 v[20:21], v[20:21], s[62:63]
    v_exp_f32 v29, v29
    v_pk_add_f32 v[22:23], v[22:23], s[62:63]
    buffer_load_dwordx4 v6, s[20:23], s27 offen offset:2048 sc1 lds
    v_exp_f32 v30, v30
    v_pk_add_f32 v[24:25], v[24:25], s[62:63]
    v_exp_f32 v31, v31
    v_pk_add_f32 v[26:27], v[26:27], s[62:63]
    v_pk_mul_f32 v[194:195], v[194:195], v[44:45]
    v_exp_f32 v32, v32
    v_pk_mul_f32 v[198:199], v[198:199], v[46:47]
    v_exp_f32 v33, v33
    v_pk_mul_f32 v[202:203], v[202:203], v[48:49]
    v_exp_f32 v34, v34
    v_pk_mul_f32 v[206:207], v[206:207], v[50:51]
    v_exp_f32 v35, v35
    v_pk_mul_f32 v[36:37], v[224:225], v[224:225]
    buffer_load_dwordx4 v15, s[20:23], s27 offen offset:3072 sc1 lds
    v_pk_mul_f32 v[38:39], v[228:229], v[228:229]
    v_rcp_f32 v20, v20
    v_pk_mul_f32 v[40:41], v[232:233], v[232:233]
    v_rcp_f32 v21, v21
    v_pk_mul_f32 v[42:43], v[236:237], v[236:237]
    v_rcp_f32 v22, v22
    v_pk_fma_f32 v[36:37], v[36:37], s[60:61], v[12:13]
    v_rcp_f32 v23, v23
    v_pk_fma_f32 v[38:39], v[38:39], s[60:61], v[12:13]
    v_pk_fma_f32 v[40:41], v[40:41], s[60:61], v[12:13]
    v_rcp_f32 v24, v24
    v_pk_fma_f32 v[42:43], v[42:43], s[60:61], v[12:13]
    v_rcp_f32 v25, v25
    v_pk_mul_f32 v[36:37], v[36:37], v[224:225]
    v_rcp_f32 v26, v26
    v_pk_mul_f32 v[38:39], v[38:39], v[228:229]
    v_rcp_f32 v27, v27
    v_pk_mul_f32 v[40:41], v[40:41], v[232:233]
    v_pk_mul_f32 v[42:43], v[42:43], v[236:237]
    v_exp_f32 v36, v36
    v_pk_add_f32 v[28:29], v[28:29], s[62:63]
    v_exp_f32 v37, v37
    v_pk_add_f32 v[30:31], v[30:31], s[62:63]
    v_exp_f32 v38, v38
    v_pk_add_f32 v[32:33], v[32:33], s[62:63]
    v_exp_f32 v39, v39
    v_pk_add_f32 v[34:35], v[34:35], s[62:63]
    v_pk_mul_f32 v[208:209], v[208:209], v[20:21]
    v_exp_f32 v40, v40
    v_pk_mul_f32 v[212:213], v[212:213], v[22:23]
    v_exp_f32 v41, v41
    v_pk_mul_f32 v[216:217], v[216:217], v[24:25]
    v_exp_f32 v42, v42
    v_pk_mul_f32 v[220:221], v[220:221], v[26:27]
    v_exp_f32 v43, v43
    v_pk_mul_f32 v[44:45], v[226:227], v[226:227]
    v_pk_mul_f32 v[46:47], v[230:231], v[230:231]
    v_rcp_f32 v28, v28
    v_pk_mul_f32 v[48:49], v[234:235], v[234:235]
    v_rcp_f32 v29, v29
    v_pk_mul_f32 v[50:51], v[238:239], v[238:239]
    v_rcp_f32 v30, v30
    v_pk_fma_f32 v[44:45], v[44:45], s[60:61], v[12:13]
    v_rcp_f32 v31, v31
    v_pk_fma_f32 v[46:47], v[46:47], s[60:61], v[12:13]
    v_pk_fma_f32 v[48:49], v[48:49], s[60:61], v[12:13]
    v_rcp_f32 v32, v32
    v_pk_fma_f32 v[50:51], v[50:51], s[60:61], v[12:13]
    v_rcp_f32 v33, v33
    v_pk_mul_f32 v[44:45], v[44:45], v[226:227]
    v_rcp_f32 v34, v34
    v_pk_mul_f32 v[46:47], v[46:47], v[230:231]
    v_rcp_f32 v35, v35
    v_pk_mul_f32 v[48:49], v[48:49], v[234:235]
    v_pk_mul_f32 v[50:51], v[50:51], v[238:239]
    v_exp_f32 v44, v44
    v_pk_add_f32 v[36:37], v[36:37], s[62:63]
    v_exp_f32 v45, v45
    v_pk_add_f32 v[38:39], v[38:39], s[62:63]
    v_exp_f32 v46, v46
    v_pk_add_f32 v[40:41], v[40:41], s[62:63]
    v_exp_f32 v47, v47
    v_pk_add_f32 v[42:43], v[42:43], s[62:63]
    v_pk_mul_f32 v[210:211], v[210:211], v[28:29]
    v_exp_f32 v48, v48
    v_pk_mul_f32 v[214:215], v[214:215], v[30:31]
    v_exp_f32 v49, v49
    v_pk_mul_f32 v[218:219], v[218:219], v[32:33]
    v_exp_f32 v50, v50
    v_pk_mul_f32 v[222:223], v[222:223], v[34:35]
    v_exp_f32 v51, v51
    v_pk_mul_f32 v[20:21], v[240:241], v[240:241]
    v_pk_mul_f32 v[22:23], v[244:245], v[244:245]
    v_rcp_f32 v36, v36
    v_pk_mul_f32 v[24:25], v[248:249], v[248:249]
    v_rcp_f32 v37, v37
    v_pk_mul_f32 v[26:27], v[252:253], v[252:253]
    v_rcp_f32 v38, v38
    v_pk_fma_f32 v[20:21], v[20:21], s[60:61], v[12:13]
    v_rcp_f32 v39, v39
    v_pk_fma_f32 v[22:23], v[22:23], s[60:61], v[12:13]
    v_pk_fma_f32 v[24:25], v[24:25], s[60:61], v[12:13]
    v_rcp_f32 v40, v40
    v_pk_fma_f32 v[26:27], v[26:27], s[60:61], v[12:13]
    v_rcp_f32 v41, v41
    v_pk_mul_f32 v[20:21], v[20:21], v[240:241]
    v_rcp_f32 v42, v42
    v_pk_mul_f32 v[22:23], v[22:23], v[244:245]
    v_rcp_f32 v43, v43
    v_pk_mul_f32 v[24:25], v[24:25], v[248:249]
    v_pk_mul_f32 v[26:27], v[26:27], v[252:253]
    v_exp_f32 v20, v20
    v_pk_add_f32 v[44:45], v[44:45], s[62:63]
    v_exp_f32 v21, v21
    v_pk_add_f32 v[46:47], v[46:47], s[62:63]
    v_exp_f32 v22, v22
    v_pk_add_f32 v[48:49], v[48:49], s[62:63]
    v_exp_f32 v23, v23
    v_pk_add_f32 v[50:51], v[50:51], s[62:63]
    v_pk_mul_f32 v[224:225], v[224:225], v[36:37]
    v_exp_f32 v24, v24
    v_pk_mul_f32 v[228:229], v[228:229], v[38:39]
    v_exp_f32 v25, v25
    v_pk_mul_f32 v[232:233], v[232:233], v[40:41]
    v_exp_f32 v26, v26
    v_pk_mul_f32 v[236:237], v[236:237], v[42:43]
    v_exp_f32 v27, v27
    v_pk_mul_f32 v[28:29], v[242:243], v[242:243]
    v_pk_mul_f32 v[30:31], v[246:247], v[246:247]
    v_rcp_f32 v44, v44
    v_pk_mul_f32 v[32:33], v[250:251], v[250:251]
    v_rcp_f32 v45, v45
    v_pk_mul_f32 v[34:35], v[254:255], v[254:255]
    v_rcp_f32 v46, v46
    v_pk_fma_f32 v[28:29], v[28:29], s[60:61], v[12:13]
    v_rcp_f32 v47, v47
    v_pk_fma_f32 v[30:31], v[30:31], s[60:61], v[12:13]
    v_pk_fma_f32 v[32:33], v[32:33], s[60:61], v[12:13]
    v_rcp_f32 v48, v48
    v_pk_fma_f32 v[34:35], v[34:35], s[60:61], v[12:13]
    v_rcp_f32 v49, v49
    v_pk_mul_f32 v[28:29], v[28:29], v[242:243]
    v_rcp_f32 v50, v50
    v_pk_mul_f32 v[30:31], v[30:31], v[246:247]
    v_rcp_f32 v51, v51
    v_pk_mul_f32 v[32:33], v[32:33], v[250:251]
    v_pk_mul_f32 v[34:35], v[34:35], v[254:255]
    v_exp_f32 v28, v28
    v_exp_f32 v29, v29
    v_pk_add_f32 v[20:21], v[20:21], s[62:63]
    v_exp_f32 v30, v30
    v_exp_f32 v31, v31
    v_pk_add_f32 v[22:23], v[22:23], s[62:63]
    v_exp_f32 v32, v32
    v_exp_f32 v33, v33
    v_pk_add_f32 v[24:25], v[24:25], s[62:63]
    v_exp_f32 v34, v34
    v_exp_f32 v35, v35
    v_pk_add_f32 v[26:27], v[26:27], s[62:63]
    v_rcp_f32 v20, v20
    v_rcp_f32 v21, v21
    v_pk_mul_f32 v[226:227], v[226:227], v[44:45]
    v_rcp_f32 v22, v22
    v_rcp_f32 v23, v23
    v_pk_mul_f32 v[230:231], v[230:231], v[46:47]
    v_rcp_f32 v24, v24
    v_rcp_f32 v25, v25
    v_pk_mul_f32 v[234:235], v[234:235], v[48:49]
    v_rcp_f32 v26, v26
    v_rcp_f32 v27, v27
    v_pk_mul_f32 v[238:239], v[238:239], v[50:51]
    v_pk_add_f32 v[28:29], v[28:29], s[62:63]
    v_pk_add_f32 v[30:31], v[30:31], s[62:63]
    v_pk_add_f32 v[32:33], v[32:33], s[62:63]
    v_pk_add_f32 v[34:35], v[34:35], s[62:63]
    v_rcp_f32 v28, v28
    v_rcp_f32 v29, v29
    v_pk_mul_f32 v[240:241], v[240:241], v[20:21]
    v_rcp_f32 v30, v30
    v_rcp_f32 v31, v31
    v_pk_mul_f32 v[244:245], v[244:245], v[22:23]
    v_rcp_f32 v32, v32
    v_rcp_f32 v33, v33
    v_pk_mul_f32 v[248:249], v[248:249], v[24:25]
    v_rcp_f32 v34, v34
    v_rcp_f32 v35, v35
    v_pk_mul_f32 v[252:253], v[252:253], v[26:27]
    v_pk_mul_f32 v[242:243], v[242:243], v[28:29]
    v_pk_mul_f32 v[246:247], v[246:247], v[30:31]
    v_pk_mul_f32 v[250:251], v[250:251], v[32:33]
    v_pk_mul_f32 v[254:255], v[254:255], v[34:35]
    v_cvt_pk_bf16_f32 v176, v176, v177
    v_cvt_pk_bf16_f32 v177, v178, v179
    v_cvt_pk_bf16_f32 v178, v180, v181
    v_cvt_pk_bf16_f32 v179, v182, v183
    v_cvt_pk_bf16_f32 v184, v184, v185
    v_cvt_pk_bf16_f32 v185, v186, v187
    v_cvt_pk_bf16_f32 v186, v188, v189
    v_cvt_pk_bf16_f32 v187, v190, v191
    v_cvt_pk_bf16_f32 v192, v192, v193
    v_cvt_pk_bf16_f32 v193, v194, v195
    v_cvt_pk_bf16_f32 v194, v196, v197
    v_cvt_pk_bf16_f32 v195, v198, v199
    v_cvt_pk_bf16_f32 v200, v200, v201
    v_cvt_pk_bf16_f32 v201, v202, v203
    v_cvt_pk_bf16_f32 v202, v204, v205
    v_cvt_pk_bf16_f32 v203, v206, v207
    v_cvt_pk_bf16_f32 v208, v208, v209
    v_cvt_pk_bf16_f32 v209, v210, v211
    v_cvt_pk_bf16_f32 v210, v212, v213
    v_cvt_pk_bf16_f32 v211, v214, v215
    v_cvt_pk_bf16_f32 v216, v216, v217
    v_cvt_pk_bf16_f32 v217, v218, v219
    v_cvt_pk_bf16_f32 v218, v220, v221
    v_cvt_pk_bf16_f32 v219, v222, v223
    v_cvt_pk_bf16_f32 v224, v224, v225
    v_cvt_pk_bf16_f32 v225, v226, v227
    v_cvt_pk_bf16_f32 v226, v228, v229
    v_cvt_pk_bf16_f32 v227, v230, v231
    v_cvt_pk_bf16_f32 v232, v232, v233
    v_cvt_pk_bf16_f32 v233, v234, v235
    v_cvt_pk_bf16_f32 v234, v236, v237
    v_cvt_pk_bf16_f32 v235, v238, v239
    v_cvt_pk_bf16_f32 v240, v240, v241
    v_cvt_pk_bf16_f32 v241, v242, v243
    v_cvt_pk_bf16_f32 v242, v244, v245
    v_cvt_pk_bf16_f32 v243, v246, v247
    v_cvt_pk_bf16_f32 v248, v248, v249
    v_cvt_pk_bf16_f32 v249, v250, v251
    v_cvt_pk_bf16_f32 v250, v252, v253
    v_cvt_pk_bf16_f32 v251, v254, v255
    v_lshlrev_b32 v11, 4, v0
    v_mov_b32 v12, 0x40000000
    s_add_u32 s52, s46, 0
    s_add_u32 s53, s48, 0
    s_add_u32 s54, s46, 1024
    s_add_u32 s55, s48, 1024
    s_add_u32 s56, s46, 2048
    s_add_u32 s57, s48, 2048
    s_add_u32 s58, s46, 3072
    s_add_u32 s59, s48, 3072
    s_add_u32 s47, s46, 4096
    s_add_u32 s49, s48, 4096
    s_mov_b32 s43, 0
    s_mov_b32 s44, 0
    s_nop 1
L_p3:
    s_cmp_eq_u32 s42, 0
    s_cbranch_scc1 L_wq_1_21
    s_waitcnt vmcnt(12)
    s_branch L_wd_1_22
L_wq_1_21:
    s_waitcnt vmcnt(13)
L_wd_1_22:
    s_barrier
    ds_read_b128 a[0:3], v8 offset:0
    ds_read_b128 a[4:7], v8 offset:2048
    ds_read_b64_tr_b16 a[8:9], v10 offset:0
    ds_read_b64_tr_b16 a[10:11], v10 offset:256
    ds_read_b64_tr_b16 a[12:13], v10 offset:1024
    ds_read_b64_tr_b16 a[14:15], v10 offset:1280
    ds_read_b64_tr_b16 a[16:17], v10 offset:2048
    ds_read_b64_tr_b16 a[18:19], v10 offset:2304
    ds_read_b64_tr_b16 a[20:21], v14 offset:3072
    ds_read_b64_tr_b16 a[22:23], v14 offset:3328
    ds_read_b64_tr_b16 a[24:25], v10 offset:4608
    ds_read_b64_tr_b16 a[26:27], v10 offset:4864
    ds_read_b64_tr_b16 a[28:29], v10 offset:5632
    ds_read_b64_tr_b16 a[30:31], v10 offset:5888
    ds_read_b64_tr_b16 a[32:33], v10 offset:6656
    ds_read_b64_tr_b16 a[34:35], v10 offset:6912
    s_waitcnt lgkmcnt(10)
    v_mfma_f32_16x16x32_bf16 v[64:67], a[8:11], a[0:3], 0
    ds_read_b128 a[36:39], v9 offset:0
    ds_read_b128 a[40:43], v9 offset:2048
    v_mfma_f32_16x16x32_bf16 v[68:71], a[8:11], a[4:7], 0
    ds_read_b64_tr_b16 a[44:45], v10 offset:8192
    v_mfma_f32_16x16x32_bf16 v[76:79], a[12:15], a[4:7], 0
    ds_read_b64_tr_b16 a[46:47], v10 offset:8448
    ds_read_b64_tr_b16 a[48:49], v10 offset:9216
    v_mfma_f32_16x16x32_bf16 v[72:75], a[12:15], a[0:3], 0
    ds_read_b64_tr_b16 a[50:51], v10 offset:9472
    s_waitcnt lgkmcnt(12)
    v_mfma_f32_16x16x32_bf16 v[80:83], a[16:19], a[0:3], 0
    ds_read_b64_tr_b16 a[52:53], v10 offset:10240
    ds_read_b64_tr_b16 a[54:55], v10 offset:10496
    v_mfma_f32_16x16x32_bf16 v[84:87], a[16:19], a[4:7], 0
    ds_read_b64_tr_b16 a[56:57], v14 offset:11264
    v_mfma_f32_16x16x32_bf16 v[92:95], a[20:23], a[4:7], 0
    ds_read_b64_tr_b16 a[58:59], v14 offset:11520
    ds_read_b64_tr_b16 a[60:61], v10 offset:12800
    v_mfma_f32_16x16x32_bf16 v[88:91], a[20:23], a[0:3], 0
    ds_read_b64_tr_b16 a[62:63], v10 offset:13056
    s_waitcnt lgkmcnt(12)
    v_mfma_f32_16x16x32_bf16 v[96:99], a[24:27], a[0:3], 0
    ds_read_b64_tr_b16 a[64:65], v10 offset:13824
    ds_read_b64_tr_b16 a[66:67], v10 offset:14080
    v_mfma_f32_16x16x32_bf16 v[100:103], a[24:27], a[4:7], 0
    ds_read_b64_tr_b16 a[68:69], v10 offset:14848
    v_mfma_f32_16x16x32_bf16 v[108:111], a[28:31], a[4:7], 0
    ds_read_b64_tr_b16 a[70:71], v10 offset:15104
    v_mfma_f32_16x16x32_bf16 v[104:107], a[28:31], a[0:3], 0
    v_mfma_f32_16x16x32_bf16 v[112:115], a[32:35], a[0:3], 0
    v_mfma_f32_16x16x32_bf16 v[116:119], a[32:35], a[4:7], 0
    s_waitcnt lgkmcnt(10)
    v_mfma_f32_16x16x32_bf16 v[64:67], a[44:47], a[36:39], v[64:67]
    v_mfma_f32_16x16x32_bf16 v[68:71], a[44:47], a[40:43], v[68:71]
    s_cmp_eq_u32 s42, 0
    s_cbranch_scc1 L_wq_1_23
    s_waitcnt vmcnt(8) lgkmcnt(0)
    s_branch L_wd_1_24
L_wq_1_23:
    s_waitcnt vmcnt(9) lgkmcnt(0)
L_wd_1_24:
    s_barrier
    v_mfma_f32_16x16x32_bf16 v[76:79], a[48:51], a[40:43], v[76:79]
    s_lshr_b32 s37, 0x3030307, s36
    s_and_b32 s37, s37, 0xff
    v_mfma_f32_16x16x32_bf16 v[72:75], a[48:51], a[36:39], v[72:75]
    s_lshl_b32 s26, s37, 7
    s_add_u32 m0, s24, 0
    v_mfma_f32_16x16x32_bf16 v[80:83], a[52:55], a[36:39], v[80:83]
    buffer_load_dwordx4 v2, s[8:11], s26 offen lds
    ds_read_b128 a[0:3], v8 offset:16384
    v_mfma_f32_16x16x32_bf16 v[84:87], a[52:55], a[40:43], v[84:87]
    ds_read_b128 a[4:7], v8 offset:18432
    ds_read_b64_tr_b16 a[8:9], v10 offset:16384
    v_mfma_f32_16x16x32_bf16 v[92:95], a[56:59], a[40:43], v[92:95]
    buffer_load_dwordx4 v3, s[8:11], s26 offen offset:1024 lds
    ds_read_b64_tr_b16 a[10:11], v10 offset:16640
    v_mfma_f32_16x16x32_bf16 v[88:91], a[56:59], a[36:39], v[88:91]
    ds_read_b64_tr_b16 a[12:13], v10 offset:17408
    ds_read_b64_tr_b16 a[14:15], v10 offset:17664
    v_mfma_f32_16x16x32_bf16 v[96:99], a[60:63], a[36:39], v[96:99]
    ds_read_b64_tr_b16 a[16:17], v10 offset:18432
    ds_read_b64_tr_b16 a[18:19], v10 offset:18688
    v_mfma_f32_16x16x32_bf16 v[100:103], a[60:63], a[40:43], v[100:103]
    ds_read_b64_tr_b16 a[20:21], v14 offset:19456
    ds_read_b64_tr_b16 a[22:23], v14 offset:19712
    v_mfma_f32_16x16x32_bf16 v[108:111], a[64:67], a[40:43], v[108:111]
    buffer_load_dwordx4 v4, s[8:11], s26 offen offset:2048 lds
    ds_read_b64_tr_b16 a[24:25], v10 offset:20992
    v_mfma_f32_16x16x32_bf16 v[104:107], a[64:67], a[36:39], v[104:107]
    ds_read_b64_tr_b16 a[26:27], v10 offset:21248
    ds_read_b64_tr_b16 a[28:29], v10 offset:22016
    v_mfma_f32_16x16x32_bf16 v[112:115], a[68:71], a[36:39], v[112:115]
    ds_read_b64_tr_b16 a[30:31], v10 offset:22272
    ds_read_b64_tr_b16 a[32:33], v10 offset:23040
    v_mfma_f32_16x16x32_bf16 v[116:119], a[68:71], a[40:43], v[116:119]
    buffer_load_dwordx4 v5, s[8:11], s26 offen offset:3072 lds
    ds_read_b64_tr_b16 a[34:35], v10 offset:23296
    s_waitcnt lgkmcnt(10)
    v_mfma_f32_16x16x32_bf16 v[64:67], a[8:11], a[0:3], v[64:67]
    ds_read_b128 a[36:39], v9 offset:16384
    ds_read_b128 a[40:43], v9 offset:18432
    v_mfma_f32_16x16x32_bf16 v[68:71], a[8:11], a[4:7], v[68:71]
    s_mul_i32 s27, s37, 229376
    ds_read_b64_tr_b16 a[44:45], v10 offset:24576
    v_mfma_f32_16x16x32_bf16 v[76:79], a[12:15], a[4:7], v[76:79]
    s_add_u32 m0, s25, 0
    ds_read_b64_tr_b16 a[46:47], v10 offset:24832
    v_mfma_f32_16x16x32_bf16 v[72:75], a[12:15], a[0:3], v[72:75]
    buffer_load_dwordx4 v6, s[20:23], s27 offen sc1 lds
    ds_read_b64_tr_b16 a[48:49], v10 offset:25600
    s_waitcnt lgkmcnt(11)
    v_mfma_f32_16x16x32_bf16 v[80:83], a[16:19], a[0:3], v[80:83]
    ds_read_b64_tr_b16 a[50:51], v10 offset:25856
    ds_read_b64_tr_b16 a[52:53], v10 offset:26624
    v_mfma_f32_16x16x32_bf16 v[84:87], a[16:19], a[4:7], v[84:87]
    ds_read_b64_tr_b16 a[54:55], v10 offset:26880
    ds_read_b64_tr_b16 a[56:57], v14 offset:27648
    v_mfma_f32_16x16x32_bf16 v[92:95], a[20:23], a[4:7], v[92:95]
    buffer_load_dwordx4 v6, s[20:23], s27 offen offset:1024 sc1 lds
    ds_read_b64_tr_b16 a[58:59], v14 offset:27904
    v_mfma_f32_16x16x32_bf16 v[88:91], a[20:23], a[0:3], v[88:91]
    ds_read_b64_tr_b16 a[60:61], v10 offset:29184
    ds_read_b64_tr_b16 a[62:63], v10 offset:29440
    s_waitcnt lgkmcnt(12)
    v_mfma_f32_16x16x32_bf16 v[96:99], a[24:27], a[0:3], v[96:99]
    ds_read_b64_tr_b16 a[64:65], v10 offset:30208
    ds_read_b64_tr_b16 a[66:67], v10 offset:30464
    v_mfma_f32_16x16x32_bf16 v[100:103], a[24:27], a[4:7], v[100:103]
    ds_read_b64_tr_b16 a[68:69], v10 offset:31232
    v_mfma_f32_16x16x32_bf16 v[108:111], a[28:31], a[4:7], v[108:111]
    buffer_load_dwordx4 v6, s[20:23], s27 offen offset:2048 sc1 lds
    ds_read_b64_tr_b16 a[70:71], v10 offset:31488
    v_mfma_f32_16x16x32_bf16 v[104:107], a[28:31], a[0:3], v[104:107]
    v_mfma_f32_16x16x32_bf16 v[112:115], a[32:35], a[0:3], v[112:115]
    v_mfma_f32_16x16x32_bf16 v[116:119], a[32:35], a[4:7], v[116:119]
    buffer_load_dwordx4 v15, s[20:23], s27 offen offset:3072 sc1 lds
    s_waitcnt lgkmcnt(10)
    v_mfma_f32_16x16x32_bf16 v[64:67], a[44:47], a[36:39], v[64:67]
    v_mfma_f32_16x16x32_bf16 v[68:71], a[44:47], a[40:43], v[68:71]
    s_cmp_eq_u32 s42, 0
    s_cbranch_scc1 L_wq_1_25
    s_waitcnt vmcnt(12) lgkmcnt(0)
    s_branch L_wd_1_26
L_wq_1_25:
    s_waitcnt vmcnt(13) lgkmcnt(0)
L_wd_1_26:
    s_barrier
    v_mfma_f32_16x16x32_bf16 v[76:79], a[48:51], a[40:43], v[76:79]
    s_lshr_b32 s37, 0x4040804, s36
    s_and_b32 s37, s37, 0xff
    v_mfma_f32_16x16x32_bf16 v[72:75], a[48:51], a[36:39], v[72:75]
    s_lshl_b32 s26, s37, 7
    s_add_u32 m0, s24, 16384
    v_mfma_f32_16x16x32_bf16 v[80:83], a[52:55], a[36:39], v[80:83]
    buffer_load_dwordx4 v2, s[8:11], s26 offen lds
    ds_read_b128 a[0:3], v8 offset:32768
    v_mfma_f32_16x16x32_bf16 v[84:87], a[52:55], a[40:43], v[84:87]
    ds_read_b128 a[4:7], v8 offset:34816
    ds_read_b64_tr_b16 a[8:9], v10 offset:32768
    v_mfma_f32_16x16x32_bf16 v[92:95], a[56:59], a[40:43], v[92:95]
    buffer_load_dwordx4 v3, s[8:11], s26 offen offset:1024 lds
    ds_read_b64_tr_b16 a[10:11], v10 offset:33024
    v_mfma_f32_16x16x32_bf16 v[88:91], a[56:59], a[36:39], v[88:91]
    ds_read_b64_tr_b16 a[12:13], v10 offset:33792
    ds_read_b64_tr_b16 a[14:15], v10 offset:34048
    v_mfma_f32_16x16x32_bf16 v[96:99], a[60:63], a[36:39], v[96:99]
    ds_read_b64_tr_b16 a[16:17], v10 offset:34816
    ds_read_b64_tr_b16 a[18:19], v10 offset:35072
    v_mfma_f32_16x16x32_bf16 v[100:103], a[60:63], a[40:43], v[100:103]
    ds_read_b64_tr_b16 a[20:21], v14 offset:35840
    ds_read_b64_tr_b16 a[22:23], v14 offset:36096
    v_mfma_f32_16x16x32_bf16 v[108:111], a[64:67], a[40:43], v[108:111]
    buffer_load_dwordx4 v4, s[8:11], s26 offen offset:2048 lds
    ds_read_b64_tr_b16 a[24:25], v10 offset:37376
    v_mfma_f32_16x16x32_bf16 v[104:107], a[64:67], a[36:39], v[104:107]
    ds_read_b64_tr_b16 a[26:27], v10 offset:37632
    ds_read_b64_tr_b16 a[28:29], v10 offset:38400
    v_mfma_f32_16x16x32_bf16 v[112:115], a[68:71], a[36:39], v[112:115]
    ds_read_b64_tr_b16 a[30:31], v10 offset:38656
    ds_read_b64_tr_b16 a[32:33], v10 offset:39424
    v_mfma_f32_16x16x32_bf16 v[116:119], a[68:71], a[40:43], v[116:119]
    buffer_load_dwordx4 v5, s[8:11], s26 offen offset:3072 lds
    ds_read_b64_tr_b16 a[34:35], v10 offset:39680
    s_waitcnt lgkmcnt(10)
    v_mfma_f32_16x16x32_bf16 v[64:67], a[8:11], a[0:3], v[64:67]
    ds_read_b128 a[36:39], v9 offset:32768
    ds_read_b128 a[40:43], v9 offset:34816
    buffer_store_dwordx4 v[176:179], v11, s[20:23], s52 offen sc1
    v_mfma_f32_16x16x32_bf16 v[68:71], a[8:11], a[4:7], v[68:71]
    s_mul_i32 s27, s37, 229376
    ds_read_b64_tr_b16 a[44:45], v10 offset:40960
    v_mfma_f32_16x16x32_bf16 v[76:79], a[12:15], a[4:7], v[76:79]
    s_add_u32 m0, s25, 16384
    ds_read_b64_tr_b16 a[46:47], v10 offset:41216
    v_mfma_f32_16x16x32_bf16 v[72:75], a[12:15], a[0:3], v[72:75]
    buffer_load_dwordx4 v6, s[20:23], s27 offen sc1 lds
    ds_read_b64_tr_b16 a[48:49], v10 offset:41984
    s_waitcnt lgkmcnt(11)
    v_mfma_f32_16x16x32_bf16 v[80:83], a[16:19], a[0:3], v[80:83]
    ds_read_b64_tr_b16 a[50:51], v10 offset:42240
    ds_read_b64_tr_b16 a[52:53], v10 offset:43008
    v_mfma_f32_16x16x32_bf16 v[84:87], a[16:19], a[4:7], v[84:87]
    ds_read_b64_tr_b16 a[54:55], v10 offset:43264
    ds_read_b64_tr_b16 a[56:57], v14 offset:44032
    v_mfma_f32_16x16x32_bf16 v[92:95], a[20:23], a[4:7], v[92:95]
    buffer_load_dwordx4 v6, s[20:23], s27 offen offset:1024 sc1 lds
    ds_read_b64_tr_b16 a[58:59], v14 offset:44288
    v_mfma_f32_16x16x32_bf16 v[88:91], a[20:23], a[0:3], v[88:91]
    ds_read_b64_tr_b16 a[60:61], v10 offset:45568
    ds_read_b64_tr_b16 a[62:63], v10 offset:45824
    s_waitcnt lgkmcnt(12)
    v_mfma_f32_16x16x32_bf16 v[96:99], a[24:27], a[0:3], v[96:99]
    ds_read_b64_tr_b16 a[64:65], v10 offset:46592
    ds_read_b64_tr_b16 a[66:67], v10 offset:46848
    v_mfma_f32_16x16x32_bf16 v[100:103], a[24:27], a[4:7], v[100:103]
    ds_read_b64_tr_b16 a[68:69], v10 offset:47616
    v_mfma_f32_16x16x32_bf16 v[108:111], a[28:31], a[4:7], v[108:111]
    buffer_load_dwordx4 v6, s[20:23], s27 offen offset:2048 sc1 lds
    ds_read_b64_tr_b16 a[70:71], v10 offset:47872
    v_mfma_f32_16x16x32_bf16 v[104:107], a[28:31], a[0:3], v[104:107]
    v_mfma_f32_16x16x32_bf16 v[112:115], a[32:35], a[0:3], v[112:115]
    v_mfma_f32_16x16x32_bf16 v[116:119], a[32:35], a[4:7], v[116:119]
    buffer_load_dwordx4 v15, s[20:23], s27 offen offset:3072 sc1 lds
    s_waitcnt lgkmcnt(10)
    v_mfma_f32_16x16x32_bf16 v[64:67], a[44:47], a[36:39], v[64:67]
    v_mfma_f32_16x16x32_bf16 v[68:71], a[44:47], a[40:43], v[68:71]
    s_cmp_eq_u32 s42, 0
    s_cbranch_scc1 L_wq_1_27
    s_waitcnt vmcnt(17) lgkmcnt(0)
    s_branch L_wd_1_28
L_wq_1_27:
    s_waitcnt vmcnt(18) lgkmcnt(0)
L_wd_1_28:
    s_barrier
    v_mfma_f32_16x16x32_bf16 v[76:79], a[48:51], a[40:43], v[76:79]
    s_lshr_b32 s37, 0x5090505, s36
    s_and_b32 s37, s37, 0xff
    v_mfma_f32_16x16x32_bf16 v[72:75], a[48:51], a[36:39], v[72:75]
    s_lshl_b32 s26, s37, 7
    s_add_u32 m0, s24, 32768
    v_mfma_f32_16x16x32_bf16 v[80:83], a[52:55], a[36:39], v[80:83]
    buffer_load_dwordx4 v2, s[8:11], s26 offen lds
    ds_read_b128 a[0:3], v8 offset:49152
    v_mfma_f32_16x16x32_bf16 v[84:87], a[52:55], a[40:43], v[84:87]
    ds_read_b128 a[4:7], v8 offset:51200
    ds_read_b64_tr_b16 a[8:9], v10 offset:49152
    v_mfma_f32_16x16x32_bf16 v[92:95], a[56:59], a[40:43], v[92:95]
    buffer_load_dwordx4 v3, s[8:11], s26 offen offset:1024 lds
    ds_read_b64_tr_b16 a[10:11], v10 offset:49408
    v_mfma_f32_16x16x32_bf16 v[88:91], a[56:59], a[36:39], v[88:91]
    ds_read_b64_tr_b16 a[12:13], v10 offset:50176
    ds_read_b64_tr_b16 a[14:15], v10 offset:50432
    buffer_store_dwordx4 v[184:187], v11, s[20:23], s53 offen sc1
    v_mfma_f32_16x16x32_bf16 v[96:99], a[60:63], a[36:39], v[96:99]
    ds_read_b64_tr_b16 a[16:17], v10 offset:51200
    ds_read_b64_tr_b16 a[18:19], v10 offset:51456
    v_mfma_f32_16x16x32_bf16 v[100:103], a[60:63], a[40:43], v[100:103]
    ds_read_b64_tr_b16 a[20:21], v14 offset:52224
    ds_read_b64_tr_b16 a[22:23], v14 offset:52480
    v_mfma_f32_16x16x32_bf16 v[108:111], a[64:67], a[40:43], v[108:111]
    buffer_load_dwordx4 v4, s[8:11], s26 offen offset:2048 lds
    ds_read_b64_tr_b16 a[24:25], v10 offset:53760
    v_mfma_f32_16x16x32_bf16 v[104:107], a[64:67], a[36:39], v[104:107]
    ds_read_b64_tr_b16 a[26:27], v10 offset:54016
    ds_read_b64_tr_b16 a[28:29], v10 offset:54784
    v_mfma_f32_16x16x32_bf16 v[112:115], a[68:71], a[36:39], v[112:115]
    ds_read_b64_tr_b16 a[30:31], v10 offset:55040
    ds_read_b64_tr_b16 a[32:33], v10 offset:55808
    v_mfma_f32_16x16x32_bf16 v[116:119], a[68:71], a[40:43], v[116:119]
    buffer_load_dwordx4 v5, s[8:11], s26 offen offset:3072 lds
    ds_read_b64_tr_b16 a[34:35], v10 offset:56064
    s_waitcnt lgkmcnt(10)
    v_mfma_f32_16x16x32_bf16 v[64:67], a[8:11], a[0:3], v[64:67]
    ds_read_b128 a[36:39], v9 offset:49152
    ds_read_b128 a[40:43], v9 offset:51200
    v_mfma_f32_16x16x32_bf16 v[68:71], a[8:11], a[4:7], v[68:71]
    s_mul_i32 s27, s37, 229376
    ds_read_b64_tr_b16 a[44:45], v10 offset:57344
    v_mfma_f32_16x16x32_bf16 v[76:79], a[12:15], a[4:7], v[76:79]
    s_add_u32 m0, s25, 32768
    ds_read_b64_tr_b16 a[46:47], v10 offset:57600
    v_mfma_f32_16x16x32_bf16 v[72:75], a[12:15], a[0:3], v[72:75]
    buffer_load_dwordx4 v6, s[20:23], s27 offen sc1 lds
    ds_read_b64_tr_b16 a[48:49], v10 offset:58368
    s_waitcnt lgkmcnt(11)
    v_mfma_f32_16x16x32_bf16 v[80:83], a[16:19], a[0:3], v[80:83]
    ds_read_b64_tr_b16 a[50:51], v10 offset:58624
    ds_read_b64_tr_b16 a[52:53], v10 offset:59392
    v_mfma_f32_16x16x32_bf16 v[84:87], a[16:19], a[4:7], v[84:87]
    ds_read_b64_tr_b16 a[54:55], v10 offset:59648
    ds_read_b64_tr_b16 a[56:57], v14 offset:60416
    v_mfma_f32_16x16x32_bf16 v[92:95], a[20:23], a[4:7], v[92:95]
    buffer_load_dwordx4 v6, s[20:23], s27 offen offset:1024 sc1 lds
    ds_read_b64_tr_b16 a[58:59], v14 offset:60672
    v_mfma_f32_16x16x32_bf16 v[88:91], a[20:23], a[0:3], v[88:91]
    ds_read_b64_tr_b16 a[60:61], v10 offset:61952
    ds_read_b64_tr_b16 a[62:63], v10 offset:62208
    s_waitcnt lgkmcnt(12)
    v_mfma_f32_16x16x32_bf16 v[96:99], a[24:27], a[0:3], v[96:99]
    ds_read_b64_tr_b16 a[64:65], v10 offset:62976
    ds_read_b64_tr_b16 a[66:67], v10 offset:63232
    v_mfma_f32_16x16x32_bf16 v[100:103], a[24:27], a[4:7], v[100:103]
    ds_read_b64_tr_b16 a[68:69], v10 offset:64000
    v_mfma_f32_16x16x32_bf16 v[108:111], a[28:31], a[4:7], v[108:111]
    buffer_load_dwordx4 v6, s[20:23], s27 offen offset:2048 sc1 lds
    ds_read_b64_tr_b16 a[70:71], v10 offset:64256
    v_mfma_f32_16x16x32_bf16 v[104:107], a[28:31], a[0:3], v[104:107]
    v_mfma_f32_16x16x32_bf16 v[112:115], a[32:35], a[0:3], v[112:115]
    v_mfma_f32_16x16x32_bf16 v[116:119], a[32:35], a[4:7], v[116:119]
    buffer_load_dwordx4 v15, s[20:23], s27 offen offset:3072 sc1 lds
    s_waitcnt lgkmcnt(10)
    v_mfma_f32_16x16x32_bf16 v[64:67], a[44:47], a[36:39], v[64:67]
    buffer_store_dwordx4 v[192:195], v11, s[20:23], s54 offen sc1
    v_mfma_f32_16x16x32_bf16 v[68:71], a[44:47], a[40:43], v[68:71]
    s_waitcnt vmcnt(19) lgkmcnt(0)
    s_barrier
    v_mfma_f32_16x16x32_bf16 v[76:79], a[48:51], a[40:43], v[76:79]
    s_lshr_b32 s37, 0xa060606, s36
    s_and_b32 s37, s37, 0xff
    v_mfma_f32_16x16x32_bf16 v[72:75], a[48:51], a[36:39], v[72:75]
    s_lshl_b32 s26, s37, 7
    s_add_u32 m0, s24, 49152
    v_mfma_f32_16x16x32_bf16 v[80:83], a[52:55], a[36:39], v[80:83]
    buffer_load_dwordx4 v2, s[8:11], s26 offen lds
    ds_read_b128 a[0:3], v8 offset:0
    v_mfma_f32_16x16x32_bf16 v[84:87], a[52:55], a[40:43], v[84:87]
    ds_read_b128 a[4:7], v8 offset:2048
    ds_read_b64_tr_b16 a[8:9], v10 offset:0
    v_mfma_f32_16x16x32_bf16 v[92:95], a[56:59], a[40:43], v[92:95]
    buffer_load_dwordx4 v3, s[8:11], s26 offen offset:1024 lds
    ds_read_b64_tr_b16 a[10:11], v10 offset:256
    v_mfma_f32_16x16x32_bf16 v[88:91], a[56:59], a[36:39], v[88:91]
    ds_read_b64_tr_b16 a[12:13], v10 offset:1024
    ds_read_b64_tr_b16 a[14:15], v10 offset:1280
    v_mfma_f32_16x16x32_bf16 v[96:99], a[60:63], a[36:39], v[96:99]
    ds_read_b64_tr_b16 a[16:17], v10 offset:2048
    ds_read_b64_tr_b16 a[18:19], v10 offset:2304
    v_mfma_f32_16x16x32_bf16 v[100:103], a[60:63], a[40:43], v[100:103]
    ds_read_b64_tr_b16 a[20:21], v14 offset:3072
    ds_read_b64_tr_b16 a[22:23], v14 offset:3328
    v_mfma_f32_16x16x32_bf16 v[108:111], a[64:67], a[40:43], v[108:111]
    buffer_load_dwordx4 v4, s[8:11], s26 offen offset:2048 lds
    ds_read_b64_tr_b16 a[24:25], v10 offset:4608
    v_mfma_f32_16x16x32_bf16 v[104:107], a[64:67], a[36:39], v[104:107]
    ds_read_b64_tr_b16 a[26:27], v10 offset:4864
    ds_read_b64_tr_b16 a[28:29], v10 offset:5632
    v_mfma_f32_16x16x32_bf16 v[112:115], a[68:71], a[36:39], v[112:115]
    ds_read_b64_tr_b16 a[30:31], v10 offset:5888
    ds_read_b64_tr_b16 a[32:33], v10 offset:6656
    v_mfma_f32_16x16x32_bf16 v[116:119], a[68:71], a[40:43], v[116:119]
    buffer_load_dwordx4 v5, s[8:11], s26 offen offset:3072 lds
    ds_read_b64_tr_b16 a[34:35], v10 offset:6912
    s_waitcnt lgkmcnt(10)
    v_mfma_f32_16x16x32_bf16 v[64:67], a[8:11], a[0:3], v[64:67]
    ds_read_b128 a[36:39], v9 offset:0
    ds_read_b128 a[40:43], v9 offset:2048
    v_mfma_f32_16x16x32_bf16 v[68:71], a[8:11], a[4:7], v[68:71]
    s_mul_i32 s27, s37, 229376
    ds_read_b64_tr_b16 a[44:45], v10 offset:8192
    v_mfma_f32_16x16x32_bf16 v[76:79], a[12:15], a[4:7], v[76:79]
    s_add_u32 m0, s25, 49152
    ds_read_b64_tr_b16 a[46:47], v10 offset:8448
    v_mfma_f32_16x16x32_bf16 v[72:75], a[12:15], a[0:3], v[72:75]
    buffer_load_dwordx4 v6, s[20:23], s27 offen sc1 lds
    ds_read_b64_tr_b16 a[48:49], v10 offset:9216
    s_waitcnt lgkmcnt(11)
    v_mfma_f32_16x16x32_bf16 v[80:83], a[16:19], a[0:3], v[80:83]
    ds_read_b64_tr_b16 a[50:51], v10 offset:9472
    ds_read_b64_tr_b16 a[52:53], v10 offset:10240
    v_mfma_f32_16x16x32_bf16 v[84:87], a[16:19], a[4:7], v[84:87]
    ds_read_b64_tr_b16 a[54:55], v10 offset:10496
    ds_read_b64_tr_b16 a[56:57], v14 offset:11264
    v_mfma_f32_16x16x32_bf16 v[92:95], a[20:23], a[4:7], v[92:95]
    buffer_load_dwordx4 v6, s[20:23], s27 offen offset:1024 sc1 lds
    ds_read_b64_tr_b16 a[58:59], v14 offset:11520
    v_mfma_f32_16x16x32_bf16 v[88:91], a[20:23], a[0:3], v[88:91]
    ds_read_b64_tr_b16 a[60:61], v10 offset:12800
    ds_read_b64_tr_b16 a[62:63], v10 offset:13056
    buffer_store_dwordx4 v[200:203], v11, s[20:23], s55 offen sc1
    s_waitcnt lgkmcnt(12)
    v_mfma_f32_16x16x32_bf16 v[96:99], a[24:27], a[0:3], v[96:99]
    ds_read_b64_tr_b16 a[64:65], v10 offset:13824
    ds_read_b64_tr_b16 a[66:67], v10 offset:14080
    v_mfma_f32_16x16x32_bf16 v[100:103], a[24:27], a[4:7], v[100:103]
    ds_read_b64_tr_b16 a[68:69], v10 offset:14848
    v_mfma_f32_16x16x32_bf16 v[108:111], a[28:31], a[4:7], v[108:111]
    buffer_load_dwordx4 v6, s[20:23], s27 offen offset:2048 sc1 lds
    ds_read_b64_tr_b16 a[70:71], v10 offset:15104
    v_mfma_f32_16x16x32_bf16 v[104:107], a[28:31], a[0:3], v[104:107]
    v_mfma_f32_16x16x32_bf16 v[112:115], a[32:35], a[0:3], v[112:115]
    v_mfma_f32_16x16x32_bf16 v[116:119], a[32:35], a[4:7], v[116:119]
    buffer_load_dwordx4 v15, s[20:23], s27 offen offset:3072 sc1 lds
    s_waitcnt lgkmcnt(10)
    v_mfma_f32_16x16x32_bf16 v[64:67], a[44:47], a[36:39], v[64:67]
    v_mfma_f32_16x16x32_bf16 v[68:71], a[44:47], a[40:43], v[68:71]
    s_waitcnt vmcnt(19) lgkmcnt(0)
    s_barrier
    v_mfma_f32_16x16x32_bf16 v[76:79], a[48:51], a[40:43], v[76:79]
    s_lshr_b32 s37, 0x707070b, s36
    s_and_b32 s37, s37, 0xff
    v_mfma_f32_16x16x32_bf16 v[72:75], a[48:51], a[36:39], v[72:75]
    s_lshl_b32 s26, s37, 7
    s_add_u32 m0, s24, 0
    v_mfma_f32_16x16x32_bf16 v[80:83], a[52:55], a[36:39], v[80:83]
    buffer_load_dwordx4 v2, s[8:11], s26 offen lds
    ds_read_b128 a[0:3], v8 offset:16384
    v_mfma_f32_16x16x32_bf16 v[84:87], a[52:55], a[40:43], v[84:87]
    ds_read_b128 a[4:7], v8 offset:18432
    ds_read_b64_tr_b16 a[8:9], v10 offset:16384
    v_mfma_f32_16x16x32_bf16 v[92:95], a[56:59], a[40:43], v[92:95]
    buffer_load_dwordx4 v3, s[8:11], s26 offen offset:1024 lds
    ds_read_b64_tr_b16 a[10:11], v10 offset:16640
    v_mfma_f32_16x16x32_bf16 v[88:91], a[56:59], a[36:39], v[88:91]
    ds_read_b64_tr_b16 a[12:13], v10 offset:17408
    ds_read_b64_tr_b16 a[14:15], v10 offset:17664
    v_mfma_f32_16x16x32_bf16 v[96:99], a[60:63], a[36:39], v[96:99]
    ds_read_b64_tr_b16 a[16:17], v10 offset:18432
    ds_read_b64_tr_b16 a[18:19], v10 offset:18688
    v_mfma_f32_16x16x32_bf16 v[100:103], a[60:63], a[40:43], v[100:103]
    ds_read_b64_tr_b16 a[20:21], v14 offset:19456
    ds_read_b64_tr_b16 a[22:23], v14 offset:19712
    v_mfma_f32_16x16x32_bf16 v[108:111], a[64:67], a[40:43], v[108:111]
    buffer_load_dwordx4 v4, s[8:11], s26 offen offset:2048 lds
    ds_read_b64_tr_b16 a[24:25], v10 offset:20992
    v_mfma_f32_16x16x32_bf16 v[104:107], a[64:67], a[36:39], v[104:107]
    ds_read_b64_tr_b16 a[26:27], v10 offset:21248
    ds_read_b64_tr_b16 a[28:29], v10 offset:22016
    v_mfma_f32_16x16x32_bf16 v[112:115], a[68:71], a[36:39], v[112:115]
    ds_read_b64_tr_b16 a[30:31], v10 offset:22272
    ds_read_b64_tr_b16 a[32:33], v10 offset:23040
    v_mfma_f32_16x16x32_bf16 v[116:119], a[68:71], a[40:43], v[116:119]
    buffer_load_dwordx4 v5, s[8:11], s26 offen offset:3072 lds
    ds_read_b64_tr_b16 a[34:35], v10 offset:23296
    s_waitcnt lgkmcnt(10)
    v_mfma_f32_16x16x32_bf16 v[64:67], a[8:11], a[0:3], v[64:67]
    ds_read_b128 a[36:39], v9 offset:16384
    ds_read_b128 a[40:43], v9 offset:18432
    buffer_store_dwordx4 v[208:211], v11, s[20:23], s56 offen sc1
    v_mfma_f32_16x16x32_bf16 v[68:71], a[8:11], a[4:7], v[68:71]
    s_mul_i32 s27, s37, 229376
    ds_read_b64_tr_b16 a[44:45], v10 offset:24576
    v_mfma_f32_16x16x32_bf16 v[76:79], a[12:15], a[4:7], v[76:79]
    s_add_u32 m0, s25, 0
    ds_read_b64_tr_b16 a[46:47], v10 offset:24832
    v_mfma_f32_16x16x32_bf16 v[72:75], a[12:15], a[0:3], v[72:75]
    buffer_load_dwordx4 v6, s[20:23], s27 offen sc1 lds
    ds_read_b64_tr_b16 a[48:49], v10 offset:25600
    s_waitcnt lgkmcnt(11)
    v_mfma_f32_16x16x32_bf16 v[80:83], a[16:19], a[0:3], v[80:83]
    ds_read_b64_tr_b16 a[50:51], v10 offset:25856
    ds_read_b64_tr_b16 a[52:53], v10 offset:26624
    v_mfma_f32_16x16x32_bf16 v[84:87], a[16:19], a[4:7], v[84:87]
    ds_read_b64_tr_b16 a[54:55], v10 offset:26880
    ds_read_b64_tr_b16 a[56:57], v14 offset:27648
    v_mfma_f32_16x16x32_bf16 v[92:95], a[20:23], a[4:7], v[92:95]
    buffer_load_dwordx4 v6, s[20:23], s27 offen offset:1024 sc1 lds
    ds_read_b64_tr_b16 a[58:59], v14 offset:27904
    v_mfma_f32_16x16x32_bf16 v[88:91], a[20:23], a[0:3], v[88:91]
    ds_read_b64_tr_b16 a[60:61], v10 offset:29184
    ds_read_b64_tr_b16 a[62:63], v10 offset:29440
    s_waitcnt lgkmcnt(12)
    v_mfma_f32_16x16x32_bf16 v[96:99], a[24:27], a[0:3], v[96:99]
    ds_read_b64_tr_b16 a[64:65], v10 offset:30208
    ds_read_b64_tr_b16 a[66:67], v10 offset:30464
    v_mfma_f32_16x16x32_bf16 v[100:103], a[24:27], a[4:7], v[100:103]
    ds_read_b64_tr_b16 a[68:69], v10 offset:31232
    v_mfma_f32_16x16x32_bf16 v[108:111], a[28:31], a[4:7], v[108:111]
    buffer_load_dwordx4 v6, s[20:23], s27 offen offset:2048 sc1 lds
    ds_read_b64_tr_b16 a[70:71], v10 offset:31488
    v_mfma_f32_16x16x32_bf16 v[104:107], a[28:31], a[0:3], v[104:107]
    v_mfma_f32_16x16x32_bf16 v[112:115], a[32:35], a[0:3], v[112:115]
    v_mfma_f32_16x16x32_bf16 v[116:119], a[32:35], a[4:7], v[116:119]
    buffer_load_dwordx4 v15, s[20:23], s27 offen offset:3072 sc1 lds
    s_waitcnt lgkmcnt(10)
    v_mfma_f32_16x16x32_bf16 v[64:67], a[44:47], a[36:39], v[64:67]
    v_mfma_f32_16x16x32_bf16 v[68:71], a[44:47], a[40:43], v[68:71]
    s_waitcnt vmcnt(19) lgkmcnt(0)
    s_barrier
    v_mfma_f32_16x16x32_bf16 v[76:79], a[48:51], a[40:43], v[76:79]
    s_lshr_b32 s37, 0x8080c08, s36
    s_and_b32 s37, s37, 0xff
    v_mfma_f32_16x16x32_bf16 v[72:75], a[48:51], a[36:39], v[72:75]
    s_lshl_b32 s26, s37, 7
    s_add_u32 m0, s24, 16384
    v_mfma_f32_16x16x32_bf16 v[80:83], a[52:55], a[36:39], v[80:83]
    buffer_load_dwordx4 v2, s[8:11], s26 offen lds
    ds_read_b128 a[0:3], v8 offset:32768
    v_mfma_f32_16x16x32_bf16 v[84:87], a[52:55], a[40:43], v[84:87]
    ds_read_b128 a[4:7], v8 offset:34816
    ds_read_b64_tr_b16 a[8:9], v10 offset:32768
    v_mfma_f32_16x16x32_bf16 v[92:95], a[56:59], a[40:43], v[92:95]
    buffer_load_dwordx4 v3, s[8:11], s26 offen offset:1024 lds
    ds_read_b64_tr_b16 a[10:11], v10 offset:33024
    v_mfma_f32_16x16x32_bf16 v[88:91], a[56:59], a[36:39], v[88:91]
    ds_read_b64_tr_b16 a[12:13], v10 offset:33792
    ds_read_b64_tr_b16 a[14:15], v10 offset:34048
    buffer_store_dwordx4 v[216:219], v11, s[20:23], s57 offen sc1
    v_mfma_f32_16x16x32_bf16 v[96:99], a[60:63], a[36:39], v[96:99]
    ds_read_b64_tr_b16 a[16:17], v10 offset:34816
    ds_read_b64_tr_b16 a[18:19], v10 offset:35072
    v_mfma_f32_16x16x32_bf16 v[100:103], a[60:63], a[40:43], v[100:103]
    ds_read_b64_tr_b16 a[20:21], v14 offset:35840
    ds_read_b64_tr_b16 a[22:23], v14 offset:36096
    v_mfma_f32_16x16x32_bf16 v[108:111], a[64:67], a[40:43], v[108:111]
    buffer_load_dwordx4 v4, s[8:11], s26 offen offset:2048 lds
    ds_read_b64_tr_b16 a[24:25], v10 offset:37376
    v_mfma_f32_16x16x32_bf16 v[104:107], a[64:67], a[36:39], v[104:107]
    ds_read_b64_tr_b16 a[26:27], v10 offset:37632
    ds_read_b64_tr_b16 a[28:29], v10 offset:38400
    v_mfma_f32_16x16x32_bf16 v[112:115], a[68:71], a[36:39], v[112:115]
    ds_read_b64_tr_b16 a[30:31], v10 offset:38656
    ds_read_b64_tr_b16 a[32:33], v10 offset:39424
    v_mfma_f32_16x16x32_bf16 v[116:119], a[68:71], a[40:43], v[116:119]
    buffer_load_dwordx4 v5, s[8:11], s26 offen offset:3072 lds
    ds_read_b64_tr_b16 a[34:35], v10 offset:39680
    s_waitcnt lgkmcnt(10)
    v_mfma_f32_16x16x32_bf16 v[64:67], a[8:11], a[0:3], v[64:67]
    ds_read_b128 a[36:39], v9 offset:32768
    ds_read_b128 a[40:43], v9 offset:34816
    v_mfma_f32_16x16x32_bf16 v[68:71], a[8:11], a[4:7], v[68:71]
    s_mul_i32 s27, s37, 229376
    ds_read_b64_tr_b16 a[44:45], v10 offset:40960
    v_mfma_f32_16x16x32_bf16 v[76:79], a[12:15], a[4:7], v[76:79]
    s_add_u32 m0, s25, 16384
    ds_read_b64_tr_b16 a[46:47], v10 offset:41216
    v_mfma_f32_16x16x32_bf16 v[72:75], a[12:15], a[0:3], v[72:75]
    buffer_load_dwordx4 v6, s[20:23], s27 offen sc1 lds
    ds_read_b64_tr_b16 a[48:49], v10 offset:41984
    s_waitcnt lgkmcnt(11)
    v_mfma_f32_16x16x32_bf16 v[80:83], a[16:19], a[0:3], v[80:83]
    ds_read_b64_tr_b16 a[50:51], v10 offset:42240
    ds_read_b64_tr_b16 a[52:53], v10 offset:43008
    v_mfma_f32_16x16x32_bf16 v[84:87], a[16:19], a[4:7], v[84:87]
    ds_read_b64_tr_b16 a[54:55], v10 offset:43264
    ds_read_b64_tr_b16 a[56:57], v14 offset:44032
    v_mfma_f32_16x16x32_bf16 v[92:95], a[20:23], a[4:7], v[92:95]
    buffer_load_dwordx4 v6, s[20:23], s27 offen offset:1024 sc1 lds
    ds_read_b64_tr_b16 a[58:59], v14 offset:44288
    v_mfma_f32_16x16x32_bf16 v[88:91], a[20:23], a[0:3], v[88:91]
    ds_read_b64_tr_b16 a[60:61], v10 offset:45568
    ds_read_b64_tr_b16 a[62:63], v10 offset:45824
    s_waitcnt lgkmcnt(12)
    v_mfma_f32_16x16x32_bf16 v[96:99], a[24:27], a[0:3], v[96:99]
    ds_read_b64_tr_b16 a[64:65], v10 offset:46592
    ds_read_b64_tr_b16 a[66:67], v10 offset:46848
    v_mfma_f32_16x16x32_bf16 v[100:103], a[24:27], a[4:7], v[100:103]
    ds_read_b64_tr_b16 a[68:69], v10 offset:47616
    v_mfma_f32_16x16x32_bf16 v[108:111], a[28:31], a[4:7], v[108:111]
    buffer_load_dwordx4 v6, s[20:23], s27 offen offset:2048 sc1 lds
    ds_read_b64_tr_b16 a[70:71], v10 offset:47872
    v_mfma_f32_16x16x32_bf16 v[104:107], a[28:31], a[0:3], v[104:107]
    v_mfma_f32_16x16x32_bf16 v[112:115], a[32:35], a[0:3], v[112:115]
    v_mfma_f32_16x16x32_bf16 v[116:119], a[32:35], a[4:7], v[116:119]
    buffer_load_dwordx4 v15, s[20:23], s27 offen offset:3072 sc1 lds
    s_waitcnt lgkmcnt(10)
    v_mfma_f32_16x16x32_bf16 v[64:67], a[44:47], a[36:39], v[64:67]
    buffer_store_dwordx4 v[224:227], v11, s[20:23], s58 offen sc1
    v_mfma_f32_16x16x32_bf16 v[68:71], a[44:47], a[40:43], v[68:71]
    s_waitcnt vmcnt(19) lgkmcnt(0)
    s_barrier
    v_mfma_f32_16x16x32_bf16 v[76:79], a[48:51], a[40:43], v[76:79]
    s_lshr_b32 s37, 0x90d0909, s36
    s_and_b32 s37, s37, 0xff
    v_mfma_f32_16x16x32_bf16 v[72:75], a[48:51], a[36:39], v[72:75]
    s_lshl_b32 s26, s37, 7
    s_add_u32 m0, s24, 32768
    v_mfma_f32_16x16x32_bf16 v[80:83], a[52:55], a[36:39], v[80:83]
    buffer_load_dwordx4 v2, s[8:11], s26 offen lds
    ds_read_b128 a[0:3], v8 offset:49152
    v_mfma_f32_16x16x32_bf16 v[84:87], a[52:55], a[40:43], v[84:87]
    ds_read_b128 a[4:7], v8 offset:51200
    ds_read_b64_tr_b16 a[8:9], v10 offset:49152
    v_mfma_f32_16x16x32_bf16 v[92:95], a[56:59], a[40:43], v[92:95]
    buffer_load_dwordx4 v3, s[8:11], s26 offen offset:1024 lds
    ds_read_b64_tr_b16 a[10:11], v10 offset:49408
    v_mfma_f32_16x16x32_bf16 v[88:91], a[56:59], a[36:39], v[88:91]
    ds_read_b64_tr_b16 a[12:13], v10 offset:50176
    ds_read_b64_tr_b16 a[14:15], v10 offset:50432
    v_mfma_f32_16x16x32_bf16 v[96:99], a[60:63], a[36:39], v[96:99]
    ds_read_b64_tr_b16 a[16:17], v10 offset:51200
    ds_read_b64_tr_b16 a[18:19], v10 offset:51456
    v_mfma_f32_16x16x32_bf16 v[100:103], a[60:63], a[40:43], v[100:103]
    ds_read_b64_tr_b16 a[20:21], v14 offset:52224
    ds_read_b64_tr_b16 a[22:23], v14 offset:52480
    v_mfma_f32_16x16x32_bf16 v[108:111], a[64:67], a[40:43], v[108:111]
    buffer_load_dwordx4 v4, s[8:11], s26 offen offset:2048 lds
    ds_read_b64_tr_b16 a[24:25], v10 offset:53760
    v_mfma_f32_16x16x32_bf16 v[104:107], a[64:67], a[36:39], v[104:107]
    ds_read_b64_tr_b16 a[26:27], v10 offset:54016
    ds_read_b64_tr_b16 a[28:29], v10 offset:54784
    v_mfma_f32_16x16x32_bf16 v[112:115], a[68:71], a[36:39], v[112:115]
    ds_read_b64_tr_b16 a[30:31], v10 offset:55040
    ds_read_b64_tr_b16 a[32:33], v10 offset:55808
    v_mfma_f32_16x16x32_bf16 v[116:119], a[68:71], a[40:43], v[116:119]
    buffer_load_dwordx4 v5, s[8:11], s26 offen offset:3072 lds
    ds_read_b64_tr_b16 a[34:35], v10 offset:56064
    s_waitcnt lgkmcnt(10)
    v_mfma_f32_16x16x32_bf16 v[64:67], a[8:11], a[0:3], v[64:67]
    ds_read_b128 a[36:39], v9 offset:49152
    ds_read_b128 a[40:43], v9 offset:51200
    v_mfma_f32_16x16x32_bf16 v[68:71], a[8:11], a[4:7], v[68:71]
    s_mul_i32 s27, s37, 229376
    ds_read_b64_tr_b16 a[44:45], v10 offset:57344
    v_mfma_f32_16x16x32_bf16 v[76:79], a[12:15], a[4:7], v[76:79]
    s_add_u32 m0, s25, 32768
    ds_read_b64_tr_b16 a[46:47], v10 offset:57600
    v_mfma_f32_16x16x32_bf16 v[72:75], a[12:15], a[0:3], v[72:75]
    buffer_load_dwordx4 v6, s[20:23], s27 offen sc1 lds
    ds_read_b64_tr_b16 a[48:49], v10 offset:58368
    s_waitcnt lgkmcnt(11)
    v_mfma_f32_16x16x32_bf16 v[80:83], a[16:19], a[0:3], v[80:83]
    ds_read_b64_tr_b16 a[50:51], v10 offset:58624
    ds_read_b64_tr_b16 a[52:53], v10 offset:59392
    v_mfma_f32_16x16x32_bf16 v[84:87], a[16:19], a[4:7], v[84:87]
    ds_read_b64_tr_b16 a[54:55], v10 offset:59648
    ds_read_b64_tr_b16 a[56:57], v14 offset:60416
    v_mfma_f32_16x16x32_bf16 v[92:95], a[20:23], a[4:7], v[92:95]
    buffer_load_dwordx4 v6, s[20:23], s27 offen offset:1024 sc1 lds
    ds_read_b64_tr_b16 a[58:59], v14 offset:60672
    v_mfma_f32_16x16x32_bf16 v[88:91], a[20:23], a[0:3], v[88:91]
    ds_read_b64_tr_b16 a[60:61], v10 offset:61952
    ds_read_b64_tr_b16 a[62:63], v10 offset:62208
    buffer_store_dwordx4 v[232:235], v11, s[20:23], s59 offen sc1
    s_waitcnt lgkmcnt(12)
    v_mfma_f32_16x16x32_bf16 v[96:99], a[24:27], a[0:3], v[96:99]
    ds_read_b64_tr_b16 a[64:65], v10 offset:62976
    ds_read_b64_tr_b16 a[66:67], v10 offset:63232
    v_mfma_f32_16x16x32_bf16 v[100:103], a[24:27], a[4:7], v[100:103]
    ds_read_b64_tr_b16 a[68:69], v10 offset:64000
    v_mfma_f32_16x16x32_bf16 v[108:111], a[28:31], a[4:7], v[108:111]
    buffer_load_dwordx4 v6, s[20:23], s27 offen offset:2048 sc1 lds
    ds_read_b64_tr_b16 a[70:71], v10 offset:64256
    v_mfma_f32_16x16x32_bf16 v[104:107], a[28:31], a[0:3], v[104:107]
    v_mfma_f32_16x16x32_bf16 v[112:115], a[32:35], a[0:3], v[112:115]
    v_mfma_f32_16x16x32_bf16 v[116:119], a[32:35], a[4:7], v[116:119]
    buffer_load_dwordx4 v15, s[20:23], s27 offen offset:3072 sc1 lds
    s_waitcnt lgkmcnt(10)
    v_mfma_f32_16x16x32_bf16 v[64:67], a[44:47], a[36:39], v[64:67]
    v_mfma_f32_16x16x32_bf16 v[68:71], a[44:47], a[40:43], v[68:71]
    s_waitcnt vmcnt(19) lgkmcnt(0)
    s_barrier
    v_mfma_f32_16x16x32_bf16 v[76:79], a[48:51], a[40:43], v[76:79]
    s_lshr_b32 s37, 0xe0a0a0a, s36
    s_and_b32 s37, s37, 0xff
    v_mfma_f32_16x16x32_bf16 v[72:75], a[48:51], a[36:39], v[72:75]
    s_lshl_b32 s26, s37, 7
    s_add_u32 m0, s24, 49152
    v_mfma_f32_16x16x32_bf16 v[80:83], a[52:55], a[36:39], v[80:83]
    buffer_load_dwordx4 v2, s[8:11], s26 offen lds
    ds_read_b128 a[0:3], v8 offset:0
    v_mfma_f32_16x16x32_bf16 v[84:87], a[52:55], a[40:43], v[84:87]
    ds_read_b128 a[4:7], v8 offset:2048
    ds_read_b64_tr_b16 a[8:9], v10 offset:0
    v_mfma_f32_16x16x32_bf16 v[92:95], a[56:59], a[40:43], v[92:95]
    buffer_load_dwordx4 v3, s[8:11], s26 offen offset:1024 lds
    ds_read_b64_tr_b16 a[10:11], v10 offset:256
    v_mfma_f32_16x16x32_bf16 v[88:91], a[56:59], a[36:39], v[88:91]
    ds_read_b64_tr_b16 a[12:13], v10 offset:1024
    ds_read_b64_tr_b16 a[14:15], v10 offset:1280
    v_mfma_f32_16x16x32_bf16 v[96:99], a[60:63], a[36:39], v[96:99]
    ds_read_b64_tr_b16 a[16:17], v10 offset:2048
    ds_read_b64_tr_b16 a[18:19], v10 offset:2304
    v_mfma_f32_16x16x32_bf16 v[100:103], a[60:63], a[40:43], v[100:103]
    ds_read_b64_tr_b16 a[20:21], v14 offset:3072
    ds_read_b64_tr_b16 a[22:23], v14 offset:3328
    v_mfma_f32_16x16x32_bf16 v[108:111], a[64:67], a[40:43], v[108:111]
    buffer_load_dwordx4 v4, s[8:11], s26 offen offset:2048 lds
    ds_read_b64_tr_b16 a[24:25], v10 offset:4608
    v_mfma_f32_16x16x32_bf16 v[104:107], a[64:67], a[36:39], v[104:107]
    ds_read_b64_tr_b16 a[26:27], v10 offset:4864
    ds_read_b64_tr_b16 a[28:29], v10 offset:5632
    v_mfma_f32_16x16x32_bf16 v[112:115], a[68:71], a[36:39], v[112:115]
    ds_read_b64_tr_b16 a[30:31], v10 offset:5888
    ds_read_b64_tr_b16 a[32:33], v10 offset:6656
    v_mfma_f32_16x16x32_bf16 v[116:119], a[68:71], a[40:43], v[116:119]
    buffer_load_dwordx4 v5, s[8:11], s26 offen offset:3072 lds
    ds_read_b64_tr_b16 a[34:35], v10 offset:6912
    s_waitcnt lgkmcnt(10)
    v_mfma_f32_16x16x32_bf16 v[64:67], a[8:11], a[0:3], v[64:67]
    ds_read_b128 a[36:39], v9 offset:0
    ds_read_b128 a[40:43], v9 offset:2048
    buffer_store_dwordx4 v[240:243], v11, s[20:23], s47 offen sc1
    v_mfma_f32_16x16x32_bf16 v[68:71], a[8:11], a[4:7], v[68:71]
    s_mul_i32 s27, s37, 229376
    ds_read_b64_tr_b16 a[44:45], v10 offset:8192
    v_mfma_f32_16x16x32_bf16 v[76:79], a[12:15], a[4:7], v[76:79]
    s_add_u32 m0, s25, 49152
    ds_read_b64_tr_b16 a[46:47], v10 offset:8448
    v_mfma_f32_16x16x32_bf16 v[72:75], a[12:15], a[0:3], v[72:75]
    buffer_load_dwordx4 v6, s[20:23], s27 offen sc1 lds
    ds_read_b64_tr_b16 a[48:49], v10 offset:9216
    s_waitcnt lgkmcnt(11)
    v_mfma_f32_16x16x32_bf16 v[80:83], a[16:19], a[0:3], v[80:83]
    ds_read_b64_tr_b16 a[50:51], v10 offset:9472
    ds_read_b64_tr_b16 a[52:53], v10 offset:10240
    v_mfma_f32_16x16x32_bf16 v[84:87], a[16:19], a[4:7], v[84:87]
    ds_read_b64_tr_b16 a[54:55], v10 offset:10496
    ds_read_b64_tr_b16 a[56:57], v14 offset:11264
    v_mfma_f32_16x16x32_bf16 v[92:95], a[20:23], a[4:7], v[92:95]
    buffer_load_dwordx4 v6, s[20:23], s27 offen offset:1024 sc1 lds
    ds_read_b64_tr_b16 a[58:59], v14 offset:11520
    v_mfma_f32_16x16x32_bf16 v[88:91], a[20:23], a[0:3], v[88:91]
    ds_read_b64_tr_b16 a[60:61], v10 offset:12800
    ds_read_b64_tr_b16 a[62:63], v10 offset:13056
    s_waitcnt lgkmcnt(12)
    v_mfma_f32_16x16x32_bf16 v[96:99], a[24:27], a[0:3], v[96:99]
    ds_read_b64_tr_b16 a[64:65], v10 offset:13824
    ds_read_b64_tr_b16 a[66:67], v10 offset:14080
    v_mfma_f32_16x16x32_bf16 v[100:103], a[24:27], a[4:7], v[100:103]
    ds_read_b64_tr_b16 a[68:69], v10 offset:14848
    v_mfma_f32_16x16x32_bf16 v[108:111], a[28:31], a[4:7], v[108:111]
    buffer_load_dwordx4 v6, s[20:23], s27 offen offset:2048 sc1 lds
    ds_read_b64_tr_b16 a[70:71], v10 offset:15104
    v_mfma_f32_16x16x32_bf16 v[104:107], a[28:31], a[0:3], v[104:107]
    v_mfma_f32_16x16x32_bf16 v[112:115], a[32:35], a[0:3], v[112:115]
    v_mfma_f32_16x16x32_bf16 v[116:119], a[32:35], a[4:7], v[116:119]
    buffer_load_dwordx4 v15, s[20:23], s27 offen offset:3072 sc1 lds
    s_waitcnt lgkmcnt(10)
    v_mfma_f32_16x16x32_bf16 v[64:67], a[44:47], a[36:39], v[64:67]
    v_mfma_f32_16x16x32_bf16 v[68:71], a[44:47], a[40:43], v[68:71]
    s_waitcnt vmcnt(19) lgkmcnt(0)
    s_barrier
    v_mfma_f32_16x16x32_bf16 v[76:79], a[48:51], a[40:43], v[76:79]
    s_lshr_b32 s37, 0xb0b0b0f, s36
    s_and_b32 s37, s37, 0xff
    v_mfma_f32_16x16x32_bf16 v[72:75], a[48:51], a[36:39], v[72:75]
    s_lshl_b32 s26, s37, 7
    s_add_u32 m0, s24, 0
    v_mfma_f32_16x16x32_bf16 v[80:83], a[52:55], a[36:39], v[80:83]
    buffer_load_dwordx4 v2, s[8:11], s26 offen lds
    ds_read_b128 a[0:3], v8 offset:16384
    v_mfma_f32_16x16x32_bf16 v[84:87], a[52:55], a[40:43], v[84:87]
    ds_read_b128 a[4:7], v8 offset:18432
    ds_read_b64_tr_b16 a[8:9], v10 offset:16384
    v_mfma_f32_16x16x32_bf16 v[92:95], a[56:59], a[40:43], v[92:95]
    buffer_load_dwordx4 v3, s[8:11], s26 offen offset:1024 lds
    ds_read_b64_tr_b16 a[10:11], v10 offset:16640
    v_mfma_f32_16x16x32_bf16 v[88:91], a[56:59], a[36:39], v[88:91]
    ds_read_b64_tr_b16 a[12:13], v10 offset:17408
    ds_read_b64_tr_b16 a[14:15], v10 offset:17664
    buffer_store_dwordx4 v[248:251], v11, s[20:23], s49 offen sc1
    v_mfma_f32_16x16x32_bf16 v[96:99], a[60:63], a[36:39], v[96:99]
    ds_read_b64_tr_b16 a[16:17], v10 offset:18432
    ds_read_b64_tr_b16 a[18:19], v10 offset:18688
    v_mfma_f32_16x16x32_bf16 v[100:103], a[60:63], a[40:43], v[100:103]
    ds_read_b64_tr_b16 a[20:21], v14 offset:19456
    ds_read_b64_tr_b16 a[22:23], v14 offset:19712
    v_mfma_f32_16x16x32_bf16 v[108:111], a[64:67], a[40:43], v[108:111]
    buffer_load_dwordx4 v4, s[8:11], s26 offen offset:2048 lds
    ds_read_b64_tr_b16 a[24:25], v10 offset:20992
    v_mfma_f32_16x16x32_bf16 v[104:107], a[64:67], a[36:39], v[104:107]
    ds_read_b64_tr_b16 a[26:27], v10 offset:21248
    ds_read_b64_tr_b16 a[28:29], v10 offset:22016
    v_mfma_f32_16x16x32_bf16 v[112:115], a[68:71], a[36:39], v[112:115]
    ds_read_b64_tr_b16 a[30:31], v10 offset:22272
    ds_read_b64_tr_b16 a[32:33], v10 offset:23040
    v_mfma_f32_16x16x32_bf16 v[116:119], a[68:71], a[40:43], v[116:119]
    buffer_load_dwordx4 v5, s[8:11], s26 offen offset:3072 lds
    ds_read_b64_tr_b16 a[34:35], v10 offset:23296
    s_waitcnt lgkmcnt(10)
    v_mfma_f32_16x16x32_bf16 v[64:67], a[8:11], a[0:3], v[64:67]
    ds_read_b128 a[36:39], v9 offset:16384
    ds_read_b128 a[40:43], v9 offset:18432
    v_mfma_f32_16x16x32_bf16 v[68:71], a[8:11], a[4:7], v[68:71]
    s_mul_i32 s27, s37, 229376
    ds_read_b64_tr_b16 a[44:45], v10 offset:24576
    v_mfma_f32_16x16x32_bf16 v[76:79], a[12:15], a[4:7], v[76:79]
    s_add_u32 m0, s25, 0
    ds_read_b64_tr_b16 a[46:47], v10 offset:24832
    v_mfma_f32_16x16x32_bf16 v[72:75], a[12:15], a[0:3], v[72:75]
    buffer_load_dwordx4 v6, s[20:23], s27 offen sc1 lds
    ds_read_b64_tr_b16 a[48:49], v10 offset:25600
    s_waitcnt lgkmcnt(11)
    v_mfma_f32_16x16x32_bf16 v[80:83], a[16:19], a[0:3], v[80:83]
    ds_read_b64_tr_b16 a[50:51], v10 offset:25856
    ds_read_b64_tr_b16 a[52:53], v10 offset:26624
    v_mfma_f32_16x16x32_bf16 v[84:87], a[16:19], a[4:7], v[84:87]
    ds_read_b64_tr_b16 a[54:55], v10 offset:26880
    ds_read_b64_tr_b16 a[56:57], v14 offset:27648
    v_mfma_f32_16x16x32_bf16 v[92:95], a[20:23], a[4:7], v[92:95]
    buffer_load_dwordx4 v6, s[20:23], s27 offen offset:1024 sc1 lds
    ds_read_b64_tr_b16 a[58:59], v14 offset:27904
    v_mfma_f32_16x16x32_bf16 v[88:91], a[20:23], a[0:3], v[88:91]
    ds_read_b64_tr_b16 a[60:61], v10 offset:29184
    ds_read_b64_tr_b16 a[62:63], v10 offset:29440
    s_waitcnt lgkmcnt(12)
    v_mfma_f32_16x16x32_bf16 v[96:99], a[24:27], a[0:3], v[96:99]
    ds_read_b64_tr_b16 a[64:65], v10 offset:30208
    ds_read_b64_tr_b16 a[66:67], v10 offset:30464
    v_mfma_f32_16x16x32_bf16 v[100:103], a[24:27], a[4:7], v[100:103]
    ds_read_b64_tr_b16 a[68:69], v10 offset:31232
    v_mfma_f32_16x16x32_bf16 v[108:111], a[28:31], a[4:7], v[108:111]
    buffer_load_dwordx4 v6, s[20:23], s27 offen offset:2048 sc1 lds
    ds_read_b64_tr_b16 a[70:71], v10 offset:31488
    v_mfma_f32_16x16x32_bf16 v[104:107], a[28:31], a[0:3], v[104:107]
    v_mfma_f32_16x16x32_bf16 v[112:115], a[32:35], a[0:3], v[112:115]
    v_mfma_f32_16x16x32_bf16 v[116:119], a[32:35], a[4:7], v[116:119]
    buffer_load_dwordx4 v15, s[20:23], s27 offen offset:3072 sc1 lds
    s_waitcnt lgkmcnt(10)
    v_mfma_f32_16x16x32_bf16 v[64:67], a[44:47], a[36:39], v[64:67]
    buffer_store_dwordx4 v[180:183], v12, s[20:23], s43 offen sc1
    v_mfma_f32_16x16x32_bf16 v[68:71], a[44:47], a[40:43], v[68:71]
    s_waitcnt vmcnt(19) lgkmcnt(0)
    s_barrier
    v_mfma_f32_16x16x32_bf16 v[76:79], a[48:51], a[40:43], v[76:79]
    s_lshr_b32 s37, 0xc0c100c, s36
    s_and_b32 s37, s37, 0xff
    v_mfma_f32_16x16x32_bf16 v[72:75], a[48:51], a[36:39], v[72:75]
    s_lshl_b32 s26, s37, 7
    s_add_u32 m0, s24, 16384
    v_mfma_f32_16x16x32_bf16 v[80:83], a[52:55], a[36:39], v[80:83]
    buffer_load_dwordx4 v2, s[8:11], s26 offen lds
    ds_read_b128 a[0:3], v8 offset:32768
    v_mfma_f32_16x16x32_bf16 v[84:87], a[52:55], a[40:43], v[84:87]
    ds_read_b128 a[4:7], v8 offset:34816
    ds_read_b64_tr_b16 a[8:9], v10 offset:32768
    v_mfma_f32_16x16x32_bf16 v[92:95], a[56:59], a[40:43], v[92:95]
    buffer_load_dwordx4 v3, s[8:11], s26 offen offset:1024 lds
    ds_read_b64_tr_b16 a[10:11], v10 offset:33024
    v_mfma_f32_16x16x32_bf16 v[88:91], a[56:59], a[36:39], v[88:91]
    ds_read_b64_tr_b16 a[12:13], v10 offset:33792
    ds_read_b64_tr_b16 a[14:15], v10 offset:34048
    v_mfma_f32_16x16x32_bf16 v[96:99], a[60:63], a[36:39], v[96:99]
    ds_read_b64_tr_b16 a[16:17], v10 offset:34816
    ds_read_b64_tr_b16 a[18:19], v10 offset:35072
    v_mfma_f32_16x16x32_bf16 v[100:103], a[60:63], a[40:43], v[100:103]
    ds_read_b64_tr_b16 a[20:21], v14 offset:35840
    ds_read_b64_tr_b16 a[22:23], v14 offset:36096
    v_mfma_f32_16x16x32_bf16 v[108:111], a[64:67], a[40:43], v[108:111]
    buffer_load_dwordx4 v4, s[8:11], s26 offen offset:2048 lds
    ds_read_b64_tr_b16 a[24:25], v10 offset:37376
    v_mfma_f32_16x16x32_bf16 v[104:107], a[64:67], a[36:39], v[104:107]
    ds_read_b64_tr_b16 a[26:27], v10 offset:37632
    ds_read_b64_tr_b16 a[28:29], v10 offset:38400
    v_mfma_f32_16x16x32_bf16 v[112:115], a[68:71], a[36:39], v[112:115]
    ds_read_b64_tr_b16 a[30:31], v10 offset:38656
    ds_read_b64_tr_b16 a[32:33], v10 offset:39424
    v_mfma_f32_16x16x32_bf16 v[116:119], a[68:71], a[40:43], v[116:119]
    buffer_load_dwordx4 v5, s[8:11], s26 offen offset:3072 lds
    ds_read_b64_tr_b16 a[34:35], v10 offset:39680
    s_waitcnt lgkmcnt(10)
    v_mfma_f32_16x16x32_bf16 v[64:67], a[8:11], a[0:3], v[64:67]
    ds_read_b128 a[36:39], v9 offset:32768
    ds_read_b128 a[40:43], v9 offset:34816
    v_mfma_f32_16x16x32_bf16 v[68:71], a[8:11], a[4:7], v[68:71]
    s_mul_i32 s27, s37, 229376
    ds_read_b64_tr_b16 a[44:45], v10 offset:40960
    v_mfma_f32_16x16x32_bf16 v[76:79], a[12:15], a[4:7], v[76:79]
    s_add_u32 m0, s25, 16384
    ds_read_b64_tr_b16 a[46:47], v10 offset:41216
    v_mfma_f32_16x16x32_bf16 v[72:75], a[12:15], a[0:3], v[72:75]
    buffer_load_dwordx4 v6, s[20:23], s27 offen sc1 lds
    ds_read_b64_tr_b16 a[48:49], v10 offset:41984
    s_waitcnt lgkmcnt(11)
    v_mfma_f32_16x16x32_bf16 v[80:83], a[16:19], a[0:3], v[80:83]
    ds_read_b64_tr_b16 a[50:51], v10 offset:42240
    ds_read_b64_tr_b16 a[52:53], v10 offset:43008
    v_mfma_f32_16x16x32_bf16 v[84:87], a[16:19], a[4:7], v[84:87]
    ds_read_b64_tr_b16 a[54:55], v10 offset:43264
    ds_read_b64_tr_b16 a[56:57], v14 offset:44032
    v_mfma_f32_16x16x32_bf16 v[92:95], a[20:23], a[4:7], v[92:95]
    buffer_load_dwordx4 v6, s[20:23], s27 offen offset:1024 sc1 lds
    ds_read_b64_tr_b16 a[58:59], v14 offset:44288
    v_mfma_f32_16x16x32_bf16 v[88:91], a[20:23], a[0:3], v[88:91]
    ds_read_b64_tr_b16 a[60:61], v10 offset:45568
    ds_read_b64_tr_b16 a[62:63], v10 offset:45824
    buffer_store_dwordx4 v[188:191], v12, s[20:23], s44 offen sc1
    s_waitcnt lgkmcnt(12)
    v_mfma_f32_16x16x32_bf16 v[96:99], a[24:27], a[0:3], v[96:99]
    ds_read_b64_tr_b16 a[64:65], v10 offset:46592
    ds_read_b64_tr_b16 a[66:67], v10 offset:46848
    v_mfma_f32_16x16x32_bf16 v[100:103], a[24:27], a[4:7], v[100:103]
    ds_read_b64_tr_b16 a[68:69], v10 offset:47616
    v_mfma_f32_16x16x32_bf16 v[108:111], a[28:31], a[4:7], v[108:111]
    buffer_load_dwordx4 v6, s[20:23], s27 offen offset:2048 sc1 lds
    ds_read_b64_tr_b16 a[70:71], v10 offset:47872
    v_mfma_f32_16x16x32_bf16 v[104:107], a[28:31], a[0:3], v[104:107]
    v_mfma_f32_16x16x32_bf16 v[112:115], a[32:35], a[0:3], v[112:115]
    v_mfma_f32_16x16x32_bf16 v[116:119], a[32:35], a[4:7], v[116:119]
    buffer_load_dwordx4 v15, s[20:23], s27 offen offset:3072 sc1 lds
    s_waitcnt lgkmcnt(10)
    v_mfma_f32_16x16x32_bf16 v[64:67], a[44:47], a[36:39], v[64:67]
    v_mfma_f32_16x16x32_bf16 v[68:71], a[44:47], a[40:43], v[68:71]
    s_waitcnt vmcnt(19) lgkmcnt(0)
    s_barrier
    v_mfma_f32_16x16x32_bf16 v[76:79], a[48:51], a[40:43], v[76:79]
    s_lshr_b32 s37, 0xd110d0d, s36
    s_and_b32 s37, s37, 0xff
    v_mfma_f32_16x16x32_bf16 v[72:75], a[48:51], a[36:39], v[72:75]
    s_lshl_b32 s26, s37, 7
    s_add_u32 m0, s24, 32768
    v_mfma_f32_16x16x32_bf16 v[80:83], a[52:55], a[36:39], v[80:83]
    buffer_load_dwordx4 v2, s[8:11], s26 offen lds
    ds_read_b128 a[0:3], v8 offset:49152
    v_mfma_f32_16x16x32_bf16 v[84:87], a[52:55], a[40:43], v[84:87]
    ds_read_b128 a[4:7], v8 offset:51200
    ds_read_b64_tr_b16 a[8:9], v10 offset:49152
    v_mfma_f32_16x16x32_bf16 v[92:95], a[56:59], a[40:43], v[92:95]
    buffer_load_dwordx4 v3, s[8:11], s26 offen offset:1024 lds
    ds_read_b64_tr_b16 a[10:11], v10 offset:49408
    v_mfma_f32_16x16x32_bf16 v[88:91], a[56:59], a[36:39], v[88:91]
    ds_read_b64_tr_b16 a[12:13], v10 offset:50176
    ds_read_b64_tr_b16 a[14:15], v10 offset:50432
    v_mfma_f32_16x16x32_bf16 v[96:99], a[60:63], a[36:39], v[96:99]
    ds_read_b64_tr_b16 a[16:17], v10 offset:51200
    ds_read_b64_tr_b16 a[18:19], v10 offset:51456
    v_mfma_f32_16x16x32_bf16 v[100:103], a[60:63], a[40:43], v[100:103]
    ds_read_b64_tr_b16 a[20:21], v14 offset:52224
    ds_read_b64_tr_b16 a[22:23], v14 offset:52480
    v_mfma_f32_16x16x32_bf16 v[108:111], a[64:67], a[40:43], v[108:111]
    buffer_load_dwordx4 v4, s[8:11], s26 offen offset:2048 lds
    ds_read_b64_tr_b16 a[24:25], v10 offset:53760
    v_mfma_f32_16x16x32_bf16 v[104:107], a[64:67], a[36:39], v[104:107]
    ds_read_b64_tr_b16 a[26:27], v10 offset:54016
    ds_read_b64_tr_b16 a[28:29], v10 offset:54784
    v_mfma_f32_16x16x32_bf16 v[112:115], a[68:71], a[36:39], v[112:115]
    ds_read_b64_tr_b16 a[30:31], v10 offset:55040
    ds_read_b64_tr_b16 a[32:33], v10 offset:55808
    v_mfma_f32_16x16x32_bf16 v[116:119], a[68:71], a[40:43], v[116:119]
    buffer_load_dwordx4 v5, s[8:11], s26 offen offset:3072 lds
    ds_read_b64_tr_b16 a[34:35], v10 offset:56064
    s_waitcnt lgkmcnt(10)
    v_mfma_f32_16x16x32_bf16 v[64:67], a[8:11], a[0:3], v[64:67]
    ds_read_b128 a[36:39], v9 offset:49152
    ds_read_b128 a[40:43], v9 offset:51200
    v_mfma_f32_16x16x32_bf16 v[68:71], a[8:11], a[4:7], v[68:71]
    s_mul_i32 s27, s37, 229376
    ds_read_b64_tr_b16 a[44:45], v10 offset:57344
    v_mfma_f32_16x16x32_bf16 v[76:79], a[12:15], a[4:7], v[76:79]
    s_add_u32 m0, s25, 32768
    ds_read_b64_tr_b16 a[46:47], v10 offset:57600
    v_mfma_f32_16x16x32_bf16 v[72:75], a[12:15], a[0:3], v[72:75]
    buffer_load_dwordx4 v6, s[20:23], s27 offen sc1 lds
    ds_read_b64_tr_b16 a[48:49], v10 offset:58368
    s_waitcnt lgkmcnt(11)
    v_mfma_f32_16x16x32_bf16 v[80:83], a[16:19], a[0:3], v[80:83]
    ds_read_b64_tr_b16 a[50:51], v10 offset:58624
    ds_read_b64_tr_b16 a[52:53], v10 offset:59392
    v_mfma_f32_16x16x32_bf16 v[84:87], a[16:19], a[4:7], v[84:87]
    ds_read_b64_tr_b16 a[54:55], v10 offset:59648
    ds_read_b64_tr_b16 a[56:57], v14 offset:60416
    v_mfma_f32_16x16x32_bf16 v[92:95], a[20:23], a[4:7], v[92:95]
    buffer_load_dwordx4 v6, s[20:23], s27 offen offset:1024 sc1 lds
    ds_read_b64_tr_b16 a[58:59], v14 offset:60672
    v_mfma_f32_16x16x32_bf16 v[88:91], a[20:23], a[0:3], v[88:91]
    ds_read_b64_tr_b16 a[60:61], v10 offset:61952
    ds_read_b64_tr_b16 a[62:63], v10 offset:62208
    s_waitcnt lgkmcnt(12)
    v_mfma_f32_16x16x32_bf16 v[96:99], a[24:27], a[0:3], v[96:99]
    ds_read_b64_tr_b16 a[64:65], v10 offset:62976
    ds_read_b64_tr_b16 a[66:67], v10 offset:63232
    v_mfma_f32_16x16x32_bf16 v[100:103], a[24:27], a[4:7], v[100:103]
    ds_read_b64_tr_b16 a[68:69], v10 offset:64000
    v_mfma_f32_16x16x32_bf16 v[108:111], a[28:31], a[4:7], v[108:111]
    buffer_load_dwordx4 v6, s[20:23], s27 offen offset:2048 sc1 lds
    ds_read_b64_tr_b16 a[70:71], v10 offset:64256
    v_mfma_f32_16x16x32_bf16 v[104:107], a[28:31], a[0:3], v[104:107]
    v_mfma_f32_16x16x32_bf16 v[112:115], a[32:35], a[0:3], v[112:115]
    v_mfma_f32_16x16x32_bf16 v[116:119], a[32:35], a[4:7], v[116:119]
    buffer_load_dwordx4 v15, s[20:23], s27 offen offset:3072 sc1 lds
    s_waitcnt lgkmcnt(10)
    v_mfma_f32_16x16x32_bf16 v[64:67], a[44:47], a[36:39], v[64:67]
    v_mfma_f32_16x16x32_bf16 v[68:71], a[44:47], a[40:43], v[68:71]
    s_waitcnt vmcnt(18) lgkmcnt(0)
    s_barrier
    v_mfma_f32_16x16x32_bf16 v[76:79], a[48:51], a[40:43], v[76:79]
    s_lshr_b32 s37, 0x120e0e0e, s36
    s_and_b32 s37, s37, 0xff
    v_mfma_f32_16x16x32_bf16 v[72:75], a[48:51], a[36:39], v[72:75]
    s_lshl_b32 s26, s37, 7
    s_add_u32 m0, s24, 49152
    v_mfma_f32_16x16x32_bf16 v[80:83], a[52:55], a[36:39], v[80:83]
    buffer_load_dwordx4 v2, s[8:11], s26 offen lds
    ds_read_b128 a[0:3], v8 offset:0
    v_mfma_f32_16x16x32_bf16 v[84:87], a[52:55], a[40:43], v[84:87]
    ds_read_b128 a[4:7], v8 offset:2048
    ds_read_b64_tr_b16 a[8:9], v10 offset:0
    v_mfma_f32_16x16x32_bf16 v[92:95], a[56:59], a[40:43], v[92:95]
    buffer_load_dwordx4 v3, s[8:11], s26 offen offset:1024 lds
    ds_read_b64_tr_b16 a[10:11], v10 offset:256
    v_mfma_f32_16x16x32_bf16 v[88:91], a[56:59], a[36:39], v[88:91]
    ds_read_b64_tr_b16 a[12:13], v10 offset:1024
    ds_read_b64_tr_b16 a[14:15], v10 offset:1280
    v_mfma_f32_16x16x32_bf16 v[96:99], a[60:63], a[36:39], v[96:99]
    ds_read_b64_tr_b16 a[16:17], v10 offset:2048
    ds_read_b64_tr_b16 a[18:19], v10 offset:2304
    v_mfma_f32_16x16x32_bf16 v[100:103], a[60:63], a[40:43], v[100:103]
    ds_read_b64_tr_b16 a[20:21], v14 offset:3072
    ds_read_b64_tr_b16 a[22:23], v14 offset:3328
    v_mfma_f32_16x16x32_bf16 v[108:111], a[64:67], a[40:43], v[108:111]
    buffer_load_dwordx4 v4, s[8:11], s26 offen offset:2048 lds
    ds_read_b64_tr_b16 a[24:25], v10 offset:4608
    v_mfma_f32_16x16x32_bf16 v[104:107], a[64:67], a[36:39], v[104:107]
    ds_read_b64_tr_b16 a[26:27], v10 offset:4864
    ds_read_b64_tr_b16 a[28:29], v10 offset:5632
    v_mfma_f32_16x16x32_bf16 v[112:115], a[68:71], a[36:39], v[112:115]
    ds_read_b64_tr_b16 a[30:31], v10 offset:5888
    ds_read_b64_tr_b16 a[32:33], v10 offset:6656
    v_mfma_f32_16x16x32_bf16 v[116:119], a[68:71], a[40:43], v[116:119]
    buffer_load_dwordx4 v5, s[8:11], s26 offen offset:3072 lds
    ds_read_b64_tr_b16 a[34:35], v10 offset:6912
    s_waitcnt lgkmcnt(10)
    v_mfma_f32_16x16x32_bf16 v[64:67], a[8:11], a[0:3], v[64:67]
    ds_read_b128 a[36:39], v9 offset:0
    ds_read_b128 a[40:43], v9 offset:2048
    v_mfma_f32_16x16x32_bf16 v[68:71], a[8:11], a[4:7], v[68:71]
    s_mul_i32 s27, s37, 229376
    ds_read_b64_tr_b16 a[44:45], v10 offset:8192
    v_mfma_f32_16x16x32_bf16 v[76:79], a[12:15], a[4:7], v[76:79]
    s_add_u32 m0, s25, 49152
    ds_read_b64_tr_b16 a[46:47], v10 offset:8448
    v_mfma_f32_16x16x32_bf16 v[72:75], a[12:15], a[0:3], v[72:75]
    buffer_load_dwordx4 v6, s[20:23], s27 offen sc1 lds
    ds_read_b64_tr_b16 a[48:49], v10 offset:9216
    s_waitcnt lgkmcnt(11)
    v_mfma_f32_16x16x32_bf16 v[80:83], a[16:19], a[0:3], v[80:83]
    ds_read_b64_tr_b16 a[50:51], v10 offset:9472
    ds_read_b64_tr_b16 a[52:53], v10 offset:10240
    v_mfma_f32_16x16x32_bf16 v[84:87], a[16:19], a[4:7], v[84:87]
    ds_read_b64_tr_b16 a[54:55], v10 offset:10496
    ds_read_b64_tr_b16 a[56:57], v14 offset:11264
    v_mfma_f32_16x16x32_bf16 v[92:95], a[20:23], a[4:7], v[92:95]
    buffer_load_dwordx4 v6, s[20:23], s27 offen offset:1024 sc1 lds
    ds_read_b64_tr_b16 a[58:59], v14 offset:11520
    v_mfma_f32_16x16x32_bf16 v[88:91], a[20:23], a[0:3], v[88:91]
    ds_read_b64_tr_b16 a[60:61], v10 offset:12800
    ds_read_b64_tr_b16 a[62:63], v10 offset:13056
    s_waitcnt lgkmcnt(12)
    v_mfma_f32_16x16x32_bf16 v[96:99], a[24:27], a[0:3], v[96:99]
    ds_read_b64_tr_b16 a[64:65], v10 offset:13824
    ds_read_b64_tr_b16 a[66:67], v10 offset:14080
    v_mfma_f32_16x16x32_bf16 v[100:103], a[24:27], a[4:7], v[100:103]
    ds_read_b64_tr_b16 a[68:69], v10 offset:14848
    v_mfma_f32_16x16x32_bf16 v[108:111], a[28:31], a[4:7], v[108:111]
    buffer_load_dwordx4 v6, s[20:23], s27 offen offset:2048 sc1 lds
    ds_read_b64_tr_b16 a[70:71], v10 offset:15104
    v_mfma_f32_16x16x32_bf16 v[104:107], a[28:31], a[0:3], v[104:107]
    v_mfma_f32_16x16x32_bf16 v[112:115], a[32:35], a[0:3], v[112:115]
    v_mfma_f32_16x16x32_bf16 v[116:119], a[32:35], a[4:7], v[116:119]
    buffer_load_dwordx4 v15, s[20:23], s27 offen offset:3072 sc1 lds
    s_waitcnt lgkmcnt(10)
    v_mfma_f32_16x16x32_bf16 v[64:67], a[44:47], a[36:39], v[64:67]
    v_mfma_f32_16x16x32_bf16 v[68:71], a[44:47], a[40:43], v[68:71]
    s_waitcnt vmcnt(16) lgkmcnt(0)
    s_barrier
    v_mfma_f32_16x16x32_bf16 v[76:79], a[48:51], a[40:43], v[76:79]
    s_lshr_b32 s37, 0xf0f0f13, s36
    s_and_b32 s37, s37, 0xff
    v_mfma_f32_16x16x32_bf16 v[72:75], a[48:51], a[36:39], v[72:75]
    s_lshl_b32 s26, s37, 7
    s_add_u32 m0, s24, 0
    v_mfma_f32_16x16x32_bf16 v[80:83], a[52:55], a[36:39], v[80:83]
    buffer_load_dwordx4 v2, s[8:11], s26 offen lds
    ds_read_b128 a[0:3], v8 offset:16384
    v_mfma_f32_16x16x32_bf16 v[84:87], a[52:55], a[40:43], v[84:87]
    ds_read_b128 a[4:7], v8 offset:18432
    ds_read_b64_tr_b16 a[8:9], v10 offset:16384
    v_mfma_f32_16x16x32_bf16 v[92:95], a[56:59], a[40:43], v[92:95]
    buffer_load_dwordx4 v3, s[8:11], s26 offen offset:1024 lds
    ds_read_b64_tr_b16 a[10:11], v10 offset:16640
    v_mfma_f32_16x16x32_bf16 v[88:91], a[56:59], a[36:39], v[88:91]
    ds_read_b64_tr_b16 a[12:13], v10 offset:17408
    ds_read_b64_tr_b16 a[14:15], v10 offset:17664
    v_mfma_f32_16x16x32_bf16 v[96:99], a[60:63], a[36:39], v[96:99]
    ds_read_b64_tr_b16 a[16:17], v10 offset:18432
    ds_read_b64_tr_b16 a[18:19], v10 offset:18688
    v_mfma_f32_16x16x32_bf16 v[100:103], a[60:63], a[40:43], v[100:103]
    ds_read_b64_tr_b16 a[20:21], v14 offset:19456
    ds_read_b64_tr_b16 a[22:23], v14 offset:19712
    v_mfma_f32_16x16x32_bf16 v[108:111], a[64:67], a[40:43], v[108:111]
    buffer_load_dwordx4 v4, s[8:11], s26 offen offset:2048 lds
    ds_read_b64_tr_b16 a[24:25], v10 offset:20992
    v_mfma_f32_16x16x32_bf16 v[104:107], a[64:67], a[36:39], v[104:107]
    ds_read_b64_tr_b16 a[26:27], v10 offset:21248
    ds_read_b64_tr_b16 a[28:29], v10 offset:22016
    v_mfma_f32_16x16x32_bf16 v[112:115], a[68:71], a[36:39], v[112:115]
    ds_read_b64_tr_b16 a[30:31], v10 offset:22272
    ds_read_b64_tr_b16 a[32:33], v10 offset:23040
    v_mfma_f32_16x16x32_bf16 v[116:119], a[68:71], a[40:43], v[116:119]
    buffer_load_dwordx4 v5, s[8:11], s26 offen offset:3072 lds
    ds_read_b64_tr_b16 a[34:35], v10 offset:23296
    s_waitcnt lgkmcnt(10)
    v_mfma_f32_16x16x32_bf16 v[64:67], a[8:11], a[0:3], v[64:67]
    ds_read_b128 a[36:39], v9 offset:16384
    ds_read_b128 a[40:43], v9 offset:18432
    v_mfma_f32_16x16x32_bf16 v[68:71], a[8:11], a[4:7], v[68:71]
    s_mul_i32 s27, s37, 229376
    ds_read_b64_tr_b16 a[44:45], v10 offset:24576
    v_mfma_f32_16x16x32_bf16 v[76:79], a[12:15], a[4:7], v[76:79]
    s_add_u32 m0, s25, 0
    ds_read_b64_tr_b16 a[46:47], v10 offset:24832
    v_mfma_f32_16x16x32_bf16 v[72:75], a[12:15], a[0:3], v[72:75]
    buffer_load_dwordx4 v6, s[20:23], s27 offen sc1 lds
    ds_read_b64_tr_b16 a[48:49], v10 offset:25600
    s_waitcnt lgkmcnt(11)
    v_mfma_f32_16x16x32_bf16 v[80:83], a[16:19], a[0:3], v[80:83]
    ds_read_b64_tr_b16 a[50:51], v10 offset:25856
    ds_read_b64_tr_b16 a[52:53], v10 offset:26624
    v_mfma_f32_16x16x32_bf16 v[84:87], a[16:19], a[4:7], v[84:87]
    ds_read_b64_tr_b16 a[54:55], v10 offset:26880
    ds_read_b64_tr_b16 a[56:57], v14 offset:27648
    v_mfma_f32_16x16x32_bf16 v[92:95], a[20:23], a[4:7], v[92:95]
    buffer_load_dwordx4 v6, s[20:23], s27 offen offset:1024 sc1 lds
    ds_read_b64_tr_b16 a[58:59], v14 offset:27904
    v_mfma_f32_16x16x32_bf16 v[88:91], a[20:23], a[0:3], v[88:91]
    ds_read_b64_tr_b16 a[60:61], v10 offset:29184
    ds_read_b64_tr_b16 a[62:63], v10 offset:29440
    s_waitcnt lgkmcnt(12)
    v_mfma_f32_16x16x32_bf16 v[96:99], a[24:27], a[0:3], v[96:99]
    ds_read_b64_tr_b16 a[64:65], v10 offset:30208
    ds_read_b64_tr_b16 a[66:67], v10 offset:30464
    v_mfma_f32_16x16x32_bf16 v[100:103], a[24:27], a[4:7], v[100:103]
    ds_read_b64_tr_b16 a[68:69], v10 offset:31232
    v_mfma_f32_16x16x32_bf16 v[108:111], a[28:31], a[4:7], v[108:111]
    buffer_load_dwordx4 v6, s[20:23], s27 offen offset:2048 sc1 lds
    ds_read_b64_tr_b16 a[70:71], v10 offset:31488
    v_mfma_f32_16x16x32_bf16 v[104:107], a[28:31], a[0:3], v[104:107]
    v_mfma_f32_16x16x32_bf16 v[112:115], a[32:35], a[0:3], v[112:115]
    v_mfma_f32_16x16x32_bf16 v[116:119], a[32:35], a[4:7], v[116:119]
    buffer_load_dwordx4 v15, s[20:23], s27 offen offset:3072 sc1 lds
    s_waitcnt lgkmcnt(10)
    v_mfma_f32_16x16x32_bf16 v[64:67], a[44:47], a[36:39], v[64:67]
    v_mfma_f32_16x16x32_bf16 v[68:71], a[44:47], a[40:43], v[68:71]
    s_waitcnt vmcnt(16) lgkmcnt(0)
    s_barrier
    v_mfma_f32_16x16x32_bf16 v[76:79], a[48:51], a[40:43], v[76:79]
    s_lshr_b32 s37, 0x10101410, s36
    s_and_b32 s37, s37, 0xff
    v_mfma_f32_16x16x32_bf16 v[72:75], a[48:51], a[36:39], v[72:75]
    s_lshl_b32 s26, s37, 7
    s_add_u32 m0, s24, 16384
    v_mfma_f32_16x16x32_bf16 v[80:83], a[52:55], a[36:39], v[80:83]
    buffer_load_dwordx4 v2, s[8:11], s26 offen lds
    ds_read_b128 a[0:3], v8 offset:32768
    v_mfma_f32_16x16x32_bf16 v[84:87], a[52:55], a[40:43], v[84:87]
    ds_read_b128 a[4:7], v8 offset:34816
    ds_read_b64_tr_b16 a[8:9], v10 offset:32768
    v_mfma_f32_16x16x32_bf16 v[92:95], a[56:59], a[40:43], v[92:95]
    buffer_load_dwordx4 v3, s[8:11], s26 offen offset:1024 lds
    ds_read_b64_tr_b16 a[10:11], v10 offset:33024
    v_mfma_f32_16x16x32_bf16 v[88:91], a[56:59], a[36:39], v[88:91]
    ds_read_b64_tr_b16 a[12:13], v10 offset:33792
    ds_read_b64_tr_b16 a[14:15], v10 offset:34048
    v_mfma_f32_16x16x32_bf16 v[96:99], a[60:63], a[36:39], v[96:99]
    ds_read_b64_tr_b16 a[16:17], v10 offset:34816
    ds_read_b64_tr_b16 a[18:19], v10 offset:35072
    v_mfma_f32_16x16x32_bf16 v[100:103], a[60:63], a[40:43], v[100:103]
    ds_read_b64_tr_b16 a[20:21], v14 offset:35840
    ds_read_b64_tr_b16 a[22:23], v14 offset:36096
    v_mfma_f32_16x16x32_bf16 v[108:111], a[64:67], a[40:43], v[108:111]
    buffer_load_dwordx4 v4, s[8:11], s26 offen offset:2048 lds
    ds_read_b64_tr_b16 a[24:25], v10 offset:37376
    v_mfma_f32_16x16x32_bf16 v[104:107], a[64:67], a[36:39], v[104:107]
    ds_read_b64_tr_b16 a[26:27], v10 offset:37632
    ds_read_b64_tr_b16 a[28:29], v10 offset:38400
    v_mfma_f32_16x16x32_bf16 v[112:115], a[68:71], a[36:39], v[112:115]
    ds_read_b64_tr_b16 a[30:31], v10 offset:38656
    ds_read_b64_tr_b16 a[32:33], v10 offset:39424
    v_mfma_f32_16x16x32_bf16 v[116:119], a[68:71], a[40:43], v[116:119]
    buffer_load_dwordx4 v5, s[8:11], s26 offen offset:3072 lds
    ds_read_b64_tr_b16 a[34:35], v10 offset:39680
    s_waitcnt lgkmcnt(10)
    v_mfma_f32_16x16x32_bf16 v[64:67], a[8:11], a[0:3], v[64:67]
    ds_read_b128 a[36:39], v9 offset:32768
    ds_read_b128 a[40:43], v9 offset:34816
    v_mfma_f32_16x16x32_bf16 v[68:71], a[8:11], a[4:7], v[68:71]
    s_mul_i32 s27, s37, 229376
    ds_read_b64_tr_b16 a[44:45], v10 offset:40960
    v_mfma_f32_16x16x32_bf16 v[76:79], a[12:15], a[4:7], v[76:79]
    s_add_u32 m0, s25, 16384
    ds_read_b64_tr_b16 a[46:47], v10 offset:41216
    v_mfma_f32_16x16x32_bf16 v[72:75], a[12:15], a[0:3], v[72:75]
    buffer_load_dwordx4 v6, s[20:23], s27 offen sc1 lds
    ds_read_b64_tr_b16 a[48:49], v10 offset:41984
    s_waitcnt lgkmcnt(11)
    v_mfma_f32_16x16x32_bf16 v[80:83], a[16:19], a[0:3], v[80:83]
    ds_read_b64_tr_b16 a[50:51], v10 offset:42240
    ds_read_b64_tr_b16 a[52:53], v10 offset:43008
    v_mfma_f32_16x16x32_bf16 v[84:87], a[16:19], a[4:7], v[84:87]
    ds_read_b64_tr_b16 a[54:55], v10 offset:43264
    ds_read_b64_tr_b16 a[56:57], v14 offset:44032
    v_mfma_f32_16x16x32_bf16 v[92:95], a[20:23], a[4:7], v[92:95]
    buffer_load_dwordx4 v6, s[20:23], s27 offen offset:1024 sc1 lds
    ds_read_b64_tr_b16 a[58:59], v14 offset:44288
    v_mfma_f32_16x16x32_bf16 v[88:91], a[20:23], a[0:3], v[88:91]
    ds_read_b64_tr_b16 a[60:61], v10 offset:45568
    ds_read_b64_tr_b16 a[62:63], v10 offset:45824
    s_waitcnt lgkmcnt(12)
    v_mfma_f32_16x16x32_bf16 v[96:99], a[24:27], a[0:3], v[96:99]
    ds_read_b64_tr_b16 a[64:65], v10 offset:46592
    ds_read_b64_tr_b16 a[66:67], v10 offset:46848
    v_mfma_f32_16x16x32_bf16 v[100:103], a[24:27], a[4:7], v[100:103]
    ds_read_b64_tr_b16 a[68:69], v10 offset:47616
    v_mfma_f32_16x16x32_bf16 v[108:111], a[28:31], a[4:7], v[108:111]
    buffer_load_dwordx4 v6, s[20:23], s27 offen offset:2048 sc1 lds
    ds_read_b64_tr_b16 a[70:71], v10 offset:47872
    v_mfma_f32_16x16x32_bf16 v[104:107], a[28:31], a[0:3], v[104:107]
    v_mfma_f32_16x16x32_bf16 v[112:115], a[32:35], a[0:3], v[112:115]
    v_mfma_f32_16x16x32_bf16 v[116:119], a[32:35], a[4:7], v[116:119]
    buffer_load_dwordx4 v15, s[20:23], s27 offen offset:3072 sc1 lds
    s_waitcnt lgkmcnt(10)
    v_mfma_f32_16x16x32_bf16 v[64:67], a[44:47], a[36:39], v[64:67]
    v_mfma_f32_16x16x32_bf16 v[68:71], a[44:47], a[40:43], v[68:71]
    s_waitcnt vmcnt(16) lgkmcnt(0)
    s_barrier
    s_cmp_lg_u32 s3, 0
    s_cbranch_scc1 L_sig_1_29
    s_add_u32 s46, s35, 8
    s_lshl_b32 s46, s46, 7
    s_add_u32 s46, s46, 26607616
    v_mov_b32 v20, 0
    v_mov_b32 v21, 1
    s_mov_b64 exec, 1
    buffer_atomic_add v21, v20, s[20:23], s46 offen
    s_mov_b64 exec, -1
L_sig_1_29:
    s_nop 1
    v_mfma_f32_16x16x32_bf16 v[76:79], a[48:51], a[40:43], v[76:79]
    s_lshr_b32 s37, 0x11151111, s36
    s_and_b32 s37, s37, 0xff
    v_mfma_f32_16x16x32_bf16 v[72:75], a[48:51], a[36:39], v[72:75]
    s_lshl_b32 s26, s37, 7
    s_add_u32 m0, s24, 32768
    v_mfma_f32_16x16x32_bf16 v[80:83], a[52:55], a[36:39], v[80:83]
    buffer_load_dwordx4 v2, s[8:11], s26 offen lds
    ds_read_b128 a[0:3], v8 offset:49152
    v_mfma_f32_16x16x32_bf16 v[84:87], a[52:55], a[40:43], v[84:87]
    ds_read_b128 a[4:7], v8 offset:51200
    ds_read_b64_tr_b16 a[8:9], v10 offset:49152
    v_mfma_f32_16x16x32_bf16 v[92:95], a[56:59], a[40:43], v[92:95]
    buffer_load_dwordx4 v3, s[8:11], s26 offen offset:1024 lds
    ds_read_b64_tr_b16 a[10:11], v10 offset:49408
    v_mfma_f32_16x16x32_bf16 v[88:91], a[56:59], a[36:39], v[88:91]
    ds_read_b64_tr_b16 a[12:13], v10 offset:50176
    ds_read_b64_tr_b16 a[14:15], v10 offset:50432
    v_mfma_f32_16x16x32_bf16 v[96:99], a[60:63], a[36:39], v[96:99]
    ds_read_b64_tr_b16 a[16:17], v10 offset:51200
    ds_read_b64_tr_b16 a[18:19], v10 offset:51456
    v_mfma_f32_16x16x32_bf16 v[100:103], a[60:63], a[40:43], v[100:103]
    ds_read_b64_tr_b16 a[20:21], v14 offset:52224
    ds_read_b64_tr_b16 a[22:23], v14 offset:52480
    v_mfma_f32_16x16x32_bf16 v[108:111], a[64:67], a[40:43], v[108:111]
    buffer_load_dwordx4 v4, s[8:11], s26 offen offset:2048 lds
    ds_read_b64_tr_b16 a[24:25], v10 offset:53760
    v_mfma_f32_16x16x32_bf16 v[104:107], a[64:67], a[36:39], v[104:107]
    ds_read_b64_tr_b16 a[26:27], v10 offset:54016
    ds_read_b64_tr_b16 a[28:29], v10 offset:54784
    v_mfma_f32_16x16x32_bf16 v[112:115], a[68:71], a[36:39], v[112:115]
    ds_read_b64_tr_b16 a[30:31], v10 offset:55040
    ds_read_b64_tr_b16 a[32:33], v10 offset:55808
    v_mfma_f32_16x16x32_bf16 v[116:119], a[68:71], a[40:43], v[116:119]
    buffer_load_dwordx4 v5, s[8:11], s26 offen offset:3072 lds
    ds_read_b64_tr_b16 a[34:35], v10 offset:56064
    s_waitcnt lgkmcnt(10)
    v_mfma_f32_16x16x32_bf16 v[64:67], a[8:11], a[0:3], v[64:67]
    ds_read_b128 a[36:39], v9 offset:49152
    ds_read_b128 a[40:43], v9 offset:51200
    v_mfma_f32_16x16x32_bf16 v[68:71], a[8:11], a[4:7], v[68:71]
    s_mul_i32 s27, s37, 229376
    ds_read_b64_tr_b16 a[44:45], v10 offset:57344
    v_mfma_f32_16x16x32_bf16 v[76:79], a[12:15], a[4:7], v[76:79]
    s_add_u32 m0, s25, 32768
    ds_read_b64_tr_b16 a[46:47], v10 offset:57600
    v_mfma_f32_16x16x32_bf16 v[72:75], a[12:15], a[0:3], v[72:75]
    buffer_load_dwordx4 v6, s[20:23], s27 offen sc1 lds
    ds_read_b64_tr_b16 a[48:49], v10 offset:58368
    s_waitcnt lgkmcnt(11)
    v_mfma_f32_16x16x32_bf16 v[80:83], a[16:19], a[0:3], v[80:83]
    ds_read_b64_tr_b16 a[50:51], v10 offset:58624
    ds_read_b64_tr_b16 a[52:53], v10 offset:59392
    v_mfma_f32_16x16x32_bf16 v[84:87], a[16:19], a[4:7], v[84:87]
    ds_read_b64_tr_b16 a[54:55], v10 offset:59648
    ds_read_b64_tr_b16 a[56:57], v14 offset:60416
    v_mfma_f32_16x16x32_bf16 v[92:95], a[20:23], a[4:7], v[92:95]
    buffer_load_dwordx4 v6, s[20:23], s27 offen offset:1024 sc1 lds
    ds_read_b64_tr_b16 a[58:59], v14 offset:60672
    v_mfma_f32_16x16x32_bf16 v[88:91], a[20:23], a[0:3], v[88:91]
    ds_read_b64_tr_b16 a[60:61], v10 offset:61952
    ds_read_b64_tr_b16 a[62:63], v10 offset:62208
    s_waitcnt lgkmcnt(12)
    v_mfma_f32_16x16x32_bf16 v[96:99], a[24:27], a[0:3], v[96:99]
    ds_read_b64_tr_b16 a[64:65], v10 offset:62976
    ds_read_b64_tr_b16 a[66:67], v10 offset:63232
    v_mfma_f32_16x16x32_bf16 v[100:103], a[24:27], a[4:7], v[100:103]
    ds_read_b64_tr_b16 a[68:69], v10 offset:64000
    v_mfma_f32_16x16x32_bf16 v[108:111], a[28:31], a[4:7], v[108:111]
    buffer_load_dwordx4 v6, s[20:23], s27 offen offset:2048 sc1 lds
    ds_read_b64_tr_b16 a[70:71], v10 offset:64256
    v_mfma_f32_16x16x32_bf16 v[104:107], a[28:31], a[0:3], v[104:107]
    v_mfma_f32_16x16x32_bf16 v[112:115], a[32:35], a[0:3], v[112:115]
    v_mfma_f32_16x16x32_bf16 v[116:119], a[32:35], a[4:7], v[116:119]
    buffer_load_dwordx4 v15, s[20:23], s27 offen offset:3072 sc1 lds
    s_waitcnt lgkmcnt(10)
    v_mfma_f32_16x16x32_bf16 v[64:67], a[44:47], a[36:39], v[64:67]
    v_mfma_f32_16x16x32_bf16 v[68:71], a[44:47], a[40:43], v[68:71]
    s_waitcnt vmcnt(16) lgkmcnt(0)
    s_barrier
    v_mfma_f32_16x16x32_bf16 v[76:79], a[48:51], a[40:43], v[76:79]
    s_lshr_b32 s37, 0x16121212, s36
    s_and_b32 s37, s37, 0xff
    v_mfma_f32_16x16x32_bf16 v[72:75], a[48:51], a[36:39], v[72:75]
    s_lshl_b32 s26, s37, 7
    s_add_u32 m0, s24, 49152
    v_mfma_f32_16x16x32_bf16 v[80:83], a[52:55], a[36:39], v[80:83]
    buffer_load_dwordx4 v2, s[8:11], s26 offen lds
    ds_read_b128 a[0:3], v8 offset:0
    v_mfma_f32_16x16x32_bf16 v[84:87], a[52:55], a[40:43], v[84:87]
    ds_read_b128 a[4:7], v8 offset:2048
    ds_read_b64_tr_b16 a[8:9], v10 offset:0
    v_mfma_f32_16x16x32_bf16 v[92:95], a[56:59], a[40:43], v[92:95]
    buffer_load_dwordx4 v3, s[8:11], s26 offen offset:1024 lds
    ds_read_b64_tr_b16 a[10:11], v10 offset:256
    v_mfma_f32_16x16x32_bf16 v[88:91], a[56:59], a[36:39], v[88:91]
    ds_read_b64_tr_b16 a[12:13], v10 offset:1024
    ds_read_b64_tr_b16 a[14:15], v10 offset:1280
    v_mfma_f32_16x16x32_bf16 v[96:99], a[60:63], a[36:39], v[96:99]
    ds_read_b64_tr_b16 a[16:17], v10 offset:2048
    ds_read_b64_tr_b16 a[18:19], v10 offset:2304
    v_mfma_f32_16x16x32_bf16 v[100:103], a[60:63], a[40:43], v[100:103]
    ds_read_b64_tr_b16 a[20:21], v14 offset:3072
    ds_read_b64_tr_b16 a[22:23], v14 offset:3328
    v_mfma_f32_16x16x32_bf16 v[108:111], a[64:67], a[40:43], v[108:111]
    buffer_load_dwordx4 v4, s[8:11], s26 offen offset:2048 lds
    ds_read_b64_tr_b16 a[24:25], v10 offset:4608
    v_mfma_f32_16x16x32_bf16 v[104:107], a[64:67], a[36:39], v[104:107]
    ds_read_b64_tr_b16 a[26:27], v10 offset:4864
    ds_read_b64_tr_b16 a[28:29], v10 offset:5632
    v_mfma_f32_16x16x32_bf16 v[112:115], a[68:71], a[36:39], v[112:115]
    ds_read_b64_tr_b16 a[30:31], v10 offset:5888
    ds_read_b64_tr_b16 a[32:33], v10 offset:6656
    v_mfma_f32_16x16x32_bf16 v[116:119], a[68:71], a[40:43], v[116:119]
    buffer_load_dwordx4 v5, s[8:11], s26 offen offset:3072 lds
    ds_read_b64_tr_b16 a[34:35], v10 offset:6912
    s_waitcnt lgkmcnt(10)
    v_mfma_f32_16x16x32_bf16 v[64:67], a[8:11], a[0:3], v[64:67]
    ds_read_b128 a[36:39], v9 offset:0
    ds_read_b128 a[40:43], v9 offset:2048
    v_mfma_f32_16x16x32_bf16 v[68:71], a[8:11], a[4:7], v[68:71]
    s_mul_i32 s27, s37, 229376
    ds_read_b64_tr_b16 a[44:45], v10 offset:8192
    v_mfma_f32_16x16x32_bf16 v[76:79], a[12:15], a[4:7], v[76:79]
    s_add_u32 m0, s25, 49152
    ds_read_b64_tr_b16 a[46:47], v10 offset:8448
    v_mfma_f32_16x16x32_bf16 v[72:75], a[12:15], a[0:3], v[72:75]
    buffer_load_dwordx4 v6, s[20:23], s27 offen sc1 lds
    ds_read_b64_tr_b16 a[48:49], v10 offset:9216
    s_waitcnt lgkmcnt(11)
    v_mfma_f32_16x16x32_bf16 v[80:83], a[16:19], a[0:3], v[80:83]
    ds_read_b64_tr_b16 a[50:51], v10 offset:9472
    ds_read_b64_tr_b16 a[52:53], v10 offset:10240
    v_mfma_f32_16x16x32_bf16 v[84:87], a[16:19], a[4:7], v[84:87]
    ds_read_b64_tr_b16 a[54:55], v10 offset:10496
    ds_read_b64_tr_b16 a[56:57], v14 offset:11264
    v_mfma_f32_16x16x32_bf16 v[92:95], a[20:23], a[4:7], v[92:95]
    buffer_load_dwordx4 v6, s[20:23], s27 offen offset:1024 sc1 lds
    ds_read_b64_tr_b16 a[58:59], v14 offset:11520
    v_mfma_f32_16x16x32_bf16 v[88:91], a[20:23], a[0:3], v[88:91]
    ds_read_b64_tr_b16 a[60:61], v10 offset:12800
    ds_read_b64_tr_b16 a[62:63], v10 offset:13056
    s_waitcnt lgkmcnt(12)
    v_mfma_f32_16x16x32_bf16 v[96:99], a[24:27], a[0:3], v[96:99]
    ds_read_b64_tr_b16 a[64:65], v10 offset:13824
    ds_read_b64_tr_b16 a[66:67], v10 offset:14080
    v_mfma_f32_16x16x32_bf16 v[100:103], a[24:27], a[4:7], v[100:103]
    ds_read_b64_tr_b16 a[68:69], v10 offset:14848
    v_mfma_f32_16x16x32_bf16 v[108:111], a[28:31], a[4:7], v[108:111]
    buffer_load_dwordx4 v6, s[20:23], s27 offen offset:2048 sc1 lds
    ds_read_b64_tr_b16 a[70:71], v10 offset:15104
    v_mfma_f32_16x16x32_bf16 v[104:107], a[28:31], a[0:3], v[104:107]
    v_mfma_f32_16x16x32_bf16 v[112:115], a[32:35], a[0:3], v[112:115]
    v_mfma_f32_16x16x32_bf16 v[116:119], a[32:35], a[4:7], v[116:119]
    buffer_load_dwordx4 v15, s[20:23], s27 offen offset:3072 sc1 lds
    s_waitcnt lgkmcnt(10)
    v_mfma_f32_16x16x32_bf16 v[64:67], a[44:47], a[36:39], v[64:67]
    v_mfma_f32_16x16x32_bf16 v[68:71], a[44:47], a[40:43], v[68:71]
    s_waitcnt vmcnt(16) lgkmcnt(0)
    s_barrier
    v_mfma_f32_16x16x32_bf16 v[76:79], a[48:51], a[40:43], v[76:79]
    s_lshr_b32 s37, 0x13131317, s36
    s_and_b32 s37, s37, 0xff
    v_mfma_f32_16x16x32_bf16 v[72:75], a[48:51], a[36:39], v[72:75]
    s_lshl_b32 s26, s37, 7
    s_add_u32 m0, s24, 0
    v_mfma_f32_16x16x32_bf16 v[80:83], a[52:55], a[36:39], v[80:83]
    buffer_load_dwordx4 v2, s[8:11], s26 offen lds
    ds_read_b128 a[0:3], v8 offset:16384
    v_mfma_f32_16x16x32_bf16 v[84:87], a[52:55], a[40:43], v[84:87]
    ds_read_b128 a[4:7], v8 offset:18432
    ds_read_b64_tr_b16 a[8:9], v10 offset:16384
    v_mfma_f32_16x16x32_bf16 v[92:95], a[56:59], a[40:43], v[92:95]
    buffer_load_dwordx4 v3, s[8:11], s26 offen offset:1024 lds
    ds_read_b64_tr_b16 a[10:11], v10 offset:16640
    v_mfma_f32_16x16x32_bf16 v[88:91], a[56:59], a[36:39], v[88:91]
    ds_read_b64_tr_b16 a[12:13], v10 offset:17408
    ds_read_b64_tr_b16 a[14:15], v10 offset:17664
    v_mfma_f32_16x16x32_bf16 v[96:99], a[60:63], a[36:39], v[96:99]
    ds_read_b64_tr_b16 a[16:17], v10 offset:18432
    ds_read_b64_tr_b16 a[18:19], v10 offset:18688
    v_mfma_f32_16x16x32_bf16 v[100:103], a[60:63], a[40:43], v[100:103]
    ds_read_b64_tr_b16 a[20:21], v14 offset:19456
    ds_read_b64_tr_b16 a[22:23], v14 offset:19712
    v_mfma_f32_16x16x32_bf16 v[108:111], a[64:67], a[40:43], v[108:111]
    buffer_load_dwordx4 v4, s[8:11], s26 offen offset:2048 lds
    ds_read_b64_tr_b16 a[24:25], v10 offset:20992
    v_mfma_f32_16x16x32_bf16 v[104:107], a[64:67], a[36:39], v[104:107]
    ds_read_b64_tr_b16 a[26:27], v10 offset:21248
    ds_read_b64_tr_b16 a[28:29], v10 offset:22016
    v_mfma_f32_16x16x32_bf16 v[112:115], a[68:71], a[36:39], v[112:115]
    ds_read_b64_tr_b16 a[30:31], v10 offset:22272
    ds_read_b64_tr_b16 a[32:33], v10 offset:23040
    v_mfma_f32_16x16x32_bf16 v[116:119], a[68:71], a[40:43], v[116:119]
    buffer_load_dwordx4 v5, s[8:11], s26 offen offset:3072 lds
    ds_read_b64_tr_b16 a[34:35], v10 offset:23296
    s_waitcnt lgkmcnt(10)
    v_mfma_f32_16x16x32_bf16 v[64:67], a[8:11], a[0:3], v[64:67]
    ds_read_b128 a[36:39], v9 offset:16384
    ds_read_b128 a[40:43], v9 offset:18432
    v_mfma_f32_16x16x32_bf16 v[68:71], a[8:11], a[4:7], v[68:71]
    s_mul_i32 s27, s37, 229376
    ds_read_b64_tr_b16 a[44:45], v10 offset:24576
    v_mfma_f32_16x16x32_bf16 v[76:79], a[12:15], a[4:7], v[76:79]
    s_add_u32 m0, s25, 0
    ds_read_b64_tr_b16 a[46:47], v10 offset:24832
    v_mfma_f32_16x16x32_bf16 v[72:75], a[12:15], a[0:3], v[72:75]
    buffer_load_dwordx4 v6, s[20:23], s27 offen sc1 lds
    ds_read_b64_tr_b16 a[48:49], v10 offset:25600
    s_waitcnt lgkmcnt(11)
    v_mfma_f32_16x16x32_bf16 v[80:83], a[16:19], a[0:3], v[80:83]
    ds_read_b64_tr_b16 a[50:51], v10 offset:25856
    ds_read_b64_tr_b16 a[52:53], v10 offset:26624
    v_mfma_f32_16x16x32_bf16 v[84:87], a[16:19], a[4:7], v[84:87]
    ds_read_b64_tr_b16 a[54:55], v10 offset:26880
    ds_read_b64_tr_b16 a[56:57], v14 offset:27648
    v_mfma_f32_16x16x32_bf16 v[92:95], a[20:23], a[4:7], v[92:95]
    buffer_load_dwordx4 v6, s[20:23], s27 offen offset:1024 sc1 lds
    ds_read_b64_tr_b16 a[58:59], v14 offset:27904
    v_mfma_f32_16x16x32_bf16 v[88:91], a[20:23], a[0:3], v[88:91]
    ds_read_b64_tr_b16 a[60:61], v10 offset:29184
    ds_read_b64_tr_b16 a[62:63], v10 offset:29440
    s_waitcnt lgkmcnt(12)
    v_mfma_f32_16x16x32_bf16 v[96:99], a[24:27], a[0:3], v[96:99]
    ds_read_b64_tr_b16 a[64:65], v10 offset:30208
    ds_read_b64_tr_b16 a[66:67], v10 offset:30464
    v_mfma_f32_16x16x32_bf16 v[100:103], a[24:27], a[4:7], v[100:103]
    ds_read_b64_tr_b16 a[68:69], v10 offset:31232
    v_mfma_f32_16x16x32_bf16 v[108:111], a[28:31], a[4:7], v[108:111]
    buffer_load_dwordx4 v6, s[20:23], s27 offen offset:2048 sc1 lds
    ds_read_b64_tr_b16 a[70:71], v10 offset:31488
    v_mfma_f32_16x16x32_bf16 v[104:107], a[28:31], a[0:3], v[104:107]
    v_mfma_f32_16x16x32_bf16 v[112:115], a[32:35], a[0:3], v[112:115]
    v_mfma_f32_16x16x32_bf16 v[116:119], a[32:35], a[4:7], v[116:119]
    buffer_load_dwordx4 v15, s[20:23], s27 offen offset:3072 sc1 lds
    s_waitcnt lgkmcnt(10)
    v_mfma_f32_16x16x32_bf16 v[64:67], a[44:47], a[36:39], v[64:67]
    v_mfma_f32_16x16x32_bf16 v[68:71], a[44:47], a[40:43], v[68:71]
    s_waitcnt vmcnt(16) lgkmcnt(0)
    s_barrier
    v_mfma_f32_16x16x32_bf16 v[76:79], a[48:51], a[40:43], v[76:79]
    s_lshr_b32 s37, 0x14141814, s36
    s_and_b32 s37, s37, 0xff
    v_mfma_f32_16x16x32_bf16 v[72:75], a[48:51], a[36:39], v[72:75]
    s_lshl_b32 s26, s37, 7
    s_add_u32 m0, s24, 16384
    v_mfma_f32_16x16x32_bf16 v[80:83], a[52:55], a[36:39], v[80:83]
    buffer_load_dwordx4 v2, s[8:11], s26 offen lds
    ds_read_b128 a[0:3], v8 offset:32768
    v_mfma_f32_16x16x32_bf16 v[84:87], a[52:55], a[40:43], v[84:87]
    ds_read_b128 a[4:7], v8 offset:34816
    ds_read_b64_tr_b16 a[8:9], v10 offset:32768
    v_mfma_f32_16x16x32_bf16 v[92:95], a[56:59], a[40:43], v[92:95]
    buffer_load_dwordx4 v3, s[8:11], s26 offen offset:1024 lds
    ds_read_b64_tr_b16 a[10:11], v10 offset:33024
    v_mfma_f32_16x16x32_bf16 v[88:91], a[56:59], a[36:39], v[88:91]
    ds_read_b64_tr_b16 a[12:13], v10 offset:33792
    ds_read_b64_tr_b16 a[14:15], v10 offset:34048
    v_mfma_f32_16x16x32_bf16 v[96:99], a[60:63], a[36:39], v[96:99]
    ds_read_b64_tr_b16 a[16:17], v10 offset:34816
    ds_read_b64_tr_b16 a[18:19], v10 offset:35072
    v_mfma_f32_16x16x32_bf16 v[100:103], a[60:63], a[40:43], v[100:103]
    ds_read_b64_tr_b16 a[20:21], v14 offset:35840
    ds_read_b64_tr_b16 a[22:23], v14 offset:36096
    v_mfma_f32_16x16x32_bf16 v[108:111], a[64:67], a[40:43], v[108:111]
    buffer_load_dwordx4 v4, s[8:11], s26 offen offset:2048 lds
    ds_read_b64_tr_b16 a[24:25], v10 offset:37376
    v_mfma_f32_16x16x32_bf16 v[104:107], a[64:67], a[36:39], v[104:107]
    ds_read_b64_tr_b16 a[26:27], v10 offset:37632
    ds_read_b64_tr_b16 a[28:29], v10 offset:38400
    v_mfma_f32_16x16x32_bf16 v[112:115], a[68:71], a[36:39], v[112:115]
    ds_read_b64_tr_b16 a[30:31], v10 offset:38656
    ds_read_b64_tr_b16 a[32:33], v10 offset:39424
    v_mfma_f32_16x16x32_bf16 v[116:119], a[68:71], a[40:43], v[116:119]
    buffer_load_dwordx4 v5, s[8:11], s26 offen offset:3072 lds
    ds_read_b64_tr_b16 a[34:35], v10 offset:39680
    s_waitcnt lgkmcnt(10)
    v_mfma_f32_16x16x32_bf16 v[64:67], a[8:11], a[0:3], v[64:67]
    ds_read_b128 a[36:39], v9 offset:32768
    ds_read_b128 a[40:43], v9 offset:34816
    v_mfma_f32_16x16x32_bf16 v[68:71], a[8:11], a[4:7], v[68:71]
    s_mul_i32 s27, s37, 229376
    ds_read_b64_tr_b16 a[44:45], v10 offset:40960
    v_mfma_f32_16x16x32_bf16 v[76:79], a[12:15], a[4:7], v[76:79]
    s_add_u32 m0, s25, 16384
    ds_read_b64_tr_b16 a[46:47], v10 offset:41216
    v_mfma_f32_16x16x32_bf16 v[72:75], a[12:15], a[0:3], v[72:75]
    buffer_load_dwordx4 v6, s[20:23], s27 offen sc1 lds
    ds_read_b64_tr_b16 a[48:49], v10 offset:41984
    s_waitcnt lgkmcnt(11)
    v_mfma_f32_16x16x32_bf16 v[80:83], a[16:19], a[0:3], v[80:83]
    ds_read_b64_tr_b16 a[50:51], v10 offset:42240
    ds_read_b64_tr_b16 a[52:53], v10 offset:43008
    v_mfma_f32_16x16x32_bf16 v[84:87], a[16:19], a[4:7], v[84:87]
    ds_read_b64_tr_b16 a[54:55], v10 offset:43264
    ds_read_b64_tr_b16 a[56:57], v14 offset:44032
    v_mfma_f32_16x16x32_bf16 v[92:95], a[20:23], a[4:7], v[92:95]
    buffer_load_dwordx4 v6, s[20:23], s27 offen offset:1024 sc1 lds
    ds_read_b64_tr_b16 a[58:59], v14 offset:44288
    v_mfma_f32_16x16x32_bf16 v[88:91], a[20:23], a[0:3], v[88:91]
    ds_read_b64_tr_b16 a[60:61], v10 offset:45568
    ds_read_b64_tr_b16 a[62:63], v10 offset:45824
    s_waitcnt lgkmcnt(12)
    v_mfma_f32_16x16x32_bf16 v[96:99], a[24:27], a[0:3], v[96:99]
    ds_read_b64_tr_b16 a[64:65], v10 offset:46592
    ds_read_b64_tr_b16 a[66:67], v10 offset:46848
    v_mfma_f32_16x16x32_bf16 v[100:103], a[24:27], a[4:7], v[100:103]
    ds_read_b64_tr_b16 a[68:69], v10 offset:47616
    v_mfma_f32_16x16x32_bf16 v[108:111], a[28:31], a[4:7], v[108:111]
    buffer_load_dwordx4 v6, s[20:23], s27 offen offset:2048 sc1 lds
    ds_read_b64_tr_b16 a[70:71], v10 offset:47872
    v_mfma_f32_16x16x32_bf16 v[104:107], a[28:31], a[0:3], v[104:107]
    v_mfma_f32_16x16x32_bf16 v[112:115], a[32:35], a[0:3], v[112:115]
    v_mfma_f32_16x16x32_bf16 v[116:119], a[32:35], a[4:7], v[116:119]
    buffer_load_dwordx4 v15, s[20:23], s27 offen offset:3072 sc1 lds
    s_waitcnt lgkmcnt(10)
    v_mfma_f32_16x16x32_bf16 v[64:67], a[44:47], a[36:39], v[64:67]
    v_mfma_f32_16x16x32_bf16 v[68:71], a[44:47], a[40:43], v[68:71]
    s_waitcnt vmcnt(16) lgkmcnt(0)
    s_barrier
    v_mfma_f32_16x16x32_bf16 v[76:79], a[48:51], a[40:43], v[76:79]
    s_lshr_b32 s37, 0x15191515, s36
    s_and_b32 s37, s37, 0xff
    v_mfma_f32_16x16x32_bf16 v[72:75], a[48:51], a[36:39], v[72:75]
    s_lshl_b32 s26, s37, 7
    s_add_u32 m0, s24, 32768
    v_mfma_f32_16x16x32_bf16 v[80:83], a[52:55], a[36:39], v[80:83]
    buffer_load_dwordx4 v2, s[8:11], s26 offen lds
    ds_read_b128 a[0:3], v8 offset:49152
    v_mfma_f32_16x16x32_bf16 v[84:87], a[52:55], a[40:43], v[84:87]
    ds_read_b128 a[4:7], v8 offset:51200
    ds_read_b64_tr_b16 a[8:9], v10 offset:49152
    v_mfma_f32_16x16x32_bf16 v[92:95], a[56:59], a[40:43], v[92:95]
    buffer_load_dwordx4 v3, s[8:11], s26 offen offset:1024 lds
    ds_read_b64_tr_b16 a[10:11], v10 offset:49408
    v_mfma_f32_16x16x32_bf16 v[88:91], a[56:59], a[36:39], v[88:91]
    ds_read_b64_tr_b16 a[12:13], v10 offset:50176
    ds_read_b64_tr_b16 a[14:15], v10 offset:50432
    v_mfma_f32_16x16x32_bf16 v[96:99], a[60:63], a[36:39], v[96:99]
    ds_read_b64_tr_b16 a[16:17], v10 offset:51200
    ds_read_b64_tr_b16 a[18:19], v10 offset:51456
    v_mfma_f32_16x16x32_bf16 v[100:103], a[60:63], a[40:43], v[100:103]
    ds_read_b64_tr_b16 a[20:21], v14 offset:52224
    ds_read_b64_tr_b16 a[22:23], v14 offset:52480
    v_mfma_f32_16x16x32_bf16 v[108:111], a[64:67], a[40:43], v[108:111]
    buffer_load_dwordx4 v4, s[8:11], s26 offen offset:2048 lds
    ds_read_b64_tr_b16 a[24:25], v10 offset:53760
    v_mfma_f32_16x16x32_bf16 v[104:107], a[64:67], a[36:39], v[104:107]
    ds_read_b64_tr_b16 a[26:27], v10 offset:54016
    ds_read_b64_tr_b16 a[28:29], v10 offset:54784
    v_mfma_f32_16x16x32_bf16 v[112:115], a[68:71], a[36:39], v[112:115]
    ds_read_b64_tr_b16 a[30:31], v10 offset:55040
    ds_read_b64_tr_b16 a[32:33], v10 offset:55808
    v_mfma_f32_16x16x32_bf16 v[116:119], a[68:71], a[40:43], v[116:119]
    buffer_load_dwordx4 v5, s[8:11], s26 offen offset:3072 lds
    ds_read_b64_tr_b16 a[34:35], v10 offset:56064
    s_waitcnt lgkmcnt(10)
    v_mfma_f32_16x16x32_bf16 v[64:67], a[8:11], a[0:3], v[64:67]
    ds_read_b128 a[36:39], v9 offset:49152
    ds_read_b128 a[40:43], v9 offset:51200
    v_mfma_f32_16x16x32_bf16 v[68:71], a[8:11], a[4:7], v[68:71]
    s_mul_i32 s27, s37, 229376
    ds_read_b64_tr_b16 a[44:45], v10 offset:57344
    v_mfma_f32_16x16x32_bf16 v[76:79], a[12:15], a[4:7], v[76:79]
    s_add_u32 m0, s25, 32768
    ds_read_b64_tr_b16 a[46:47], v10 offset:57600
    v_mfma_f32_16x16x32_bf16 v[72:75], a[12:15], a[0:3], v[72:75]
    buffer_load_dwordx4 v6, s[20:23], s27 offen sc1 lds
    ds_read_b64_tr_b16 a[48:49], v10 offset:58368
    s_waitcnt lgkmcnt(11)
    v_mfma_f32_16x16x32_bf16 v[80:83], a[16:19], a[0:3], v[80:83]
    ds_read_b64_tr_b16 a[50:51], v10 offset:58624
    ds_read_b64_tr_b16 a[52:53], v10 offset:59392
    v_mfma_f32_16x16x32_bf16 v[84:87], a[16:19], a[4:7], v[84:87]
    ds_read_b64_tr_b16 a[54:55], v10 offset:59648
    ds_read_b64_tr_b16 a[56:57], v14 offset:60416
    v_mfma_f32_16x16x32_bf16 v[92:95], a[20:23], a[4:7], v[92:95]
    buffer_load_dwordx4 v6, s[20:23], s27 offen offset:1024 sc1 lds
    ds_read_b64_tr_b16 a[58:59], v14 offset:60672
    v_mfma_f32_16x16x32_bf16 v[88:91], a[20:23], a[0:3], v[88:91]
    ds_read_b64_tr_b16 a[60:61], v10 offset:61952
    ds_read_b64_tr_b16 a[62:63], v10 offset:62208
    s_waitcnt lgkmcnt(12)
    v_mfma_f32_16x16x32_bf16 v[96:99], a[24:27], a[0:3], v[96:99]
    ds_read_b64_tr_b16 a[64:65], v10 offset:62976
    ds_read_b64_tr_b16 a[66:67], v10 offset:63232
    v_mfma_f32_16x16x32_bf16 v[100:103], a[24:27], a[4:7], v[100:103]
    ds_read_b64_tr_b16 a[68:69], v10 offset:64000
    v_mfma_f32_16x16x32_bf16 v[108:111], a[28:31], a[4:7], v[108:111]
    buffer_load_dwordx4 v6, s[20:23], s27 offen offset:2048 sc1 lds
    ds_read_b64_tr_b16 a[70:71], v10 offset:64256
    v_mfma_f32_16x16x32_bf16 v[104:107], a[28:31], a[0:3], v[104:107]
    v_mfma_f32_16x16x32_bf16 v[112:115], a[32:35], a[0:3], v[112:115]
    v_mfma_f32_16x16x32_bf16 v[116:119], a[32:35], a[4:7], v[116:119]
    buffer_load_dwordx4 v15, s[20:23], s27 offen offset:3072 sc1 lds
    s_waitcnt lgkmcnt(10)
    v_mfma_f32_16x16x32_bf16 v[64:67], a[44:47], a[36:39], v[64:67]
    v_mfma_f32_16x16x32_bf16 v[68:71], a[44:47], a[40:43], v[68:71]
    s_waitcnt vmcnt(16) lgkmcnt(0)
    s_barrier
    v_mfma_f32_16x16x32_bf16 v[76:79], a[48:51], a[40:43], v[76:79]
    s_lshr_b32 s37, 0x1a161616, s36
    s_and_b32 s37, s37, 0xff
    v_mfma_f32_16x16x32_bf16 v[72:75], a[48:51], a[36:39], v[72:75]
    s_lshl_b32 s26, s37, 7
    s_add_u32 m0, s24, 49152
    v_mfma_f32_16x16x32_bf16 v[80:83], a[52:55], a[36:39], v[80:83]
    buffer_load_dwordx4 v2, s[8:11], s26 offen lds
    ds_read_b128 a[0:3], v8 offset:0
    v_mfma_f32_16x16x32_bf16 v[84:87], a[52:55], a[40:43], v[84:87]
    ds_read_b128 a[4:7], v8 offset:2048
    ds_read_b64_tr_b16 a[8:9], v10 offset:0
    v_mfma_f32_16x16x32_bf16 v[92:95], a[56:59], a[40:43], v[92:95]
    buffer_load_dwordx4 v3, s[8:11], s26 offen offset:1024 lds
    ds_read_b64_tr_b16 a[10:11], v10 offset:256
    v_mfma_f32_16x16x32_bf16 v[88:91], a[56:59], a[36:39], v[88:91]
    ds_read_b64_tr_b16 a[12:13], v10 offset:1024
    ds_read_b64_tr_b16 a[14:15], v10 offset:1280
    v_mfma_f32_16x16x32_bf16 v[96:99], a[60:63], a[36:39], v[96:99]
    ds_read_b64_tr_b16 a[16:17], v10 offset:2048
    ds_read_b64_tr_b16 a[18:19], v10 offset:2304
    v_mfma_f32_16x16x32_bf16 v[100:103], a[60:63], a[40:43], v[100:103]
    ds_read_b64_tr_b16 a[20:21], v14 offset:3072
    ds_read_b64_tr_b16 a[22:23], v14 offset:3328
    v_mfma_f32_16x16x32_bf16 v[108:111], a[64:67], a[40:43], v[108:111]
    buffer_load_dwordx4 v4, s[8:11], s26 offen offset:2048 lds
    ds_read_b64_tr_b16 a[24:25], v10 offset:4608
    v_mfma_f32_16x16x32_bf16 v[104:107], a[64:67], a[36:39], v[104:107]
    ds_read_b64_tr_b16 a[26:27], v10 offset:4864
    ds_read_b64_tr_b16 a[28:29], v10 offset:5632
    v_mfma_f32_16x16x32_bf16 v[112:115], a[68:71], a[36:39], v[112:115]
    ds_read_b64_tr_b16 a[30:31], v10 offset:5888
    ds_read_b64_tr_b16 a[32:33], v10 offset:6656
    v_mfma_f32_16x16x32_bf16 v[116:119], a[68:71], a[40:43], v[116:119]
    buffer_load_dwordx4 v5, s[8:11], s26 offen offset:3072 lds
    ds_read_b64_tr_b16 a[34:35], v10 offset:6912
    s_waitcnt lgkmcnt(10)
    v_mfma_f32_16x16x32_bf16 v[64:67], a[8:11], a[0:3], v[64:67]
    ds_read_b128 a[36:39], v9 offset:0
    ds_read_b128 a[40:43], v9 offset:2048
    v_mfma_f32_16x16x32_bf16 v[68:71], a[8:11], a[4:7], v[68:71]
    s_mul_i32 s27, s37, 229376
    ds_read_b64_tr_b16 a[44:45], v10 offset:8192
    v_mfma_f32_16x16x32_bf16 v[76:79], a[12:15], a[4:7], v[76:79]
    s_add_u32 m0, s25, 49152
    ds_read_b64_tr_b16 a[46:47], v10 offset:8448
    v_mfma_f32_16x16x32_bf16 v[72:75], a[12:15], a[0:3], v[72:75]
    buffer_load_dwordx4 v6, s[20:23], s27 offen sc1 lds
    ds_read_b64_tr_b16 a[48:49], v10 offset:9216
    s_waitcnt lgkmcnt(11)
    v_mfma_f32_16x16x32_bf16 v[80:83], a[16:19], a[0:3], v[80:83]
    ds_read_b64_tr_b16 a[50:51], v10 offset:9472
    ds_read_b64_tr_b16 a[52:53], v10 offset:10240
    v_mfma_f32_16x16x32_bf16 v[84:87], a[16:19], a[4:7], v[84:87]
    ds_read_b64_tr_b16 a[54:55], v10 offset:10496
    ds_read_b64_tr_b16 a[56:57], v14 offset:11264
    v_mfma_f32_16x16x32_bf16 v[92:95], a[20:23], a[4:7], v[92:95]
    buffer_load_dwordx4 v6, s[20:23], s27 offen offset:1024 sc1 lds
    ds_read_b64_tr_b16 a[58:59], v14 offset:11520
    v_mfma_f32_16x16x32_bf16 v[88:91], a[20:23], a[0:3], v[88:91]
    ds_read_b64_tr_b16 a[60:61], v10 offset:12800
    ds_read_b64_tr_b16 a[62:63], v10 offset:13056
    s_waitcnt lgkmcnt(12)
    v_mfma_f32_16x16x32_bf16 v[96:99], a[24:27], a[0:3], v[96:99]
    ds_read_b64_tr_b16 a[64:65], v10 offset:13824
    ds_read_b64_tr_b16 a[66:67], v10 offset:14080
    v_mfma_f32_16x16x32_bf16 v[100:103], a[24:27], a[4:7], v[100:103]
    ds_read_b64_tr_b16 a[68:69], v10 offset:14848
    v_mfma_f32_16x16x32_bf16 v[108:111], a[28:31], a[4:7], v[108:111]
    buffer_load_dwordx4 v6, s[20:23], s27 offen offset:2048 sc1 lds
    ds_read_b64_tr_b16 a[70:71], v10 offset:15104
    v_mfma_f32_16x16x32_bf16 v[104:107], a[28:31], a[0:3], v[104:107]
    v_mfma_f32_16x16x32_bf16 v[112:115], a[32:35], a[0:3], v[112:115]
    v_mfma_f32_16x16x32_bf16 v[116:119], a[32:35], a[4:7], v[116:119]
    buffer_load_dwordx4 v15, s[20:23], s27 offen offset:3072 sc1 lds
    s_waitcnt lgkmcnt(10)
    v_mfma_f32_16x16x32_bf16 v[64:67], a[44:47], a[36:39], v[64:67]
    s_lshr_b32 s48, s38, 1
    v_mfma_f32_16x16x32_bf16 v[68:71], a[44:47], a[40:43], v[68:71]
    s_waitcnt vmcnt(16) lgkmcnt(0)
    s_barrier
    v_mfma_f32_16x16x32_bf16 v[76:79], a[48:51], a[40:43], v[76:79]
    s_lshr_b32 s37, 0x1717171b, s36
    s_and_b32 s37, s37, 0xff
    s_add_u32 s48, s48, 8
    v_mfma_f32_16x16x32_bf16 v[72:75], a[48:51], a[36:39], v[72:75]
    s_lshl_b32 s26, s37, 7
    s_add_u32 m0, s24, 0
    v_mfma_f32_16x16x32_bf16 v[80:83], a[52:55], a[36:39], v[80:83]
    buffer_load_dwordx4 v2, s[8:11], s26 offen lds
    ds_read_b128 a[0:3], v8 offset:16384
    s_lshl_b32 s48, s48, 7
    v_mfma_f32_16x16x32_bf16 v[84:87], a[52:55], a[40:43], v[84:87]
    ds_read_b128 a[4:7], v8 offset:18432
    ds_read_b64_tr_b16 a[8:9], v10 offset:16384
    v_mfma_f32_16x16x32_bf16 v[92:95], a[56:59], a[40:43], v[92:95]
    buffer_load_dwordx4 v3, s[8:11], s26 offen offset:1024 lds
    ds_read_b64_tr_b16 a[10:11], v10 offset:16640
    v_mfma_f32_16x16x32_bf16 v[88:91], a[56:59], a[36:39], v[88:91]
    ds_read_b64_tr_b16 a[12:13], v10 offset:17408
    ds_read_b64_tr_b16 a[14:15], v10 offset:17664
    s_add_u32 s48, s48, 26607616
    v_mfma_f32_16x16x32_bf16 v[96:99], a[60:63], a[36:39], v[96:99]
    ds_read_b64_tr_b16 a[16:17], v10 offset:18432
    ds_read_b64_tr_b16 a[18:19], v10 offset:18688
    v_mfma_f32_16x16x32_bf16 v[100:103], a[60:63], a[40:43], v[100:103]
    ds_read_b64_tr_b16 a[20:21], v14 offset:19456
    ds_read_b64_tr_b16 a[22:23], v14 offset:19712
    v_mov_b32 v22, 0
    v_mfma_f32_16x16x32_bf16 v[108:111], a[64:67], a[40:43], v[108:111]
    buffer_load_dwordx4 v4, s[8:11], s26 offen offset:2048 lds
    ds_read_b64_tr_b16 a[24:25], v10 offset:20992
    v_mfma_f32_16x16x32_bf16 v[104:107], a[64:67], a[36:39], v[104:107]
    ds_read_b64_tr_b16 a[26:27], v10 offset:21248
    ds_read_b64_tr_b16 a[28:29], v10 offset:22016
    buffer_load_dword v23, v22, s[20:23], s48 offen sc1
    v_mfma_f32_16x16x32_bf16 v[112:115], a[68:71], a[36:39], v[112:115]
    ds_read_b64_tr_b16 a[30:31], v10 offset:22272
    ds_read_b64_tr_b16 a[32:33], v10 offset:23040
    v_mfma_f32_16x16x32_bf16 v[116:119], a[68:71], a[40:43], v[116:119]
    buffer_load_dwordx4 v5, s[8:11], s26 offen offset:3072 lds
    ds_read_b64_tr_b16 a[34:35], v10 offset:23296
    s_waitcnt lgkmcnt(10)
    v_mfma_f32_16x16x32_bf16 v[64:67], a[8:11], a[0:3], v[64:67]
    ds_read_b128 a[36:39], v9 offset:16384
    ds_read_b128 a[40:43], v9 offset:18432
    v_mfma_f32_16x16x32_bf16 v[68:71], a[8:11], a[4:7], v[68:71]
    s_mul_i32 s27, s37, 229376
    ds_read_b64_tr_b16 a[44:45], v10 offset:24576
    v_mfma_f32_16x16x32_bf16 v[76:79], a[12:15], a[4:7], v[76:79]
    s_add_u32 m0, s25, 0
    ds_read_b64_tr_b16 a[46:47], v10 offset:24832
    v_mfma_f32_16x16x32_bf16 v[72:75], a[12:15], a[0:3], v[72:75]
    buffer_load_dwordx4 v6, s[20:23], s27 offen sc1 lds
    ds_read_b64_tr_b16 a[48:49], v10 offset:25600
    s_waitcnt lgkmcnt(11)
    v_mfma_f32_16x16x32_bf16 v[80:83], a[16:19], a[0:3], v[80:83]
    ds_read_b64_tr_b16 a[50:51], v10 offset:25856
    ds_read_b64_tr_b16 a[52:53], v10 offset:26624
    v_mfma_f32_16x16x32_bf16 v[84:87], a[16:19], a[4:7], v[84:87]
    ds_read_b64_tr_b16 a[54:55], v10 offset:26880
    ds_read_b64_tr_b16 a[56:57], v14 offset:27648
    v_mfma_f32_16x16x32_bf16 v[92:95], a[20:23], a[4:7], v[92:95]
    buffer_load_dwordx4 v6, s[20:23], s27 offen offset:1024 sc1 lds
    ds_read_b64_tr_b16 a[58:59], v14 offset:27904
    v_mfma_f32_16x16x32_bf16 v[88:91], a[20:23], a[0:3], v[88:91]
    ds_read_b64_tr_b16 a[60:61], v10 offset:29184
    ds_read_b64_tr_b16 a[62:63], v10 offset:29440
    s_waitcnt lgkmcnt(12)
    v_mfma_f32_16x16x32_bf16 v[96:99], a[24:27], a[0:3], v[96:99]
    ds_read_b64_tr_b16 a[64:65], v10 offset:30208
    ds_read_b64_tr_b16 a[66:67], v10 offset:30464
    v_mfma_f32_16x16x32_bf16 v[100:103], a[24:27], a[4:7], v[100:103]
    ds_read_b64_tr_b16 a[68:69], v10 offset:31232
    v_mfma_f32_16x16x32_bf16 v[108:111], a[28:31], a[4:7], v[108:111]
    buffer_load_dwordx4 v6, s[20:23], s27 offen offset:2048 sc1 lds
    ds_read_b64_tr_b16 a[70:71], v10 offset:31488
    v_mfma_f32_16x16x32_bf16 v[104:107], a[28:31], a[0:3], v[104:107]
    v_mfma_f32_16x16x32_bf16 v[112:115], a[32:35], a[0:3], v[112:115]
    v_mfma_f32_16x16x32_bf16 v[116:119], a[32:35], a[4:7], v[116:119]
    buffer_load_dwordx4 v15, s[20:23], s27 offen offset:3072 sc1 lds
    s_waitcnt lgkmcnt(10)
    v_mfma_f32_16x16x32_bf16 v[64:67], a[44:47], a[36:39], v[64:67]
    v_mfma_f32_16x16x32_bf16 v[68:71], a[44:47], a[40:43], v[68:71]
    s_waitcnt vmcnt(17) lgkmcnt(0)
    s_barrier
    v_mfma_f32_16x16x32_bf16 v[76:79], a[48:51], a[40:43], v[76:79]
    s_lshr_b32 s37, 0x18181c18, s36
    s_and_b32 s37, s37, 0xff
    v_mfma_f32_16x16x32_bf16 v[72:75], a[48:51], a[36:39], v[72:75]
    s_lshl_b32 s26, s37, 7
    s_add_u32 m0, s24, 16384
    v_mfma_f32_16x16x32_bf16 v[80:83], a[52:55], a[36:39], v[80:83]
    buffer_load_dwordx4 v2, s[8:11], s26 offen lds
    ds_read_b128 a[0:3], v8 offset:32768
    v_mfma_f32_16x16x32_bf16 v[84:87], a[52:55], a[40:43], v[84:87]
    ds_read_b128 a[4:7], v8 offset:34816
    ds_read_b64_tr_b16 a[8:9], v10 offset:32768
    v_mfma_f32_16x16x32_bf16 v[92:95], a[56:59], a[40:43], v[92:95]
    buffer_load_dwordx4 v3, s[8:11], s26 offen offset:1024 lds
    ds_read_b64_tr_b16 a[10:11], v10 offset:33024
    v_mfma_f32_16x16x32_bf16 v[88:91], a[56:59], a[36:39], v[88:91]
    ds_read_b64_tr_b16 a[12:13], v10 offset:33792
    ds_read_b64_tr_b16 a[14:15], v10 offset:34048
    v_mfma_f32_16x16x32_bf16 v[96:99], a[60:63], a[36:39], v[96:99]
    ds_read_b64_tr_b16 a[16:17], v10 offset:34816
    ds_read_b64_tr_b16 a[18:19], v10 offset:35072
    v_mfma_f32_16x16x32_bf16 v[100:103], a[60:63], a[40:43], v[100:103]
    ds_read_b64_tr_b16 a[20:21], v14 offset:35840
    ds_read_b64_tr_b16 a[22:23], v14 offset:36096
    v_mfma_f32_16x16x32_bf16 v[108:111], a[64:67], a[40:43], v[108:111]
    buffer_load_dwordx4 v4, s[8:11], s26 offen offset:2048 lds
    ds_read_b64_tr_b16 a[24:25], v10 offset:37376
    v_mfma_f32_16x16x32_bf16 v[104:107], a[64:67], a[36:39], v[104:107]
    ds_read_b64_tr_b16 a[26:27], v10 offset:37632
    ds_read_b64_tr_b16 a[28:29], v10 offset:38400
    v_mfma_f32_16x16x32_bf16 v[112:115], a[68:71], a[36:39], v[112:115]
    ds_read_b64_tr_b16 a[30:31], v10 offset:38656
    ds_read_b64_tr_b16 a[32:33], v10 offset:39424
    v_mfma_f32_16x16x32_bf16 v[116:119], a[68:71], a[40:43], v[116:119]
    buffer_load_dwordx4 v5, s[8:11], s26 offen offset:3072 lds
    ds_read_b64_tr_b16 a[34:35], v10 offset:39680
    s_waitcnt lgkmcnt(10)
    v_mfma_f32_16x16x32_bf16 v[64:67], a[8:11], a[0:3], v[64:67]
    ds_read_b128 a[36:39], v9 offset:32768
    ds_read_b128 a[40:43], v9 offset:34816
    v_mfma_f32_16x16x32_bf16 v[68:71], a[8:11], a[4:7], v[68:71]
    s_mul_i32 s27, s37, 229376
    ds_read_b64_tr_b16 a[44:45], v10 offset:40960
    v_mfma_f32_16x16x32_bf16 v[76:79], a[12:15], a[4:7], v[76:79]
    s_add_u32 m0, s25, 16384
    ds_read_b64_tr_b16 a[46:47], v10 offset:41216
    v_mfma_f32_16x16x32_bf16 v[72:75], a[12:15], a[0:3], v[72:75]
    buffer_load_dwordx4 v6, s[20:23], s27 offen sc1 lds
    ds_read_b64_tr_b16 a[48:49], v10 offset:41984
    s_waitcnt lgkmcnt(11)
    v_mfma_f32_16x16x32_bf16 v[80:83], a[16:19], a[0:3], v[80:83]
    ds_read_b64_tr_b16 a[50:51], v10 offset:42240
    ds_read_b64_tr_b16 a[52:53], v10 offset:43008
    v_mfma_f32_16x16x32_bf16 v[84:87], a[16:19], a[4:7], v[84:87]
    ds_read_b64_tr_b16 a[54:55], v10 offset:43264
    ds_read_b64_tr_b16 a[56:57], v14 offset:44032
    v_mfma_f32_16x16x32_bf16 v[92:95], a[20:23], a[4:7], v[92:95]
    buffer_load_dwordx4 v6, s[20:23], s27 offen offset:1024 sc1 lds
    ds_read_b64_tr_b16 a[58:59], v14 offset:44288
    v_mfma_f32_16x16x32_bf16 v[88:91], a[20:23], a[0:3], v[88:91]
    ds_read_b64_tr_b16 a[60:61], v10 offset:45568
    ds_read_b64_tr_b16 a[62:63], v10 offset:45824
    s_waitcnt lgkmcnt(12)
    v_mfma_f32_16x16x32_bf16 v[96:99], a[24:27], a[0:3], v[96:99]
    ds_read_b64_tr_b16 a[64:65], v10 offset:46592
    ds_read_b64_tr_b16 a[66:67], v10 offset:46848
    v_mfma_f32_16x16x32_bf16 v[100:103], a[24:27], a[4:7], v[100:103]
    ds_read_b64_tr_b16 a[68:69], v10 offset:47616
    v_mfma_f32_16x16x32_bf16 v[108:111], a[28:31], a[4:7], v[108:111]
    buffer_load_dwordx4 v6, s[20:23], s27 offen offset:2048 sc1 lds
    ds_read_b64_tr_b16 a[70:71], v10 offset:47872
    v_mfma_f32_16x16x32_bf16 v[104:107], a[28:31], a[0:3], v[104:107]
    v_mfma_f32_16x16x32_bf16 v[112:115], a[32:35], a[0:3], v[112:115]
    v_mfma_f32_16x16x32_bf16 v[116:119], a[32:35], a[4:7], v[116:119]
    buffer_load_dwordx4 v15, s[20:23], s27 offen offset:3072 sc1 lds
    s_waitcnt lgkmcnt(10)
    s_waitcnt vmcnt(13)
    s_mov_b32 s47, 0
    v_cmp_gt_u32 vcc, 32, v23
    s_nop 1
    s_cmp_eq_u64 vcc, 0
    s_cbranch_scc1 L_polled_1_31
L_poll_1_30:
    buffer_load_dword v23, v22, s[20:23], s48 offen sc1
    s_waitcnt vmcnt(0)
    v_cmp_gt_u32 vcc, 32, v23
    s_nop 1
    s_cmp_eq_u64 vcc, 0
    s_cbranch_scc1 L_polled_1_31
    s_add_u32 s47, s47, 1
    s_cmp_lt_u32 s47, 262144
    s_cbranch_scc1 L_poll_1_30
L_polled_1_31:
    s_nop 1
    v_mfma_f32_16x16x32_bf16 v[64:67], a[44:47], a[36:39], v[64:67]
    buffer_load_dwordx4 v[192:195], v7, s[20:23], s50 offen offset:0 sc1
    v_mfma_f32_16x16x32_bf16 v[68:71], a[44:47], a[40:43], v[68:71]
    s_waitcnt vmcnt(18) lgkmcnt(0)
    s_barrier
    v_mfma_f32_16x16x32_bf16 v[76:79], a[48:51], a[40:43], v[76:79]
    s_lshr_b32 s37, 0x191d1919, s36
    s_and_b32 s37, s37, 0xff
    v_mfma_f32_16x16x32_bf16 v[72:75], a[48:51], a[36:39], v[72:75]
    s_lshl_b32 s26, s37, 7
    s_add_u32 m0, s24, 32768
    v_mfma_f32_16x16x32_bf16 v[80:83], a[52:55], a[36:39], v[80:83]
    buffer_load_dwordx4 v2, s[8:11], s26 offen lds
    ds_read_b128 a[0:3], v8 offset:49152
    v_mfma_f32_16x16x32_bf16 v[84:87], a[52:55], a[40:43], v[84:87]
    ds_read_b128 a[4:7], v8 offset:51200
    ds_read_b64_tr_b16 a[8:9], v10 offset:49152
    v_mfma_f32_16x16x32_bf16 v[92:95], a[56:59], a[40:43], v[92:95]
    buffer_load_dwordx4 v3, s[8:11], s26 offen offset:1024 lds
    ds_read_b64_tr_b16 a[10:11], v10 offset:49408
    v_mfma_f32_16x16x32_bf16 v[88:91], a[56:59], a[36:39], v[88:91]
    ds_read_b64_tr_b16 a[12:13], v10 offset:50176
    ds_read_b64_tr_b16 a[14:15], v10 offset:50432
    v_mfma_f32_16x16x32_bf16 v[96:99], a[60:63], a[36:39], v[96:99]
    ds_read_b64_tr_b16 a[16:17], v10 offset:51200
    ds_read_b64_tr_b16 a[18:19], v10 offset:51456
    buffer_load_dwordx4 v[196:199], v7, s[20:23], s50 offen offset:1024 sc1
    v_mfma_f32_16x16x32_bf16 v[100:103], a[60:63], a[40:43], v[100:103]
    ds_read_b64_tr_b16 a[20:21], v14 offset:52224
    ds_read_b64_tr_b16 a[22:23], v14 offset:52480
    v_mfma_f32_16x16x32_bf16 v[108:111], a[64:67], a[40:43], v[108:111]
    buffer_load_dwordx4 v4, s[8:11], s26 offen offset:2048 lds
    ds_read_b64_tr_b16 a[24:25], v10 offset:53760
    v_mfma_f32_16x16x32_bf16 v[104:107], a[64:67], a[36:39], v[104:107]
    ds_read_b64_tr_b16 a[26:27], v10 offset:54016
    ds_read_b64_tr_b16 a[28:29], v10 offset:54784
    v_mfma_f32_16x16x32_bf16 v[112:115], a[68:71], a[36:39], v[112:115]
    ds_read_b64_tr_b16 a[30:31], v10 offset:55040
    ds_read_b64_tr_b16 a[32:33], v10 offset:55808
    v_mfma_f32_16x16x32_bf16 v[116:119], a[68:71], a[40:43], v[116:119]
    buffer_load_dwordx4 v5, s[8:11], s26 offen offset:3072 lds
    ds_read_b64_tr_b16 a[34:35], v10 offset:56064
    s_waitcnt lgkmcnt(10)
    v_mfma_f32_16x16x32_bf16 v[64:67], a[8:11], a[0:3], v[64:67]
    ds_read_b128 a[36:39], v9 offset:49152
    ds_read_b128 a[40:43], v9 offset:51200
    v_mfma_f32_16x16x32_bf16 v[68:71], a[8:11], a[4:7], v[68:71]
    s_mul_i32 s27, s37, 229376
    ds_read_b64_tr_b16 a[44:45], v10 offset:57344
    v_mfma_f32_16x16x32_bf16 v[76:79], a[12:15], a[4:7], v[76:79]
    s_add_u32 m0, s25, 32768
    ds_read_b64_tr_b16 a[46:47], v10 offset:57600
    buffer_load_dwordx4 v[200:203], v7, s[20:23], s50 offen offset:2048 sc1
    v_mfma_f32_16x16x32_bf16 v[72:75], a[12:15], a[0:3], v[72:75]
    buffer_load_dwordx4 v6, s[20:23], s27 offen sc1 lds
    ds_read_b64_tr_b16 a[48:49], v10 offset:58368
    s_waitcnt lgkmcnt(11)
    v_mfma_f32_16x16x32_bf16 v[80:83], a[16:19], a[0:3], v[80:83]
    ds_read_b64_tr_b16 a[50:51], v10 offset:58624
    ds_read_b64_tr_b16 a[52:53], v10 offset:59392
    v_mfma_f32_16x16x32_bf16 v[84:87], a[16:19], a[4:7], v[84:87]
    ds_read_b64_tr_b16 a[54:55], v10 offset:59648
    ds_read_b64_tr_b16 a[56:57], v14 offset:60416
    v_mfma_f32_16x16x32_bf16 v[92:95], a[20:23], a[4:7], v[92:95]
    buffer_load_dwordx4 v6, s[20:23], s27 offen offset:1024 sc1 lds
    ds_read_b64_tr_b16 a[58:59], v14 offset:60672
    v_mfma_f32_16x16x32_bf16 v[88:91], a[20:23], a[0:3], v[88:91]
    ds_read_b64_tr_b16 a[60:61], v10 offset:61952
    ds_read_b64_tr_b16 a[62:63], v10 offset:62208
    s_waitcnt lgkmcnt(12)
    v_mfma_f32_16x16x32_bf16 v[96:99], a[24:27], a[0:3], v[96:99]
    ds_read_b64_tr_b16 a[64:65], v10 offset:62976
    ds_read_b64_tr_b16 a[66:67], v10 offset:63232
    v_mfma_f32_16x16x32_bf16 v[100:103], a[24:27], a[4:7], v[100:103]
    ds_read_b64_tr_b16 a[68:69], v10 offset:64000
    v_mfma_f32_16x16x32_bf16 v[108:111], a[28:31], a[4:7], v[108:111]
    buffer_load_dwordx4 v6, s[20:23], s27 offen offset:2048 sc1 lds
    ds_read_b64_tr_b16 a[70:71], v10 offset:64256
    buffer_load_dwordx4 v[204:207], v7, s[20:23], s50 offen offset:3072 sc1
    v_mfma_f32_16x16x32_bf16 v[104:107], a[28:31], a[0:3], v[104:107]
    v_mfma_f32_16x16x32_bf16 v[112:115], a[32:35], a[0:3], v[112:115]
    v_mfma_f32_16x16x32_bf16 v[116:119], a[32:35], a[4:7], v[116:119]
    buffer_load_dwordx4 v15, s[20:23], s27 offen offset:3072 sc1 lds
    s_waitcnt lgkmcnt(10)
    v_mfma_f32_16x16x32_bf16 v[64:67], a[44:47], a[36:39], v[64:67]
    v_mfma_f32_16x16x32_bf16 v[68:71], a[44:47], a[40:43], v[68:71]
    s_waitcnt vmcnt(20) lgkmcnt(0)
    s_barrier
    v_mfma_f32_16x16x32_bf16 v[76:79], a[48:51], a[40:43], v[76:79]
    s_lshr_b32 s37, 0x1e1a1a1a, s36
    s_and_b32 s37, s37, 0xff
    v_mfma_f32_16x16x32_bf16 v[72:75], a[48:51], a[36:39], v[72:75]
    s_lshl_b32 s26, s37, 7
    s_add_u32 m0, s24, 49152
    v_mfma_f32_16x16x32_bf16 v[80:83], a[52:55], a[36:39], v[80:83]
    buffer_load_dwordx4 v2, s[8:11], s26 offen lds
    ds_read_b128 a[0:3], v8 offset:0
    buffer_load_dwordx4 v[208:211], v7, s[20:23], s51 offen offset:0 sc1
    v_mfma_f32_16x16x32_bf16 v[84:87], a[52:55], a[40:43], v[84:87]
    ds_read_b128 a[4:7], v8 offset:2048
    ds_read_b64_tr_b16 a[8:9], v10 offset:0
    v_mfma_f32_16x16x32_bf16 v[92:95], a[56:59], a[40:43], v[92:95]
    buffer_load_dwordx4 v3, s[8:11], s26 offen offset:1024 lds
    ds_read_b64_tr_b16 a[10:11], v10 offset:256
    v_mfma_f32_16x16x32_bf16 v[88:91], a[56:59], a[36:39], v[88:91]
    ds_read_b64_tr_b16 a[12:13], v10 offset:1024
    ds_read_b64_tr_b16 a[14:15], v10 offset:1280
    v_mfma_f32_16x16x32_bf16 v[96:99], a[60:63], a[36:39], v[96:99]
    ds_read_b64_tr_b16 a[16:17], v10 offset:2048
    ds_read_b64_tr_b16 a[18:19], v10 offset:2304
    v_mfma_f32_16x16x32_bf16 v[100:103], a[60:63], a[40:43], v[100:103]
    ds_read_b64_tr_b16 a[20:21], v14 offset:3072
    ds_read_b64_tr_b16 a[22:23], v14 offset:3328
    v_mfma_f32_16x16x32_bf16 v[108:111], a[64:67], a[40:43], v[108:111]
    buffer_load_dwordx4 v4, s[8:11], s26 offen offset:2048 lds
    ds_read_b64_tr_b16 a[24:25], v10 offset:4608
    v_mfma_f32_16x16x32_bf16 v[104:107], a[64:67], a[36:39], v[104:107]
    ds_read_b64_tr_b16 a[26:27], v10 offset:4864
    ds_read_b64_tr_b16 a[28:29], v10 offset:5632
    v_mfma_f32_16x16x32_bf16 v[112:115], a[68:71], a[36:39], v[112:115]
    ds_read_b64_tr_b16 a[30:31], v10 offset:5888
    ds_read_b64_tr_b16 a[32:33], v10 offset:6656
    buffer_load_dwordx4 v[212:215], v7, s[20:23], s51 offen offset:1024 sc1
    v_mfma_f32_16x16x32_bf16 v[116:119], a[68:71], a[40:43], v[116:119]
    buffer_load_dwordx4 v5, s[8:11], s26 offen offset:3072 lds
    ds_read_b64_tr_b16 a[34:35], v10 offset:6912
    s_waitcnt lgkmcnt(10)
    v_mfma_f32_16x16x32_bf16 v[64:67], a[8:11], a[0:3], v[64:67]
    ds_read_b128 a[36:39], v9 offset:0
    ds_read_b128 a[40:43], v9 offset:2048
    v_mfma_f32_16x16x32_bf16 v[68:71], a[8:11], a[4:7], v[68:71]
    s_mul_i32 s27, s37, 229376
    ds_read_b64_tr_b16 a[44:45], v10 offset:8192
    v_mfma_f32_16x16x32_bf16 v[76:79], a[12:15], a[4:7], v[76:79]
    s_add_u32 m0, s25, 49152
    ds_read_b64_tr_b16 a[46:47], v10 offset:8448
    v_mfma_f32_16x16x32_bf16 v[72:75], a[12:15], a[0:3], v[72:75]
    buffer_load_dwordx4 v6, s[20:23], s27 offen sc1 lds
    ds_read_b64_tr_b16 a[48:49], v10 offset:9216
    s_waitcnt lgkmcnt(11)
    v_mfma_f32_16x16x32_bf16 v[80:83], a[16:19], a[0:3], v[80:83]
    ds_read_b64_tr_b16 a[50:51], v10 offset:9472
    ds_read_b64_tr_b16 a[52:53], v10 offset:10240
    v_mfma_f32_16x16x32_bf16 v[84:87], a[16:19], a[4:7], v[84:87]
    ds_read_b64_tr_b16 a[54:55], v10 offset:10496
    ds_read_b64_tr_b16 a[56:57], v14 offset:11264
    v_mfma_f32_16x16x32_bf16 v[92:95], a[20:23], a[4:7], v[92:95]
    buffer_load_dwordx4 v6, s[20:23], s27 offen offset:1024 sc1 lds
    ds_read_b64_tr_b16 a[58:59], v14 offset:11520
    buffer_load_dwordx4 v[216:219], v7, s[20:23], s51 offen offset:2048 sc1
    v_mfma_f32_16x16x32_bf16 v[88:91], a[20:23], a[0:3], v[88:91]
    ds_read_b64_tr_b16 a[60:61], v10 offset:12800
    ds_read_b64_tr_b16 a[62:63], v10 offset:13056
    s_waitcnt lgkmcnt(12)
    v_mfma_f32_16x16x32_bf16 v[96:99], a[24:27], a[0:3], v[96:99]
    ds_read_b64_tr_b16 a[64:65], v10 offset:13824
    ds_read_b64_tr_b16 a[66:67], v10 offset:14080
    v_mfma_f32_16x16x32_bf16 v[100:103], a[24:27], a[4:7], v[100:103]
    ds_read_b64_tr_b16 a[68:69], v10 offset:14848
    v_mfma_f32_16x16x32_bf16 v[108:111], a[28:31], a[4:7], v[108:111]
    buffer_load_dwordx4 v6, s[20:23], s27 offen offset:2048 sc1 lds
    ds_read_b64_tr_b16 a[70:71], v10 offset:15104
    v_mfma_f32_16x16x32_bf16 v[104:107], a[28:31], a[0:3], v[104:107]
    v_mfma_f32_16x16x32_bf16 v[112:115], a[32:35], a[0:3], v[112:115]
    v_mfma_f32_16x16x32_bf16 v[116:119], a[32:35], a[4:7], v[116:119]
    buffer_load_dwordx4 v15, s[20:23], s27 offen offset:3072 sc1 lds
    s_waitcnt lgkmcnt(10)
    v_mfma_f32_16x16x32_bf16 v[64:67], a[44:47], a[36:39], v[64:67]
    v_mfma_f32_16x16x32_bf16 v[68:71], a[44:47], a[40:43], v[68:71]
    s_waitcnt vmcnt(23) lgkmcnt(0)
    s_barrier
    v_mfma_f32_16x16x32_bf16 v[76:79], a[48:51], a[40:43], v[76:79]
    s_lshr_b32 s37, 0x1b1b1b1f, s36
    s_and_b32 s37, s37, 0xff
    v_mfma_f32_16x16x32_bf16 v[72:75], a[48:51], a[36:39], v[72:75]
    s_lshl_b32 s26, s37, 7
    s_add_u32 m0, s24, 0
    v_mfma_f32_16x16x32_bf16 v[80:83], a[52:55], a[36:39], v[80:83]
    buffer_load_dwordx4 v2, s[8:11], s26 offen lds
    ds_read_b128 a[0:3], v8 offset:16384
    v_mfma_f32_16x16x32_bf16 v[84:87], a[52:55], a[40:43], v[84:87]
    ds_read_b128 a[4:7], v8 offset:18432
    ds_read_b64_tr_b16 a[8:9], v10 offset:16384
    v_mfma_f32_16x16x32_bf16 v[92:95], a[56:59], a[40:43], v[92:95]
    buffer_load_dwordx4 v3, s[8:11], s26 offen offset:1024 lds
    ds_read_b64_tr_b16 a[10:11], v10 offset:16640
    v_mfma_f32_16x16x32_bf16 v[88:91], a[56:59], a[36:39], v[88:91]
    ds_read_b64_tr_b16 a[12:13], v10 offset:17408
    ds_read_b64_tr_b16 a[14:15], v10 offset:17664
    v_mfma_f32_16x16x32_bf16 v[96:99], a[60:63], a[36:39], v[96:99]
    ds_read_b64_tr_b16 a[16:17], v10 offset:18432
    ds_read_b64_tr_b16 a[18:19], v10 offset:18688
    v_mfma_f32_16x16x32_bf16 v[100:103], a[60:63], a[40:43], v[100:103]
    ds_read_b64_tr_b16 a[20:21], v14 offset:19456
    ds_read_b64_tr_b16 a[22:23], v14 offset:19712
    v_mfma_f32_16x16x32_bf16 v[108:111], a[64:67], a[40:43], v[108:111]
    buffer_load_dwordx4 v4, s[8:11], s26 offen offset:2048 lds
    ds_read_b64_tr_b16 a[24:25], v10 offset:20992
    v_mfma_f32_16x16x32_bf16 v[104:107], a[64:67], a[36:39], v[104:107]
    ds_read_b64_tr_b16 a[26:27], v10 offset:21248
    ds_read_b64_tr_b16 a[28:29], v10 offset:22016
    v_mfma_f32_16x16x32_bf16 v[112:115], a[68:71], a[36:39], v[112:115]
    ds_read_b64_tr_b16 a[30:31], v10 offset:22272
    ds_read_b64_tr_b16 a[32:33], v10 offset:23040
    v_mfma_f32_16x16x32_bf16 v[116:119], a[68:71], a[40:43], v[116:119]
    buffer_load_dwordx4 v5, s[8:11], s26 offen offset:3072 lds
    ds_read_b64_tr_b16 a[34:35], v10 offset:23296
    s_waitcnt lgkmcnt(10)
    v_mfma_f32_16x16x32_bf16 v[64:67], a[8:11], a[0:3], v[64:67]
    ds_read_b128 a[36:39], v9 offset:16384
    ds_read_b128 a[40:43], v9 offset:18432
    v_lshrrev_b32 v46, 3, v0
    v_mfma_f32_16x16x32_bf16 v[68:71], a[8:11], a[4:7], v[68:71]
    s_mul_i32 s27, s37, 229376
    ds_read_b64_tr_b16 a[44:45], v10 offset:24576
    v_and_b32 v47, 7, v0
    v_mfma_f32_16x16x32_bf16 v[76:79], a[12:15], a[4:7], v[76:79]
    s_add_u32 m0, s25, 0
    ds_read_b64_tr_b16 a[46:47], v10 offset:24832
    v_lshrrev_b32 v48, 4, v0
    v_mfma_f32_16x16x32_bf16 v[72:75], a[12:15], a[0:3], v[72:75]
    buffer_load_dwordx4 v6, s[20:23], s27 offen sc1 lds
    ds_read_b64_tr_b16 a[48:49], v10 offset:25600
    v_lshrrev_b32 v49, 1, v47
    s_waitcnt lgkmcnt(11)
    v_mfma_f32_16x16x32_bf16 v[80:83], a[16:19], a[0:3], v[80:83]
    ds_read_b64_tr_b16 a[50:51], v10 offset:25856
    ds_read_b64_tr_b16 a[52:53], v10 offset:26624
    v_and_b32 v50, 1, v0
    v_mfma_f32_16x16x32_bf16 v[84:87], a[16:19], a[4:7], v[84:87]
    ds_read_b64_tr_b16 a[54:55], v10 offset:26880
    ds_read_b64_tr_b16 a[56:57], v14 offset:27648
    s_lshl_b32 s59, s39, 7
    v_mfma_f32_16x16x32_bf16 v[92:95], a[20:23], a[4:7], v[92:95]
    buffer_load_dwordx4 v6, s[20:23], s27 offen offset:1024 sc1 lds
    ds_read_b64_tr_b16 a[58:59], v14 offset:27904
    v_xor_b32 v51, v49, v48
    v_mfma_f32_16x16x32_bf16 v[88:91], a[20:23], a[0:3], v[88:91]
    ds_read_b64_tr_b16 a[60:61], v10 offset:29184
    ds_read_b64_tr_b16 a[62:63], v10 offset:29440
    v_lshlrev_b32 v51, 5, v51
    s_waitcnt lgkmcnt(12)
    v_mfma_f32_16x16x32_bf16 v[96:99], a[24:27], a[0:3], v[96:99]
    ds_read_b64_tr_b16 a[64:65], v10 offset:30208
    ds_read_b64_tr_b16 a[66:67], v10 offset:30464
    v_lshl_add_u32 v51, v50, 4, v51
    v_mfma_f32_16x16x32_bf16 v[100:103], a[24:27], a[4:7], v[100:103]
    ds_read_b64_tr_b16 a[68:69], v10 offset:31232
    v_add_u32 v51, s59, v51
    s_lshl_b32 s48, s3, 4
    v_mfma_f32_16x16x32_bf16 v[108:111], a[28:31], a[4:7], v[108:111]
    buffer_load_dwordx4 v6, s[20:23], s27 offen offset:2048 sc1 lds
    ds_read_b64_tr_b16 a[70:71], v10 offset:31488
    v_add_u32 v52, s48, v46
    v_mfma_f32_16x16x32_bf16 v[104:107], a[28:31], a[0:3], v[104:107]
    v_lshl_add_u32 v34, v52, 11, v51
    v_add_u32 v35, 15360, v34
    s_lshl_b32 s48, s3, 3
    v_mfma_f32_16x16x32_bf16 v[112:115], a[32:35], a[0:3], v[112:115]
    v_add_u32 v52, s48, v46
    v_lshl_add_u32 v36, v52, 11, v51
    v_mfma_f32_16x16x32_bf16 v[116:119], a[32:35], a[4:7], v[116:119]
    buffer_load_dwordx4 v15, s[20:23], s27 offen offset:3072 sc1 lds
    s_lshl_b32 s48, s3, 2
    s_waitcnt lgkmcnt(10)
    v_mfma_f32_16x16x32_bf16 v[64:67], a[44:47], a[36:39], v[64:67]
    s_add_u32 s48, s48, 32
    v_add_u32 v52, s48, v46
    v_mfma_f32_16x16x32_bf16 v[68:71], a[44:47], a[40:43], v[68:71]
    s_and_b32 s49, s3, 1
    s_waitcnt vmcnt(19) lgkmcnt(0)
    s_barrier
    v_mfma_f32_16x16x32_bf16 v[76:79], a[48:51], a[40:43], v[76:79]
    s_lshr_b32 s37, 0x1c1c1d1c, s36
    s_and_b32 s37, s37, 0xff
    s_lshl_b32 s49, s49, 1
    v_mfma_f32_16x16x32_bf16 v[72:75], a[48:51], a[36:39], v[72:75]
    s_lshl_b32 s26, s37, 7
    s_add_u32 m0, s24, 16384
    v_add_u32 v53, s49, v48
    v_mfma_f32_16x16x32_bf16 v[80:83], a[52:55], a[36:39], v[80:83]
    buffer_load_dwordx4 v2, s[8:11], s26 offen lds
    ds_read_b128 a[0:3], v8 offset:32768
    v_and_b32 v53, 3, v53
    v_mfma_f32_16x16x32_bf16 v[84:87], a[52:55], a[40:43], v[84:87]
    ds_read_b128 a[4:7], v8 offset:34816
    ds_read_b64_tr_b16 a[8:9], v10 offset:32768
    v_xor_b32 v53, v49, v53
    v_mfma_f32_16x16x32_bf16 v[92:95], a[56:59], a[40:43], v[92:95]
    buffer_load_dwordx4 v3, s[8:11], s26 offen offset:1024 lds
    ds_read_b64_tr_b16 a[10:11], v10 offset:33024
    v_lshlrev_b32 v53, 5, v53
    v_mfma_f32_16x16x32_bf16 v[88:91], a[56:59], a[36:39], v[88:91]
    ds_read_b64_tr_b16 a[12:13], v10 offset:33792
    ds_read_b64_tr_b16 a[14:15], v10 offset:34048
    v_lshl_add_u32 v53, v50, 4, v53
    v_mfma_f32_16x16x32_bf16 v[96:99], a[60:63], a[36:39], v[96:99]
    ds_read_b64_tr_b16 a[16:17], v10 offset:34816
    ds_read_b64_tr_b16 a[18:19], v10 offset:35072
    v_add_u32 v53, s59, v53
    v_mfma_f32_16x16x32_bf16 v[100:103], a[60:63], a[40:43], v[100:103]
    ds_read_b64_tr_b16 a[20:21], v14 offset:35840
    ds_read_b64_tr_b16 a[22:23], v14 offset:36096
    v_lshl_add_u32 v37, v52, 11, v53
    v_mfma_f32_16x16x32_bf16 v[108:111], a[64:67], a[40:43], v[108:111]
    buffer_load_dwordx4 v4, s[8:11], s26 offen offset:2048 lds
    ds_read_b64_tr_b16 a[24:25], v10 offset:37376
    s_lshl_b32 s54, s40, 16
    v_mfma_f32_16x16x32_bf16 v[104:107], a[64:67], a[36:39], v[104:107]
    ds_read_b64_tr_b16 a[26:27], v10 offset:37632
    ds_read_b64_tr_b16 a[28:29], v10 offset:38400
    s_add_u32 s54, s54, 14680064
    v_mfma_f32_16x16x32_bf16 v[112:115], a[68:71], a[36:39], v[112:115]
    ds_read_b64_tr_b16 a[30:31], v10 offset:38656
    ds_read_b64_tr_b16 a[32:33], v10 offset:39424
    s_mul_i32 s55, s40, 114688
    v_mfma_f32_16x16x32_bf16 v[116:119], a[68:71], a[40:43], v[116:119]
    buffer_load_dwordx4 v5, s[8:11], s26 offen offset:3072 lds
    ds_read_b64_tr_b16 a[34:35], v10 offset:39680
    s_add_u32 s55, s55, 18874368
    s_waitcnt lgkmcnt(10)
    s_waitcnt vmcnt(14)
    v_mfma_f32_16x16x32_bf16 v[64:67], a[8:11], a[0:3], v[64:67]
    ds_read_b128 a[36:39], v9 offset:32768
    ds_read_b128 a[40:43], v9 offset:34816
    s_lshl_b32 s56, s3, 11
    v_lshlrev_b32 v128, 16, v192
    v_mfma_f32_16x16x32_bf16 v[68:71], a[8:11], a[4:7], v[68:71]
    s_mul_i32 s27, s37, 229376
    ds_read_b64_tr_b16 a[44:45], v10 offset:40960
    s_add_u32 s56, s56, 131072
    v_mfma_f32_16x16x32_bf16 v[76:79], a[12:15], a[4:7], v[76:79]
    s_add_u32 m0, s25, 16384
    ds_read_b64_tr_b16 a[46:47], v10 offset:41216
    s_lshl_b32 s57, s3, 10
    v_and_b32 v129, 0xffff0000, v192
    v_mfma_f32_16x16x32_bf16 v[72:75], a[12:15], a[0:3], v[72:75]
    buffer_load_dwordx4 v6, s[20:23], s27 offen sc1 lds
    ds_read_b64_tr_b16 a[48:49], v10 offset:41984
    s_add_u32 s57, s57, 131072
    s_waitcnt lgkmcnt(11)
    v_mfma_f32_16x16x32_bf16 v[80:83], a[16:19], a[0:3], v[80:83]
    ds_read_b64_tr_b16 a[50:51], v10 offset:42240
    ds_read_b64_tr_b16 a[52:53], v10 offset:43008
    s_lshl_b32 s58, s3, 9
    v_mfma_f32_16x16x32_bf16 v[84:87], a[16:19], a[4:7], v[84:87]
    ds_read_b64_tr_b16 a[54:55], v10 offset:43264
    ds_read_b64_tr_b16 a[56:57], v14 offset:44032
    s_add_u32 s58, s58, 135168
    v_lshlrev_b32 v130, 16, v193
    v_mfma_f32_16x16x32_bf16 v[92:95], a[20:23], a[4:7], v[92:95]
    buffer_load_dwordx4 v6, s[20:23], s27 offen offset:1024 sc1 lds
    ds_read_b64_tr_b16 a[58:59], v14 offset:44288
    v_lshrrev_b32 v46, 2, v0
    v_mfma_f32_16x16x32_bf16 v[88:91], a[20:23], a[0:3], v[88:91]
    ds_read_b64_tr_b16 a[60:61], v10 offset:45568
    ds_read_b64_tr_b16 a[62:63], v10 offset:45824
    v_and_b32 v47, 3, v0
    s_waitcnt lgkmcnt(12)
    v_mfma_f32_16x16x32_bf16 v[96:99], a[24:27], a[0:3], v[96:99]
    ds_read_b64_tr_b16 a[64:65], v10 offset:46592
    ds_read_b64_tr_b16 a[66:67], v10 offset:46848
    v_lshlrev_b32 v48, 7, v46
    v_and_b32 v131, 0xffff0000, v193
    v_mfma_f32_16x16x32_bf16 v[100:103], a[24:27], a[4:7], v[100:103]
    ds_read_b64_tr_b16 a[68:69], v10 offset:47616
    v_lshl_add_u32 v48, v47, 3, v48
    v_add_u32 v48, 131072, v48
    v_mfma_f32_16x16x32_bf16 v[108:111], a[28:31], a[4:7], v[108:111]
    buffer_load_dwordx4 v6, s[20:23], s27 offen offset:2048 sc1 lds
    ds_read_b64_tr_b16 a[70:71], v10 offset:47872
    v_lshrrev_b32 v49, 1, v46
    v_lshlrev_b32 v132, 16, v194
    v_mfma_f32_16x16x32_bf16 v[104:107], a[28:31], a[0:3], v[104:107]
    v_and_b32 v49, 3, v49
    v_xor_b32 v50, 0, v49
    v_lshl_add_u32 v38, v50, 5, v48
    v_mfma_f32_16x16x32_bf16 v[112:115], a[32:35], a[0:3], v[112:115]
    v_subrev_u32 v54, 131072, v38
    v_xor_b32 v50, 1, v49
    v_lshl_add_u32 v39, v50, 5, v48
    v_mfma_f32_16x16x32_bf16 v[116:119], a[32:35], a[4:7], v[116:119]
    buffer_load_dwordx4 v15, s[20:23], s27 offen offset:3072 sc1 lds
    v_subrev_u32 v55, 131072, v39
    v_xor_b32 v50, 2, v49
    v_and_b32 v133, 0xffff0000, v194
    s_waitcnt lgkmcnt(10)
    v_mfma_f32_16x16x32_bf16 v[64:67], a[44:47], a[36:39], v[64:67]
    v_lshl_add_u32 v40, v50, 5, v48
    v_subrev_u32 v56, 131072, v40
    v_xor_b32 v50, 3, v49
    v_mfma_f32_16x16x32_bf16 v[68:71], a[44:47], a[40:43], v[68:71]
    v_lshl_add_u32 v41, v50, 5, v48
    s_waitcnt vmcnt(16) lgkmcnt(0)
    s_barrier
    v_mfma_f32_16x16x32_bf16 v[76:79], a[48:51], a[40:43], v[76:79]
    s_lshr_b32 s37, 0x1d1e1e1d, s36
    s_and_b32 s37, s37, 0xff
    v_subrev_u32 v57, 131072, v41
    v_lshlrev_b32 v134, 16, v195
    v_mfma_f32_16x16x32_bf16 v[72:75], a[48:51], a[36:39], v[72:75]
    s_lshl_b32 s26, s37, 7
    s_add_u32 m0, s24, 32768
    s_mov_b32 s12, s68
    v_mfma_f32_16x16x32_bf16 v[80:83], a[52:55], a[36:39], v[80:83]
    buffer_load_dwordx4 v2, s[8:11], s26 offen lds
    ds_read_b128 a[0:3], v8 offset:49152
    s_mov_b32 s13, s69
    v_and_b32 v135, 0xffff0000, v195
    v_mfma_f32_16x16x32_bf16 v[84:87], a[52:55], a[40:43], v[84:87]
    ds_read_b128 a[4:7], v8 offset:51200
    ds_read_b64_tr_b16 a[8:9], v10 offset:49152
    s_mov_b32 s14, 0x200000
    v_mfma_f32_16x16x32_bf16 v[92:95], a[56:59], a[40:43], v[92:95]
    buffer_load_dwordx4 v3, s[8:11], s26 offen offset:1024 lds
    ds_read_b64_tr_b16 a[10:11], v10 offset:49408
    s_mov_b32 s15, 0x20000
    v_mfma_f32_16x16x32_bf16 v[88:91], a[56:59], a[36:39], v[88:91]
    ds_read_b64_tr_b16 a[12:13], v10 offset:50176
    ds_read_b64_tr_b16 a[14:15], v10 offset:50432
    s_mov_b32 s16, s78
    v_lshlrev_b32 v136, 16, v196
    v_mfma_f32_16x16x32_bf16 v[96:99], a[60:63], a[36:39], v[96:99]
    ds_read_b64_tr_b16 a[16:17], v10 offset:51200
    ds_read_b64_tr_b16 a[18:19], v10 offset:51456
    s_mov_b32 s17, s79
    v_mfma_f32_16x16x32_bf16 v[100:103], a[60:63], a[40:43], v[100:103]
    ds_read_b64_tr_b16 a[20:21], v14 offset:52224
    ds_read_b64_tr_b16 a[22:23], v14 offset:52480
    s_mov_b32 s18, 0x380000
    v_mfma_f32_16x16x32_bf16 v[108:111], a[64:67], a[40:43], v[108:111]
    buffer_load_dwordx4 v4, s[8:11], s26 offen offset:2048 lds
    ds_read_b64_tr_b16 a[24:25], v10 offset:53760
    s_mov_b32 s19, 0x20000
    v_and_b32 v137, 0xffff0000, v196
    v_mfma_f32_16x16x32_bf16 v[104:107], a[64:67], a[36:39], v[104:107]
    ds_read_b64_tr_b16 a[26:27], v10 offset:54016
    ds_read_b64_tr_b16 a[28:29], v10 offset:54784
    v_and_b32 v46, 15, v0
    v_mfma_f32_16x16x32_bf16 v[112:115], a[68:71], a[36:39], v[112:115]
    ds_read_b64_tr_b16 a[30:31], v10 offset:55040
    ds_read_b64_tr_b16 a[32:33], v10 offset:55808
    v_lshlrev_b32 v46, 2, v46
    v_lshlrev_b32 v138, 16, v197
    v_mfma_f32_16x16x32_bf16 v[116:119], a[68:71], a[40:43], v[116:119]
    buffer_load_dwordx4 v5, s[8:11], s26 offen offset:3072 lds
    ds_read_b64_tr_b16 a[34:35], v10 offset:56064
    s_lshl_b32 s48, s40, 7
    s_waitcnt lgkmcnt(10)
    v_mfma_f32_16x16x32_bf16 v[64:67], a[8:11], a[0:3], v[64:67]
    ds_read_b128 a[36:39], v9 offset:49152
    ds_read_b128 a[40:43], v9 offset:51200
    s_add_u32 s48, s48, 26214400
    v_mfma_f32_16x16x32_bf16 v[68:71], a[8:11], a[4:7], v[68:71]
    s_mul_i32 s27, s37, 229376
    ds_read_b64_tr_b16 a[44:45], v10 offset:57344
    buffer_load_dword v42, v46, s[20:23], s48 offen sc1
    v_and_b32 v139, 0xffff0000, v197
    v_mfma_f32_16x16x32_bf16 v[76:79], a[12:15], a[4:7], v[76:79]
    s_add_u32 m0, s25, 32768
    ds_read_b64_tr_b16 a[46:47], v10 offset:57600
    buffer_load_dword v43, v46, s[20:23], s48 offen offset:64 sc1
    v_mfma_f32_16x16x32_bf16 v[72:75], a[12:15], a[0:3], v[72:75]
    buffer_load_dwordx4 v6, s[20:23], s27 offen sc1 lds
    ds_read_b64_tr_b16 a[48:49], v10 offset:58368
    s_waitcnt lgkmcnt(11)
    v_mfma_f32_16x16x32_bf16 v[80:83], a[16:19], a[0:3], v[80:83]
    ds_read_b64_tr_b16 a[50:51], v10 offset:58624
    ds_read_b64_tr_b16 a[52:53], v10 offset:59392
    v_lshlrev_b32 v140, 16, v198
    v_mfma_f32_16x16x32_bf16 v[84:87], a[16:19], a[4:7], v[84:87]
    ds_read_b64_tr_b16 a[54:55], v10 offset:59648
    ds_read_b64_tr_b16 a[56:57], v14 offset:60416
    v_mfma_f32_16x16x32_bf16 v[92:95], a[20:23], a[4:7], v[92:95]
    buffer_load_dwordx4 v6, s[20:23], s27 offen offset:1024 sc1 lds
    ds_read_b64_tr_b16 a[58:59], v14 offset:60672
    v_and_b32 v141, 0xffff0000, v198
    v_mfma_f32_16x16x32_bf16 v[88:91], a[20:23], a[0:3], v[88:91]
    ds_read_b64_tr_b16 a[60:61], v10 offset:61952
    ds_read_b64_tr_b16 a[62:63], v10 offset:62208
    s_waitcnt lgkmcnt(12)
    v_mfma_f32_16x16x32_bf16 v[96:99], a[24:27], a[0:3], v[96:99]
    ds_read_b64_tr_b16 a[64:65], v10 offset:62976
    ds_read_b64_tr_b16 a[66:67], v10 offset:63232
    v_mfma_f32_16x16x32_bf16 v[100:103], a[24:27], a[4:7], v[100:103]
    ds_read_b64_tr_b16 a[68:69], v10 offset:64000
    v_lshlrev_b32 v142, 16, v199
    v_mfma_f32_16x16x32_bf16 v[108:111], a[28:31], a[4:7], v[108:111]
    buffer_load_dwordx4 v6, s[20:23], s27 offen offset:2048 sc1 lds
    ds_read_b64_tr_b16 a[70:71], v10 offset:64256
    v_mfma_f32_16x16x32_bf16 v[104:107], a[28:31], a[0:3], v[104:107]
    v_mfma_f32_16x16x32_bf16 v[112:115], a[32:35], a[0:3], v[112:115]
    v_and_b32 v143, 0xffff0000, v199
    v_mfma_f32_16x16x32_bf16 v[116:119], a[32:35], a[4:7], v[116:119]
    buffer_load_dwordx4 v15, s[20:23], s27 offen offset:3072 sc1 lds
    s_waitcnt lgkmcnt(10)
    v_mfma_f32_16x16x32_bf16 v[64:67], a[44:47], a[36:39], v[64:67]
    v_lshlrev_b32 v144, 16, v200
    v_mfma_f32_16x16x32_bf16 v[68:71], a[44:47], a[40:43], v[68:71]
    s_waitcnt vmcnt(18) lgkmcnt(0)
    s_barrier
    v_mfma_f32_16x16x32_bf16 v[76:79], a[48:51], a[40:43], v[76:79]
    s_lshr_b32 s37, 0x1f1f1f1e, s36
    s_and_b32 s37, s37, 0xff
    v_mfma_f32_16x16x32_bf16 v[72:75], a[48:51], a[36:39], v[72:75]
    s_lshl_b32 s26, s37, 7
    s_add_u32 m0, s24, 49152
    v_and_b32 v145, 0xffff0000, v200
    v_mfma_f32_16x16x32_bf16 v[80:83], a[52:55], a[36:39], v[80:83]
    buffer_load_dwordx4 v2, s[8:11], s26 offen lds
    ds_read_b128 a[0:3], v8 offset:0
    v_mfma_f32_16x16x32_bf16 v[84:87], a[52:55], a[40:43], v[84:87]
    ds_read_b128 a[4:7], v8 offset:2048
    ds_read_b64_tr_b16 a[8:9], v10 offset:0
    v_mfma_f32_16x16x32_bf16 v[92:95], a[56:59], a[40:43], v[92:95]
    buffer_load_dwordx4 v3, s[8:11], s26 offen offset:1024 lds
    ds_read_b64_tr_b16 a[10:11], v10 offset:256
    v_lshlrev_b32 v146, 16, v201
    v_mfma_f32_16x16x32_bf16 v[88:91], a[56:59], a[36:39], v[88:91]
    ds_read_b64_tr_b16 a[12:13], v10 offset:1024
    ds_read_b64_tr_b16 a[14:15], v10 offset:1280
    v_mfma_f32_16x16x32_bf16 v[96:99], a[60:63], a[36:39], v[96:99]
    ds_read_b64_tr_b16 a[16:17], v10 offset:2048
    ds_read_b64_tr_b16 a[18:19], v10 offset:2304
    v_and_b32 v147, 0xffff0000, v201
    v_mfma_f32_16x16x32_bf16 v[100:103], a[60:63], a[40:43], v[100:103]
    ds_read_b64_tr_b16 a[20:21], v14 offset:3072
    ds_read_b64_tr_b16 a[22:23], v14 offset:3328
    v_mfma_f32_16x16x32_bf16 v[108:111], a[64:67], a[40:43], v[108:111]
    buffer_load_dwordx4 v4, s[8:11], s26 offen offset:2048 lds
    ds_read_b64_tr_b16 a[24:25], v10 offset:4608
    v_mfma_f32_16x16x32_bf16 v[104:107], a[64:67], a[36:39], v[104:107]
    ds_read_b64_tr_b16 a[26:27], v10 offset:4864
    ds_read_b64_tr_b16 a[28:29], v10 offset:5632
    v_lshlrev_b32 v148, 16, v202
    v_mfma_f32_16x16x32_bf16 v[112:115], a[68:71], a[36:39], v[112:115]
    ds_read_b64_tr_b16 a[30:31], v10 offset:5888
    ds_read_b64_tr_b16 a[32:33], v10 offset:6656
    v_mfma_f32_16x16x32_bf16 v[116:119], a[68:71], a[40:43], v[116:119]
    buffer_load_dwordx4 v5, s[8:11], s26 offen offset:3072 lds
    ds_read_b64_tr_b16 a[34:35], v10 offset:6912
    s_waitcnt lgkmcnt(10)
    v_mfma_f32_16x16x32_bf16 v[64:67], a[8:11], a[0:3], v[64:67]
    ds_read_b128 a[36:39], v9 offset:0
    ds_read_b128 a[40:43], v9 offset:2048
    v_and_b32 v149, 0xffff0000, v202
    v_mfma_f32_16x16x32_bf16 v[68:71], a[8:11], a[4:7], v[68:71]
    s_mul_i32 s27, s37, 229376
    ds_read_b64_tr_b16 a[44:45], v10 offset:8192
    v_mfma_f32_16x16x32_bf16 v[76:79], a[12:15], a[4:7], v[76:79]
    s_add_u32 m0, s25, 49152
    ds_read_b64_tr_b16 a[46:47], v10 offset:8448
    v_mfma_f32_16x16x32_bf16 v[72:75], a[12:15], a[0:3], v[72:75]
    buffer_load_dwordx4 v6, s[20:23], s27 offen sc1 lds
    ds_read_b64_tr_b16 a[48:49], v10 offset:9216
    v_lshlrev_b32 v150, 16, v203
    s_waitcnt lgkmcnt(11)
    v_mfma_f32_16x16x32_bf16 v[80:83], a[16:19], a[0:3], v[80:83]
    ds_read_b64_tr_b16 a[50:51], v10 offset:9472
    ds_read_b64_tr_b16 a[52:53], v10 offset:10240
    v_mfma_f32_16x16x32_bf16 v[84:87], a[16:19], a[4:7], v[84:87]
    ds_read_b64_tr_b16 a[54:55], v10 offset:10496
    ds_read_b64_tr_b16 a[56:57], v14 offset:11264
    v_and_b32 v151, 0xffff0000, v203
    v_mfma_f32_16x16x32_bf16 v[92:95], a[20:23], a[4:7], v[92:95]
    buffer_load_dwordx4 v6, s[20:23], s27 offen offset:1024 sc1 lds
    ds_read_b64_tr_b16 a[58:59], v14 offset:11520
    v_mfma_f32_16x16x32_bf16 v[88:91], a[20:23], a[0:3], v[88:91]
    ds_read_b64_tr_b16 a[60:61], v10 offset:12800
    ds_read_b64_tr_b16 a[62:63], v10 offset:13056
    s_waitcnt lgkmcnt(12)
    v_mfma_f32_16x16x32_bf16 v[96:99], a[24:27], a[0:3], v[96:99]
    ds_read_b64_tr_b16 a[64:65], v10 offset:13824
    ds_read_b64_tr_b16 a[66:67], v10 offset:14080
    v_lshlrev_b32 v152, 16, v204
    v_mfma_f32_16x16x32_bf16 v[100:103], a[24:27], a[4:7], v[100:103]
    ds_read_b64_tr_b16 a[68:69], v10 offset:14848
    v_mfma_f32_16x16x32_bf16 v[108:111], a[28:31], a[4:7], v[108:111]
    buffer_load_dwordx4 v6, s[20:23], s27 offen offset:2048 sc1 lds
    ds_read_b64_tr_b16 a[70:71], v10 offset:15104
    v_mfma_f32_16x16x32_bf16 v[104:107], a[28:31], a[0:3], v[104:107]
    v_and_b32 v153, 0xffff0000, v204
    v_mfma_f32_16x16x32_bf16 v[112:115], a[32:35], a[0:3], v[112:115]
    v_mfma_f32_16x16x32_bf16 v[116:119], a[32:35], a[4:7], v[116:119]
    buffer_load_dwordx4 v15, s[20:23], s27 offen offset:3072 sc1 lds
    v_lshlrev_b32 v154, 16, v205
    s_waitcnt lgkmcnt(10)
    v_mfma_f32_16x16x32_bf16 v[64:67], a[44:47], a[36:39], v[64:67]
    s_lshr_b32 s45, 0x3, s36
    s_and_b32 s45, s45, 0xff
    v_mfma_f32_16x16x32_bf16 v[68:71], a[44:47], a[40:43], v[68:71]
    s_lshl_b32 s28, s45, 18
    s_waitcnt vmcnt(18) lgkmcnt(0)
    s_barrier
    v_mfma_f32_16x16x32_bf16 v[76:79], a[48:51], a[40:43], v[76:79]
    ds_read_b128 a[0:3], v8 offset:16384
    ds_read_b128 a[4:7], v8 offset:18432
    s_lshl_b32 s45, s45, 12
    v_and_b32 v155, 0xffff0000, v205
    v_mfma_f32_16x16x32_bf16 v[72:75], a[48:51], a[36:39], v[72:75]
    ds_read_b64_tr_b16 a[8:9], v10 offset:16384
    s_add_u32 s29, s54, s45
    v_mfma_f32_16x16x32_bf16 v[80:83], a[52:55], a[36:39], v[80:83]
    ds_read_b64_tr_b16 a[10:11], v10 offset:16640
    ds_read_b64_tr_b16 a[12:13], v10 offset:17408
    s_add_u32 s30, s29, 32768
    v_mfma_f32_16x16x32_bf16 v[84:87], a[52:55], a[40:43], v[84:87]
    ds_read_b64_tr_b16 a[14:15], v10 offset:17664
    s_add_u32 m0, s56, 0x0
    s_nop 0
    buffer_load_dwordx4 v34, s[12:15], s28 offen lds
    v_lshlrev_b32 v156, 16, v206
    v_mfma_f32_16x16x32_bf16 v[92:95], a[56:59], a[40:43], v[92:95]
    ds_read_b64_tr_b16 a[16:17], v10 offset:18432
    ds_read_b64_tr_b16 a[18:19], v10 offset:18688
    buffer_load_dwordx4 v35, s[12:15], s28 offen offset:1024 lds
    v_mfma_f32_16x16x32_bf16 v[88:91], a[56:59], a[36:39], v[88:91]
    ds_read_b64_tr_b16 a[20:21], v14 offset:19456
    s_add_u32 s28, s28, 131072
    v_and_b32 v157, 0xffff0000, v206
    v_mfma_f32_16x16x32_bf16 v[96:99], a[60:63], a[36:39], v[96:99]
    ds_read_b64_tr_b16 a[22:23], v14 offset:19712
    ds_read_b64_tr_b16 a[24:25], v10 offset:20992
    buffer_load_dwordx4 a[104:107], v7, s[20:23], s29 offen offset:0 sc1
    v_mfma_f32_16x16x32_bf16 v[100:103], a[60:63], a[40:43], v[100:103]
    ds_read_b64_tr_b16 a[26:27], v10 offset:21248
    buffer_load_dwordx4 a[108:111], v7, s[20:23], s30 offen offset:0 sc1
    buffer_load_dwordx4 a[112:115], v7, s[20:23], s29 offen offset:1024 sc1
    v_mfma_f32_16x16x32_bf16 v[108:111], a[64:67], a[40:43], v[108:111]
    ds_read_b64_tr_b16 a[28:29], v10 offset:22016
    ds_read_b64_tr_b16 a[30:31], v10 offset:22272
    buffer_load_dwordx4 a[116:119], v7, s[20:23], s30 offen offset:1024 sc1
    v_lshlrev_b32 v158, 16, v207
    v_mfma_f32_16x16x32_bf16 v[104:107], a[64:67], a[36:39], v[104:107]
    ds_read_b64_tr_b16 a[32:33], v10 offset:23040
    s_add_u32 s29, s29, 2048
    v_mfma_f32_16x16x32_bf16 v[112:115], a[68:71], a[36:39], v[112:115]
    ds_read_b64_tr_b16 a[34:35], v10 offset:23296
    s_add_u32 s30, s30, 2048
    v_mfma_f32_16x16x32_bf16 v[116:119], a[68:71], a[40:43], v[116:119]
    ds_read_b128 a[36:39], v9 offset:16384
    ds_read_b128 a[40:43], v9 offset:18432
    s_add_u32 m0, s56, 0x2000
    v_and_b32 v159, 0xffff0000, v207
    s_waitcnt lgkmcnt(12)
    v_mfma_f32_16x16x32_bf16 v[64:67], a[8:11], a[0:3], v[64:67]
    ds_read_b64_tr_b16 a[44:45], v10 offset:24576
    buffer_load_dwordx4 v34, s[12:15], s28 offen lds
    v_mfma_f32_16x16x32_bf16 v[68:71], a[8:11], a[4:7], v[68:71]
    ds_read_b64_tr_b16 a[46:47], v10 offset:24832
    buffer_load_dwordx4 v35, s[12:15], s28 offen offset:1024 lds
    v_lshlrev_b32 v160, 16, v208
    v_mfma_f32_16x16x32_bf16 v[76:79], a[12:15], a[4:7], v[76:79]
    ds_read_b64_tr_b16 a[48:49], v10 offset:25600
    ds_read_b64_tr_b16 a[50:51], v10 offset:25856
    v_mfma_f32_16x16x32_bf16 v[72:75], a[12:15], a[0:3], v[72:75]
    ds_read_b64_tr_b16 a[52:53], v10 offset:26624
    s_add_u32 s28, s28, 131072
    s_waitcnt lgkmcnt(13)
    v_mfma_f32_16x16x32_bf16 v[80:83], a[16:19], a[0:3], v[80:83]
    ds_read_b64_tr_b16 a[54:55], v10 offset:26880
    buffer_load_dwordx4 a[120:123], v7, s[20:23], s29 offen offset:0 sc1
    v_and_b32 v161, 0xffff0000, v208
    v_mfma_f32_16x16x32_bf16 v[84:87], a[16:19], a[4:7], v[84:87]
    ds_read_b64_tr_b16 a[56:57], v14 offset:27648
    ds_read_b64_tr_b16 a[58:59], v14 offset:27904
    v_mfma_f32_16x16x32_bf16 v[92:95], a[20:23], a[4:7], v[92:95]
    ds_read_b64_tr_b16 a[60:61], v10 offset:29184
    buffer_load_dwordx4 a[124:127], v7, s[20:23], s30 offen offset:0 sc1
    v_mfma_f32_16x16x32_bf16 v[88:91], a[20:23], a[0:3], v[88:91]
    ds_read_b64_tr_b16 a[62:63], v10 offset:29440
    buffer_load_dwordx4 a[128:131], v7, s[20:23], s29 offen offset:1024 sc1
    v_lshlrev_b32 v162, 16, v209
    s_waitcnt lgkmcnt(12)
    v_mfma_f32_16x16x32_bf16 v[96:99], a[24:27], a[0:3], v[96:99]
    ds_read_b64_tr_b16 a[64:65], v10 offset:30208
    ds_read_b64_tr_b16 a[66:67], v10 offset:30464
    buffer_load_dwordx4 a[132:135], v7, s[20:23], s30 offen offset:1024 sc1
    v_mfma_f32_16x16x32_bf16 v[100:103], a[24:27], a[4:7], v[100:103]
    ds_read_b64_tr_b16 a[68:69], v10 offset:31232
    v_and_b32 v163, 0xffff0000, v209
    v_mfma_f32_16x16x32_bf16 v[108:111], a[28:31], a[4:7], v[108:111]
    ds_read_b64_tr_b16 a[70:71], v10 offset:31488
    s_add_u32 s29, s29, 2048
    v_mfma_f32_16x16x32_bf16 v[104:107], a[28:31], a[0:3], v[104:107]
    s_add_u32 s30, s30, 2048
    v_mfma_f32_16x16x32_bf16 v[112:115], a[32:35], a[0:3], v[112:115]
    v_lshlrev_b32 v164, 16, v210
    v_mfma_f32_16x16x32_bf16 v[116:119], a[32:35], a[4:7], v[116:119]
    s_lshr_b32 s45, 0x1010400, s36
    s_and_b32 s45, s45, 0xff
    s_waitcnt lgkmcnt(10)
    v_mfma_f32_16x16x32_bf16 v[64:67], a[44:47], a[36:39], v[64:67]
    s_lshl_b32 s28, s45, 18
    v_mfma_f32_16x16x32_bf16 v[68:71], a[44:47], a[40:43], v[68:71]
    s_lshl_b32 s45, s45, 12
    v_and_b32 v165, 0xffff0000, v210
    s_waitcnt vmcnt(20) lgkmcnt(0)
    s_barrier
    v_mfma_f32_16x16x32_bf16 v[76:79], a[48:51], a[40:43], v[76:79]
    ds_read_b128 a[0:3], v8 offset:32768
    ds_read_b128 a[4:7], v8 offset:34816
    s_add_u32 s29, s54, s45
    v_mfma_f32_16x16x32_bf16 v[72:75], a[48:51], a[36:39], v[72:75]
    ds_read_b64_tr_b16 a[8:9], v10 offset:32768
    s_add_u32 s30, s29, 32768
    v_lshlrev_b32 v166, 16, v211
    v_mfma_f32_16x16x32_bf16 v[80:83], a[52:55], a[36:39], v[80:83]
    ds_read_b64_tr_b16 a[10:11], v10 offset:33024
    ds_read_b64_tr_b16 a[12:13], v10 offset:33792
    s_add_u32 m0, s56, 0x4000
    v_mfma_f32_16x16x32_bf16 v[84:87], a[52:55], a[40:43], v[84:87]
    ds_read_b64_tr_b16 a[14:15], v10 offset:34048
    buffer_load_dwordx4 v34, s[12:15], s28 offen lds
    v_mfma_f32_16x16x32_bf16 v[92:95], a[56:59], a[40:43], v[92:95]
    ds_read_b64_tr_b16 a[16:17], v10 offset:34816
    ds_read_b64_tr_b16 a[18:19], v10 offset:35072
    buffer_load_dwordx4 v35, s[12:15], s28 offen offset:1024 lds
    v_and_b32 v167, 0xffff0000, v211
    v_mfma_f32_16x16x32_bf16 v[88:91], a[56:59], a[36:39], v[88:91]
    ds_read_b64_tr_b16 a[20:21], v14 offset:35840
    s_add_u32 s28, s28, 131072
    buffer_load_dwordx4 a[136:139], v7, s[20:23], s29 offen offset:0 sc1
    v_mfma_f32_16x16x32_bf16 v[96:99], a[60:63], a[36:39], v[96:99]
    ds_read_b64_tr_b16 a[22:23], v14 offset:36096
    ds_read_b64_tr_b16 a[24:25], v10 offset:37376
    buffer_load_dwordx4 a[140:143], v7, s[20:23], s30 offen offset:0 sc1
    v_mfma_f32_16x16x32_bf16 v[100:103], a[60:63], a[40:43], v[100:103]
    ds_read_b64_tr_b16 a[26:27], v10 offset:37632
    buffer_load_dwordx4 a[144:147], v7, s[20:23], s29 offen offset:1024 sc1
    v_lshlrev_b32 v168, 16, v212
    v_mfma_f32_16x16x32_bf16 v[108:111], a[64:67], a[40:43], v[108:111]
    ds_read_b64_tr_b16 a[28:29], v10 offset:38400
    ds_read_b64_tr_b16 a[30:31], v10 offset:38656
    buffer_load_dwordx4 a[148:151], v7, s[20:23], s30 offen offset:1024 sc1
    v_mfma_f32_16x16x32_bf16 v[104:107], a[64:67], a[36:39], v[104:107]
    ds_read_b64_tr_b16 a[32:33], v10 offset:39424
    s_add_u32 s29, s29, 2048
    v_mfma_f32_16x16x32_bf16 v[112:115], a[68:71], a[36:39], v[112:115]
    ds_read_b64_tr_b16 a[34:35], v10 offset:39680
    s_add_u32 s30, s30, 2048
    v_and_b32 v169, 0xffff0000, v212
    v_mfma_f32_16x16x32_bf16 v[116:119], a[68:71], a[40:43], v[116:119]
    ds_read_b128 a[36:39], v9 offset:32768
    ds_read_b128 a[40:43], v9 offset:34816
    s_add_u32 m0, s56, 0x6000
    s_waitcnt lgkmcnt(12)
    v_mfma_f32_16x16x32_bf16 v[64:67], a[8:11], a[0:3], v[64:67]
    ds_read_b64_tr_b16 a[44:45], v10 offset:40960
    buffer_load_dwordx4 v34, s[12:15], s28 offen lds
    v_lshlrev_b32 v170, 16, v213
    v_mfma_f32_16x16x32_bf16 v[68:71], a[8:11], a[4:7], v[68:71]
    ds_read_b64_tr_b16 a[46:47], v10 offset:41216
    buffer_load_dwordx4 v35, s[12:15], s28 offen offset:1024 lds
    v_mfma_f32_16x16x32_bf16 v[76:79], a[12:15], a[4:7], v[76:79]
    ds_read_b64_tr_b16 a[48:49], v10 offset:41984
    ds_read_b64_tr_b16 a[50:51], v10 offset:42240
    s_add_u32 s28, s28, 131072
    v_mfma_f32_16x16x32_bf16 v[72:75], a[12:15], a[0:3], v[72:75]
    ds_read_b64_tr_b16 a[52:53], v10 offset:43008
    v_and_b32 v171, 0xffff0000, v213
    s_waitcnt lgkmcnt(13)
    v_mfma_f32_16x16x32_bf16 v[80:83], a[16:19], a[0:3], v[80:83]
    ds_read_b64_tr_b16 a[54:55], v10 offset:43264
    buffer_load_dwordx4 a[152:155], v7, s[20:23], s29 offen offset:0 sc1
    v_mfma_f32_16x16x32_bf16 v[84:87], a[16:19], a[4:7], v[84:87]
    ds_read_b64_tr_b16 a[56:57], v14 offset:44032
    ds_read_b64_tr_b16 a[58:59], v14 offset:44288
    buffer_load_dwordx4 a[156:159], v7, s[20:23], s30 offen offset:0 sc1
    v_mfma_f32_16x16x32_bf16 v[92:95], a[20:23], a[4:7], v[92:95]
    ds_read_b64_tr_b16 a[60:61], v10 offset:45568
    buffer_load_dwordx4 a[160:163], v7, s[20:23], s29 offen offset:1024 sc1
    v_lshlrev_b32 v172, 16, v214
    v_mfma_f32_16x16x32_bf16 v[88:91], a[20:23], a[0:3], v[88:91]
    ds_read_b64_tr_b16 a[62:63], v10 offset:45824
    s_waitcnt lgkmcnt(12)
    v_mfma_f32_16x16x32_bf16 v[96:99], a[24:27], a[0:3], v[96:99]
    ds_read_b64_tr_b16 a[64:65], v10 offset:46592
    ds_read_b64_tr_b16 a[66:67], v10 offset:46848
    buffer_load_dwordx4 a[164:167], v7, s[20:23], s30 offen offset:1024 sc1
    v_and_b32 v173, 0xffff0000, v214
    v_mfma_f32_16x16x32_bf16 v[100:103], a[24:27], a[4:7], v[100:103]
    ds_read_b64_tr_b16 a[68:69], v10 offset:47616
    s_add_u32 s29, s29, 2048
    v_mfma_f32_16x16x32_bf16 v[108:111], a[28:31], a[4:7], v[108:111]
    ds_read_b64_tr_b16 a[70:71], v10 offset:47872
    s_add_u32 s30, s30, 2048
    v_mfma_f32_16x16x32_bf16 v[104:107], a[28:31], a[0:3], v[104:107]
    v_lshlrev_b32 v174, 16, v215
    v_mfma_f32_16x16x32_bf16 v[112:115], a[32:35], a[0:3], v[112:115]
    s_lshr_b32 s45, 0x2050101, s36
    s_and_b32 s45, s45, 0xff
    v_mfma_f32_16x16x32_bf16 v[116:119], a[32:35], a[4:7], v[116:119]
    s_lshl_b32 s28, s45, 18
    s_waitcnt lgkmcnt(10)
    v_mfma_f32_16x16x32_bf16 v[64:67], a[44:47], a[36:39], v[64:67]
    s_lshl_b32 s45, s45, 12
    v_and_b32 v175, 0xffff0000, v215
    v_mfma_f32_16x16x32_bf16 v[68:71], a[44:47], a[40:43], v[68:71]
    s_add_u32 s29, s54, s45
    s_waitcnt vmcnt(24) lgkmcnt(0)
    s_barrier
    v_mfma_f32_16x16x32_bf16 v[76:79], a[48:51], a[40:43], v[76:79]
    ds_read_b128 a[0:3], v8 offset:49152
    ds_read_b128 a[4:7], v8 offset:51200
    s_add_u32 s30, s29, 32768
    v_lshlrev_b32 v176, 16, v216
    v_mfma_f32_16x16x32_bf16 v[72:75], a[48:51], a[36:39], v[72:75]
    ds_read_b64_tr_b16 a[8:9], v10 offset:49152
    s_add_u32 m0, s56, 0xfffe0000
    v_mfma_f32_16x16x32_bf16 v[80:83], a[52:55], a[36:39], v[80:83]
    ds_read_b64_tr_b16 a[10:11], v10 offset:49408
    ds_read_b64_tr_b16 a[12:13], v10 offset:50176
    buffer_load_dwordx4 v34, s[12:15], s28 offen lds
    v_mfma_f32_16x16x32_bf16 v[84:87], a[52:55], a[40:43], v[84:87]
    ds_read_b64_tr_b16 a[14:15], v10 offset:50432
    buffer_load_dwordx4 v35, s[12:15], s28 offen offset:1024 lds
    s_add_u32 s28, s28, 131072
    v_and_b32 v177, 0xffff0000, v216
    v_mfma_f32_16x16x32_bf16 v[92:95], a[56:59], a[40:43], v[92:95]
    ds_read_b64_tr_b16 a[16:17], v10 offset:51200
    ds_read_b64_tr_b16 a[18:19], v10 offset:51456
    buffer_load_dwordx4 a[168:171], v7, s[20:23], s29 offen offset:0 sc1
    v_mfma_f32_16x16x32_bf16 v[88:91], a[56:59], a[36:39], v[88:91]
    ds_read_b64_tr_b16 a[20:21], v14 offset:52224
    buffer_load_dwordx4 a[172:175], v7, s[20:23], s30 offen offset:0 sc1
    v_mfma_f32_16x16x32_bf16 v[96:99], a[60:63], a[36:39], v[96:99]
    ds_read_b64_tr_b16 a[22:23], v14 offset:52480
    ds_read_b64_tr_b16 a[24:25], v10 offset:53760
    buffer_load_dwordx4 a[176:179], v7, s[20:23], s29 offen offset:1024 sc1
    v_lshlrev_b32 v178, 16, v217
    v_mfma_f32_16x16x32_bf16 v[100:103], a[60:63], a[40:43], v[100:103]
    ds_read_b64_tr_b16 a[26:27], v10 offset:54016
    buffer_load_dwordx4 a[180:183], v7, s[20:23], s30 offen offset:1024 sc1
    v_mfma_f32_16x16x32_bf16 v[108:111], a[64:67], a[40:43], v[108:111]
    ds_read_b64_tr_b16 a[28:29], v10 offset:54784
    ds_read_b64_tr_b16 a[30:31], v10 offset:55040
    s_add_u32 s29, s29, 2048
    v_and_b32 v179, 0xffff0000, v217
    v_mfma_f32_16x16x32_bf16 v[104:107], a[64:67], a[36:39], v[104:107]
    ds_read_b64_tr_b16 a[32:33], v10 offset:55808
    s_add_u32 s30, s30, 2048
    v_mfma_f32_16x16x32_bf16 v[112:115], a[68:71], a[36:39], v[112:115]
    ds_read_b64_tr_b16 a[34:35], v10 offset:56064
    s_add_u32 m0, s56, 0xfffe2000
    v_mfma_f32_16x16x32_bf16 v[116:119], a[68:71], a[40:43], v[116:119]
    ds_read_b128 a[36:39], v9 offset:49152
    ds_read_b128 a[40:43], v9 offset:51200
    buffer_load_dwordx4 v34, s[12:15], s28 offen lds
    v_lshlrev_b32 v180, 16, v218
    s_waitcnt lgkmcnt(12)
    v_mfma_f32_16x16x32_bf16 v[64:67], a[8:11], a[0:3], v[64:67]
    ds_read_b64_tr_b16 a[44:45], v10 offset:57344
    buffer_load_dwordx4 v35, s[12:15], s28 offen offset:1024 lds
    v_mfma_f32_16x16x32_bf16 v[68:71], a[8:11], a[4:7], v[68:71]
    ds_read_b64_tr_b16 a[46:47], v10 offset:57600
    v_mfma_f32_16x16x32_bf16 v[76:79], a[12:15], a[4:7], v[76:79]
    ds_read_b64_tr_b16 a[48:49], v10 offset:58368
    ds_read_b64_tr_b16 a[50:51], v10 offset:58624
    s_add_u32 s28, s28, 131072
    v_and_b32 v181, 0xffff0000, v218
    v_mfma_f32_16x16x32_bf16 v[72:75], a[12:15], a[0:3], v[72:75]
    ds_read_b64_tr_b16 a[52:53], v10 offset:59392
    buffer_load_dwordx4 a[184:187], v7, s[20:23], s29 offen offset:0 sc1
    s_waitcnt lgkmcnt(13)
    v_mfma_f32_16x16x32_bf16 v[80:83], a[16:19], a[0:3], v[80:83]
    ds_read_b64_tr_b16 a[54:55], v10 offset:59648
    v_lshlrev_b32 v182, 16, v219
    v_mfma_f32_16x16x32_bf16 v[84:87], a[16:19], a[4:7], v[84:87]
    ds_read_b64_tr_b16 a[56:57], v14 offset:60416
    ds_read_b64_tr_b16 a[58:59], v14 offset:60672
    buffer_load_dwordx4 a[188:191], v7, s[20:23], s30 offen offset:0 sc1
    v_mfma_f32_16x16x32_bf16 v[92:95], a[20:23], a[4:7], v[92:95]
    ds_read_b64_tr_b16 a[60:61], v10 offset:61952
    buffer_load_dwordx4 a[192:195], v7, s[20:23], s29 offen offset:1024 sc1
    v_mfma_f32_16x16x32_bf16 v[88:91], a[20:23], a[0:3], v[88:91]
    ds_read_b64_tr_b16 a[62:63], v10 offset:62208
    buffer_load_dwordx4 a[196:199], v7, s[20:23], s30 offen offset:1024 sc1
    v_and_b32 v183, 0xffff0000, v219
    s_waitcnt lgkmcnt(12)
    v_mfma_f32_16x16x32_bf16 v[96:99], a[24:27], a[0:3], v[96:99]
    ds_read_b64_tr_b16 a[64:65], v10 offset:62976
    ds_read_b64_tr_b16 a[66:67], v10 offset:63232
    v_mfma_f32_16x16x32_bf16 v[100:103], a[24:27], a[4:7], v[100:103]
    ds_read_b64_tr_b16 a[68:69], v10 offset:64000
    s_add_u32 s29, s29, 2048
    v_mfma_f32_16x16x32_bf16 v[108:111], a[28:31], a[4:7], v[108:111]
    ds_read_b64_tr_b16 a[70:71], v10 offset:64256
    s_add_u32 s30, s30, 2048
    v_lshlrev_b32 v16, 16, v16
    v_mfma_f32_16x16x32_bf16 v[104:107], a[28:31], a[0:3], v[104:107]
    v_mfma_f32_16x16x32_bf16 v[112:115], a[32:35], a[0:3], v[112:115]
    s_lshr_b32 s45, 0x6020202, s36
    s_and_b32 s45, s45, 0xff
    v_lshlrev_b32 v18, 16, v17
    v_mfma_f32_16x16x32_bf16 v[116:119], a[32:35], a[4:7], v[116:119]
    s_lshl_b32 s28, s45, 18
    s_waitcnt lgkmcnt(0)
    v_mfma_f32_16x16x32_bf16 v[64:67], a[44:47], a[36:39], v[64:67]
    s_lshl_b32 s45, s45, 12
    v_mfma_f32_16x16x32_bf16 v[68:71], a[44:47], a[40:43], v[68:71]
    s_add_u32 s29, s54, s45
    v_mov_b32 v17, v16
    v_mfma_f32_16x16x32_bf16 v[76:79], a[48:51], a[40:43], v[76:79]
    s_add_u32 s30, s29, 32768
    v_mfma_f32_16x16x32_bf16 v[72:75], a[48:51], a[36:39], v[72:75]
    s_add_u32 m0, s56, 0xfffe4000
    v_mfma_f32_16x16x32_bf16 v[80:83], a[52:55], a[36:39], v[80:83]
    buffer_load_dwordx4 v34, s[12:15], s28 offen lds
    v_mov_b32 v19, v18
    v_mfma_f32_16x16x32_bf16 v[84:87], a[52:55], a[40:43], v[84:87]
    buffer_load_dwordx4 v35, s[12:15], s28 offen offset:1024 lds
    s_add_u32 s28, s28, 131072
    v_mfma_f32_16x16x32_bf16 v[92:95], a[56:59], a[40:43], v[92:95]
    buffer_load_dwordx4 a[200:203], v7, s[20:23], s29 offen offset:0 sc1
    v_mfma_f32_16x16x32_bf16 v[88:91], a[56:59], a[36:39], v[88:91]
    buffer_load_dwordx4 a[204:207], v7, s[20:23], s30 offen offset:0 sc1
    v_mfma_f32_16x16x32_bf16 v[96:99], a[60:63], a[36:39], v[96:99]
    buffer_load_dwordx4 a[208:211], v7, s[20:23], s29 offen offset:1024 sc1
    v_mfma_f32_16x16x32_bf16 v[100:103], a[60:63], a[40:43], v[100:103]
    buffer_load_dwordx4 a[212:215], v7, s[20:23], s30 offen offset:1024 sc1
    v_mfma_f32_16x16x32_bf16 v[108:111], a[64:67], a[40:43], v[108:111]
    s_add_u32 s29, s29, 2048
    v_mfma_f32_16x16x32_bf16 v[104:107], a[64:67], a[36:39], v[104:107]
    s_add_u32 s30, s30, 2048
    v_mfma_f32_16x16x32_bf16 v[112:115], a[68:71], a[36:39], v[112:115]
    v_mfma_f32_16x16x32_bf16 v[116:119], a[68:71], a[40:43], v[116:119]
    s_lshl_b32 s46, s40, 4
    s_add_u32 s46, s46, s39
    s_mul_i32 s46, s46, 7168
    s_add_u32 s46, s46, 18874368
    s_add_u32 s47, s46, 4096
    v_pk_add_f32 v[64:65], v[64:65], v[16:17]
    v_pk_add_f32 v[66:67], v[66:67], v[16:17]
    v_pk_add_f32 v[68:69], v[68:69], v[18:19]
    v_pk_add_f32 v[70:71], v[70:71], v[18:19]
    v_pk_add_f32 v[72:73], v[72:73], v[16:17]
    v_pk_add_f32 v[74:75], v[74:75], v[16:17]
    v_pk_add_f32 v[76:77], v[76:77], v[18:19]
    v_pk_add_f32 v[78:79], v[78:79], v[18:19]
    v_pk_add_f32 v[80:81], v[80:81], v[16:17]
    v_pk_add_f32 v[82:83], v[82:83], v[16:17]
    v_pk_add_f32 v[84:85], v[84:85], v[18:19]
    v_pk_add_f32 v[86:87], v[86:87], v[18:19]
    v_pk_add_f32 v[88:89], v[88:89], v[16:17]
    v_pk_add_f32 v[90:91], v[90:91], v[16:17]
    v_pk_add_f32 v[92:93], v[92:93], v[18:19]
    v_pk_add_f32 v[94:95], v[94:95], v[18:19]
    v_pk_add_f32 v[96:97], v[96:97], v[16:17]
    v_pk_add_f32 v[98:99], v[98:99], v[16:17]
    v_pk_add_f32 v[100:101], v[100:101], v[18:19]
    v_pk_add_f32 v[102:103], v[102:103], v[18:19]
    v_pk_add_f32 v[104:105], v[104:105], v[16:17]
    v_pk_add_f32 v[106:107], v[106:107], v[16:17]
    v_pk_add_f32 v[108:109], v[108:109], v[18:19]
    v_pk_add_f32 v[110:111], v[110:111], v[18:19]
    v_pk_add_f32 v[112:113], v[112:113], v[16:17]
    v_pk_add_f32 v[114:115], v[114:115], v[16:17]
    v_pk_add_f32 v[116:117], v[116:117], v[18:19]
    v_pk_add_f32 v[118:119], v[118:119], v[18:19]
    v_pk_mul_f32 v[64:65], v[64:65], v[128:129]
    v_pk_mul_f32 v[66:67], v[66:67], v[130:131]
    v_pk_mul_f32 v[68:69], v[68:69], v[132:133]
    v_pk_mul_f32 v[70:71], v[70:71], v[134:135]
    v_pk_mul_f32 v[72:73], v[72:73], v[136:137]
    v_pk_mul_f32 v[74:75], v[74:75], v[138:139]
    v_pk_mul_f32 v[76:77], v[76:77], v[140:141]
    v_pk_mul_f32 v[78:79], v[78:79], v[142:143]
    v_pk_mul_f32 v[80:81], v[80:81], v[144:145]
    v_pk_mul_f32 v[82:83], v[82:83], v[146:147]
    v_pk_mul_f32 v[84:85], v[84:85], v[148:149]
    v_pk_mul_f32 v[86:87], v[86:87], v[150:151]
    v_pk_mul_f32 v[88:89], v[88:89], v[152:153]
    v_pk_mul_f32 v[90:91], v[90:91], v[154:155]
    v_pk_mul_f32 v[92:93], v[92:93], v[156:157]
    v_pk_mul_f32 v[94:95], v[94:95], v[158:159]
    v_pk_mul_f32 v[96:97], v[96:97], v[160:161]
    v_pk_mul_f32 v[98:99], v[98:99], v[162:163]
    v_pk_mul_f32 v[100:101], v[100:101], v[164:165]
    v_pk_mul_f32 v[102:103], v[102:103], v[166:167]
    v_pk_mul_f32 v[104:105], v[104:105], v[168:169]
    v_pk_mul_f32 v[106:107], v[106:107], v[170:171]
    v_pk_mul_f32 v[108:109], v[108:109], v[172:173]
    v_pk_mul_f32 v[110:111], v[110:111], v[174:175]
    v_pk_mul_f32 v[112:113], v[112:113], v[176:177]
    v_pk_mul_f32 v[114:115], v[114:115], v[178:179]
    v_pk_mul_f32 v[116:117], v[116:117], v[180:181]
    v_pk_mul_f32 v[118:119], v[118:119], v[182:183]
    v_cvt_pk_bf16_f32 v192, v64, v65
    v_cvt_pk_bf16_f32 v193, v66, v67
    v_cvt_pk_bf16_f32 v194, v72, v73
    v_cvt_pk_bf16_f32 v195, v74, v75
    buffer_store_dwordx4 v[192:195], v7, s[20:23], s46 offen offset:0 sc1
    v_cvt_pk_bf16_f32 v196, v80, v81
    v_cvt_pk_bf16_f32 v197, v82, v83
    v_cvt_pk_bf16_f32 v198, v88, v89
    v_cvt_pk_bf16_f32 v199, v90, v91
    buffer_store_dwordx4 v[196:199], v7, s[20:23], s46 offen offset:1024 sc1
    v_cvt_pk_bf16_f32 v200, v96, v97
    v_cvt_pk_bf16_f32 v201, v98, v99
    v_cvt_pk_bf16_f32 v202, v104, v105
    v_cvt_pk_bf16_f32 v203, v106, v107
    buffer_store_dwordx4 v[200:203], v7, s[20:23], s46 offen offset:2048 sc1
    v_cvt_pk_bf16_f32 v204, v68, v69
    v_cvt_pk_bf16_f32 v205, v70, v71
    v_cvt_pk_bf16_f32 v206, v76, v77
    v_cvt_pk_bf16_f32 v207, v78, v79
    buffer_store_dwordx4 v[204:207], v7, s[20:23], s46 offen offset:3072 sc1
    v_cvt_pk_bf16_f32 v208, v84, v85
    v_cvt_pk_bf16_f32 v209, v86, v87
    v_cvt_pk_bf16_f32 v210, v92, v93
    v_cvt_pk_bf16_f32 v211, v94, v95
    buffer_store_dwordx4 v[208:211], v7, s[20:23], s47 offen offset:0 sc1
    v_cvt_pk_bf16_f32 v212, v100, v101
    v_cvt_pk_bf16_f32 v213, v102, v103
    v_cvt_pk_bf16_f32 v214, v108, v109
    v_cvt_pk_bf16_f32 v215, v110, v111
    buffer_store_dwordx4 v[212:215], v7, s[20:23], s47 offen offset:1024 sc1
    v_cvt_pk_bf16_f32 v216, v112, v113
    v_cvt_pk_bf16_f32 v217, v114, v115
    v_cvt_pk_bf16_f32 v218, v116, v117
    v_cvt_pk_bf16_f32 v219, v118, v119
    buffer_store_dwordx4 v[216:219], v7, s[20:23], s47 offen offset:2048 sc1
    s_waitcnt vmcnt(43)
    s_barrier
    ds_read_b64_tr_b16 a[0:1], v38 offset:0
    ds_read_b64_tr_b16 a[2:3], v38 offset:2048
    ds_read_b64_tr_b16 a[4:5], v39 offset:0
    ds_read_b64_tr_b16 a[6:7], v39 offset:2048
    ds_read_b64_tr_b16 a[8:9], v40 offset:0
    ds_read_b64_tr_b16 a[10:11], v40 offset:2048
    ds_read_b64_tr_b16 a[12:13], v41 offset:0
    ds_read_b64_tr_b16 a[14:15], v41 offset:2048
    ds_read_b64_tr_b16 a[16:17], v38 offset:4096
    ds_read_b64_tr_b16 a[18:19], v38 offset:6144
    ds_read_b64_tr_b16 a[20:21], v39 offset:4096
    ds_read_b64_tr_b16 a[22:23], v39 offset:6144
    ds_read_b64_tr_b16 a[24:25], v40 offset:4096
    ds_read_b64_tr_b16 a[26:27], v40 offset:6144
    ds_read_b64_tr_b16 a[28:29], v41 offset:4096
    ds_read_b64_tr_b16 a[30:31], v41 offset:6144
    s_waitcnt lgkmcnt(8)
    v_mfma_f32_16x16x32_bf16 v[220:223], a[0:3], a[104:107], 0
    s_waitcnt vmcnt(37)
    s_barrier
    v_mfma_f32_16x16x32_bf16 v[224:227], a[4:7], a[104:107], 0
    s_add_u32 m0, s56, 0xfffe6000
    ds_read_b64_tr_b16 a[32:33], v38 offset:8192
    ds_read_b64_tr_b16 a[34:35], v38 offset:10240
    v_mfma_f32_16x16x32_bf16 v[228:231], a[8:11], a[104:107], 0
    buffer_load_dwordx4 v34, s[12:15], s28 offen lds
    ds_read_b64_tr_b16 a[36:37], v39 offset:8192
    v_mfma_f32_16x16x32_bf16 v[232:235], a[12:15], a[104:107], 0
    ds_read_b64_tr_b16 a[38:39], v39 offset:10240
    v_mfma_f32_16x16x32_bf16 v[248:251], a[12:15], a[108:111], 0
    buffer_load_dwordx4 v35, s[12:15], s28 offen offset:1024 lds
    s_add_u32 s28, s28, 131072
    ds_read_b64_tr_b16 a[40:41], v40 offset:8192
    v_mfma_f32_16x16x32_bf16 v[244:247], a[8:11], a[108:111], 0
    ds_read_b64_tr_b16 a[42:43], v40 offset:10240
    ds_read_b64_tr_b16 a[44:45], v41 offset:8192
    v_mfma_f32_16x16x32_bf16 v[240:243], a[4:7], a[108:111], 0
    ds_read_b64_tr_b16 a[46:47], v41 offset:10240
    v_mfma_f32_16x16x32_bf16 v[236:239], a[0:3], a[108:111], 0
    buffer_load_dwordx4 a[216:219], v7, s[20:23], s29 offen offset:0 sc1
    ds_read_b64_tr_b16 a[48:49], v38 offset:12288
    s_waitcnt lgkmcnt(9)
    v_mfma_f32_16x16x32_bf16 v[220:223], a[16:19], a[112:115], v[220:223]
    ds_read_b64_tr_b16 a[50:51], v38 offset:14336
    v_mfma_f32_16x16x32_bf16 v[224:227], a[20:23], a[112:115], v[224:227]
    buffer_load_dwordx4 a[220:223], v7, s[20:23], s30 offen offset:0 sc1
    ds_read_b64_tr_b16 a[52:53], v39 offset:12288
    ds_read_b64_tr_b16 a[54:55], v39 offset:14336
    v_mfma_f32_16x16x32_bf16 v[228:231], a[24:27], a[112:115], v[228:231]
    ds_read_b64_tr_b16 a[56:57], v40 offset:12288
    v_mfma_f32_16x16x32_bf16 v[232:235], a[28:31], a[112:115], v[232:235]
    ds_read_b64_tr_b16 a[58:59], v40 offset:14336
    v_mfma_f32_16x16x32_bf16 v[248:251], a[28:31], a[116:119], v[248:251]
    buffer_load_dwordx4 a[224:227], v7, s[20:23], s29 offen offset:1024 sc1
    ds_read_b64_tr_b16 a[60:61], v41 offset:12288
    v_mfma_f32_16x16x32_bf16 v[244:247], a[24:27], a[116:119], v[244:247]
    ds_read_b64_tr_b16 a[62:63], v41 offset:14336
    v_mfma_f32_16x16x32_bf16 v[240:243], a[20:23], a[116:119], v[240:243]
    buffer_load_dwordx4 a[228:231], v7, s[20:23], s30 offen offset:1024 sc1
    s_add_u32 s29, s29, 2048
    v_mfma_f32_16x16x32_bf16 v[236:239], a[16:19], a[116:119], v[236:239]
    s_add_u32 s30, s30, 2048
    s_waitcnt lgkmcnt(8)
    v_mfma_f32_16x16x32_bf16 v[220:223], a[32:35], a[120:123], v[220:223]
    s_waitcnt vmcnt(37)
    s_barrier
    v_mfma_f32_16x16x32_bf16 v[224:227], a[36:39], a[120:123], v[224:227]
    s_lshr_b32 s45, 0x3030307, s36
    s_and_b32 s45, s45, 0xff
    ds_read_b64_tr_b16 a[0:1], v38 offset:16384
    v_mfma_f32_16x16x32_bf16 v[228:231], a[40:43], a[120:123], v[228:231]
    s_lshl_b32 s28, s45, 18
    s_lshl_b32 s45, s45, 12
    ds_read_b64_tr_b16 a[2:3], v38 offset:18432
    v_mfma_f32_16x16x32_bf16 v[232:235], a[44:47], a[120:123], v[232:235]
    s_add_u32 s29, s54, s45
    s_add_u32 s30, s29, 32768
    ds_read_b64_tr_b16 a[4:5], v39 offset:16384
    v_mfma_f32_16x16x32_bf16 v[248:251], a[44:47], a[124:127], v[248:251]
    s_add_u32 m0, s56, 0x0
    s_nop 0
    buffer_load_dwordx4 v34, s[12:15], s28 offen lds
    ds_read_b64_tr_b16 a[6:7], v39 offset:18432
    v_mfma_f32_16x16x32_bf16 v[244:247], a[40:43], a[124:127], v[244:247]
    buffer_load_dwordx4 v35, s[12:15], s28 offen offset:1024 lds
    s_add_u32 s28, s28, 131072
    ds_read_b64_tr_b16 a[8:9], v40 offset:16384
    v_mfma_f32_16x16x32_bf16 v[240:243], a[36:39], a[124:127], v[240:243]
    ds_read_b64_tr_b16 a[10:11], v40 offset:18432
    ds_read_b64_tr_b16 a[12:13], v41 offset:16384
    ds_read_b64_tr_b16 a[14:15], v41 offset:18432
    v_mfma_f32_16x16x32_bf16 v[236:239], a[32:35], a[124:127], v[236:239]
    buffer_load_dwordx4 a[104:107], v7, s[20:23], s29 offen offset:0 sc1
    ds_read_b64_tr_b16 a[16:17], v38 offset:20480
    s_waitcnt lgkmcnt(9)
    v_mfma_f32_16x16x32_bf16 v[220:223], a[48:51], a[128:131], v[220:223]
    ds_read_b64_tr_b16 a[18:19], v38 offset:22528
    v_mfma_f32_16x16x32_bf16 v[224:227], a[52:55], a[128:131], v[224:227]
    buffer_load_dwordx4 a[108:111], v7, s[20:23], s30 offen offset:0 sc1
    ds_read_b64_tr_b16 a[20:21], v39 offset:20480
    ds_read_b64_tr_b16 a[22:23], v39 offset:22528
    v_mfma_f32_16x16x32_bf16 v[228:231], a[56:59], a[128:131], v[228:231]
    ds_read_b64_tr_b16 a[24:25], v40 offset:20480
    v_mfma_f32_16x16x32_bf16 v[232:235], a[60:63], a[128:131], v[232:235]
    ds_read_b64_tr_b16 a[26:27], v40 offset:22528
    v_mfma_f32_16x16x32_bf16 v[248:251], a[60:63], a[132:135], v[248:251]
    buffer_load_dwordx4 a[112:115], v7, s[20:23], s29 offen offset:1024 sc1
    ds_read_b64_tr_b16 a[28:29], v41 offset:20480
    v_mfma_f32_16x16x32_bf16 v[244:247], a[56:59], a[132:135], v[244:247]
    ds_read_b64_tr_b16 a[30:31], v41 offset:22528
    v_mfma_f32_16x16x32_bf16 v[240:243], a[52:55], a[132:135], v[240:243]
    buffer_load_dwordx4 a[116:119], v7, s[20:23], s30 offen offset:1024 sc1
    s_add_u32 s29, s29, 2048
    v_mfma_f32_16x16x32_bf16 v[236:239], a[48:51], a[132:135], v[236:239]
    s_add_u32 s30, s30, 2048
    s_waitcnt lgkmcnt(8)
    v_mfma_f32_16x16x32_bf16 v[220:223], a[0:3], a[136:139], v[220:223]
    s_waitcnt vmcnt(37)
    s_barrier
    v_mfma_f32_16x16x32_bf16 v[224:227], a[4:7], a[136:139], v[224:227]
    s_add_u32 m0, s56, 0x2000
    ds_read_b64_tr_b16 a[32:33], v38 offset:24576
    ds_read_b64_tr_b16 a[34:35], v38 offset:26624
    v_mfma_f32_16x16x32_bf16 v[228:231], a[8:11], a[136:139], v[228:231]
    buffer_load_dwordx4 v34, s[12:15], s28 offen lds
    ds_read_b64_tr_b16 a[36:37], v39 offset:24576
    v_mfma_f32_16x16x32_bf16 v[232:235], a[12:15], a[136:139], v[232:235]
    ds_read_b64_tr_b16 a[38:39], v39 offset:26624
    v_mfma_f32_16x16x32_bf16 v[248:251], a[12:15], a[140:143], v[248:251]
    buffer_load_dwordx4 v35, s[12:15], s28 offen offset:1024 lds
    s_add_u32 s28, s28, 131072
    ds_read_b64_tr_b16 a[40:41], v40 offset:24576
    v_mfma_f32_16x16x32_bf16 v[244:247], a[8:11], a[140:143], v[244:247]
    ds_read_b64_tr_b16 a[42:43], v40 offset:26624
    ds_read_b64_tr_b16 a[44:45], v41 offset:24576
    v_mfma_f32_16x16x32_bf16 v[240:243], a[4:7], a[140:143], v[240:243]
    ds_read_b64_tr_b16 a[46:47], v41 offset:26624
    v_mfma_f32_16x16x32_bf16 v[236:239], a[0:3], a[140:143], v[236:239]
    buffer_load_dwordx4 a[120:123], v7, s[20:23], s29 offen offset:0 sc1
    ds_read_b64_tr_b16 a[48:49], v38 offset:28672
    s_waitcnt lgkmcnt(9)
    v_mfma_f32_16x16x32_bf16 v[220:223], a[16:19], a[144:147], v[220:223]
    ds_read_b64_tr_b16 a[50:51], v38 offset:30720
    v_mfma_f32_16x16x32_bf16 v[224:227], a[20:23], a[144:147], v[224:227]
    buffer_load_dwordx4 a[124:127], v7, s[20:23], s30 offen offset:0 sc1
    ds_read_b64_tr_b16 a[52:53], v39 offset:28672
    ds_read_b64_tr_b16 a[54:55], v39 offset:30720
    v_mfma_f32_16x16x32_bf16 v[228:231], a[24:27], a[144:147], v[228:231]
    ds_read_b64_tr_b16 a[56:57], v40 offset:28672
    v_mfma_f32_16x16x32_bf16 v[232:235], a[28:31], a[144:147], v[232:235]
    ds_read_b64_tr_b16 a[58:59], v40 offset:30720
    v_mfma_f32_16x16x32_bf16 v[248:251], a[28:31], a[148:151], v[248:251]
    buffer_load_dwordx4 a[128:131], v7, s[20:23], s29 offen offset:1024 sc1
    ds_read_b64_tr_b16 a[60:61], v41 offset:28672
    v_mfma_f32_16x16x32_bf16 v[244:247], a[24:27], a[148:151], v[244:247]
    ds_read_b64_tr_b16 a[62:63], v41 offset:30720
    v_mfma_f32_16x16x32_bf16 v[240:243], a[20:23], a[148:151], v[240:243]
    buffer_load_dwordx4 a[132:135], v7, s[20:23], s30 offen offset:1024 sc1
    s_add_u32 s29, s29, 2048
    v_mfma_f32_16x16x32_bf16 v[236:239], a[16:19], a[148:151], v[236:239]
    s_add_u32 s30, s30, 2048
    s_waitcnt lgkmcnt(8)
    v_mfma_f32_16x16x32_bf16 v[220:223], a[32:35], a[152:155], v[220:223]
    s_waitcnt vmcnt(37)
    s_barrier
    v_mfma_f32_16x16x32_bf16 v[224:227], a[36:39], a[152:155], v[224:227]
    s_lshr_b32 s45, 0x4040504, s36
    s_and_b32 s45, s45, 0xff
    ds_read_b64_tr_b16 a[0:1], v54 offset:0
    v_mfma_f32_16x16x32_bf16 v[228:231], a[40:43], a[152:155], v[228:231]
    s_lshl_b32 s28, s45, 18
    s_lshl_b32 s45, s45, 12
    ds_read_b64_tr_b16 a[2:3], v54 offset:2048
    v_mfma_f32_16x16x32_bf16 v[232:235], a[44:47], a[152:155], v[232:235]
    s_add_u32 s29, s54, s45
    s_add_u32 s30, s29, 32768
    ds_read_b64_tr_b16 a[4:5], v55 offset:0
    v_mfma_f32_16x16x32_bf16 v[248:251], a[44:47], a[156:159], v[248:251]
    s_add_u32 m0, s56, 0x4000
    s_nop 0
    buffer_load_dwordx4 v34, s[12:15], s28 offen lds
    ds_read_b64_tr_b16 a[6:7], v55 offset:2048
    v_mfma_f32_16x16x32_bf16 v[244:247], a[40:43], a[156:159], v[244:247]
    buffer_load_dwordx4 v35, s[12:15], s28 offen offset:1024 lds
    s_add_u32 s28, s28, 131072
    ds_read_b64_tr_b16 a[8:9], v56 offset:0
    v_mfma_f32_16x16x32_bf16 v[240:243], a[36:39], a[156:159], v[240:243]
    ds_read_b64_tr_b16 a[10:11], v56 offset:2048
    ds_read_b64_tr_b16 a[12:13], v57 offset:0
    ds_read_b64_tr_b16 a[14:15], v57 offset:2048
    v_mfma_f32_16x16x32_bf16 v[236:239], a[32:35], a[156:159], v[236:239]
    buffer_load_dwordx4 a[136:139], v7, s[20:23], s29 offen offset:0 sc1
    ds_read_b64_tr_b16 a[16:17], v54 offset:4096
    s_waitcnt lgkmcnt(9)
    v_mfma_f32_16x16x32_bf16 v[220:223], a[48:51], a[160:163], v[220:223]
    ds_read_b64_tr_b16 a[18:19], v54 offset:6144
    v_mfma_f32_16x16x32_bf16 v[224:227], a[52:55], a[160:163], v[224:227]
    buffer_load_dwordx4 a[140:143], v7, s[20:23], s30 offen offset:0 sc1
    ds_read_b64_tr_b16 a[20:21], v55 offset:4096
    ds_read_b64_tr_b16 a[22:23], v55 offset:6144
    v_mfma_f32_16x16x32_bf16 v[228:231], a[56:59], a[160:163], v[228:231]
    ds_read_b64_tr_b16 a[24:25], v56 offset:4096
    v_mfma_f32_16x16x32_bf16 v[232:235], a[60:63], a[160:163], v[232:235]
    ds_read_b64_tr_b16 a[26:27], v56 offset:6144
    v_mfma_f32_16x16x32_bf16 v[248:251], a[60:63], a[164:167], v[248:251]
    buffer_load_dwordx4 a[144:147], v7, s[20:23], s29 offen offset:1024 sc1
    ds_read_b64_tr_b16 a[28:29], v57 offset:4096
    v_mfma_f32_16x16x32_bf16 v[244:247], a[56:59], a[164:167], v[244:247]
    ds_read_b64_tr_b16 a[30:31], v57 offset:6144
    v_mfma_f32_16x16x32_bf16 v[240:243], a[52:55], a[164:167], v[240:243]
    buffer_load_dwordx4 a[148:151], v7, s[20:23], s30 offen offset:1024 sc1
    s_add_u32 s29, s29, 2048
    v_mfma_f32_16x16x32_bf16 v[236:239], a[48:51], a[164:167], v[236:239]
    s_add_u32 s30, s30, 2048
    s_waitcnt lgkmcnt(8)
    v_mfma_f32_16x16x32_bf16 v[220:223], a[0:3], a[168:171], v[220:223]
    s_waitcnt vmcnt(24)
    s_barrier
    s_cmp_lg_u32 s3, 0
    s_cbranch_scc1 L_sig_1_32
    s_add_u32 s46, s38, 16
    s_lshl_b32 s46, s46, 7
    s_add_u32 s46, s46, 26607616
    v_mov_b32 v46, 0
    v_mov_b32 v47, 1
    s_mov_b64 exec, 1
    buffer_atomic_add v47, v46, s[20:23], s46 offen
    s_mov_b64 exec, -1
L_sig_1_32:
    s_nop 1
    v_mfma_f32_16x16x32_bf16 v[224:227], a[4:7], a[168:171], v[224:227]
    s_add_u32 m0, s56, 0x6000
    ds_read_b64_tr_b16 a[32:33], v54 offset:8192
    ds_read_b64_tr_b16 a[34:35], v54 offset:10240
    v_mfma_f32_16x16x32_bf16 v[228:231], a[8:11], a[168:171], v[228:231]
    buffer_load_dwordx4 v34, s[12:15], s28 offen lds
    ds_read_b64_tr_b16 a[36:37], v55 offset:8192
    v_mfma_f32_16x16x32_bf16 v[232:235], a[12:15], a[168:171], v[232:235]
    ds_read_b64_tr_b16 a[38:39], v55 offset:10240
    v_mfma_f32_16x16x32_bf16 v[248:251], a[12:15], a[172:175], v[248:251]
    buffer_load_dwordx4 v35, s[12:15], s28 offen offset:1024 lds
    s_add_u32 s28, s28, 131072
    ds_read_b64_tr_b16 a[40:41], v56 offset:8192
    v_mfma_f32_16x16x32_bf16 v[244:247], a[8:11], a[172:175], v[244:247]
    ds_read_b64_tr_b16 a[42:43], v56 offset:10240
    ds_read_b64_tr_b16 a[44:45], v57 offset:8192
    v_mfma_f32_16x16x32_bf16 v[240:243], a[4:7], a[172:175], v[240:243]
    ds_read_b64_tr_b16 a[46:47], v57 offset:10240
    v_mfma_f32_16x16x32_bf16 v[236:239], a[0:3], a[172:175], v[236:239]
    buffer_load_dwordx4 a[152:155], v7, s[20:23], s29 offen offset:0 sc1
    ds_read_b64_tr_b16 a[48:49], v54 offset:12288
    s_waitcnt lgkmcnt(9)
    v_mfma_f32_16x16x32_bf16 v[220:223], a[16:19], a[176:179], v[220:223]
    ds_read_b64_tr_b16 a[50:51], v54 offset:14336
    v_mfma_f32_16x16x32_bf16 v[224:227], a[20:23], a[176:179], v[224:227]
    buffer_load_dwordx4 a[156:159], v7, s[20:23], s30 offen offset:0 sc1
    ds_read_b64_tr_b16 a[52:53], v55 offset:12288
    ds_read_b64_tr_b16 a[54:55], v55 offset:14336
    v_mfma_f32_16x16x32_bf16 v[228:231], a[24:27], a[176:179], v[228:231]
    ds_read_b64_tr_b16 a[56:57], v56 offset:12288
    v_mfma_f32_16x16x32_bf16 v[232:235], a[28:31], a[176:179], v[232:235]
    ds_read_b64_tr_b16 a[58:59], v56 offset:14336
    v_mfma_f32_16x16x32_bf16 v[248:251], a[28:31], a[180:183], v[248:251]
    buffer_load_dwordx4 a[160:163], v7, s[20:23], s29 offen offset:1024 sc1
    ds_read_b64_tr_b16 a[60:61], v57 offset:12288
    v_mfma_f32_16x16x32_bf16 v[244:247], a[24:27], a[180:183], v[244:247]
    ds_read_b64_tr_b16 a[62:63], v57 offset:14336
    v_mfma_f32_16x16x32_bf16 v[240:243], a[20:23], a[180:183], v[240:243]
    buffer_load_dwordx4 a[164:167], v7, s[20:23], s30 offen offset:1024 sc1
    s_add_u32 s29, s29, 2048
    v_mfma_f32_16x16x32_bf16 v[236:239], a[16:19], a[180:183], v[236:239]
    s_add_u32 s30, s30, 2048
    s_waitcnt lgkmcnt(8)
    v_mfma_f32_16x16x32_bf16 v[220:223], a[32:35], a[184:187], v[220:223]
    s_waitcnt vmcnt(37)
    s_barrier
    v_mfma_f32_16x16x32_bf16 v[224:227], a[36:39], a[184:187], v[224:227]
    s_lshr_b32 s45, 0x5060605, s36
    s_and_b32 s45, s45, 0xff
    ds_read_b64_tr_b16 a[0:1], v54 offset:16384
    v_mfma_f32_16x16x32_bf16 v[228:231], a[40:43], a[184:187], v[228:231]
    s_lshl_b32 s28, s45, 18
    s_lshl_b32 s45, s45, 12
    ds_read_b64_tr_b16 a[2:3], v54 offset:18432
    v_mfma_f32_16x16x32_bf16 v[232:235], a[44:47], a[184:187], v[232:235]
    s_add_u32 s29, s54, s45
    s_add_u32 s30, s29, 32768
    ds_read_b64_tr_b16 a[4:5], v55 offset:16384
    v_mfma_f32_16x16x32_bf16 v[248:251], a[44:47], a[188:191], v[248:251]
    s_add_u32 m0, s56, 0xfffe0000
    s_nop 0
    buffer_load_dwordx4 v34, s[12:15], s28 offen lds
    ds_read_b64_tr_b16 a[6:7], v55 offset:18432
    v_mfma_f32_16x16x32_bf16 v[244:247], a[40:43], a[188:191], v[244:247]
    buffer_load_dwordx4 v35, s[12:15], s28 offen offset:1024 lds
    s_add_u32 s28, s28, 131072
    ds_read_b64_tr_b16 a[8:9], v56 offset:16384
    v_mfma_f32_16x16x32_bf16 v[240:243], a[36:39], a[188:191], v[240:243]
    ds_read_b64_tr_b16 a[10:11], v56 offset:18432
    ds_read_b64_tr_b16 a[12:13], v57 offset:16384
    ds_read_b64_tr_b16 a[14:15], v57 offset:18432
    v_mfma_f32_16x16x32_bf16 v[236:239], a[32:35], a[188:191], v[236:239]
    buffer_load_dwordx4 a[168:171], v7, s[20:23], s29 offen offset:0 sc1
    ds_read_b64_tr_b16 a[16:17], v54 offset:20480
    s_waitcnt lgkmcnt(9)
    v_mfma_f32_16x16x32_bf16 v[220:223], a[48:51], a[192:195], v[220:223]
    ds_read_b64_tr_b16 a[18:19], v54 offset:22528
    v_mfma_f32_16x16x32_bf16 v[224:227], a[52:55], a[192:195], v[224:227]
    buffer_load_dwordx4 a[172:175], v7, s[20:23], s30 offen offset:0 sc1
    ds_read_b64_tr_b16 a[20:21], v55 offset:20480
    ds_read_b64_tr_b16 a[22:23], v55 offset:22528
    v_mfma_f32_16x16x32_bf16 v[228:231], a[56:59], a[192:195], v[228:231]
    ds_read_b64_tr_b16 a[24:25], v56 offset:20480
    v_mfma_f32_16x16x32_bf16 v[232:235], a[60:63], a[192:195], v[232:235]
    ds_read_b64_tr_b16 a[26:27], v56 offset:22528
    v_mfma_f32_16x16x32_bf16 v[248:251], a[60:63], a[196:199], v[248:251]
    buffer_load_dwordx4 a[176:179], v7, s[20:23], s29 offen offset:1024 sc1
    ds_read_b64_tr_b16 a[28:29], v57 offset:20480
    v_mfma_f32_16x16x32_bf16 v[244:247], a[56:59], a[196:199], v[244:247]
    ds_read_b64_tr_b16 a[30:31], v57 offset:22528
    v_mfma_f32_16x16x32_bf16 v[240:243], a[52:55], a[196:199], v[240:243]
    buffer_load_dwordx4 a[180:183], v7, s[20:23], s30 offen offset:1024 sc1
    s_add_u32 s29, s29, 2048
    v_mfma_f32_16x16x32_bf16 v[236:239], a[48:51], a[196:199], v[236:239]
    s_add_u32 s30, s30, 2048
    s_waitcnt lgkmcnt(8)
    v_mfma_f32_16x16x32_bf16 v[220:223], a[0:3], a[200:203], v[220:223]
    s_waitcnt vmcnt(30)
    s_barrier
    v_mfma_f32_16x16x32_bf16 v[224:227], a[4:7], a[200:203], v[224:227]
    s_add_u32 m0, s56, 0xfffe2000
    ds_read_b64_tr_b16 a[32:33], v54 offset:24576
    ds_read_b64_tr_b16 a[34:35], v54 offset:26624
    v_mfma_f32_16x16x32_bf16 v[228:231], a[8:11], a[200:203], v[228:231]
    buffer_load_dwordx4 v34, s[12:15], s28 offen lds
    ds_read_b64_tr_b16 a[36:37], v55 offset:24576
    v_mfma_f32_16x16x32_bf16 v[232:235], a[12:15], a[200:203], v[232:235]
    ds_read_b64_tr_b16 a[38:39], v55 offset:26624
    v_mfma_f32_16x16x32_bf16 v[248:251], a[12:15], a[204:207], v[248:251]
    buffer_load_dwordx4 v35, s[12:15], s28 offen offset:1024 lds
    s_add_u32 s28, s28, 131072
    ds_read_b64_tr_b16 a[40:41], v56 offset:24576
    v_mfma_f32_16x16x32_bf16 v[244:247], a[8:11], a[204:207], v[244:247]
    ds_read_b64_tr_b16 a[42:43], v56 offset:26624
    ds_read_b64_tr_b16 a[44:45], v57 offset:24576
    v_mfma_f32_16x16x32_bf16 v[240:243], a[4:7], a[204:207], v[240:243]
    ds_read_b64_tr_b16 a[46:47], v57 offset:26624
    v_mfma_f32_16x16x32_bf16 v[236:239], a[0:3], a[204:207], v[236:239]
    buffer_load_dwordx4 a[184:187], v7, s[20:23], s29 offen offset:0 sc1
    ds_read_b64_tr_b16 a[48:49], v54 offset:28672
    s_waitcnt lgkmcnt(9)
    v_mfma_f32_16x16x32_bf16 v[220:223], a[16:19], a[208:211], v[220:223]
    ds_read_b64_tr_b16 a[50:51], v54 offset:30720
    v_mfma_f32_16x16x32_bf16 v[224:227], a[20:23], a[208:211], v[224:227]
    buffer_load_dwordx4 a[188:191], v7, s[20:23], s30 offen offset:0 sc1
    ds_read_b64_tr_b16 a[52:53], v55 offset:28672
    ds_read_b64_tr_b16 a[54:55], v55 offset:30720
    v_mfma_f32_16x16x32_bf16 v[228:231], a[24:27], a[208:211], v[228:231]
    ds_read_b64_tr_b16 a[56:57], v56 offset:28672
    v_mfma_f32_16x16x32_bf16 v[232:235], a[28:31], a[208:211], v[232:235]
    ds_read_b64_tr_b16 a[58:59], v56 offset:30720
    v_mfma_f32_16x16x32_bf16 v[248:251], a[28:31], a[212:215], v[248:251]
    buffer_load_dwordx4 a[192:195], v7, s[20:23], s29 offen offset:1024 sc1
    ds_read_b64_tr_b16 a[60:61], v57 offset:28672
    v_mfma_f32_16x16x32_bf16 v[244:247], a[24:27], a[212:215], v[244:247]
    ds_read_b64_tr_b16 a[62:63], v57 offset:30720
    v_mfma_f32_16x16x32_bf16 v[240:243], a[20:23], a[212:215], v[240:243]
    buffer_load_dwordx4 a[196:199], v7, s[20:23], s30 offen offset:1024 sc1
    s_add_u32 s29, s29, 2048
    v_mfma_f32_16x16x32_bf16 v[236:239], a[16:19], a[212:215], v[236:239]
    s_add_u32 s30, s30, 2048
    s_waitcnt lgkmcnt(8)
    v_mfma_f32_16x16x32_bf16 v[220:223], a[32:35], a[216:219], v[220:223]
    s_waitcnt vmcnt(30)
    s_barrier
    v_mfma_f32_16x16x32_bf16 v[224:227], a[36:39], a[216:219], v[224:227]
    s_lshr_b32 s45, 0x7070706, s36
    s_and_b32 s45, s45, 0xff
    ds_read_b64_tr_b16 a[0:1], v38 offset:0
    v_mfma_f32_16x16x32_bf16 v[228:231], a[40:43], a[216:219], v[228:231]
    s_lshl_b32 s28, s45, 18
    s_lshl_b32 s45, s45, 12
    ds_read_b64_tr_b16 a[2:3], v38 offset:2048
    v_mfma_f32_16x16x32_bf16 v[232:235], a[44:47], a[216:219], v[232:235]
    s_add_u32 s29, s54, s45
    s_add_u32 s30, s29, 32768
    ds_read_b64_tr_b16 a[4:5], v39 offset:0
    v_mfma_f32_16x16x32_bf16 v[248:251], a[44:47], a[220:223], v[248:251]
    s_add_u32 m0, s56, 0xfffe4000
    s_nop 0
    buffer_load_dwordx4 v34, s[12:15], s28 offen lds
    ds_read_b64_tr_b16 a[6:7], v39 offset:2048
    v_mfma_f32_16x16x32_bf16 v[244:247], a[40:43], a[220:223], v[244:247]
    buffer_load_dwordx4 v35, s[12:15], s28 offen offset:1024 lds
    s_add_u32 s28, s28, 131072
    ds_read_b64_tr_b16 a[8:9], v40 offset:0
    v_mfma_f32_16x16x32_bf16 v[240:243], a[36:39], a[220:223], v[240:243]
    ds_read_b64_tr_b16 a[10:11], v40 offset:2048
    ds_read_b64_tr_b16 a[12:13], v41 offset:0
    ds_read_b64_tr_b16 a[14:15], v41 offset:2048
    v_mfma_f32_16x16x32_bf16 v[236:239], a[32:35], a[220:223], v[236:239]
    buffer_load_dwordx4 a[200:203], v7, s[20:23], s29 offen offset:0 sc1
    ds_read_b64_tr_b16 a[16:17], v38 offset:4096
    s_waitcnt lgkmcnt(9)
    v_mfma_f32_16x16x32_bf16 v[220:223], a[48:51], a[224:227], v[220:223]
    ds_read_b64_tr_b16 a[18:19], v38 offset:6144
    v_mfma_f32_16x16x32_bf16 v[224:227], a[52:55], a[224:227], v[224:227]
    buffer_load_dwordx4 a[204:207], v7, s[20:23], s30 offen offset:0 sc1
    ds_read_b64_tr_b16 a[20:21], v39 offset:4096
    ds_read_b64_tr_b16 a[22:23], v39 offset:6144
    v_mfma_f32_16x16x32_bf16 v[228:231], a[56:59], a[224:227], v[228:231]
    ds_read_b64_tr_b16 a[24:25], v40 offset:4096
    v_mfma_f32_16x16x32_bf16 v[232:235], a[60:63], a[224:227], v[232:235]
    ds_read_b64_tr_b16 a[26:27], v40 offset:6144
    v_mfma_f32_16x16x32_bf16 v[248:251], a[60:63], a[228:231], v[248:251]
    buffer_load_dwordx4 a[208:211], v7, s[20:23], s29 offen offset:1024 sc1
    ds_read_b64_tr_b16 a[28:29], v41 offset:4096
    v_mfma_f32_16x16x32_bf16 v[244:247], a[56:59], a[228:231], v[244:247]
    ds_read_b64_tr_b16 a[30:31], v41 offset:6144
    v_mfma_f32_16x16x32_bf16 v[240:243], a[52:55], a[228:231], v[240:243]
    buffer_load_dwordx4 a[212:215], v7, s[20:23], s30 offen offset:1024 sc1
    s_add_u32 s29, s29, 2048
    v_mfma_f32_16x16x32_bf16 v[236:239], a[48:51], a[228:231], v[236:239]
    s_add_u32 s30, s30, 2048
    s_waitcnt lgkmcnt(8)
    v_mfma_f32_16x16x32_bf16 v[220:223], a[0:3], a[104:107], v[220:223]
    s_waitcnt vmcnt(30)
    s_barrier
    v_mfma_f32_16x16x32_bf16 v[224:227], a[4:7], a[104:107], v[224:227]
    s_add_u32 m0, s56, 0xfffe6000
    ds_read_b64_tr_b16 a[32:33], v38 offset:8192
    ds_read_b64_tr_b16 a[34:35], v38 offset:10240
    v_mfma_f32_16x16x32_bf16 v[228:231], a[8:11], a[104:107], v[228:231]
    buffer_load_dwordx4 v34, s[12:15], s28 offen lds
    ds_read_b64_tr_b16 a[36:37], v39 offset:8192
    v_mfma_f32_16x16x32_bf16 v[232:235], a[12:15], a[104:107], v[232:235]
    ds_read_b64_tr_b16 a[38:39], v39 offset:10240
    v_mfma_f32_16x16x32_bf16 v[248:251], a[12:15], a[108:111], v[248:251]
    buffer_load_dwordx4 v35, s[12:15], s28 offen offset:1024 lds
    s_add_u32 s28, s28, 131072
    ds_read_b64_tr_b16 a[40:41], v40 offset:8192
    v_mfma_f32_16x16x32_bf16 v[244:247], a[8:11], a[108:111], v[244:247]
    ds_read_b64_tr_b16 a[42:43], v40 offset:10240
    ds_read_b64_tr_b16 a[44:45], v41 offset:8192
    v_mfma_f32_16x16x32_bf16 v[240:243], a[4:7], a[108:111], v[240:243]
    ds_read_b64_tr_b16 a[46:47], v41 offset:10240
    v_mfma_f32_16x16x32_bf16 v[236:239], a[0:3], a[108:111], v[236:239]
    buffer_load_dwordx4 a[216:219], v7, s[20:23], s29 offen offset:0 sc1
    ds_read_b64_tr_b16 a[48:49], v38 offset:12288
    s_waitcnt lgkmcnt(9)
    v_mfma_f32_16x16x32_bf16 v[220:223], a[16:19], a[112:115], v[220:223]
    ds_read_b64_tr_b16 a[50:51], v38 offset:14336
    v_mfma_f32_16x16x32_bf16 v[224:227], a[20:23], a[112:115], v[224:227]
    buffer_load_dwordx4 a[220:223], v7, s[20:23], s30 offen offset:0 sc1
    ds_read_b64_tr_b16 a[52:53], v39 offset:12288
    ds_read_b64_tr_b16 a[54:55], v39 offset:14336
    v_mfma_f32_16x16x32_bf16 v[228:231], a[24:27], a[112:115], v[228:231]
    ds_read_b64_tr_b16 a[56:57], v40 offset:12288
    v_mfma_f32_16x16x32_bf16 v[232:235], a[28:31], a[112:115], v[232:235]
    ds_read_b64_tr_b16 a[58:59], v40 offset:14336
    v_mfma_f32_16x16x32_bf16 v[248:251], a[28:31], a[116:119], v[248:251]
    buffer_load_dwordx4 a[224:227], v7, s[20:23], s29 offen offset:1024 sc1
    ds_read_b64_tr_b16 a[60:61], v41 offset:12288
    v_mfma_f32_16x16x32_bf16 v[244:247], a[24:27], a[116:119], v[244:247]
    ds_read_b64_tr_b16 a[62:63], v41 offset:14336
    v_mfma_f32_16x16x32_bf16 v[240:243], a[20:23], a[116:119], v[240:243]
    buffer_load_dwordx4 a[228:231], v7, s[20:23], s30 offen offset:1024 sc1
    s_add_u32 s29, s29, 2048
    v_mfma_f32_16x16x32_bf16 v[236:239], a[16:19], a[116:119], v[236:239]
    s_add_u32 s30, s30, 2048
    s_waitcnt lgkmcnt(8)
    v_mfma_f32_16x16x32_bf16 v[220:223], a[32:35], a[120:123], v[220:223]
    s_waitcnt vmcnt(30)
    s_barrier
    v_mfma_f32_16x16x32_bf16 v[224:227], a[36:39], a[120:123], v[224:227]
    s_mov_b32 s45, s39
    s_mul_i32 s28, s45, 229376
    ds_read_b64_tr_b16 a[0:1], v38 offset:16384
    v_mfma_f32_16x16x32_bf16 v[228:231], a[40:43], a[120:123], v[228:231]
    s_mul_i32 s45, s45, 7168
    s_add_u32 s52, s55, s45
    ds_read_b64_tr_b16 a[2:3], v38 offset:18432
    v_mfma_f32_16x16x32_bf16 v[232:235], a[44:47], a[120:123], v[232:235]
    s_add_u32 s53, s52, 3072
    s_add_u32 m0, s56, 0x0
    ds_read_b64_tr_b16 a[4:5], v39 offset:16384
    v_mfma_f32_16x16x32_bf16 v[248:251], a[44:47], a[124:127], v[248:251]
    buffer_load_dwordx4 v34, s[16:19], s28 offen lds
    ds_read_b64_tr_b16 a[6:7], v39 offset:18432
    ds_read_b64_tr_b16 a[8:9], v40 offset:16384
    v_mfma_f32_16x16x32_bf16 v[244:247], a[40:43], a[124:127], v[244:247]
    ds_read_b64_tr_b16 a[10:11], v40 offset:18432
    ds_read_b64_tr_b16 a[12:13], v41 offset:16384
    v_mfma_f32_16x16x32_bf16 v[240:243], a[36:39], a[124:127], v[240:243]
    ds_read_b64_tr_b16 a[14:15], v41 offset:18432
    v_mfma_f32_16x16x32_bf16 v[236:239], a[32:35], a[124:127], v[236:239]
    ds_read_b64_tr_b16 a[16:17], v38 offset:20480
    s_waitcnt lgkmcnt(9)
    v_mfma_f32_16x16x32_bf16 v[220:223], a[48:51], a[128:131], v[220:223]
    ds_read_b64_tr_b16 a[18:19], v38 offset:22528
    v_mfma_f32_16x16x32_bf16 v[224:227], a[52:55], a[128:131], v[224:227]
    buffer_load_dwordx4 v35, s[16:19], s28 offen offset:1024 lds
    s_add_u32 s28, s28, 131072
    ds_read_b64_tr_b16 a[20:21], v39 offset:20480
    v_mfma_f32_16x16x32_bf16 v[228:231], a[56:59], a[128:131], v[228:231]
    ds_read_b64_tr_b16 a[22:23], v39 offset:22528
    ds_read_b64_tr_b16 a[24:25], v40 offset:20480
    v_mfma_f32_16x16x32_bf16 v[232:235], a[60:63], a[128:131], v[232:235]
    ds_read_b64_tr_b16 a[26:27], v40 offset:22528
    v_mfma_f32_16x16x32_bf16 v[248:251], a[60:63], a[132:135], v[248:251]
    ds_read_b64_tr_b16 a[28:29], v41 offset:20480
    v_mfma_f32_16x16x32_bf16 v[244:247], a[56:59], a[132:135], v[244:247]
    ds_read_b64_tr_b16 a[30:31], v41 offset:22528
    v_mfma_f32_16x16x32_bf16 v[240:243], a[52:55], a[132:135], v[240:243]
    v_mfma_f32_16x16x32_bf16 v[236:239], a[48:51], a[132:135], v[236:239]
    s_waitcnt lgkmcnt(8)
    v_mfma_f32_16x16x32_bf16 v[220:223], a[0:3], a[136:139], v[220:223]
    s_waitcnt vmcnt(26)
    s_barrier
    v_mfma_f32_16x16x32_bf16 v[224:227], a[4:7], a[136:139], v[224:227]
    s_add_u32 m0, s57, 0x2000
    ds_read_b64_tr_b16 a[32:33], v38 offset:24576
    ds_read_b64_tr_b16 a[34:35], v38 offset:26624
    v_mfma_f32_16x16x32_bf16 v[228:231], a[8:11], a[136:139], v[228:231]
    buffer_load_dwordx4 v36, s[16:19], s28 offen lds
    ds_read_b64_tr_b16 a[36:37], v39 offset:24576
    v_mfma_f32_16x16x32_bf16 v[232:235], a[12:15], a[136:139], v[232:235]
    ds_read_b64_tr_b16 a[38:39], v39 offset:26624
    v_mfma_f32_16x16x32_bf16 v[248:251], a[12:15], a[140:143], v[248:251]
    ds_read_b64_tr_b16 a[40:41], v40 offset:24576
    v_mfma_f32_16x16x32_bf16 v[244:247], a[8:11], a[140:143], v[244:247]
    ds_read_b64_tr_b16 a[42:43], v40 offset:26624
    ds_read_b64_tr_b16 a[44:45], v41 offset:24576
    v_mfma_f32_16x16x32_bf16 v[240:243], a[4:7], a[140:143], v[240:243]
    ds_read_b64_tr_b16 a[46:47], v41 offset:26624
    v_mfma_f32_16x16x32_bf16 v[236:239], a[0:3], a[140:143], v[236:239]
    ds_read_b64_tr_b16 a[48:49], v38 offset:28672
    s_waitcnt lgkmcnt(9)
    v_mfma_f32_16x16x32_bf16 v[220:223], a[16:19], a[144:147], v[220:223]
    s_add_u32 m0, s58, 0x2000
    ds_read_b64_tr_b16 a[50:51], v38 offset:30720
    v_mfma_f32_16x16x32_bf16 v[224:227], a[20:23], a[144:147], v[224:227]
    s_mov_b64 exec, s[32:33]
    buffer_load_dwordx4 v37, s[16:19], s28 offen lds
    s_mov_b64 exec, -1
    v_mfma_f32_16x16x32_bf16 v[228:231], a[24:27], a[144:147], v[228:231]
    ds_read_b64_tr_b16 a[52:53], v39 offset:28672
    ds_read_b64_tr_b16 a[54:55], v39 offset:30720
    ds_read_b64_tr_b16 a[56:57], v40 offset:28672
    v_mfma_f32_16x16x32_bf16 v[232:235], a[28:31], a[144:147], v[232:235]
    ds_read_b64_tr_b16 a[58:59], v40 offset:30720
    v_mfma_f32_16x16x32_bf16 v[248:251], a[28:31], a[148:151], v[248:251]
    ds_read_b64_tr_b16 a[60:61], v41 offset:28672
    v_mfma_f32_16x16x32_bf16 v[244:247], a[24:27], a[148:151], v[244:247]
    ds_read_b64_tr_b16 a[62:63], v41 offset:30720
    v_mfma_f32_16x16x32_bf16 v[240:243], a[20:23], a[148:151], v[240:243]
    v_mfma_f32_16x16x32_bf16 v[236:239], a[16:19], a[148:151], v[236:239]
    s_waitcnt lgkmcnt(8)
    v_mfma_f32_16x16x32_bf16 v[220:223], a[32:35], a[152:155], v[220:223]
    s_waitcnt vmcnt(22)
    s_barrier
    v_mfma_f32_16x16x32_bf16 v[224:227], a[36:39], a[152:155], v[224:227]
    ds_read_b64_tr_b16 a[0:1], v54 offset:0
    ds_read_b64_tr_b16 a[2:3], v54 offset:2048
    v_mfma_f32_16x16x32_bf16 v[228:231], a[40:43], a[152:155], v[228:231]
    ds_read_b64_tr_b16 a[4:5], v55 offset:0
    v_mfma_f32_16x16x32_bf16 v[232:235], a[44:47], a[152:155], v[232:235]
    ds_read_b64_tr_b16 a[6:7], v55 offset:2048
    v_mfma_f32_16x16x32_bf16 v[248:251], a[44:47], a[156:159], v[248:251]
    ds_read_b64_tr_b16 a[8:9], v56 offset:0
    v_mfma_f32_16x16x32_bf16 v[244:247], a[40:43], a[156:159], v[244:247]
    ds_read_b64_tr_b16 a[10:11], v56 offset:2048
    ds_read_b64_tr_b16 a[12:13], v57 offset:0
    v_mfma_f32_16x16x32_bf16 v[240:243], a[36:39], a[156:159], v[240:243]
    ds_read_b64_tr_b16 a[14:15], v57 offset:2048
    v_mfma_f32_16x16x32_bf16 v[236:239], a[32:35], a[156:159], v[236:239]
    ds_read_b64_tr_b16 a[16:17], v54 offset:4096
    s_waitcnt lgkmcnt(9)
    v_mfma_f32_16x16x32_bf16 v[220:223], a[48:51], a[160:163], v[220:223]
    ds_read_b64_tr_b16 a[18:19], v54 offset:6144
    v_mfma_f32_16x16x32_bf16 v[224:227], a[52:55], a[160:163], v[224:227]
    ds_read_b64_tr_b16 a[20:21], v55 offset:4096
    ds_read_b64_tr_b16 a[22:23], v55 offset:6144
    v_mfma_f32_16x16x32_bf16 v[228:231], a[56:59], a[160:163], v[228:231]
    ds_read_b64_tr_b16 a[24:25], v56 offset:4096
    v_mfma_f32_16x16x32_bf16 v[232:235], a[60:63], a[160:163], v[232:235]
    ds_read_b64_tr_b16 a[26:27], v56 offset:6144
    v_mfma_f32_16x16x32_bf16 v[248:251], a[60:63], a[164:167], v[248:251]
    ds_read_b64_tr_b16 a[28:29], v57 offset:4096
    v_mfma_f32_16x16x32_bf16 v[244:247], a[56:59], a[164:167], v[244:247]
    ds_read_b64_tr_b16 a[30:31], v57 offset:6144
    v_mfma_f32_16x16x32_bf16 v[240:243], a[52:55], a[164:167], v[240:243]
    v_mfma_f32_16x16x32_bf16 v[236:239], a[48:51], a[164:167], v[236:239]
    s_waitcnt lgkmcnt(8)
    v_mfma_f32_16x16x32_bf16 v[220:223], a[0:3], a[168:171], v[220:223]
    s_add_u32 s48, s38, 16
    s_lshl_b32 s48, s48, 7
    s_add_u32 s48, s48, 26607616
    v_mov_b32 v46, 0
    s_cmp_lg_u32 s3, 0
    s_cbranch_scc1 L_polled_1_34
    s_mov_b32 s47, 0
L_poll_1_33:
    buffer_load_dword v47, v46, s[20:23], s48 offen sc1
    s_waitcnt vmcnt(0)
    v_cmp_gt_u32 vcc, 16, v47
    s_nop 1
    s_cmp_eq_u64 vcc, 0
    s_cbranch_scc1 L_polled_1_34
    s_add_u32 s47, s47, 1
    s_cmp_lt_u32 s47, 262144
    s_cbranch_scc1 L_poll_1_33
L_polled_1_34:
    s_nop 1
    s_waitcnt vmcnt(16)
    s_barrier
    v_mfma_f32_16x16x32_bf16 v[224:227], a[4:7], a[168:171], v[224:227]
    s_lshr_b32 s45, 0x3, s36
    s_and_b32 s45, s45, 0xff
    ds_read_b64_tr_b16 a[32:33], v54 offset:8192
    v_mfma_f32_16x16x32_bf16 v[228:231], a[8:11], a[168:171], v[228:231]
    s_cmp_ge_u32 s45, s39
    s_addc_u32 s45, s45, 0
    ds_read_b64_tr_b16 a[34:35], v54 offset:10240
    v_mfma_f32_16x16x32_bf16 v[232:235], a[12:15], a[168:171], v[232:235]
    s_mul_i32 s28, s45, 229376
    s_mul_i32 s45, s45, 7168
    ds_read_b64_tr_b16 a[36:37], v55 offset:8192
    v_mfma_f32_16x16x32_bf16 v[248:251], a[12:15], a[172:175], v[248:251]
    s_add_u32 s52, s55, s45
    s_add_u32 s53, s52, 3072
    ds_read_b64_tr_b16 a[38:39], v55 offset:10240
    v_mfma_f32_16x16x32_bf16 v[244:247], a[8:11], a[172:175], v[244:247]
    s_add_u32 m0, s56, 0x4000
    s_nop 0
    buffer_load_dwordx4 v34, s[16:19], s28 offen lds
    ds_read_b64_tr_b16 a[40:41], v56 offset:8192
    v_mfma_f32_16x16x32_bf16 v[240:243], a[4:7], a[172:175], v[240:243]
    buffer_load_dwordx4 v35, s[16:19], s28 offen offset:1024 lds
    s_add_u32 s28, s28, 131072
    ds_read_b64_tr_b16 a[42:43], v56 offset:10240
    v_mfma_f32_16x16x32_bf16 v[236:239], a[0:3], a[172:175], v[236:239]
    buffer_load_dwordx4 a[136:139], v7, s[20:23], s52 offen offset:0 sc1
    buffer_load_dwordx4 a[140:143], v7, s[20:23], s53 offen offset:0 sc1
    ds_read_b64_tr_b16 a[44:45], v57 offset:8192
    s_waitcnt lgkmcnt(7)
    v_mfma_f32_16x16x32_bf16 v[220:223], a[16:19], a[176:179], v[220:223]
    buffer_load_dwordx4 a[144:147], v7, s[20:23], s52 offen offset:1024 sc1
    buffer_load_dwordx4 a[148:151], v7, s[20:23], s53 offen offset:1024 sc1
    ds_read_b64_tr_b16 a[46:47], v57 offset:10240
    v_mfma_f32_16x16x32_bf16 v[224:227], a[20:23], a[176:179], v[224:227]
    s_add_u32 m0, s57, 0x6000
    ds_read_b64_tr_b16 a[48:49], v54 offset:12288
    ds_read_b64_tr_b16 a[50:51], v54 offset:14336
    v_mfma_f32_16x16x32_bf16 v[228:231], a[24:27], a[176:179], v[228:231]
    buffer_load_dwordx4 v36, s[16:19], s28 offen lds
    s_add_u32 m0, s58, 0x6000
    ds_read_b64_tr_b16 a[52:53], v55 offset:12288
    v_mfma_f32_16x16x32_bf16 v[232:235], a[28:31], a[176:179], v[232:235]
    s_mov_b64 exec, s[32:33]
    buffer_load_dwordx4 v37, s[16:19], s28 offen lds
    s_mov_b64 exec, -1
    v_mfma_f32_16x16x32_bf16 v[248:251], a[28:31], a[180:183], v[248:251]
    buffer_load_dwordx4 a[152:155], v7, s[20:23], s52 offen offset:2048 sc1
    ds_read_b64_tr_b16 a[54:55], v55 offset:14336
    ds_read_b64_tr_b16 a[56:57], v56 offset:12288
    v_mfma_f32_16x16x32_bf16 v[244:247], a[24:27], a[180:183], v[244:247]
    ds_read_b64_tr_b16 a[58:59], v56 offset:14336
    ds_read_b64_tr_b16 a[60:61], v57 offset:12288
    ds_read_b64_tr_b16 a[62:63], v57 offset:14336
    v_mfma_f32_16x16x32_bf16 v[240:243], a[20:23], a[180:183], v[240:243]
    buffer_load_dwordx4 a[156:159], v7, s[20:23], s53 offen offset:2048 sc1
    v_mfma_f32_16x16x32_bf16 v[236:239], a[16:19], a[180:183], v[236:239]
    buffer_load_dwordx4 a[160:163], v7, s[20:23], s53 offen offset:3072 sc1
    s_waitcnt lgkmcnt(8)
    v_mfma_f32_16x16x32_bf16 v[220:223], a[32:35], a[184:187], v[220:223]
    s_waitcnt vmcnt(21)
    s_barrier
    v_mfma_f32_16x16x32_bf16 v[224:227], a[36:39], a[184:187], v[224:227]
    s_lshr_b32 s45, 0x1010400, s36
    s_and_b32 s45, s45, 0xff
    ds_read_b64_tr_b16 a[0:1], v54 offset:16384
    v_mfma_f32_16x16x32_bf16 v[228:231], a[40:43], a[184:187], v[228:231]
    s_cmp_ge_u32 s45, s39
    s_addc_u32 s45, s45, 0
    ds_read_b64_tr_b16 a[2:3], v54 offset:18432
    v_mfma_f32_16x16x32_bf16 v[232:235], a[44:47], a[184:187], v[232:235]
    s_mul_i32 s28, s45, 229376
    s_mul_i32 s45, s45, 7168
    ds_read_b64_tr_b16 a[4:5], v55 offset:16384
    v_mfma_f32_16x16x32_bf16 v[248:251], a[44:47], a[188:191], v[248:251]
    s_add_u32 s52, s55, s45
    s_add_u32 s53, s52, 3072
    ds_read_b64_tr_b16 a[6:7], v55 offset:18432
    v_mfma_f32_16x16x32_bf16 v[244:247], a[40:43], a[188:191], v[244:247]
    s_add_u32 m0, s56, 0xfffe0000
    s_nop 0
    buffer_load_dwordx4 v34, s[16:19], s28 offen lds
    ds_read_b64_tr_b16 a[8:9], v56 offset:16384
    v_mfma_f32_16x16x32_bf16 v[240:243], a[36:39], a[188:191], v[240:243]
    buffer_load_dwordx4 v35, s[16:19], s28 offen offset:1024 lds
    s_add_u32 s28, s28, 131072
    ds_read_b64_tr_b16 a[10:11], v56 offset:18432
    v_mfma_f32_16x16x32_bf16 v[236:239], a[32:35], a[188:191], v[236:239]
    buffer_load_dwordx4 a[168:171], v7, s[20:23], s52 offen offset:0 sc1
    ds_read_b64_tr_b16 a[12:13], v57 offset:16384
    ds_read_b64_tr_b16 a[14:15], v57 offset:18432
    s_waitcnt lgkmcnt(8)
    v_mfma_f32_16x16x32_bf16 v[220:223], a[48:51], a[192:195], v[220:223]
    ds_read_b64_tr_b16 a[16:17], v54 offset:20480
    ds_read_b64_tr_b16 a[18:19], v54 offset:22528
    v_mfma_f32_16x16x32_bf16 v[224:227], a[52:55], a[192:195], v[224:227]
    buffer_load_dwordx4 a[172:175], v7, s[20:23], s53 offen offset:0 sc1
    ds_read_b64_tr_b16 a[20:21], v55 offset:20480
    ds_read_b64_tr_b16 a[22:23], v55 offset:22528
    v_mfma_f32_16x16x32_bf16 v[228:231], a[56:59], a[192:195], v[228:231]
    ds_read_b64_tr_b16 a[24:25], v56 offset:20480
    v_mfma_f32_16x16x32_bf16 v[232:235], a[60:63], a[192:195], v[232:235]
    ds_read_b64_tr_b16 a[26:27], v56 offset:22528
    v_mfma_f32_16x16x32_bf16 v[248:251], a[60:63], a[196:199], v[248:251]
    buffer_load_dwordx4 a[176:179], v7, s[20:23], s52 offen offset:1024 sc1
    ds_read_b64_tr_b16 a[28:29], v57 offset:20480
    v_mfma_f32_16x16x32_bf16 v[244:247], a[56:59], a[196:199], v[244:247]
    ds_read_b64_tr_b16 a[30:31], v57 offset:22528
    v_mfma_f32_16x16x32_bf16 v[240:243], a[52:55], a[196:199], v[240:243]
    buffer_load_dwordx4 a[180:183], v7, s[20:23], s53 offen offset:1024 sc1
    v_mfma_f32_16x16x32_bf16 v[236:239], a[48:51], a[196:199], v[236:239]
    s_waitcnt lgkmcnt(8)
    v_mfma_f32_16x16x32_bf16 v[220:223], a[0:3], a[200:203], v[220:223]
    s_waitcnt vmcnt(21)
    s_barrier
    v_mfma_f32_16x16x32_bf16 v[224:227], a[4:7], a[200:203], v[224:227]
    s_add_u32 m0, s57, 0xfffe2000
    ds_read_b64_tr_b16 a[32:33], v54 offset:24576
    ds_read_b64_tr_b16 a[34:35], v54 offset:26624
    v_mfma_f32_16x16x32_bf16 v[228:231], a[8:11], a[200:203], v[228:231]
    buffer_load_dwordx4 v36, s[16:19], s28 offen lds
    ds_read_b64_tr_b16 a[36:37], v55 offset:24576
    v_mfma_f32_16x16x32_bf16 v[232:235], a[12:15], a[200:203], v[232:235]
    ds_read_b64_tr_b16 a[38:39], v55 offset:26624
    v_mfma_f32_16x16x32_bf16 v[248:251], a[12:15], a[204:207], v[248:251]
    s_add_u32 m0, s58, 0xfffe2000
    ds_read_b64_tr_b16 a[40:41], v56 offset:24576
    v_mfma_f32_16x16x32_bf16 v[244:247], a[8:11], a[204:207], v[244:247]
    s_mov_b64 exec, s[32:33]
    buffer_load_dwordx4 v37, s[16:19], s28 offen lds
    s_mov_b64 exec, -1
    v_mfma_f32_16x16x32_bf16 v[240:243], a[4:7], a[204:207], v[240:243]
    ds_read_b64_tr_b16 a[42:43], v56 offset:26624
    ds_read_b64_tr_b16 a[44:45], v57 offset:24576
    ds_read_b64_tr_b16 a[46:47], v57 offset:26624
    v_mfma_f32_16x16x32_bf16 v[236:239], a[0:3], a[204:207], v[236:239]
    ds_read_b64_tr_b16 a[48:49], v54 offset:28672
    s_waitcnt lgkmcnt(9)
    v_mfma_f32_16x16x32_bf16 v[220:223], a[16:19], a[208:211], v[220:223]
    buffer_load_dwordx4 a[184:187], v7, s[20:23], s52 offen offset:2048 sc1
    ds_read_b64_tr_b16 a[50:51], v54 offset:30720
    v_mfma_f32_16x16x32_bf16 v[224:227], a[20:23], a[208:211], v[224:227]
    ds_read_b64_tr_b16 a[52:53], v55 offset:28672
    ds_read_b64_tr_b16 a[54:55], v55 offset:30720
    v_mfma_f32_16x16x32_bf16 v[228:231], a[24:27], a[208:211], v[228:231]
    ds_read_b64_tr_b16 a[56:57], v56 offset:28672
    v_mfma_f32_16x16x32_bf16 v[232:235], a[28:31], a[208:211], v[232:235]
    buffer_load_dwordx4 a[188:191], v7, s[20:23], s53 offen offset:2048 sc1
    ds_read_b64_tr_b16 a[58:59], v56 offset:30720
    v_mfma_f32_16x16x32_bf16 v[248:251], a[28:31], a[212:215], v[248:251]
    ds_read_b64_tr_b16 a[60:61], v57 offset:28672
    v_mfma_f32_16x16x32_bf16 v[244:247], a[24:27], a[212:215], v[244:247]
    ds_read_b64_tr_b16 a[62:63], v57 offset:30720
    v_mfma_f32_16x16x32_bf16 v[240:243], a[20:23], a[212:215], v[240:243]
    buffer_load_dwordx4 a[192:195], v7, s[20:23], s53 offen offset:3072 sc1
    v_mfma_f32_16x16x32_bf16 v[236:239], a[16:19], a[212:215], v[236:239]
    s_waitcnt lgkmcnt(8)
    v_mfma_f32_16x16x32_bf16 v[220:223], a[32:35], a[216:219], v[220:223]
    s_waitcnt vmcnt(24)
    s_barrier
    v_mfma_f32_16x16x32_bf16 v[224:227], a[36:39], a[216:219], v[224:227]
    s_lshr_b32 s45, 0x2050101, s36
    s_and_b32 s45, s45, 0xff
    ds_read_b64_tr_b16 a[0:1], v38 offset:0
    v_mfma_f32_16x16x32_bf16 v[228:231], a[40:43], a[216:219], v[228:231]
    s_cmp_ge_u32 s45, s39
    s_addc_u32 s45, s45, 0
    ds_read_b64_tr_b16 a[2:3], v38 offset:2048
    v_mfma_f32_16x16x32_bf16 v[232:235], a[44:47], a[216:219], v[232:235]
    s_mul_i32 s28, s45, 229376
    s_mul_i32 s45, s45, 7168
    ds_read_b64_tr_b16 a[4:5], v39 offset:0
    v_mfma_f32_16x16x32_bf16 v[248:251], a[44:47], a[220:223], v[248:251]
    s_add_u32 s52, s55, s45
    s_add_u32 s53, s52, 3072
    ds_read_b64_tr_b16 a[6:7], v39 offset:2048
    v_mfma_f32_16x16x32_bf16 v[244:247], a[40:43], a[220:223], v[244:247]
    s_add_u32 m0, s56, 0xfffe4000
    s_nop 0
    buffer_load_dwordx4 v34, s[16:19], s28 offen lds
    ds_read_b64_tr_b16 a[8:9], v40 offset:0
    v_mfma_f32_16x16x32_bf16 v[240:243], a[36:39], a[220:223], v[240:243]
    buffer_load_dwordx4 v35, s[16:19], s28 offen offset:1024 lds
    s_add_u32 s28, s28, 131072
    ds_read_b64_tr_b16 a[10:11], v40 offset:2048
    v_mfma_f32_16x16x32_bf16 v[236:239], a[32:35], a[220:223], v[236:239]
    buffer_load_dwordx4 a[200:203], v7, s[20:23], s52 offen offset:0 sc1
    ds_read_b64_tr_b16 a[12:13], v41 offset:0
    ds_read_b64_tr_b16 a[14:15], v41 offset:2048
    s_waitcnt lgkmcnt(8)
    v_mfma_f32_16x16x32_bf16 v[220:223], a[48:51], a[224:227], v[220:223]
    ds_read_b64_tr_b16 a[16:17], v38 offset:4096
    ds_read_b64_tr_b16 a[18:19], v38 offset:6144
    v_mfma_f32_16x16x32_bf16 v[224:227], a[52:55], a[224:227], v[224:227]
    buffer_load_dwordx4 a[204:207], v7, s[20:23], s53 offen offset:0 sc1
    ds_read_b64_tr_b16 a[20:21], v39 offset:4096
    ds_read_b64_tr_b16 a[22:23], v39 offset:6144
    v_mfma_f32_16x16x32_bf16 v[228:231], a[56:59], a[224:227], v[228:231]
    ds_read_b64_tr_b16 a[24:25], v40 offset:4096
    v_mfma_f32_16x16x32_bf16 v[232:235], a[60:63], a[224:227], v[232:235]
    ds_read_b64_tr_b16 a[26:27], v40 offset:6144
    v_mfma_f32_16x16x32_bf16 v[248:251], a[60:63], a[228:231], v[248:251]
    buffer_load_dwordx4 a[208:211], v7, s[20:23], s52 offen offset:1024 sc1
    ds_read_b64_tr_b16 a[28:29], v41 offset:4096
    v_mfma_f32_16x16x32_bf16 v[244:247], a[56:59], a[228:231], v[244:247]
    ds_read_b64_tr_b16 a[30:31], v41 offset:6144
    v_mfma_f32_16x16x32_bf16 v[240:243], a[52:55], a[228:231], v[240:243]
    buffer_load_dwordx4 a[212:215], v7, s[20:23], s53 offen offset:1024 sc1
    v_mfma_f32_16x16x32_bf16 v[236:239], a[48:51], a[228:231], v[236:239]
    s_waitcnt lgkmcnt(8)
    v_mfma_f32_16x16x32_bf16 v[128:131], a[0:3], v[192:195], 0
    s_waitcnt vmcnt(28)
    s_barrier
    v_mfma_f32_16x16x32_bf16 v[132:135], a[4:7], v[192:195], 0
    s_add_u32 m0, s57, 0xfffe6000
    ds_read_b64_tr_b16 a[32:33], v38 offset:8192
    v_mfma_f32_16x16x32_bf16 v[136:139], a[8:11], v[192:195], 0
    buffer_load_dwordx4 v36, s[16:19], s28 offen lds
    ds_read_b64_tr_b16 a[34:35], v38 offset:10240
    v_mfma_f32_16x16x32_bf16 v[140:143], a[12:15], v[192:195], 0
    ds_read_b64_tr_b16 a[36:37], v39 offset:8192
    v_mfma_f32_16x16x32_bf16 v[156:159], a[12:15], v[204:207], 0
    s_add_u32 m0, s58, 0xfffe6000
    ds_read_b64_tr_b16 a[38:39], v39 offset:10240
    v_mfma_f32_16x16x32_bf16 v[152:155], a[8:11], v[204:207], 0
    s_mov_b64 exec, s[32:33]
    buffer_load_dwordx4 v37, s[16:19], s28 offen lds
    s_mov_b64 exec, -1
    v_mfma_f32_16x16x32_bf16 v[148:151], a[4:7], v[204:207], 0
    ds_read_b64_tr_b16 a[40:41], v40 offset:8192
    ds_read_b64_tr_b16 a[42:43], v40 offset:10240
    v_mfma_f32_16x16x32_bf16 v[144:147], a[0:3], v[204:207], 0
    ds_read_b64_tr_b16 a[44:45], v41 offset:8192
    s_waitcnt lgkmcnt(7)
    v_mfma_f32_16x16x32_bf16 v[128:131], a[16:19], v[196:199], v[128:131]
    buffer_load_dwordx4 a[216:219], v7, s[20:23], s52 offen offset:2048 sc1
    ds_read_b64_tr_b16 a[46:47], v41 offset:10240
    v_mfma_f32_16x16x32_bf16 v[132:135], a[20:23], v[196:199], v[132:135]
    ds_read_b64_tr_b16 a[48:49], v38 offset:12288
    v_mfma_f32_16x16x32_bf16 v[136:139], a[24:27], v[196:199], v[136:139]
    ds_read_b64_tr_b16 a[52:53], v39 offset:12288
    v_mfma_f32_16x16x32_bf16 v[140:143], a[28:31], v[196:199], v[140:143]
    buffer_load_dwordx4 a[220:223], v7, s[20:23], s53 offen offset:2048 sc1
    ds_read_b64_tr_b16 a[56:57], v40 offset:12288
    v_mfma_f32_16x16x32_bf16 v[156:159], a[28:31], v[208:211], v[156:159]
    ds_read_b64_tr_b16 a[60:61], v41 offset:12288
    v_mfma_f32_16x16x32_bf16 v[152:155], a[24:27], v[208:211], v[152:155]
    v_mfma_f32_16x16x32_bf16 v[148:151], a[20:23], v[208:211], v[148:151]
    buffer_load_dwordx4 a[224:227], v7, s[20:23], s53 offen offset:3072 sc1
    v_mfma_f32_16x16x32_bf16 v[144:147], a[16:19], v[208:211], v[144:147]
    s_waitcnt lgkmcnt(4)
    v_mfma_f32_16x16x32_bf16 v[128:131], a[32:35], v[200:203], v[128:131]
    s_waitcnt vmcnt(27)
    s_barrier
    v_mfma_f32_16x16x32_bf16 v[132:135], a[36:39], v[200:203], v[132:135]
    s_lshr_b32 s45, 0x6020202, s36
    s_and_b32 s45, s45, 0xff
    ds_read_b64_tr_b16 a[0:1], v38 offset:16384
    v_mfma_f32_16x16x32_bf16 v[136:139], a[40:43], v[200:203], v[136:139]
    s_cmp_ge_u32 s45, s39
    s_addc_u32 s45, s45, 0
    ds_read_b64_tr_b16 a[2:3], v38 offset:18432
    v_mfma_f32_16x16x32_bf16 v[140:143], a[44:47], v[200:203], v[140:143]
    s_mul_i32 s28, s45, 229376
    s_mul_i32 s45, s45, 7168
    ds_read_b64_tr_b16 a[4:5], v39 offset:16384
    v_mfma_f32_16x16x32_bf16 v[156:159], a[44:47], v[212:215], v[156:159]
    s_add_u32 s52, s55, s45
    s_add_u32 s53, s52, 3072
    ds_read_b64_tr_b16 a[6:7], v39 offset:18432
    v_mfma_f32_16x16x32_bf16 v[152:155], a[40:43], v[212:215], v[152:155]
    s_add_u32 m0, s56, 0x0
    s_nop 0
    buffer_load_dwordx4 v34, s[16:19], s28 offen lds
    ds_read_b64_tr_b16 a[8:9], v40 offset:16384
    v_mfma_f32_16x16x32_bf16 v[148:151], a[36:39], v[212:215], v[148:151]
    buffer_load_dwordx4 v35, s[16:19], s28 offen offset:1024 lds
    s_add_u32 s28, s28, 131072
    ds_read_b64_tr_b16 a[10:11], v40 offset:18432
    v_mfma_f32_16x16x32_bf16 v[144:147], a[32:35], v[212:215], v[144:147]
    buffer_load_dwordx4 a[104:107], v7, s[20:23], s52 offen offset:0 sc1
    ds_read_b64_tr_b16 a[12:13], v41 offset:16384
    ds_read_b64_tr_b16 a[14:15], v41 offset:18432
    s_waitcnt lgkmcnt(8)
    v_mfma_f32_16x16x16_bf16 v[128:131], a[48:49], v[216:217], v[128:131]
    ds_read_b64_tr_b16 a[16:17], v38 offset:20480
    ds_read_b64_tr_b16 a[18:19], v38 offset:22528
    v_mfma_f32_16x16x16_bf16 v[132:135], a[52:53], v[216:217], v[132:135]
    buffer_load_dwordx4 a[108:111], v7, s[20:23], s53 offen offset:0 sc1
    ds_read_b64_tr_b16 a[20:21], v39 offset:20480
    ds_read_b64_tr_b16 a[22:23], v39 offset:22528
    v_mfma_f32_16x16x16_bf16 v[136:139], a[56:57], v[216:217], v[136:139]
    ds_read_b64_tr_b16 a[24:25], v40 offset:20480
    v_mfma_f32_16x16x16_bf16 v[140:143], a[60:61], v[216:217], v[140:143]
    ds_read_b64_tr_b16 a[26:27], v40 offset:22528
    v_mfma_f32_16x16x16_bf16 v[156:159], a[60:61], v[218:219], v[156:159]
    buffer_load_dwordx4 a[112:115], v7, s[20:23], s52 offen offset:1024 sc1
    ds_read_b64_tr_b16 a[28:29], v41 offset:20480
    v_mfma_f32_16x16x16_bf16 v[152:155], a[56:57], v[218:219], v[152:155]
    ds_read_b64_tr_b16 a[30:31], v41 offset:22528
    v_mfma_f32_16x16x16_bf16 v[148:151], a[52:53], v[218:219], v[148:151]
    buffer_load_dwordx4 a[116:119], v7, s[20:23], s53 offen offset:1024 sc1
    v_mfma_f32_16x16x16_bf16 v[144:147], a[48:49], v[218:219], v[144:147]
    s_waitcnt lgkmcnt(8)
    v_mfma_f32_16x16x32_bf16 v[128:131], a[0:3], a[136:139], v[128:131]
    s_waitcnt vmcnt(28)
    s_barrier
    v_mfma_f32_16x16x32_bf16 v[132:135], a[4:7], a[136:139], v[132:135]
    s_add_u32 m0, s57, 0x2000
    ds_read_b64_tr_b16 a[32:33], v38 offset:24576
    v_mfma_f32_16x16x32_bf16 v[136:139], a[8:11], a[136:139], v[136:139]
    buffer_load_dwordx4 v36, s[16:19], s28 offen lds
    ds_read_b64_tr_b16 a[34:35], v38 offset:26624
    v_mfma_f32_16x16x32_bf16 v[140:143], a[12:15], a[136:139], v[140:143]
    ds_read_b64_tr_b16 a[36:37], v39 offset:24576
    v_mfma_f32_16x16x32_bf16 v[156:159], a[12:15], a[140:143], v[156:159]
    s_add_u32 m0, s58, 0x2000
    ds_read_b64_tr_b16 a[38:39], v39 offset:26624
    v_mfma_f32_16x16x32_bf16 v[152:155], a[8:11], a[140:143], v[152:155]
    s_mov_b64 exec, s[32:33]
    buffer_load_dwordx4 v37, s[16:19], s28 offen lds
    s_mov_b64 exec, -1
    v_mfma_f32_16x16x32_bf16 v[148:151], a[4:7], a[140:143], v[148:151]
    ds_read_b64_tr_b16 a[40:41], v40 offset:24576
    ds_read_b64_tr_b16 a[42:43], v40 offset:26624
    v_mfma_f32_16x16x32_bf16 v[144:147], a[0:3], a[140:143], v[144:147]
    ds_read_b64_tr_b16 a[44:45], v41 offset:24576
    s_waitcnt lgkmcnt(7)
    v_mfma_f32_16x16x32_bf16 v[128:131], a[16:19], a[144:147], v[128:131]
    buffer_load_dwordx4 a[120:123], v7, s[20:23], s52 offen offset:2048 sc1
    ds_read_b64_tr_b16 a[46:47], v41 offset:26624
    v_mfma_f32_16x16x32_bf16 v[132:135], a[20:23], a[144:147], v[132:135]
    ds_read_b64_tr_b16 a[48:49], v38 offset:28672
    v_mfma_f32_16x16x32_bf16 v[136:139], a[24:27], a[144:147], v[136:139]
    ds_read_b64_tr_b16 a[52:53], v39 offset:28672
    v_mfma_f32_16x16x32_bf16 v[140:143], a[28:31], a[144:147], v[140:143]
    buffer_load_dwordx4 a[124:127], v7, s[20:23], s53 offen offset:2048 sc1
    ds_read_b64_tr_b16 a[56:57], v40 offset:28672
    v_mfma_f32_16x16x32_bf16 v[156:159], a[28:31], a[148:151], v[156:159]
    ds_read_b64_tr_b16 a[60:61], v41 offset:28672
    v_mfma_f32_16x16x32_bf16 v[152:155], a[24:27], a[148:151], v[152:155]
    v_mfma_f32_16x16x32_bf16 v[148:151], a[20:23], a[148:151], v[148:151]
    buffer_load_dwordx4 a[128:131], v7, s[20:23], s53 offen offset:3072 sc1
    v_mfma_f32_16x16x32_bf16 v[144:147], a[16:19], a[148:151], v[144:147]
    s_waitcnt lgkmcnt(4)
    v_mfma_f32_16x16x32_bf16 v[128:131], a[32:35], a[152:155], v[128:131]
    s_waitcnt vmcnt(27)
    s_barrier
    v_mfma_f32_16x16x32_bf16 v[132:135], a[36:39], a[152:155], v[132:135]
    s_lshr_b32 s45, 0x3030307, s36
    s_and_b32 s45, s45, 0xff
    ds_read_b64_tr_b16 a[0:1], v54 offset:0
    v_mfma_f32_16x16x32_bf16 v[136:139], a[40:43], a[152:155], v[136:139]
    s_cmp_ge_u32 s45, s39
    s_addc_u32 s45, s45, 0
    ds_read_b64_tr_b16 a[2:3], v54 offset:2048
    v_mfma_f32_16x16x32_bf16 v[140:143], a[44:47], a[152:155], v[140:143]
    s_mul_i32 s28, s45, 229376
    s_mul_i32 s45, s45, 7168
    ds_read_b64_tr_b16 a[4:5], v55 offset:0
    v_mfma_f32_16x16x32_bf16 v[156:159], a[44:47], a[156:159], v[156:159]
    s_add_u32 s52, s55, s45
    s_add_u32 s53, s52, 3072
    ds_read_b64_tr_b16 a[6:7], v55 offset:2048
    v_mfma_f32_16x16x32_bf16 v[152:155], a[40:43], a[156:159], v[152:155]
    s_add_u32 m0, s56, 0x4000
    s_nop 0
    buffer_load_dwordx4 v34, s[16:19], s28 offen lds
    ds_read_b64_tr_b16 a[8:9], v56 offset:0
    v_mfma_f32_16x16x32_bf16 v[148:151], a[36:39], a[156:159], v[148:151]
    buffer_load_dwordx4 v35, s[16:19], s28 offen offset:1024 lds
    s_add_u32 s28, s28, 131072
    ds_read_b64_tr_b16 a[10:11], v56 offset:2048
    v_mfma_f32_16x16x32_bf16 v[144:147], a[32:35], a[156:159], v[144:147]
    buffer_load_dwordx4 a[136:139], v7, s[20:23], s52 offen offset:0 sc1
    ds_read_b64_tr_b16 a[12:13], v57 offset:0
    ds_read_b64_tr_b16 a[14:15], v57 offset:2048
    s_waitcnt lgkmcnt(8)
    v_mfma_f32_16x16x16_bf16 v[128:131], a[48:49], a[160:161], v[128:131]
    ds_read_b64_tr_b16 a[16:17], v54 offset:4096
    ds_read_b64_tr_b16 a[18:19], v54 offset:6144
    v_mfma_f32_16x16x16_bf16 v[132:135], a[52:53], a[160:161], v[132:135]
    buffer_load_dwordx4 a[140:143], v7, s[20:23], s53 offen offset:0 sc1
    ds_read_b64_tr_b16 a[20:21], v55 offset:4096
    ds_read_b64_tr_b16 a[22:23], v55 offset:6144
    v_mfma_f32_16x16x16_bf16 v[136:139], a[56:57], a[160:161], v[136:139]
    ds_read_b64_tr_b16 a[24:25], v56 offset:4096
    v_mfma_f32_16x16x16_bf16 v[140:143], a[60:61], a[160:161], v[140:143]
    ds_read_b64_tr_b16 a[26:27], v56 offset:6144
    v_mfma_f32_16x16x16_bf16 v[156:159], a[60:61], a[162:163], v[156:159]
    buffer_load_dwordx4 a[144:147], v7, s[20:23], s52 offen offset:1024 sc1
    ds_read_b64_tr_b16 a[28:29], v57 offset:4096
    v_mfma_f32_16x16x16_bf16 v[152:155], a[56:57], a[162:163], v[152:155]
    ds_read_b64_tr_b16 a[30:31], v57 offset:6144
    v_mfma_f32_16x16x16_bf16 v[148:151], a[52:53], a[162:163], v[148:151]
    buffer_load_dwordx4 a[148:151], v7, s[20:23], s53 offen offset:1024 sc1
    v_mfma_f32_16x16x16_bf16 v[144:147], a[48:49], a[162:163], v[144:147]
    s_waitcnt lgkmcnt(8)
    v_mfma_f32_16x16x32_bf16 v[128:131], a[0:3], a[168:171], v[128:131]
    s_waitcnt vmcnt(28)
    s_barrier
    v_mfma_f32_16x16x32_bf16 v[132:135], a[4:7], a[168:171], v[132:135]
    s_add_u32 m0, s57, 0x6000
    ds_read_b64_tr_b16 a[32:33], v54 offset:8192
    v_mfma_f32_16x16x32_bf16 v[136:139], a[8:11], a[168:171], v[136:139]
    buffer_load_dwordx4 v36, s[16:19], s28 offen lds
    ds_read_b64_tr_b16 a[34:35], v54 offset:10240
    v_mfma_f32_16x16x32_bf16 v[140:143], a[12:15], a[168:171], v[140:143]
    ds_read_b64_tr_b16 a[36:37], v55 offset:8192
    v_mfma_f32_16x16x32_bf16 v[156:159], a[12:15], a[172:175], v[156:159]
    s_add_u32 m0, s58, 0x6000
    ds_read_b64_tr_b16 a[38:39], v55 offset:10240
    v_mfma_f32_16x16x32_bf16 v[152:155], a[8:11], a[172:175], v[152:155]
    s_mov_b64 exec, s[32:33]
    buffer_load_dwordx4 v37, s[16:19], s28 offen lds
    s_mov_b64 exec, -1
    v_mfma_f32_16x16x32_bf16 v[148:151], a[4:7], a[172:175], v[148:151]
    ds_read_b64_tr_b16 a[40:41], v56 offset:8192
    ds_read_b64_tr_b16 a[42:43], v56 offset:10240
    v_mfma_f32_16x16x32_bf16 v[144:147], a[0:3], a[172:175], v[144:147]
    ds_read_b64_tr_b16 a[44:45], v57 offset:8192
    s_waitcnt lgkmcnt(7)
    v_mfma_f32_16x16x32_bf16 v[128:131], a[16:19], a[176:179], v[128:131]
    buffer_load_dwordx4 a[152:155], v7, s[20:23], s52 offen offset:2048 sc1
    ds_read_b64_tr_b16 a[46:47], v57 offset:10240
    v_mfma_f32_16x16x32_bf16 v[132:135], a[20:23], a[176:179], v[132:135]
    ds_read_b64_tr_b16 a[48:49], v54 offset:12288
    v_mfma_f32_16x16x32_bf16 v[136:139], a[24:27], a[176:179], v[136:139]
    ds_read_b64_tr_b16 a[52:53], v55 offset:12288
    v_mfma_f32_16x16x32_bf16 v[140:143], a[28:31], a[176:179], v[140:143]
    buffer_load_dwordx4 a[156:159], v7, s[20:23], s53 offen offset:2048 sc1
    ds_read_b64_tr_b16 a[56:57], v56 offset:12288
    v_mfma_f32_16x16x32_bf16 v[156:159], a[28:31], a[180:183], v[156:159]
    ds_read_b64_tr_b16 a[60:61], v57 offset:12288
    v_mfma_f32_16x16x32_bf16 v[152:155], a[24:27], a[180:183], v[152:155]
    v_mfma_f32_16x16x32_bf16 v[148:151], a[20:23], a[180:183], v[148:151]
    buffer_load_dwordx4 a[160:163], v7, s[20:23], s53 offen offset:3072 sc1
    v_mfma_f32_16x16x32_bf16 v[144:147], a[16:19], a[180:183], v[144:147]
    s_waitcnt lgkmcnt(4)
    v_mfma_f32_16x16x32_bf16 v[128:131], a[32:35], a[184:187], v[128:131]
    s_waitcnt vmcnt(27)
    s_barrier
    v_mfma_f32_16x16x32_bf16 v[132:135], a[36:39], a[184:187], v[132:135]
    s_lshr_b32 s45, 0x4040804, s36
    s_and_b32 s45, s45, 0xff
    ds_read_b64_tr_b16 a[0:1], v54 offset:16384
    v_mfma_f32_16x16x32_bf16 v[136:139], a[40:43], a[184:187], v[136:139]
    s_cmp_ge_u32 s45, s39
    s_addc_u32 s45, s45, 0
    ds_read_b64_tr_b16 a[2:3], v54 offset:18432
    v_mfma_f32_16x16x32_bf16 v[140:143], a[44:47], a[184:187], v[140:143]
    s_mul_i32 s28, s45, 229376
    s_mul_i32 s45, s45, 7168
    ds_read_b64_tr_b16 a[4:5], v55 offset:16384
    v_mfma_f32_16x16x32_bf16 v[156:159], a[44:47], a[188:191], v[156:159]
    s_add_u32 s52, s55, s45
    s_add_u32 s53, s52, 3072
    ds_read_b64_tr_b16 a[6:7], v55 offset:18432
    v_mfma_f32_16x16x32_bf16 v[152:155], a[40:43], a[188:191], v[152:155]
    s_add_u32 m0, s56, 0xfffe0000
    s_nop 0
    buffer_load_dwordx4 v34, s[16:19], s28 offen lds
    ds_read_b64_tr_b16 a[8:9], v56 offset:16384
    v_mfma_f32_16x16x32_bf16 v[148:151], a[36:39], a[188:191], v[148:151]
    buffer_load_dwordx4 v35, s[16:19], s28 offen offset:1024 lds
    s_add_u32 s28, s28, 131072
    ds_read_b64_tr_b16 a[10:11], v56 offset:18432
    v_mfma_f32_16x16x32_bf16 v[144:147], a[32:35], a[188:191], v[144:147]
    buffer_load_dwordx4 a[168:171], v7, s[20:23], s52 offen offset:0 sc1
    ds_read_b64_tr_b16 a[12:13], v57 offset:16384
    ds_read_b64_tr_b16 a[14:15], v57 offset:18432
    s_waitcnt lgkmcnt(8)
    v_mfma_f32_16x16x16_bf16 v[128:131], a[48:49], a[192:193], v[128:131]
    ds_read_b64_tr_b16 a[16:17], v54 offset:20480
    ds_read_b64_tr_b16 a[18:19], v54 offset:22528
    v_mfma_f32_16x16x16_bf16 v[132:135], a[52:53], a[192:193], v[132:135]
    buffer_load_dwordx4 a[172:175], v7, s[20:23], s53 offen offset:0 sc1
    ds_read_b64_tr_b16 a[20:21], v55 offset:20480
    ds_read_b64_tr_b16 a[22:23], v55 offset:22528
    v_mfma_f32_16x16x16_bf16 v[136:139], a[56:57], a[192:193], v[136:139]
    ds_read_b64_tr_b16 a[24:25], v56 offset:20480
    v_mfma_f32_16x16x16_bf16 v[140:143], a[60:61], a[192:193], v[140:143]
    ds_read_b64_tr_b16 a[26:27], v56 offset:22528
    v_mfma_f32_16x16x16_bf16 v[156:159], a[60:61], a[194:195], v[156:159]
    buffer_load_dwordx4 a[176:179], v7, s[20:23], s52 offen offset:1024 sc1
    ds_read_b64_tr_b16 a[28:29], v57 offset:20480
    v_mfma_f32_16x16x16_bf16 v[152:155], a[56:57], a[194:195], v[152:155]
    ds_read_b64_tr_b16 a[30:31], v57 offset:22528
    v_mfma_f32_16x16x16_bf16 v[148:151], a[52:53], a[194:195], v[148:151]
    buffer_load_dwordx4 a[180:183], v7, s[20:23], s53 offen offset:1024 sc1
    v_mfma_f32_16x16x16_bf16 v[144:147], a[48:49], a[194:195], v[144:147]
    s_waitcnt lgkmcnt(8)
    v_mfma_f32_16x16x32_bf16 v[128:131], a[0:3], a[200:203], v[128:131]
    s_waitcnt vmcnt(28)
    s_barrier
    v_mfma_f32_16x16x32_bf16 v[132:135], a[4:7], a[200:203], v[132:135]
    s_add_u32 m0, s57, 0xfffe2000
    ds_read_b64_tr_b16 a[32:33], v54 offset:24576
    v_mfma_f32_16x16x32_bf16 v[136:139], a[8:11], a[200:203], v[136:139]
    buffer_load_dwordx4 v36, s[16:19], s28 offen lds
    ds_read_b64_tr_b16 a[34:35], v54 offset:26624
    v_mfma_f32_16x16x32_bf16 v[140:143], a[12:15], a[200:203], v[140:143]
    ds_read_b64_tr_b16 a[36:37], v55 offset:24576
    v_mfma_f32_16x16x32_bf16 v[156:159], a[12:15], a[204:207], v[156:159]
    s_add_u32 m0, s58, 0xfffe2000
    ds_read_b64_tr_b16 a[38:39], v55 offset:26624
    v_mfma_f32_16x16x32_bf16 v[152:155], a[8:11], a[204:207], v[152:155]
    s_mov_b64 exec, s[32:33]
    buffer_load_dwordx4 v37, s[16:19], s28 offen lds
    s_mov_b64 exec, -1
    v_mfma_f32_16x16x32_bf16 v[148:151], a[4:7], a[204:207], v[148:151]
    ds_read_b64_tr_b16 a[40:41], v56 offset:24576
    ds_read_b64_tr_b16 a[42:43], v56 offset:26624
    v_mfma_f32_16x16x32_bf16 v[144:147], a[0:3], a[204:207], v[144:147]
    ds_read_b64_tr_b16 a[44:45], v57 offset:24576
    s_waitcnt lgkmcnt(7)
    v_mfma_f32_16x16x32_bf16 v[128:131], a[16:19], a[208:211], v[128:131]
    buffer_load_dwordx4 a[184:187], v7, s[20:23], s52 offen offset:2048 sc1
    ds_read_b64_tr_b16 a[46:47], v57 offset:26624
    v_mfma_f32_16x16x32_bf16 v[132:135], a[20:23], a[208:211], v[132:135]
    ds_read_b64_tr_b16 a[48:49], v54 offset:28672
    v_mfma_f32_16x16x32_bf16 v[136:139], a[24:27], a[208:211], v[136:139]
    ds_read_b64_tr_b16 a[52:53], v55 offset:28672
    v_mfma_f32_16x16x32_bf16 v[140:143], a[28:31], a[208:211], v[140:143]
    buffer_load_dwordx4 a[188:191], v7, s[20:23], s53 offen offset:2048 sc1
    ds_read_b64_tr_b16 a[56:57], v56 offset:28672
    v_mfma_f32_16x16x32_bf16 v[156:159], a[28:31], a[212:215], v[156:159]
    ds_read_b64_tr_b16 a[60:61], v57 offset:28672
    v_mfma_f32_16x16x32_bf16 v[152:155], a[24:27], a[212:215], v[152:155]
    v_mfma_f32_16x16x32_bf16 v[148:151], a[20:23], a[212:215], v[148:151]
    buffer_load_dwordx4 a[192:195], v7, s[20:23], s53 offen offset:3072 sc1
    v_mfma_f32_16x16x32_bf16 v[144:147], a[16:19], a[212:215], v[144:147]
    s_waitcnt lgkmcnt(4)
    v_mfma_f32_16x16x32_bf16 v[128:131], a[32:35], a[216:219], v[128:131]
    s_waitcnt vmcnt(27)
    s_barrier
    v_mfma_f32_16x16x32_bf16 v[132:135], a[36:39], a[216:219], v[132:135]
    s_lshr_b32 s45, 0x5090505, s36
    s_and_b32 s45, s45, 0xff
    ds_read_b64_tr_b16 a[0:1], v38 offset:0
    v_mfma_f32_16x16x32_bf16 v[136:139], a[40:43], a[216:219], v[136:139]
    s_cmp_ge_u32 s45, s39
    s_addc_u32 s45, s45, 0
    ds_read_b64_tr_b16 a[2:3], v38 offset:2048
    v_mfma_f32_16x16x32_bf16 v[140:143], a[44:47], a[216:219], v[140:143]
    s_mul_i32 s28, s45, 229376
    s_mul_i32 s45, s45, 7168
    ds_read_b64_tr_b16 a[4:5], v39 offset:0
    v_mfma_f32_16x16x32_bf16 v[156:159], a[44:47], a[220:223], v[156:159]
    s_add_u32 s52, s55, s45
    s_add_u32 s53, s52, 3072
    ds_read_b64_tr_b16 a[6:7], v39 offset:2048
    v_mfma_f32_16x16x32_bf16 v[152:155], a[40:43], a[220:223], v[152:155]
    s_add_u32 m0, s56, 0xfffe4000
    s_nop 0
    buffer_load_dwordx4 v34, s[16:19], s28 offen lds
    ds_read_b64_tr_b16 a[8:9], v40 offset:0
    v_mfma_f32_16x16x32_bf16 v[148:151], a[36:39], a[220:223], v[148:151]
    buffer_load_dwordx4 v35, s[16:19], s28 offen offset:1024 lds
    s_add_u32 s28, s28, 131072
    ds_read_b64_tr_b16 a[10:11], v40 offset:2048
    v_mfma_f32_16x16x32_bf16 v[144:147], a[32:35], a[220:223], v[144:147]
    buffer_load_dwordx4 a[200:203], v7, s[20:23], s52 offen offset:0 sc1
    ds_read_b64_tr_b16 a[12:13], v41 offset:0
    ds_read_b64_tr_b16 a[14:15], v41 offset:2048
    s_waitcnt lgkmcnt(8)
    v_mfma_f32_16x16x16_bf16 v[128:131], a[48:49], a[224:225], v[128:131]
    ds_read_b64_tr_b16 a[16:17], v38 offset:4096
    ds_read_b64_tr_b16 a[18:19], v38 offset:6144
    v_mfma_f32_16x16x16_bf16 v[132:135], a[52:53], a[224:225], v[132:135]
    buffer_load_dwordx4 a[204:207], v7, s[20:23], s53 offen offset:0 sc1
    ds_read_b64_tr_b16 a[20:21], v39 offset:4096
    ds_read_b64_tr_b16 a[22:23], v39 offset:6144
    v_mfma_f32_16x16x16_bf16 v[136:139], a[56:57], a[224:225], v[136:139]
    ds_read_b64_tr_b16 a[24:25], v40 offset:4096
    v_mfma_f32_16x16x16_bf16 v[140:143], a[60:61], a[224:225], v[140:143]
    ds_read_b64_tr_b16 a[26:27], v40 offset:6144
    v_mfma_f32_16x16x16_bf16 v[156:159], a[60:61], a[226:227], v[156:159]
    buffer_load_dwordx4 a[208:211], v7, s[20:23], s52 offen offset:1024 sc1
    ds_read_b64_tr_b16 a[28:29], v41 offset:4096
    v_mfma_f32_16x16x16_bf16 v[152:155], a[56:57], a[226:227], v[152:155]
    ds_read_b64_tr_b16 a[30:31], v41 offset:6144
    v_mfma_f32_16x16x16_bf16 v[148:151], a[52:53], a[226:227], v[148:151]
    buffer_load_dwordx4 a[212:215], v7, s[20:23], s53 offen offset:1024 sc1
    v_mfma_f32_16x16x16_bf16 v[144:147], a[48:49], a[226:227], v[144:147]
    s_waitcnt lgkmcnt(8)
    v_mfma_f32_16x16x32_bf16 v[128:131], a[0:3], a[104:107], v[128:131]
    s_waitcnt vmcnt(28)
    s_barrier
    v_mfma_f32_16x16x32_bf16 v[132:135], a[4:7], a[104:107], v[132:135]
    s_add_u32 m0, s57, 0xfffe6000
    ds_read_b64_tr_b16 a[32:33], v38 offset:8192
    v_mfma_f32_16x16x32_bf16 v[136:139], a[8:11], a[104:107], v[136:139]
    buffer_load_dwordx4 v36, s[16:19], s28 offen lds
    ds_read_b64_tr_b16 a[34:35], v38 offset:10240
    v_mfma_f32_16x16x32_bf16 v[140:143], a[12:15], a[104:107], v[140:143]
    ds_read_b64_tr_b16 a[36:37], v39 offset:8192
    v_mfma_f32_16x16x32_bf16 v[156:159], a[12:15], a[108:111], v[156:159]
    s_add_u32 m0, s58, 0xfffe6000
    ds_read_b64_tr_b16 a[38:39], v39 offset:10240
    v_mfma_f32_16x16x32_bf16 v[152:155], a[8:11], a[108:111], v[152:155]
    s_mov_b64 exec, s[32:33]
    buffer_load_dwordx4 v37, s[16:19], s28 offen lds
    s_mov_b64 exec, -1
    v_mfma_f32_16x16x32_bf16 v[148:151], a[4:7], a[108:111], v[148:151]
    ds_read_b64_tr_b16 a[40:41], v40 offset:8192
    ds_read_b64_tr_b16 a[42:43], v40 offset:10240
    v_mfma_f32_16x16x32_bf16 v[144:147], a[0:3], a[108:111], v[144:147]
    ds_read_b64_tr_b16 a[44:45], v41 offset:8192
    s_waitcnt lgkmcnt(7)
    v_mfma_f32_16x16x32_bf16 v[128:131], a[16:19], a[112:115], v[128:131]
    buffer_load_dwordx4 a[216:219], v7, s[20:23], s52 offen offset:2048 sc1
    ds_read_b64_tr_b16 a[46:47], v41 offset:10240
    v_mfma_f32_16x16x32_bf16 v[132:135], a[20:23], a[112:115], v[132:135]
    ds_read_b64_tr_b16 a[48:49], v38 offset:12288
    v_mfma_f32_16x16x32_bf16 v[136:139], a[24:27], a[112:115], v[136:139]
    ds_read_b64_tr_b16 a[52:53], v39 offset:12288
    v_mfma_f32_16x16x32_bf16 v[140:143], a[28:31], a[112:115], v[140:143]
    buffer_load_dwordx4 a[220:223], v7, s[20:23], s53 offen offset:2048 sc1
    ds_read_b64_tr_b16 a[56:57], v40 offset:12288
    v_mfma_f32_16x16x32_bf16 v[156:159], a[28:31], a[116:119], v[156:159]
    ds_read_b64_tr_b16 a[60:61], v41 offset:12288
    v_mfma_f32_16x16x32_bf16 v[152:155], a[24:27], a[116:119], v[152:155]
    v_mfma_f32_16x16x32_bf16 v[148:151], a[20:23], a[116:119], v[148:151]
    buffer_load_dwordx4 a[224:227], v7, s[20:23], s53 offen offset:3072 sc1
    v_mfma_f32_16x16x32_bf16 v[144:147], a[16:19], a[116:119], v[144:147]
    s_waitcnt lgkmcnt(4)
    v_mfma_f32_16x16x32_bf16 v[128:131], a[32:35], a[120:123], v[128:131]
    s_waitcnt vmcnt(27)
    s_barrier
    v_mfma_f32_16x16x32_bf16 v[132:135], a[36:39], a[120:123], v[132:135]
    s_lshr_b32 s45, 0xa060606, s36
    s_and_b32 s45, s45, 0xff
    ds_read_b64_tr_b16 a[0:1], v38 offset:16384
    v_mfma_f32_16x16x32_bf16 v[136:139], a[40:43], a[120:123], v[136:139]
    s_cmp_ge_u32 s45, s39
    s_addc_u32 s45, s45, 0
    ds_read_b64_tr_b16 a[2:3], v38 offset:18432
    v_mfma_f32_16x16x32_bf16 v[140:143], a[44:47], a[120:123], v[140:143]
    s_mul_i32 s28, s45, 229376
    s_mul_i32 s45, s45, 7168
    ds_read_b64_tr_b16 a[4:5], v39 offset:16384
    v_mfma_f32_16x16x32_bf16 v[156:159], a[44:47], a[124:127], v[156:159]
    s_add_u32 s52, s55, s45
    s_add_u32 s53, s52, 3072
    ds_read_b64_tr_b16 a[6:7], v39 offset:18432
    v_mfma_f32_16x16x32_bf16 v[152:155], a[40:43], a[124:127], v[152:155]
    s_add_u32 m0, s56, 0x0
    s_nop 0
    buffer_load_dwordx4 v34, s[16:19], s28 offen lds
    ds_read_b64_tr_b16 a[8:9], v40 offset:16384
    v_mfma_f32_16x16x32_bf16 v[148:151], a[36:39], a[124:127], v[148:151]
    buffer_load_dwordx4 v35, s[16:19], s28 offen offset:1024 lds
    s_add_u32 s28, s28, 131072
    ds_read_b64_tr_b16 a[10:11], v40 offset:18432
    v_mfma_f32_16x16x32_bf16 v[144:147], a[32:35], a[124:127], v[144:147]
    buffer_load_dwordx4 a[104:107], v7, s[20:23], s52 offen offset:0 sc1
    ds_read_b64_tr_b16 a[12:13], v41 offset:16384
    ds_read_b64_tr_b16 a[14:15], v41 offset:18432
    s_waitcnt lgkmcnt(8)
    v_mfma_f32_16x16x16_bf16 v[128:131], a[48:49], a[128:129], v[128:131]
    ds_read_b64_tr_b16 a[16:17], v38 offset:20480
    ds_read_b64_tr_b16 a[18:19], v38 offset:22528
    v_mfma_f32_16x16x16_bf16 v[132:135], a[52:53], a[128:129], v[132:135]
    buffer_load_dwordx4 a[108:111], v7, s[20:23], s53 offen offset:0 sc1
    ds_read_b64_tr_b16 a[20:21], v39 offset:20480
    ds_read_b64_tr_b16 a[22:23], v39 offset:22528
    v_mfma_f32_16x16x16_bf16 v[136:139], a[56:57], a[128:129], v[136:139]
    ds_read_b64_tr_b16 a[24:25], v40 offset:20480
    v_mfma_f32_16x16x16_bf16 v[140:143], a[60:61], a[128:129], v[140:143]
    ds_read_b64_tr_b16 a[26:27], v40 offset:22528
    v_mfma_f32_16x16x16_bf16 v[156:159], a[60:61], a[130:131], v[156:159]
    buffer_load_dwordx4 a[112:115], v7, s[20:23], s52 offen offset:1024 sc1
    ds_read_b64_tr_b16 a[28:29], v41 offset:20480
    v_mfma_f32_16x16x16_bf16 v[152:155], a[56:57], a[130:131], v[152:155]
    ds_read_b64_tr_b16 a[30:31], v41 offset:22528
    v_mfma_f32_16x16x16_bf16 v[148:151], a[52:53], a[130:131], v[148:151]
    buffer_load_dwordx4 a[116:119], v7, s[20:23], s53 offen offset:1024 sc1
    v_mfma_f32_16x16x16_bf16 v[144:147], a[48:49], a[130:131], v[144:147]
    s_waitcnt lgkmcnt(8)
    v_mfma_f32_16x16x32_bf16 v[128:131], a[0:3], a[136:139], v[128:131]
    s_waitcnt vmcnt(28)
    s_barrier
    v_mfma_f32_16x16x32_bf16 v[132:135], a[4:7], a[136:139], v[132:135]
    s_add_u32 m0, s57, 0x2000
    ds_read_b64_tr_b16 a[32:33], v38 offset:24576
    v_mfma_f32_16x16x32_bf16 v[136:139], a[8:11], a[136:139], v[136:139]
    buffer_load_dwordx4 v36, s[16:19], s28 offen lds
    ds_read_b64_tr_b16 a[34:35], v38 offset:26624
    v_mfma_f32_16x16x32_bf16 v[140:143], a[12:15], a[136:139], v[140:143]
    ds_read_b64_tr_b16 a[36:37], v39 offset:24576
    v_mfma_f32_16x16x32_bf16 v[156:159], a[12:15], a[140:143], v[156:159]
    s_add_u32 m0, s58, 0x2000
    ds_read_b64_tr_b16 a[38:39], v39 offset:26624
    v_mfma_f32_16x16x32_bf16 v[152:155], a[8:11], a[140:143], v[152:155]
    s_mov_b64 exec, s[32:33]
    buffer_load_dwordx4 v37, s[16:19], s28 offen lds
    s_mov_b64 exec, -1
    v_mfma_f32_16x16x32_bf16 v[148:151], a[4:7], a[140:143], v[148:151]
    ds_read_b64_tr_b16 a[40:41], v40 offset:24576
    ds_read_b64_tr_b16 a[42:43], v40 offset:26624
    v_mfma_f32_16x16x32_bf16 v[144:147], a[0:3], a[140:143], v[144:147]
    ds_read_b64_tr_b16 a[44:45], v41 offset:24576
    s_waitcnt lgkmcnt(7)
    v_mfma_f32_16x16x32_bf16 v[128:131], a[16:19], a[144:147], v[128:131]
    buffer_load_dwordx4 a[120:123], v7, s[20:23], s52 offen offset:2048 sc1
    ds_read_b64_tr_b16 a[46:47], v41 offset:26624
    v_mfma_f32_16x16x32_bf16 v[132:135], a[20:23], a[144:147], v[132:135]
    ds_read_b64_tr_b16 a[48:49], v38 offset:28672
    v_mfma_f32_16x16x32_bf16 v[136:139], a[24:27], a[144:147], v[136:139]
    ds_read_b64_tr_b16 a[52:53], v39 offset:28672
    v_mfma_f32_16x16x32_bf16 v[140:143], a[28:31], a[144:147], v[140:143]
    buffer_load_dwordx4 a[124:127], v7, s[20:23], s53 offen offset:2048 sc1
    ds_read_b64_tr_b16 a[56:57], v40 offset:28672
    v_mfma_f32_16x16x32_bf16 v[156:159], a[28:31], a[148:151], v[156:159]
    ds_read_b64_tr_b16 a[60:61], v41 offset:28672
    v_mfma_f32_16x16x32_bf16 v[152:155], a[24:27], a[148:151], v[152:155]
    v_mfma_f32_16x16x32_bf16 v[148:151], a[20:23], a[148:151], v[148:151]
    buffer_load_dwordx4 a[128:131], v7, s[20:23], s53 offen offset:3072 sc1
    v_mfma_f32_16x16x32_bf16 v[144:147], a[16:19], a[148:151], v[144:147]
    s_waitcnt lgkmcnt(4)
    v_mfma_f32_16x16x32_bf16 v[128:131], a[32:35], a[152:155], v[128:131]
    s_waitcnt vmcnt(27)
    s_barrier
    v_mfma_f32_16x16x32_bf16 v[132:135], a[36:39], a[152:155], v[132:135]
    s_lshr_b32 s45, 0x707070b, s36
    s_and_b32 s45, s45, 0xff
    ds_read_b64_tr_b16 a[0:1], v54 offset:0
    v_mfma_f32_16x16x32_bf16 v[136:139], a[40:43], a[152:155], v[136:139]
    s_cmp_ge_u32 s45, s39
    s_addc_u32 s45, s45, 0
    ds_read_b64_tr_b16 a[2:3], v54 offset:2048
    v_mfma_f32_16x16x32_bf16 v[140:143], a[44:47], a[152:155], v[140:143]
    s_mul_i32 s28, s45, 229376
    s_mul_i32 s45, s45, 7168
    ds_read_b64_tr_b16 a[4:5], v55 offset:0
    v_mfma_f32_16x16x32_bf16 v[156:159], a[44:47], a[156:159], v[156:159]
    s_add_u32 s52, s55, s45
    s_add_u32 s53, s52, 3072
    ds_read_b64_tr_b16 a[6:7], v55 offset:2048
    v_mfma_f32_16x16x32_bf16 v[152:155], a[40:43], a[156:159], v[152:155]
    s_add_u32 m0, s56, 0x4000
    s_nop 0
    buffer_load_dwordx4 v34, s[16:19], s28 offen lds
    ds_read_b64_tr_b16 a[8:9], v56 offset:0
    v_mfma_f32_16x16x32_bf16 v[148:151], a[36:39], a[156:159], v[148:151]
    buffer_load_dwordx4 v35, s[16:19], s28 offen offset:1024 lds
    s_add_u32 s28, s28, 131072
    ds_read_b64_tr_b16 a[10:11], v56 offset:2048
    v_mfma_f32_16x16x32_bf16 v[144:147], a[32:35], a[156:159], v[144:147]
    buffer_load_dwordx4 a[136:139], v7, s[20:23], s52 offen offset:0 sc1
    ds_read_b64_tr_b16 a[12:13], v57 offset:0
    ds_read_b64_tr_b16 a[14:15], v57 offset:2048
    s_waitcnt lgkmcnt(8)
    v_mfma_f32_16x16x16_bf16 v[128:131], a[48:49], a[160:161], v[128:131]
    ds_read_b64_tr_b16 a[16:17], v54 offset:4096
    ds_read_b64_tr_b16 a[18:19], v54 offset:6144
    v_mfma_f32_16x16x16_bf16 v[132:135], a[52:53], a[160:161], v[132:135]
    buffer_load_dwordx4 a[140:143], v7, s[20:23], s53 offen offset:0 sc1
    ds_read_b64_tr_b16 a[20:21], v55 offset:4096
    ds_read_b64_tr_b16 a[22:23], v55 offset:6144
    v_mfma_f32_16x16x16_bf16 v[136:139], a[56:57], a[160:161], v[136:139]
    ds_read_b64_tr_b16 a[24:25], v56 offset:4096
    v_mfma_f32_16x16x16_bf16 v[140:143], a[60:61], a[160:161], v[140:143]
    ds_read_b64_tr_b16 a[26:27], v56 offset:6144
    v_mfma_f32_16x16x16_bf16 v[156:159], a[60:61], a[162:163], v[156:159]
    buffer_load_dwordx4 a[144:147], v7, s[20:23], s52 offen offset:1024 sc1
    ds_read_b64_tr_b16 a[28:29], v57 offset:4096
    v_mfma_f32_16x16x16_bf16 v[152:155], a[56:57], a[162:163], v[152:155]
    ds_read_b64_tr_b16 a[30:31], v57 offset:6144
    v_mfma_f32_16x16x16_bf16 v[148:151], a[52:53], a[162:163], v[148:151]
    buffer_load_dwordx4 a[148:151], v7, s[20:23], s53 offen offset:1024 sc1
    v_mfma_f32_16x16x16_bf16 v[144:147], a[48:49], a[162:163], v[144:147]
    s_waitcnt lgkmcnt(8)
    v_mfma_f32_16x16x32_bf16 v[128:131], a[0:3], a[168:171], v[128:131]
    s_waitcnt vmcnt(28)
    s_barrier
    v_mfma_f32_16x16x32_bf16 v[132:135], a[4:7], a[168:171], v[132:135]
    s_add_u32 m0, s57, 0x6000
    ds_read_b64_tr_b16 a[32:33], v54 offset:8192
    v_mfma_f32_16x16x32_bf16 v[136:139], a[8:11], a[168:171], v[136:139]
    buffer_load_dwordx4 v36, s[16:19], s28 offen lds
    ds_read_b64_tr_b16 a[34:35], v54 offset:10240
    v_mfma_f32_16x16x32_bf16 v[140:143], a[12:15], a[168:171], v[140:143]
    ds_read_b64_tr_b16 a[36:37], v55 offset:8192
    v_mfma_f32_16x16x32_bf16 v[156:159], a[12:15], a[172:175], v[156:159]
    s_add_u32 m0, s58, 0x6000
    ds_read_b64_tr_b16 a[38:39], v55 offset:10240
    v_mfma_f32_16x16x32_bf16 v[152:155], a[8:11], a[172:175], v[152:155]
    s_mov_b64 exec, s[32:33]
    buffer_load_dwordx4 v37, s[16:19], s28 offen lds
    s_mov_b64 exec, -1
    v_mfma_f32_16x16x32_bf16 v[148:151], a[4:7], a[172:175], v[148:151]
    ds_read_b64_tr_b16 a[40:41], v56 offset:8192
    ds_read_b64_tr_b16 a[42:43], v56 offset:10240
    v_mfma_f32_16x16x32_bf16 v[144:147], a[0:3], a[172:175], v[144:147]
    ds_read_b64_tr_b16 a[44:45], v57 offset:8192
    s_waitcnt lgkmcnt(7)
    v_mfma_f32_16x16x32_bf16 v[128:131], a[16:19], a[176:179], v[128:131]
    buffer_load_dwordx4 a[152:155], v7, s[20:23], s52 offen offset:2048 sc1
    ds_read_b64_tr_b16 a[46:47], v57 offset:10240
    v_mfma_f32_16x16x32_bf16 v[132:135], a[20:23], a[176:179], v[132:135]
    ds_read_b64_tr_b16 a[48:49], v54 offset:12288
    v_mfma_f32_16x16x32_bf16 v[136:139], a[24:27], a[176:179], v[136:139]
    ds_read_b64_tr_b16 a[52:53], v55 offset:12288
    v_mfma_f32_16x16x32_bf16 v[140:143], a[28:31], a[176:179], v[140:143]
    buffer_load_dwordx4 a[156:159], v7, s[20:23], s53 offen offset:2048 sc1
    ds_read_b64_tr_b16 a[56:57], v56 offset:12288
    v_mfma_f32_16x16x32_bf16 v[156:159], a[28:31], a[180:183], v[156:159]
    ds_read_b64_tr_b16 a[60:61], v57 offset:12288
    v_mfma_f32_16x16x32_bf16 v[152:155], a[24:27], a[180:183], v[152:155]
    v_mfma_f32_16x16x32_bf16 v[148:151], a[20:23], a[180:183], v[148:151]
    buffer_load_dwordx4 a[160:163], v7, s[20:23], s53 offen offset:3072 sc1
    v_mfma_f32_16x16x32_bf16 v[144:147], a[16:19], a[180:183], v[144:147]
    s_waitcnt lgkmcnt(4)
    v_mfma_f32_16x16x32_bf16 v[128:131], a[32:35], a[184:187], v[128:131]
    s_waitcnt vmcnt(27)
    s_barrier
    v_mfma_f32_16x16x32_bf16 v[132:135], a[36:39], a[184:187], v[132:135]
    s_lshr_b32 s45, 0x8080c08, s36
    s_and_b32 s45, s45, 0xff
    ds_read_b64_tr_b16 a[0:1], v54 offset:16384
    v_mfma_f32_16x16x32_bf16 v[136:139], a[40:43], a[184:187], v[136:139]
    s_cmp_ge_u32 s45, s39
    s_addc_u32 s45, s45, 0
    ds_read_b64_tr_b16 a[2:3], v54 offset:18432
    v_mfma_f32_16x16x32_bf16 v[140:143], a[44:47], a[184:187], v[140:143]
    s_mul_i32 s28, s45, 229376
    s_mul_i32 s45, s45, 7168
    ds_read_b64_tr_b16 a[4:5], v55 offset:16384
    v_mfma_f32_16x16x32_bf16 v[156:159], a[44:47], a[188:191], v[156:159]
    s_add_u32 s52, s55, s45
    s_add_u32 s53, s52, 3072
    ds_read_b64_tr_b16 a[6:7], v55 offset:18432
    v_mfma_f32_16x16x32_bf16 v[152:155], a[40:43], a[188:191], v[152:155]
    s_add_u32 m0, s56, 0xfffe0000
    s_nop 0
    buffer_load_dwordx4 v34, s[16:19], s28 offen lds
    ds_read_b64_tr_b16 a[8:9], v56 offset:16384
    v_mfma_f32_16x16x32_bf16 v[148:151], a[36:39], a[188:191], v[148:151]
    buffer_load_dwordx4 v35, s[16:19], s28 offen offset:1024 lds
    s_add_u32 s28, s28, 131072
    ds_read_b64_tr_b16 a[10:11], v56 offset:18432
    v_mfma_f32_16x16x32_bf16 v[144:147], a[32:35], a[188:191], v[144:147]
    buffer_load_dwordx4 a[168:171], v7, s[20:23], s52 offen offset:0 sc1
    ds_read_b64_tr_b16 a[12:13], v57 offset:16384
    ds_read_b64_tr_b16 a[14:15], v57 offset:18432
    s_waitcnt lgkmcnt(8)
    v_mfma_f32_16x16x16_bf16 v[128:131], a[48:49], a[192:193], v[128:131]
    ds_read_b64_tr_b16 a[16:17], v54 offset:20480
    ds_read_b64_tr_b16 a[18:19], v54 offset:22528
    v_mfma_f32_16x16x16_bf16 v[132:135], a[52:53], a[192:193], v[132:135]
    buffer_load_dwordx4 a[172:175], v7, s[20:23], s53 offen offset:0 sc1
    ds_read_b64_tr_b16 a[20:21], v55 offset:20480
    ds_read_b64_tr_b16 a[22:23], v55 offset:22528
    v_mfma_f32_16x16x16_bf16 v[136:139], a[56:57], a[192:193], v[136:139]
    ds_read_b64_tr_b16 a[24:25], v56 offset:20480
    v_mfma_f32_16x16x16_bf16 v[140:143], a[60:61], a[192:193], v[140:143]
    ds_read_b64_tr_b16 a[26:27], v56 offset:22528
    v_mfma_f32_16x16x16_bf16 v[156:159], a[60:61], a[194:195], v[156:159]
    buffer_load_dwordx4 a[176:179], v7, s[20:23], s52 offen offset:1024 sc1
    ds_read_b64_tr_b16 a[28:29], v57 offset:20480
    v_mfma_f32_16x16x16_bf16 v[152:155], a[56:57], a[194:195], v[152:155]
    ds_read_b64_tr_b16 a[30:31], v57 offset:22528
    v_mfma_f32_16x16x16_bf16 v[148:151], a[52:53], a[194:195], v[148:151]
    buffer_load_dwordx4 a[180:183], v7, s[20:23], s53 offen offset:1024 sc1
    v_mfma_f32_16x16x16_bf16 v[144:147], a[48:49], a[194:195], v[144:147]
    s_waitcnt lgkmcnt(8)
    v_mfma_f32_16x16x32_bf16 v[128:131], a[0:3], a[200:203], v[128:131]
    s_waitcnt vmcnt(28)
    s_barrier
    v_mfma_f32_16x16x32_bf16 v[132:135], a[4:7], a[200:203], v[132:135]
    s_add_u32 m0, s57, 0xfffe2000
    ds_read_b64_tr_b16 a[32:33], v54 offset:24576
    v_mfma_f32_16x16x32_bf16 v[136:139], a[8:11], a[200:203], v[136:139]
    buffer_load_dwordx4 v36, s[16:19], s28 offen lds
    ds_read_b64_tr_b16 a[34:35], v54 offset:26624
    v_mfma_f32_16x16x32_bf16 v[140:143], a[12:15], a[200:203], v[140:143]
    ds_read_b64_tr_b16 a[36:37], v55 offset:24576
    v_mfma_f32_16x16x32_bf16 v[156:159], a[12:15], a[204:207], v[156:159]
    s_add_u32 m0, s58, 0xfffe2000
    ds_read_b64_tr_b16 a[38:39], v55 offset:26624
    v_mfma_f32_16x16x32_bf16 v[152:155], a[8:11], a[204:207], v[152:155]
    s_mov_b64 exec, s[32:33]
    buffer_load_dwordx4 v37, s[16:19], s28 offen lds
    s_mov_b64 exec, -1
    v_mfma_f32_16x16x32_bf16 v[148:151], a[4:7], a[204:207], v[148:151]
    ds_read_b64_tr_b16 a[40:41], v56 offset:24576
    ds_read_b64_tr_b16 a[42:43], v56 offset:26624
    v_mfma_f32_16x16x32_bf16 v[144:147], a[0:3], a[204:207], v[144:147]
    ds_read_b64_tr_b16 a[44:45], v57 offset:24576
    s_waitcnt lgkmcnt(7)
    v_mfma_f32_16x16x32_bf16 v[128:131], a[16:19], a[208:211], v[128:131]
    buffer_load_dwordx4 a[184:187], v7, s[20:23], s52 offen offset:2048 sc1
    ds_read_b64_tr_b16 a[46:47], v57 offset:26624
    v_mfma_f32_16x16x32_bf16 v[132:135], a[20:23], a[208:211], v[132:135]
    ds_read_b64_tr_b16 a[48:49], v54 offset:28672
    v_mfma_f32_16x16x32_bf16 v[136:139], a[24:27], a[208:211], v[136:139]
    ds_read_b64_tr_b16 a[52:53], v55 offset:28672
    v_mfma_f32_16x16x32_bf16 v[140:143], a[28:31], a[208:211], v[140:143]
    buffer_load_dwordx4 a[188:191], v7, s[20:23], s53 offen offset:2048 sc1
    ds_read_b64_tr_b16 a[56:57], v56 offset:28672
    v_mfma_f32_16x16x32_bf16 v[156:159], a[28:31], a[212:215], v[156:159]
    ds_read_b64_tr_b16 a[60:61], v57 offset:28672
    v_mfma_f32_16x16x32_bf16 v[152:155], a[24:27], a[212:215], v[152:155]
    v_mfma_f32_16x16x32_bf16 v[148:151], a[20:23], a[212:215], v[148:151]
    buffer_load_dwordx4 a[192:195], v7, s[20:23], s53 offen offset:3072 sc1
    v_mfma_f32_16x16x32_bf16 v[144:147], a[16:19], a[212:215], v[144:147]
    s_waitcnt lgkmcnt(4)
    v_mfma_f32_16x16x32_bf16 v[128:131], a[32:35], a[216:219], v[128:131]
    s_waitcnt vmcnt(27)
    s_barrier
    v_mfma_f32_16x16x32_bf16 v[132:135], a[36:39], a[216:219], v[132:135]
    s_lshr_b32 s45, 0x90d0909, s36
    s_and_b32 s45, s45, 0xff
    ds_read_b64_tr_b16 a[0:1], v38 offset:0
    v_mfma_f32_16x16x32_bf16 v[136:139], a[40:43], a[216:219], v[136:139]
    s_cmp_ge_u32 s45, s39
    s_addc_u32 s45, s45, 0
    ds_read_b64_tr_b16 a[2:3], v38 offset:2048
    v_mfma_f32_16x16x32_bf16 v[140:143], a[44:47], a[216:219], v[140:143]
    s_mul_i32 s28, s45, 229376
    s_mul_i32 s45, s45, 7168
    ds_read_b64_tr_b16 a[4:5], v39 offset:0
    v_mfma_f32_16x16x32_bf16 v[156:159], a[44:47], a[220:223], v[156:159]
    s_add_u32 s52, s55, s45
    s_add_u32 s53, s52, 3072
    ds_read_b64_tr_b16 a[6:7], v39 offset:2048
    v_mfma_f32_16x16x32_bf16 v[152:155], a[40:43], a[220:223], v[152:155]
    s_add_u32 m0, s56, 0xfffe4000
    s_nop 0
    buffer_load_dwordx4 v34, s[16:19], s28 offen lds
    ds_read_b64_tr_b16 a[8:9], v40 offset:0
    v_mfma_f32_16x16x32_bf16 v[148:151], a[36:39], a[220:223], v[148:151]
    buffer_load_dwordx4 v35, s[16:19], s28 offen offset:1024 lds
    s_add_u32 s28, s28, 131072
    ds_read_b64_tr_b16 a[10:11], v40 offset:2048
    v_mfma_f32_16x16x32_bf16 v[144:147], a[32:35], a[220:223], v[144:147]
    buffer_load_dwordx4 a[200:203], v7, s[20:23], s52 offen offset:0 sc1
    ds_read_b64_tr_b16 a[12:13], v41 offset:0
    ds_read_b64_tr_b16 a[14:15], v41 offset:2048
    s_waitcnt lgkmcnt(8)
    v_mfma_f32_16x16x16_bf16 v[128:131], a[48:49], a[224:225], v[128:131]
    ds_read_b64_tr_b16 a[16:17], v38 offset:4096
    ds_read_b64_tr_b16 a[18:19], v38 offset:6144
    v_mfma_f32_16x16x16_bf16 v[132:135], a[52:53], a[224:225], v[132:135]
    buffer_load_dwordx4 a[204:207], v7, s[20:23], s53 offen offset:0 sc1
    ds_read_b64_tr_b16 a[20:21], v39 offset:4096
    ds_read_b64_tr_b16 a[22:23], v39 offset:6144
    v_mfma_f32_16x16x16_bf16 v[136:139], a[56:57], a[224:225], v[136:139]
    ds_read_b64_tr_b16 a[24:25], v40 offset:4096
    v_mfma_f32_16x16x16_bf16 v[140:143], a[60:61], a[224:225], v[140:143]
    ds_read_b64_tr_b16 a[26:27], v40 offset:6144
    v_mfma_f32_16x16x16_bf16 v[156:159], a[60:61], a[226:227], v[156:159]
    buffer_load_dwordx4 a[208:211], v7, s[20:23], s52 offen offset:1024 sc1
    ds_read_b64_tr_b16 a[28:29], v41 offset:4096
    v_mfma_f32_16x16x16_bf16 v[152:155], a[56:57], a[226:227], v[152:155]
    ds_read_b64_tr_b16 a[30:31], v41 offset:6144
    v_mfma_f32_16x16x16_bf16 v[148:151], a[52:53], a[226:227], v[148:151]
    buffer_load_dwordx4 a[212:215], v7, s[20:23], s53 offen offset:1024 sc1
    v_mfma_f32_16x16x16_bf16 v[144:147], a[48:49], a[226:227], v[144:147]
    s_waitcnt lgkmcnt(8)
    v_mfma_f32_16x16x32_bf16 v[128:131], a[0:3], a[104:107], v[128:131]
    s_waitcnt vmcnt(28)
    s_barrier
    v_mfma_f32_16x16x32_bf16 v[132:135], a[4:7], a[104:107], v[132:135]
    s_add_u32 m0, s57, 0xfffe6000
    ds_read_b64_tr_b16 a[32:33], v38 offset:8192
    v_mfma_f32_16x16x32_bf16 v[136:139], a[8:11], a[104:107], v[136:139]
    buffer_load_dwordx4 v36, s[16:19], s28 offen lds
    ds_read_b64_tr_b16 a[34:35], v38 offset:10240
    v_mfma_f32_16x16x32_bf16 v[140:143], a[12:15], a[104:107], v[140:143]
    ds_read_b64_tr_b16 a[36:37], v39 offset:8192
    v_mfma_f32_16x16x32_bf16 v[156:159], a[12:15], a[108:111], v[156:159]
    s_add_u32 m0, s58, 0xfffe6000
    ds_read_b64_tr_b16 a[38:39], v39 offset:10240
    v_mfma_f32_16x16x32_bf16 v[152:155], a[8:11], a[108:111], v[152:155]
    s_mov_b64 exec, s[32:33]
    buffer_load_dwordx4 v37, s[16:19], s28 offen lds
    s_mov_b64 exec, -1
    v_mfma_f32_16x16x32_bf16 v[148:151], a[4:7], a[108:111], v[148:151]
    ds_read_b64_tr_b16 a[40:41], v40 offset:8192
    ds_read_b64_tr_b16 a[42:43], v40 offset:10240
    v_mfma_f32_16x16x32_bf16 v[144:147], a[0:3], a[108:111], v[144:147]
    ds_read_b64_tr_b16 a[44:45], v41 offset:8192
    s_waitcnt lgkmcnt(7)
    v_mfma_f32_16x16x32_bf16 v[128:131], a[16:19], a[112:115], v[128:131]
    buffer_load_dwordx4 a[216:219], v7, s[20:23], s52 offen offset:2048 sc1
    ds_read_b64_tr_b16 a[46:47], v41 offset:10240
    v_mfma_f32_16x16x32_bf16 v[132:135], a[20:23], a[112:115], v[132:135]
    ds_read_b64_tr_b16 a[48:49], v38 offset:12288
    v_mfma_f32_16x16x32_bf16 v[136:139], a[24:27], a[112:115], v[136:139]
    ds_read_b64_tr_b16 a[52:53], v39 offset:12288
    v_mfma_f32_16x16x32_bf16 v[140:143], a[28:31], a[112:115], v[140:143]
    buffer_load_dwordx4 a[220:223], v7, s[20:23], s53 offen offset:2048 sc1
    ds_read_b64_tr_b16 a[56:57], v40 offset:12288
    v_mfma_f32_16x16x32_bf16 v[156:159], a[28:31], a[116:119], v[156:159]
    ds_read_b64_tr_b16 a[60:61], v41 offset:12288
    v_mfma_f32_16x16x32_bf16 v[152:155], a[24:27], a[116:119], v[152:155]
    v_mfma_f32_16x16x32_bf16 v[148:151], a[20:23], a[116:119], v[148:151]
    buffer_load_dwordx4 a[224:227], v7, s[20:23], s53 offen offset:3072 sc1
    v_mfma_f32_16x16x32_bf16 v[144:147], a[16:19], a[116:119], v[144:147]
    s_waitcnt lgkmcnt(4)
    v_mfma_f32_16x16x32_bf16 v[128:131], a[32:35], a[120:123], v[128:131]
    s_waitcnt vmcnt(27)
    s_barrier
    v_mfma_f32_16x16x32_bf16 v[132:135], a[36:39], a[120:123], v[132:135]
    s_lshr_b32 s45, 0xe0a0a0a, s36
    s_and_b32 s45, s45, 0xff
    ds_read_b64_tr_b16 a[0:1], v38 offset:16384
    v_mfma_f32_16x16x32_bf16 v[136:139], a[40:43], a[120:123], v[136:139]
    s_cmp_ge_u32 s45, s39
    s_addc_u32 s45, s45, 0
    ds_read_b64_tr_b16 a[2:3], v38 offset:18432
    v_mfma_f32_16x16x32_bf16 v[140:143], a[44:47], a[120:123], v[140:143]
    s_mul_i32 s28, s45, 229376
    s_mul_i32 s45, s45, 7168
    ds_read_b64_tr_b16 a[4:5], v39 offset:16384
    v_mfma_f32_16x16x32_bf16 v[156:159], a[44:47], a[124:127], v[156:159]
    s_add_u32 s52, s55, s45
    s_add_u32 s53, s52, 3072
    ds_read_b64_tr_b16 a[6:7], v39 offset:18432
    v_mfma_f32_16x16x32_bf16 v[152:155], a[40:43], a[124:127], v[152:155]
    s_add_u32 m0, s56, 0x0
    s_nop 0
    buffer_load_dwordx4 v34, s[16:19], s28 offen lds
    ds_read_b64_tr_b16 a[8:9], v40 offset:16384
    v_mfma_f32_16x16x32_bf16 v[148:151], a[36:39], a[124:127], v[148:151]
    buffer_load_dwordx4 v35, s[16:19], s28 offen offset:1024 lds
    s_add_u32 s28, s28, 131072
    ds_read_b64_tr_b16 a[10:11], v40 offset:18432
    v_mfma_f32_16x16x32_bf16 v[144:147], a[32:35], a[124:127], v[144:147]
    buffer_load_dwordx4 a[104:107], v7, s[20:23], s52 offen offset:0 sc1
    ds_read_b64_tr_b16 a[12:13], v41 offset:16384
    ds_read_b64_tr_b16 a[14:15], v41 offset:18432
    s_waitcnt lgkmcnt(8)
    v_mfma_f32_16x16x16_bf16 v[128:131], a[48:49], a[128:129], v[128:131]
    ds_read_b64_tr_b16 a[16:17], v38 offset:20480
    ds_read_b64_tr_b16 a[18:19], v38 offset:22528
    v_mfma_f32_16x16x16_bf16 v[132:135], a[52:53], a[128:129], v[132:135]
    buffer_load_dwordx4 a[108:111], v7, s[20:23], s53 offen offset:0 sc1
    ds_read_b64_tr_b16 a[20:21], v39 offset:20480
    ds_read_b64_tr_b16 a[22:23], v39 offset:22528
    v_mfma_f32_16x16x16_bf16 v[136:139], a[56:57], a[128:129], v[136:139]
    ds_read_b64_tr_b16 a[24:25], v40 offset:20480
    v_mfma_f32_16x16x16_bf16 v[140:143], a[60:61], a[128:129], v[140:143]
    ds_read_b64_tr_b16 a[26:27], v40 offset:22528
    v_mfma_f32_16x16x16_bf16 v[156:159], a[60:61], a[130:131], v[156:159]
    buffer_load_dwordx4 a[112:115], v7, s[20:23], s52 offen offset:1024 sc1
    ds_read_b64_tr_b16 a[28:29], v41 offset:20480
    v_mfma_f32_16x16x16_bf16 v[152:155], a[56:57], a[130:131], v[152:155]
    ds_read_b64_tr_b16 a[30:31], v41 offset:22528
    v_mfma_f32_16x16x16_bf16 v[148:151], a[52:53], a[130:131], v[148:151]
    buffer_load_dwordx4 a[116:119], v7, s[20:23], s53 offen offset:1024 sc1
    v_mfma_f32_16x16x16_bf16 v[144:147], a[48:49], a[130:131], v[144:147]
    s_waitcnt lgkmcnt(8)
    v_mfma_f32_16x16x32_bf16 v[128:131], a[0:3], a[136:139], v[128:131]
    s_waitcnt vmcnt(28)
    s_barrier
    v_mfma_f32_16x16x32_bf16 v[132:135], a[4:7], a[136:139], v[132:135]
    s_add_u32 m0, s57, 0x2000
    ds_read_b64_tr_b16 a[32:33], v38 offset:24576
    v_mfma_f32_16x16x32_bf16 v[136:139], a[8:11], a[136:139], v[136:139]
    buffer_load_dwordx4 v36, s[16:19], s28 offen lds
    ds_read_b64_tr_b16 a[34:35], v38 offset:26624
    v_mfma_f32_16x16x32_bf16 v[140:143], a[12:15], a[136:139], v[140:143]
    ds_read_b64_tr_b16 a[36:37], v39 offset:24576
    v_mfma_f32_16x16x32_bf16 v[156:159], a[12:15], a[140:143], v[156:159]
    s_add_u32 m0, s58, 0x2000
    ds_read_b64_tr_b16 a[38:39], v39 offset:26624
    v_mfma_f32_16x16x32_bf16 v[152:155], a[8:11], a[140:143], v[152:155]
    s_mov_b64 exec, s[32:33]
    buffer_load_dwordx4 v37, s[16:19], s28 offen lds
    s_mov_b64 exec, -1
    v_mfma_f32_16x16x32_bf16 v[148:151], a[4:7], a[140:143], v[148:151]
    ds_read_b64_tr_b16 a[40:41], v40 offset:24576
    ds_read_b64_tr_b16 a[42:43], v40 offset:26624
    v_mfma_f32_16x16x32_bf16 v[144:147], a[0:3], a[140:143], v[144:147]
    ds_read_b64_tr_b16 a[44:45], v41 offset:24576
    s_waitcnt lgkmcnt(7)
    v_mfma_f32_16x16x32_bf16 v[128:131], a[16:19], a[144:147], v[128:131]
    buffer_load_dwordx4 a[120:123], v7, s[20:23], s52 offen offset:2048 sc1
    ds_read_b64_tr_b16 a[46:47], v41 offset:26624
    v_mfma_f32_16x16x32_bf16 v[132:135], a[20:23], a[144:147], v[132:135]
    ds_read_b64_tr_b16 a[48:49], v38 offset:28672
    v_mfma_f32_16x16x32_bf16 v[136:139], a[24:27], a[144:147], v[136:139]
    ds_read_b64_tr_b16 a[52:53], v39 offset:28672
    v_mfma_f32_16x16x32_bf16 v[140:143], a[28:31], a[144:147], v[140:143]
    buffer_load_dwordx4 a[124:127], v7, s[20:23], s53 offen offset:2048 sc1
    ds_read_b64_tr_b16 a[56:57], v40 offset:28672
    v_mfma_f32_16x16x32_bf16 v[156:159], a[28:31], a[148:151], v[156:159]
    ds_read_b64_tr_b16 a[60:61], v41 offset:28672
    v_mfma_f32_16x16x32_bf16 v[152:155], a[24:27], a[148:151], v[152:155]
    v_mfma_f32_16x16x32_bf16 v[148:151], a[20:23], a[148:151], v[148:151]
    buffer_load_dwordx4 a[128:131], v7, s[20:23], s53 offen offset:3072 sc1
    v_mfma_f32_16x16x32_bf16 v[144:147], a[16:19], a[148:151], v[144:147]
    s_waitcnt lgkmcnt(4)
    v_mfma_f32_16x16x32_bf16 v[128:131], a[32:35], a[152:155], v[128:131]
    s_waitcnt vmcnt(27)
    s_barrier
    v_mfma_f32_16x16x32_bf16 v[132:135], a[36:39], a[152:155], v[132:135]
    s_lshr_b32 s45, 0xb0b0b0c, s36
    s_and_b32 s45, s45, 0xff
    ds_read_b64_tr_b16 a[0:1], v54 offset:0
    v_mfma_f32_16x16x32_bf16 v[136:139], a[40:43], a[152:155], v[136:139]
    s_cmp_ge_u32 s45, s39
    s_addc_u32 s45, s45, 0
    ds_read_b64_tr_b16 a[2:3], v54 offset:2048
    v_mfma_f32_16x16x32_bf16 v[140:143], a[44:47], a[152:155], v[140:143]
    s_mul_i32 s28, s45, 229376
    s_mul_i32 s45, s45, 7168
    ds_read_b64_tr_b16 a[4:5], v55 offset:0
    v_mfma_f32_16x16x32_bf16 v[156:159], a[44:47], a[156:159], v[156:159]
    s_add_u32 s52, s55, s45
    s_add_u32 s53, s52, 3072
    ds_read_b64_tr_b16 a[6:7], v55 offset:2048
    v_mfma_f32_16x16x32_bf16 v[152:155], a[40:43], a[156:159], v[152:155]
    s_add_u32 m0, s56, 0x4000
    s_nop 0
    buffer_load_dwordx4 v34, s[16:19], s28 offen lds
    ds_read_b64_tr_b16 a[8:9], v56 offset:0
    v_mfma_f32_16x16x32_bf16 v[148:151], a[36:39], a[156:159], v[148:151]
    buffer_load_dwordx4 v35, s[16:19], s28 offen offset:1024 lds
    s_add_u32 s28, s28, 131072
    ds_read_b64_tr_b16 a[10:11], v56 offset:2048
    v_mfma_f32_16x16x32_bf16 v[144:147], a[32:35], a[156:159], v[144:147]
    buffer_load_dwordx4 a[136:139], v7, s[20:23], s52 offen offset:0 sc1
    ds_read_b64_tr_b16 a[12:13], v57 offset:0
    ds_read_b64_tr_b16 a[14:15], v57 offset:2048
    s_waitcnt lgkmcnt(8)
    v_mfma_f32_16x16x16_bf16 v[128:131], a[48:49], a[160:161], v[128:131]
    ds_read_b64_tr_b16 a[16:17], v54 offset:4096
    ds_read_b64_tr_b16 a[18:19], v54 offset:6144
    v_mfma_f32_16x16x16_bf16 v[132:135], a[52:53], a[160:161], v[132:135]
    buffer_load_dwordx4 a[140:143], v7, s[20:23], s53 offen offset:0 sc1
    ds_read_b64_tr_b16 a[20:21], v55 offset:4096
    ds_read_b64_tr_b16 a[22:23], v55 offset:6144
    v_mfma_f32_16x16x16_bf16 v[136:139], a[56:57], a[160:161], v[136:139]
    ds_read_b64_tr_b16 a[24:25], v56 offset:4096
    v_mfma_f32_16x16x16_bf16 v[140:143], a[60:61], a[160:161], v[140:143]
    ds_read_b64_tr_b16 a[26:27], v56 offset:6144
    v_mfma_f32_16x16x16_bf16 v[156:159], a[60:61], a[162:163], v[156:159]
    buffer_load_dwordx4 a[144:147], v7, s[20:23], s52 offen offset:1024 sc1
    ds_read_b64_tr_b16 a[28:29], v57 offset:4096
    v_mfma_f32_16x16x16_bf16 v[152:155], a[56:57], a[162:163], v[152:155]
    ds_read_b64_tr_b16 a[30:31], v57 offset:6144
    v_mfma_f32_16x16x16_bf16 v[148:151], a[52:53], a[162:163], v[148:151]
    buffer_load_dwordx4 a[148:151], v7, s[20:23], s53 offen offset:1024 sc1
    v_mfma_f32_16x16x16_bf16 v[144:147], a[48:49], a[162:163], v[144:147]
    s_waitcnt lgkmcnt(8)
    v_mfma_f32_16x16x32_bf16 v[128:131], a[0:3], a[168:171], v[128:131]
    s_waitcnt vmcnt(28)
    s_barrier
    v_mfma_f32_16x16x32_bf16 v[132:135], a[4:7], a[168:171], v[132:135]
    s_add_u32 m0, s57, 0x6000
    ds_read_b64_tr_b16 a[32:33], v54 offset:8192
    v_mfma_f32_16x16x32_bf16 v[136:139], a[8:11], a[168:171], v[136:139]
    buffer_load_dwordx4 v36, s[16:19], s28 offen lds
    ds_read_b64_tr_b16 a[34:35], v54 offset:10240
    v_mfma_f32_16x16x32_bf16 v[140:143], a[12:15], a[168:171], v[140:143]
    ds_read_b64_tr_b16 a[36:37], v55 offset:8192
    v_mfma_f32_16x16x32_bf16 v[156:159], a[12:15], a[172:175], v[156:159]
    s_add_u32 m0, s58, 0x6000
    ds_read_b64_tr_b16 a[38:39], v55 offset:10240
    v_mfma_f32_16x16x32_bf16 v[152:155], a[8:11], a[172:175], v[152:155]
    s_mov_b64 exec, s[32:33]
    buffer_load_dwordx4 v37, s[16:19], s28 offen lds
    s_mov_b64 exec, -1
    v_mfma_f32_16x16x32_bf16 v[148:151], a[4:7], a[172:175], v[148:151]
    ds_read_b64_tr_b16 a[40:41], v56 offset:8192
    ds_read_b64_tr_b16 a[42:43], v56 offset:10240
    v_mfma_f32_16x16x32_bf16 v[144:147], a[0:3], a[172:175], v[144:147]
    ds_read_b64_tr_b16 a[44:45], v57 offset:8192
    s_waitcnt lgkmcnt(7)
    v_mfma_f32_16x16x32_bf16 v[128:131], a[16:19], a[176:179], v[128:131]
    buffer_load_dwordx4 a[152:155], v7, s[20:23], s52 offen offset:2048 sc1
    ds_read_b64_tr_b16 a[46:47], v57 offset:10240
    v_mfma_f32_16x16x32_bf16 v[132:135], a[20:23], a[176:179], v[132:135]
    ds_read_b64_tr_b16 a[48:49], v54 offset:12288
    v_mfma_f32_16x16x32_bf16 v[136:139], a[24:27], a[176:179], v[136:139]
    ds_read_b64_tr_b16 a[52:53], v55 offset:12288
    v_mfma_f32_16x16x32_bf16 v[140:143], a[28:31], a[176:179], v[140:143]
    buffer_load_dwordx4 a[156:159], v7, s[20:23], s53 offen offset:2048 sc1
    ds_read_b64_tr_b16 a[56:57], v56 offset:12288
    v_mfma_f32_16x16x32_bf16 v[156:159], a[28:31], a[180:183], v[156:159]
    ds_read_b64_tr_b16 a[60:61], v57 offset:12288
    v_mfma_f32_16x16x32_bf16 v[152:155], a[24:27], a[180:183], v[152:155]
    v_mfma_f32_16x16x32_bf16 v[148:151], a[20:23], a[180:183], v[148:151]
    buffer_load_dwordx4 a[160:163], v7, s[20:23], s53 offen offset:3072 sc1
    v_mfma_f32_16x16x32_bf16 v[144:147], a[16:19], a[180:183], v[144:147]
    s_waitcnt lgkmcnt(4)
    v_mfma_f32_16x16x32_bf16 v[128:131], a[32:35], a[184:187], v[128:131]
    s_waitcnt vmcnt(27)
    s_barrier
    v_mfma_f32_16x16x32_bf16 v[132:135], a[36:39], a[184:187], v[132:135]
    s_lshr_b32 s45, 0xc0c0d0d, s36
    s_and_b32 s45, s45, 0xff
    ds_read_b64_tr_b16 a[0:1], v54 offset:16384
    v_mfma_f32_16x16x32_bf16 v[136:139], a[40:43], a[184:187], v[136:139]
    s_cmp_ge_u32 s45, s39
    s_addc_u32 s45, s45, 0
    ds_read_b64_tr_b16 a[2:3], v54 offset:18432
    v_mfma_f32_16x16x32_bf16 v[140:143], a[44:47], a[184:187], v[140:143]
    s_mul_i32 s28, s45, 229376
    s_mul_i32 s45, s45, 7168
    ds_read_b64_tr_b16 a[4:5], v55 offset:16384
    v_mfma_f32_16x16x32_bf16 v[156:159], a[44:47], a[188:191], v[156:159]
    s_add_u32 s52, s55, s45
    s_add_u32 s53, s52, 3072
    ds_read_b64_tr_b16 a[6:7], v55 offset:18432
    v_mfma_f32_16x16x32_bf16 v[152:155], a[40:43], a[188:191], v[152:155]
    s_add_u32 m0, s56, 0xfffe0000
    s_nop 0
    buffer_load_dwordx4 v34, s[16:19], s28 offen lds
    ds_read_b64_tr_b16 a[8:9], v56 offset:16384
    v_mfma_f32_16x16x32_bf16 v[148:151], a[36:39], a[188:191], v[148:151]
    buffer_load_dwordx4 v35, s[16:19], s28 offen offset:1024 lds
    s_add_u32 s28, s28, 131072
    ds_read_b64_tr_b16 a[10:11], v56 offset:18432
    v_mfma_f32_16x16x32_bf16 v[144:147], a[32:35], a[188:191], v[144:147]
    buffer_load_dwordx4 a[168:171], v7, s[20:23], s52 offen offset:0 sc1
    ds_read_b64_tr_b16 a[12:13], v57 offset:16384
    ds_read_b64_tr_b16 a[14:15], v57 offset:18432
    s_waitcnt lgkmcnt(8)
    v_mfma_f32_16x16x16_bf16 v[128:131], a[48:49], a[192:193], v[128:131]
    ds_read_b64_tr_b16 a[16:17], v54 offset:20480
    ds_read_b64_tr_b16 a[18:19], v54 offset:22528
    v_mfma_f32_16x16x16_bf16 v[132:135], a[52:53], a[192:193], v[132:135]
    buffer_load_dwordx4 a[172:175], v7, s[20:23], s53 offen offset:0 sc1
    ds_read_b64_tr_b16 a[20:21], v55 offset:20480
    ds_read_b64_tr_b16 a[22:23], v55 offset:22528
    v_mfma_f32_16x16x16_bf16 v[136:139], a[56:57], a[192:193], v[136:139]
    ds_read_b64_tr_b16 a[24:25], v56 offset:20480
    v_mfma_f32_16x16x16_bf16 v[140:143], a[60:61], a[192:193], v[140:143]
    ds_read_b64_tr_b16 a[26:27], v56 offset:22528
    v_mfma_f32_16x16x16_bf16 v[156:159], a[60:61], a[194:195], v[156:159]
    buffer_load_dwordx4 a[176:179], v7, s[20:23], s52 offen offset:1024 sc1
    ds_read_b64_tr_b16 a[28:29], v57 offset:20480
    v_mfma_f32_16x16x16_bf16 v[152:155], a[56:57], a[194:195], v[152:155]
    ds_read_b64_tr_b16 a[30:31], v57 offset:22528
    v_mfma_f32_16x16x16_bf16 v[148:151], a[52:53], a[194:195], v[148:151]
    buffer_load_dwordx4 a[180:183], v7, s[20:23], s53 offen offset:1024 sc1
    v_mfma_f32_16x16x16_bf16 v[144:147], a[48:49], a[194:195], v[144:147]
    s_waitcnt lgkmcnt(8)
    v_mfma_f32_16x16x32_bf16 v[128:131], a[0:3], a[200:203], v[128:131]
    s_waitcnt vmcnt(28)
    s_barrier
    v_mfma_f32_16x16x32_bf16 v[132:135], a[4:7], a[200:203], v[132:135]
    s_add_u32 m0, s57, 0xfffe2000
    ds_read_b64_tr_b16 a[32:33], v54 offset:24576
    v_mfma_f32_16x16x32_bf16 v[136:139], a[8:11], a[200:203], v[136:139]
    buffer_load_dwordx4 v36, s[16:19], s28 offen lds
    ds_read_b64_tr_b16 a[34:35], v54 offset:26624
    v_mfma_f32_16x16x32_bf16 v[140:143], a[12:15], a[200:203], v[140:143]
    ds_read_b64_tr_b16 a[36:37], v55 offset:24576
    v_mfma_f32_16x16x32_bf16 v[156:159], a[12:15], a[204:207], v[156:159]
    s_add_u32 m0, s58, 0xfffe2000
    ds_read_b64_tr_b16 a[38:39], v55 offset:26624
    v_mfma_f32_16x16x32_bf16 v[152:155], a[8:11], a[204:207], v[152:155]
    s_mov_b64 exec, s[32:33]
    buffer_load_dwordx4 v37, s[16:19], s28 offen lds
    s_mov_b64 exec, -1
    v_mfma_f32_16x16x32_bf16 v[148:151], a[4:7], a[204:207], v[148:151]
    ds_read_b64_tr_b16 a[40:41], v56 offset:24576
    ds_read_b64_tr_b16 a[42:43], v56 offset:26624
    v_mfma_f32_16x16x32_bf16 v[144:147], a[0:3], a[204:207], v[144:147]
    ds_read_b64_tr_b16 a[44:45], v57 offset:24576
    s_waitcnt lgkmcnt(7)
    v_mfma_f32_16x16x32_bf16 v[128:131], a[16:19], a[208:211], v[128:131]
    buffer_load_dwordx4 a[184:187], v7, s[20:23], s52 offen offset:2048 sc1
    ds_read_b64_tr_b16 a[46:47], v57 offset:26624
    v_mfma_f32_16x16x32_bf16 v[132:135], a[20:23], a[208:211], v[132:135]
    ds_read_b64_tr_b16 a[48:49], v54 offset:28672
    v_mfma_f32_16x16x32_bf16 v[136:139], a[24:27], a[208:211], v[136:139]
    ds_read_b64_tr_b16 a[52:53], v55 offset:28672
    v_mfma_f32_16x16x32_bf16 v[140:143], a[28:31], a[208:211], v[140:143]
    buffer_load_dwordx4 a[188:191], v7, s[20:23], s53 offen offset:2048 sc1
    ds_read_b64_tr_b16 a[56:57], v56 offset:28672
    v_mfma_f32_16x16x32_bf16 v[156:159], a[28:31], a[212:215], v[156:159]
    ds_read_b64_tr_b16 a[60:61], v57 offset:28672
    v_mfma_f32_16x16x32_bf16 v[152:155], a[24:27], a[212:215], v[152:155]
    v_mfma_f32_16x16x32_bf16 v[148:151], a[20:23], a[212:215], v[148:151]
    buffer_load_dwordx4 a[192:195], v7, s[20:23], s53 offen offset:3072 sc1
    v_mfma_f32_16x16x32_bf16 v[144:147], a[16:19], a[212:215], v[144:147]
    s_waitcnt lgkmcnt(4)
    v_mfma_f32_16x16x32_bf16 v[128:131], a[32:35], a[216:219], v[128:131]
    s_waitcnt vmcnt(27)
    s_barrier
    v_mfma_f32_16x16x32_bf16 v[132:135], a[36:39], a[216:219], v[132:135]
    s_lshr_b32 s45, 0xd0e0e0e, s36
    s_and_b32 s45, s45, 0xff
    ds_read_b64_tr_b16 a[0:1], v38 offset:0
    v_mfma_f32_16x16x32_bf16 v[136:139], a[40:43], a[216:219], v[136:139]
    s_cmp_ge_u32 s45, s39
    s_addc_u32 s45, s45, 0
    ds_read_b64_tr_b16 a[2:3], v38 offset:2048
    v_mfma_f32_16x16x32_bf16 v[140:143], a[44:47], a[216:219], v[140:143]
    s_mul_i32 s28, s45, 229376
    s_mul_i32 s45, s45, 7168
    ds_read_b64_tr_b16 a[4:5], v39 offset:0
    v_mfma_f32_16x16x32_bf16 v[156:159], a[44:47], a[220:223], v[156:159]
    s_add_u32 s52, s55, s45
    s_add_u32 s53, s52, 3072
    ds_read_b64_tr_b16 a[6:7], v39 offset:2048
    v_mfma_f32_16x16x32_bf16 v[152:155], a[40:43], a[220:223], v[152:155]
    s_add_u32 m0, s56, 0xfffe4000
    s_nop 0
    buffer_load_dwordx4 v34, s[16:19], s28 offen lds
    ds_read_b64_tr_b16 a[8:9], v40 offset:0
    v_mfma_f32_16x16x32_bf16 v[148:151], a[36:39], a[220:223], v[148:151]
    buffer_load_dwordx4 v35, s[16:19], s28 offen offset:1024 lds
    s_add_u32 s28, s28, 131072
    ds_read_b64_tr_b16 a[10:11], v40 offset:2048
    v_mfma_f32_16x16x32_bf16 v[144:147], a[32:35], a[220:223], v[144:147]
    buffer_load_dwordx4 a[200:203], v7, s[20:23], s52 offen offset:0 sc1
    ds_read_b64_tr_b16 a[12:13], v41 offset:0
    ds_read_b64_tr_b16 a[14:15], v41 offset:2048
    s_waitcnt lgkmcnt(8)
    v_mfma_f32_16x16x16_bf16 v[128:131], a[48:49], a[224:225], v[128:131]
    ds_read_b64_tr_b16 a[16:17], v38 offset:4096
    ds_read_b64_tr_b16 a[18:19], v38 offset:6144
    v_mfma_f32_16x16x16_bf16 v[132:135], a[52:53], a[224:225], v[132:135]
    buffer_load_dwordx4 a[204:207], v7, s[20:23], s53 offen offset:0 sc1
    ds_read_b64_tr_b16 a[20:21], v39 offset:4096
    ds_read_b64_tr_b16 a[22:23], v39 offset:6144
    v_mfma_f32_16x16x16_bf16 v[136:139], a[56:57], a[224:225], v[136:139]
    ds_read_b64_tr_b16 a[24:25], v40 offset:4096
    v_mfma_f32_16x16x16_bf16 v[140:143], a[60:61], a[224:225], v[140:143]
    ds_read_b64_tr_b16 a[26:27], v40 offset:6144
    v_mfma_f32_16x16x16_bf16 v[156:159], a[60:61], a[226:227], v[156:159]
    buffer_load_dwordx4 a[208:211], v7, s[20:23], s52 offen offset:1024 sc1
    ds_read_b64_tr_b16 a[28:29], v41 offset:4096
    v_mfma_f32_16x16x16_bf16 v[152:155], a[56:57], a[226:227], v[152:155]
    ds_read_b64_tr_b16 a[30:31], v41 offset:6144
    v_mfma_f32_16x16x16_bf16 v[148:151], a[52:53], a[226:227], v[148:151]
    buffer_load_dwordx4 a[212:215], v7, s[20:23], s53 offen offset:1024 sc1
    v_mfma_f32_16x16x16_bf16 v[144:147], a[48:49], a[226:227], v[144:147]
    s_waitcnt lgkmcnt(8)
    v_mfma_f32_16x16x32_bf16 v[128:131], a[0:3], a[104:107], v[128:131]
    s_waitcnt vmcnt(28)
    s_barrier
    v_mfma_f32_16x16x32_bf16 v[132:135], a[4:7], a[104:107], v[132:135]
    s_add_u32 m0, s57, 0xfffe6000
    ds_read_b64_tr_b16 a[32:33], v38 offset:8192
    v_mfma_f32_16x16x32_bf16 v[136:139], a[8:11], a[104:107], v[136:139]
    buffer_load_dwordx4 v36, s[16:19], s28 offen lds
    ds_read_b64_tr_b16 a[34:35], v38 offset:10240
    v_mfma_f32_16x16x32_bf16 v[140:143], a[12:15], a[104:107], v[140:143]
    ds_read_b64_tr_b16 a[36:37], v39 offset:8192
    v_mfma_f32_16x16x32_bf16 v[156:159], a[12:15], a[108:111], v[156:159]
    s_add_u32 m0, s58, 0xfffe6000
    ds_read_b64_tr_b16 a[38:39], v39 offset:10240
    v_mfma_f32_16x16x32_bf16 v[152:155], a[8:11], a[108:111], v[152:155]
    s_mov_b64 exec, s[32:33]
    buffer_load_dwordx4 v37, s[16:19], s28 offen lds
    s_mov_b64 exec, -1
    v_mfma_f32_16x16x32_bf16 v[148:151], a[4:7], a[108:111], v[148:151]
    ds_read_b64_tr_b16 a[40:41], v40 offset:8192
    ds_read_b64_tr_b16 a[42:43], v40 offset:10240
    v_mfma_f32_16x16x32_bf16 v[144:147], a[0:3], a[108:111], v[144:147]
    ds_read_b64_tr_b16 a[44:45], v41 offset:8192
    s_waitcnt lgkmcnt(7)
    v_mfma_f32_16x16x32_bf16 v[128:131], a[16:19], a[112:115], v[128:131]
    buffer_load_dwordx4 a[216:219], v7, s[20:23], s52 offen offset:2048 sc1
    ds_read_b64_tr_b16 a[46:47], v41 offset:10240
    v_mfma_f32_16x16x32_bf16 v[132:135], a[20:23], a[112:115], v[132:135]
    ds_read_b64_tr_b16 a[48:49], v38 offset:12288
    v_mfma_f32_16x16x32_bf16 v[136:139], a[24:27], a[112:115], v[136:139]
    ds_read_b64_tr_b16 a[52:53], v39 offset:12288
    v_mfma_f32_16x16x32_bf16 v[140:143], a[28:31], a[112:115], v[140:143]
    buffer_load_dwordx4 a[220:223], v7, s[20:23], s53 offen offset:2048 sc1
    ds_read_b64_tr_b16 a[56:57], v40 offset:12288
    v_mfma_f32_16x16x32_bf16 v[156:159], a[28:31], a[116:119], v[156:159]
    ds_read_b64_tr_b16 a[60:61], v41 offset:12288
    v_mfma_f32_16x16x32_bf16 v[152:155], a[24:27], a[116:119], v[152:155]
    v_mfma_f32_16x16x32_bf16 v[148:151], a[20:23], a[116:119], v[148:151]
    buffer_load_dwordx4 a[224:227], v7, s[20:23], s53 offen offset:3072 sc1
    v_mfma_f32_16x16x32_bf16 v[144:147], a[16:19], a[116:119], v[144:147]
    s_waitcnt lgkmcnt(4)
    v_mfma_f32_16x16x32_bf16 v[128:131], a[32:35], a[120:123], v[128:131]
    s_waitcnt vmcnt(27)
    s_barrier
    v_mfma_f32_16x16x32_bf16 v[132:135], a[36:39], a[120:123], v[132:135]
    ds_read_b64_tr_b16 a[0:1], v38 offset:16384
    ds_read_b64_tr_b16 a[2:3], v38 offset:18432
    v_mfma_f32_16x16x32_bf16 v[136:139], a[40:43], a[120:123], v[136:139]
    ds_read_b64_tr_b16 a[4:5], v39 offset:16384
    v_mfma_f32_16x16x32_bf16 v[140:143], a[44:47], a[120:123], v[140:143]
    ds_read_b64_tr_b16 a[6:7], v39 offset:18432
    v_mfma_f32_16x16x32_bf16 v[156:159], a[44:47], a[124:127], v[156:159]
    ds_read_b64_tr_b16 a[8:9], v40 offset:16384
    v_mfma_f32_16x16x32_bf16 v[152:155], a[40:43], a[124:127], v[152:155]
    ds_read_b64_tr_b16 a[10:11], v40 offset:18432
    ds_read_b64_tr_b16 a[12:13], v41 offset:16384
    v_mfma_f32_16x16x32_bf16 v[148:151], a[36:39], a[124:127], v[148:151]
    ds_read_b64_tr_b16 a[14:15], v41 offset:18432
    v_mfma_f32_16x16x32_bf16 v[144:147], a[32:35], a[124:127], v[144:147]
    ds_read_b64_tr_b16 a[16:17], v38 offset:20480
    s_waitcnt lgkmcnt(9)
    v_mfma_f32_16x16x16_bf16 v[128:131], a[48:49], a[128:129], v[128:131]
    ds_read_b64_tr_b16 a[18:19], v38 offset:22528
    v_mfma_f32_16x16x16_bf16 v[132:135], a[52:53], a[128:129], v[132:135]
    ds_read_b64_tr_b16 a[20:21], v39 offset:20480
    ds_read_b64_tr_b16 a[22:23], v39 offset:22528
    v_mfma_f32_16x16x16_bf16 v[136:139], a[56:57], a[128:129], v[136:139]
    ds_read_b64_tr_b16 a[24:25], v40 offset:20480
    v_mfma_f32_16x16x16_bf16 v[140:143], a[60:61], a[128:129], v[140:143]
    ds_read_b64_tr_b16 a[26:27], v40 offset:22528
    v_mfma_f32_16x16x16_bf16 v[156:159], a[60:61], a[130:131], v[156:159]
    ds_read_b64_tr_b16 a[28:29], v41 offset:20480
    v_mfma_f32_16x16x16_bf16 v[152:155], a[56:57], a[130:131], v[152:155]
    ds_read_b64_tr_b16 a[30:31], v41 offset:22528
    v_mfma_f32_16x16x16_bf16 v[148:151], a[52:53], a[130:131], v[148:151]
    v_mfma_f32_16x16x16_bf16 v[144:147], a[48:49], a[130:131], v[144:147]
    s_waitcnt lgkmcnt(8)
    v_mfma_f32_16x16x32_bf16 v[128:131], a[0:3], a[136:139], v[128:131]
    s_waitcnt vmcnt(22)
    s_barrier
    v_mfma_f32_16x16x32_bf16 v[132:135], a[4:7], a[136:139], v[132:135]
    ds_read_b64_tr_b16 a[32:33], v38 offset:24576
    v_mfma_f32_16x16x32_bf16 v[136:139], a[8:11], a[136:139], v[136:139]
    ds_read_b64_tr_b16 a[34:35], v38 offset:26624
    v_mfma_f32_16x16x32_bf16 v[140:143], a[12:15], a[136:139], v[140:143]
    ds_read_b64_tr_b16 a[36:37], v39 offset:24576
    v_mfma_f32_16x16x32_bf16 v[156:159], a[12:15], a[140:143], v[156:159]
    ds_read_b64_tr_b16 a[38:39], v39 offset:26624
    v_mfma_f32_16x16x32_bf16 v[152:155], a[8:11], a[140:143], v[152:155]
    ds_read_b64_tr_b16 a[40:41], v40 offset:24576
    v_mfma_f32_16x16x32_bf16 v[148:151], a[4:7], a[140:143], v[148:151]
    ds_read_b64_tr_b16 a[42:43], v40 offset:26624
    v_mfma_f32_16x16x32_bf16 v[144:147], a[0:3], a[140:143], v[144:147]
    ds_read_b64_tr_b16 a[44:45], v41 offset:24576
    s_waitcnt lgkmcnt(7)
    v_mfma_f32_16x16x32_bf16 v[128:131], a[16:19], a[144:147], v[128:131]
    ds_read_b64_tr_b16 a[46:47], v41 offset:26624
    v_mfma_f32_16x16x32_bf16 v[132:135], a[20:23], a[144:147], v[132:135]
    ds_read_b64_tr_b16 a[48:49], v38 offset:28672
    v_mfma_f32_16x16x32_bf16 v[136:139], a[24:27], a[144:147], v[136:139]
    ds_read_b64_tr_b16 a[52:53], v39 offset:28672
    v_mfma_f32_16x16x32_bf16 v[140:143], a[28:31], a[144:147], v[140:143]
    ds_read_b64_tr_b16 a[56:57], v40 offset:28672
    v_mfma_f32_16x16x32_bf16 v[156:159], a[28:31], a[148:151], v[156:159]
    ds_read_b64_tr_b16 a[60:61], v41 offset:28672
    v_mfma_f32_16x16x32_bf16 v[152:155], a[24:27], a[148:151], v[152:155]
    v_mfma_f32_16x16x32_bf16 v[148:151], a[20:23], a[148:151], v[148:151]
    v_mfma_f32_16x16x32_bf16 v[144:147], a[16:19], a[148:151], v[144:147]
    s_waitcnt lgkmcnt(4)
    v_mfma_f32_16x16x32_bf16 v[128:131], a[32:35], a[152:155], v[128:131]
    s_waitcnt vmcnt(16)
    s_barrier
    v_mfma_f32_16x16x32_bf16 v[132:135], a[36:39], a[152:155], v[132:135]
    ds_read_b64_tr_b16 a[0:1], v54 offset:0
    ds_read_b64_tr_b16 a[2:3], v54 offset:2048
    v_mfma_f32_16x16x32_bf16 v[136:139], a[40:43], a[152:155], v[136:139]
    ds_read_b64_tr_b16 a[4:5], v55 offset:0
    v_mfma_f32_16x16x32_bf16 v[140:143], a[44:47], a[152:155], v[140:143]
    ds_read_b64_tr_b16 a[6:7], v55 offset:2048
    v_mfma_f32_16x16x32_bf16 v[156:159], a[44:47], a[156:159], v[156:159]
    ds_read_b64_tr_b16 a[8:9], v56 offset:0
    v_mfma_f32_16x16x32_bf16 v[152:155], a[40:43], a[156:159], v[152:155]
    ds_read_b64_tr_b16 a[10:11], v56 offset:2048
    ds_read_b64_tr_b16 a[12:13], v57 offset:0
    v_mfma_f32_16x16x32_bf16 v[148:151], a[36:39], a[156:159], v[148:151]
    ds_read_b64_tr_b16 a[14:15], v57 offset:2048
    v_mfma_f32_16x16x32_bf16 v[144:147], a[32:35], a[156:159], v[144:147]
    ds_read_b64_tr_b16 a[16:17], v54 offset:4096
    s_waitcnt lgkmcnt(9)
    v_mfma_f32_16x16x16_bf16 v[128:131], a[48:49], a[160:161], v[128:131]
    ds_read_b64_tr_b16 a[18:19], v54 offset:6144
    v_mfma_f32_16x16x16_bf16 v[132:135], a[52:53], a[160:161], v[132:135]
    ds_read_b64_tr_b16 a[20:21], v55 offset:4096
    ds_read_b64_tr_b16 a[22:23], v55 offset:6144
    v_mfma_f32_16x16x16_bf16 v[136:139], a[56:57], a[160:161], v[136:139]
    ds_read_b64_tr_b16 a[24:25], v56 offset:4096
    v_mfma_f32_16x16x16_bf16 v[140:143], a[60:61], a[160:161], v[140:143]
    ds_read_b64_tr_b16 a[26:27], v56 offset:6144
    v_mfma_f32_16x16x16_bf16 v[156:159], a[60:61], a[162:163], v[156:159]
    ds_read_b64_tr_b16 a[28:29], v57 offset:4096
    v_mfma_f32_16x16x16_bf16 v[152:155], a[56:57], a[162:163], v[152:155]
    ds_read_b64_tr_b16 a[30:31], v57 offset:6144
    v_mfma_f32_16x16x16_bf16 v[148:151], a[52:53], a[162:163], v[148:151]
    v_mfma_f32_16x16x16_bf16 v[144:147], a[48:49], a[162:163], v[144:147]
    s_waitcnt lgkmcnt(8)
    v_mfma_f32_16x16x32_bf16 v[128:131], a[0:3], a[168:171], v[128:131]
    s_waitcnt vmcnt(11)
    s_barrier
    v_mfma_f32_16x16x32_bf16 v[132:135], a[4:7], a[168:171], v[132:135]
    ds_read_b64_tr_b16 a[32:33], v54 offset:8192
    v_mfma_f32_16x16x32_bf16 v[136:139], a[8:11], a[168:171], v[136:139]
    ds_read_b64_tr_b16 a[34:35], v54 offset:10240
    v_mfma_f32_16x16x32_bf16 v[140:143], a[12:15], a[168:171], v[140:143]
    ds_read_b64_tr_b16 a[36:37], v55 offset:8192
    v_mfma_f32_16x16x32_bf16 v[156:159], a[12:15], a[172:175], v[156:159]
    ds_read_b64_tr_b16 a[38:39], v55 offset:10240
    v_mfma_f32_16x16x32_bf16 v[152:155], a[8:11], a[172:175], v[152:155]
    ds_read_b64_tr_b16 a[40:41], v56 offset:8192
    v_mfma_f32_16x16x32_bf16 v[148:151], a[4:7], a[172:175], v[148:151]
    ds_read_b64_tr_b16 a[42:43], v56 offset:10240
    v_mfma_f32_16x16x32_bf16 v[144:147], a[0:3], a[172:175], v[144:147]
    ds_read_b64_tr_b16 a[44:45], v57 offset:8192
    s_waitcnt lgkmcnt(7)
    v_mfma_f32_16x16x32_bf16 v[128:131], a[16:19], a[176:179], v[128:131]
    ds_read_b64_tr_b16 a[46:47], v57 offset:10240
    v_mfma_f32_16x16x32_bf16 v[132:135], a[20:23], a[176:179], v[132:135]
    ds_read_b64_tr_b16 a[48:49], v54 offset:12288
    v_mfma_f32_16x16x32_bf16 v[136:139], a[24:27], a[176:179], v[136:139]
    ds_read_b64_tr_b16 a[52:53], v55 offset:12288
    v_mfma_f32_16x16x32_bf16 v[140:143], a[28:31], a[176:179], v[140:143]
    ds_read_b64_tr_b16 a[56:57], v56 offset:12288
    v_mfma_f32_16x16x32_bf16 v[156:159], a[28:31], a[180:183], v[156:159]
    ds_read_b64_tr_b16 a[60:61], v57 offset:12288
    v_mfma_f32_16x16x32_bf16 v[152:155], a[24:27], a[180:183], v[152:155]
    v_mfma_f32_16x16x32_bf16 v[148:151], a[20:23], a[180:183], v[148:151]
    v_mfma_f32_16x16x32_bf16 v[144:147], a[16:19], a[180:183], v[144:147]
    s_waitcnt lgkmcnt(4)
    v_mfma_f32_16x16x32_bf16 v[128:131], a[32:35], a[184:187], v[128:131]
    s_waitcnt vmcnt(5)
    s_barrier
    v_mfma_f32_16x16x32_bf16 v[132:135], a[36:39], a[184:187], v[132:135]
    ds_read_b64_tr_b16 a[0:1], v54 offset:16384
    ds_read_b64_tr_b16 a[2:3], v54 offset:18432
    v_mfma_f32_16x16x32_bf16 v[136:139], a[40:43], a[184:187], v[136:139]
    ds_read_b64_tr_b16 a[4:5], v55 offset:16384
    v_mfma_f32_16x16x32_bf16 v[140:143], a[44:47], a[184:187], v[140:143]
    ds_read_b64_tr_b16 a[6:7], v55 offset:18432
    v_mfma_f32_16x16x32_bf16 v[156:159], a[44:47], a[188:191], v[156:159]
    ds_read_b64_tr_b16 a[8:9], v56 offset:16384
    v_mfma_f32_16x16x32_bf16 v[152:155], a[40:43], a[188:191], v[152:155]
    ds_read_b64_tr_b16 a[10:11], v56 offset:18432
    ds_read_b64_tr_b16 a[12:13], v57 offset:16384
    v_mfma_f32_16x16x32_bf16 v[148:151], a[36:39], a[188:191], v[148:151]
    ds_read_b64_tr_b16 a[14:15], v57 offset:18432
    v_mfma_f32_16x16x32_bf16 v[144:147], a[32:35], a[188:191], v[144:147]
    ds_read_b64_tr_b16 a[16:17], v54 offset:20480
    s_waitcnt lgkmcnt(9)
    v_mfma_f32_16x16x16_bf16 v[128:131], a[48:49], a[192:193], v[128:131]
    ds_read_b64_tr_b16 a[18:19], v54 offset:22528
    v_mfma_f32_16x16x16_bf16 v[132:135], a[52:53], a[192:193], v[132:135]
    ds_read_b64_tr_b16 a[20:21], v55 offset:20480
    ds_read_b64_tr_b16 a[22:23], v55 offset:22528
    v_mfma_f32_16x16x16_bf16 v[136:139], a[56:57], a[192:193], v[136:139]
    ds_read_b64_tr_b16 a[24:25], v56 offset:20480
    v_mfma_f32_16x16x16_bf16 v[140:143], a[60:61], a[192:193], v[140:143]
    ds_read_b64_tr_b16 a[26:27], v56 offset:22528
    v_mfma_f32_16x16x16_bf16 v[156:159], a[60:61], a[194:195], v[156:159]
    ds_read_b64_tr_b16 a[28:29], v57 offset:20480
    v_mfma_f32_16x16x16_bf16 v[152:155], a[56:57], a[194:195], v[152:155]
    ds_read_b64_tr_b16 a[30:31], v57 offset:22528
    v_mfma_f32_16x16x16_bf16 v[148:151], a[52:53], a[194:195], v[148:151]
    v_mfma_f32_16x16x16_bf16 v[144:147], a[48:49], a[194:195], v[144:147]
    s_waitcnt lgkmcnt(8)
    v_mfma_f32_16x16x32_bf16 v[128:131], a[0:3], a[200:203], v[128:131]
    s_waitcnt vmcnt(0)
    s_barrier
    v_mfma_f32_16x16x32_bf16 v[132:135], a[4:7], a[200:203], v[132:135]
    ds_read_b64_tr_b16 a[32:33], v54 offset:24576
    v_mfma_f32_16x16x32_bf16 v[136:139], a[8:11], a[200:203], v[136:139]
    ds_read_b64_tr_b16 a[34:35], v54 offset:26624
    v_mfma_f32_16x16x32_bf16 v[140:143], a[12:15], a[200:203], v[140:143]
    ds_read_b64_tr_b16 a[36:37], v55 offset:24576
    v_mfma_f32_16x16x32_bf16 v[156:159], a[12:15], a[204:207], v[156:159]
    ds_read_b64_tr_b16 a[38:39], v55 offset:26624
    v_mfma_f32_16x16x32_bf16 v[152:155], a[8:11], a[204:207], v[152:155]
    ds_read_b64_tr_b16 a[40:41], v56 offset:24576
    v_mfma_f32_16x16x32_bf16 v[148:151], a[4:7], a[204:207], v[148:151]
    ds_read_b64_tr_b16 a[42:43], v56 offset:26624
    v_mfma_f32_16x16x32_bf16 v[144:147], a[0:3], a[204:207], v[144:147]
    ds_read_b64_tr_b16 a[44:45], v57 offset:24576
    s_waitcnt lgkmcnt(7)
    v_mfma_f32_16x16x32_bf16 v[128:131], a[16:19], a[208:211], v[128:131]
    ds_read_b64_tr_b16 a[46:47], v57 offset:26624
    v_mfma_f32_16x16x32_bf16 v[132:135], a[20:23], a[208:211], v[132:135]
    ds_read_b64_tr_b16 a[48:49], v54 offset:28672
    v_mfma_f32_16x16x32_bf16 v[136:139], a[24:27], a[208:211], v[136:139]
    ds_read_b64_tr_b16 a[52:53], v55 offset:28672
    v_mfma_f32_16x16x32_bf16 v[140:143], a[28:31], a[208:211], v[140:143]
    ds_read_b64_tr_b16 a[56:57], v56 offset:28672
    v_mfma_f32_16x16x32_bf16 v[156:159], a[28:31], a[212:215], v[156:159]
    ds_read_b64_tr_b16 a[60:61], v57 offset:28672
    v_mfma_f32_16x16x32_bf16 v[152:155], a[24:27], a[212:215], v[152:155]
    v_mfma_f32_16x16x32_bf16 v[148:151], a[20:23], a[212:215], v[148:151]
    v_mfma_f32_16x16x32_bf16 v[144:147], a[16:19], a[212:215], v[144:147]
    s_waitcnt lgkmcnt(4)
    v_mfma_f32_16x16x32_bf16 v[128:131], a[32:35], a[216:219], v[128:131]
    v_mfma_f32_16x16x32_bf16 v[132:135], a[36:39], a[216:219], v[132:135]
    v_mfma_f32_16x16x32_bf16 v[136:139], a[40:43], a[216:219], v[136:139]
    v_mfma_f32_16x16x32_bf16 v[140:143], a[44:47], a[216:219], v[140:143]
    v_mfma_f32_16x16x32_bf16 v[156:159], a[44:47], a[220:223], v[156:159]
    v_mfma_f32_16x16x32_bf16 v[152:155], a[40:43], a[220:223], v[152:155]
    v_mfma_f32_16x16x32_bf16 v[148:151], a[36:39], a[220:223], v[148:151]
    v_mfma_f32_16x16x32_bf16 v[144:147], a[32:35], a[220:223], v[144:147]
    s_waitcnt lgkmcnt(0)
    v_mfma_f32_16x16x16_bf16 v[128:131], a[48:49], a[224:225], v[128:131]
    v_mfma_f32_16x16x16_bf16 v[132:135], a[52:53], a[224:225], v[132:135]
    v_mfma_f32_16x16x16_bf16 v[136:139], a[56:57], a[224:225], v[136:139]
    v_mfma_f32_16x16x16_bf16 v[140:143], a[60:61], a[224:225], v[140:143]
    v_mfma_f32_16x16x16_bf16 v[156:159], a[60:61], a[226:227], v[156:159]
    v_mfma_f32_16x16x16_bf16 v[152:155], a[56:57], a[226:227], v[152:155]
    v_mfma_f32_16x16x16_bf16 v[148:151], a[52:53], a[226:227], v[148:151]
    v_mfma_f32_16x16x16_bf16 v[144:147], a[48:49], a[226:227], v[144:147]
    s_mov_b32 s8, s82
    s_mov_b32 s9, s83
    s_mov_b32 s10, 0x400000
    s_mov_b32 s11, 0x20000
    v_and_b32 v46, 15, v0
    v_lshlrev_b32 v46, 11, v46
    v_bfe_u32 v47, v0, 4, 1
    v_lshl_or_b32 v46, v47, 5, v46
    v_lshrrev_b32 v47, 5, v0
    v_lshl_or_b32 v46, v47, 4, v46
    s_lshl_b32 s46, s40, 16
    s_add_u32 s46, s46, s59
    s_add_u32 s47, s46, 32768
    v_mov_b32 v44, v43
    v_mov_b32 v45, v43
    v_mov_b32 v43, v42
    v_pk_add_f32 v[220:221], v[220:221], v[128:129] neg_lo:[0,1] neg_hi:[0,1]
    v_pk_add_f32 v[222:223], v[222:223], v[130:131] neg_lo:[0,1] neg_hi:[0,1]
    v_pk_add_f32 v[224:225], v[224:225], v[132:133] neg_lo:[0,1] neg_hi:[0,1]
    v_pk_add_f32 v[226:227], v[226:227], v[134:135] neg_lo:[0,1] neg_hi:[0,1]
    v_pk_add_f32 v[228:229], v[228:229], v[136:137] neg_lo:[0,1] neg_hi:[0,1]
    v_pk_add_f32 v[230:231], v[230:231], v[138:139] neg_lo:[0,1] neg_hi:[0,1]
    v_pk_add_f32 v[232:233], v[232:233], v[140:141] neg_lo:[0,1] neg_hi:[0,1]
    v_pk_add_f32 v[234:235], v[234:235], v[142:143] neg_lo:[0,1] neg_hi:[0,1]
    v_pk_add_f32 v[236:237], v[236:237], v[144:145] neg_lo:[0,1] neg_hi:[0,1]
    v_pk_add_f32 v[238:239], v[238:239], v[146:147] neg_lo:[0,1] neg_hi:[0,1]
    v_pk_add_f32 v[240:241], v[240:241], v[148:149] neg_lo:[0,1] neg_hi:[0,1]
    v_pk_add_f32 v[242:243], v[242:243], v[150:151] neg_lo:[0,1] neg_hi:[0,1]
    v_pk_add_f32 v[244:245], v[244:245], v[152:153] neg_lo:[0,1] neg_hi:[0,1]
    v_pk_add_f32 v[246:247], v[246:247], v[154:155] neg_lo:[0,1] neg_hi:[0,1]
    v_pk_add_f32 v[248:249], v[248:249], v[156:157] neg_lo:[0,1] neg_hi:[0,1]
    v_pk_add_f32 v[250:251], v[250:251], v[158:159] neg_lo:[0,1] neg_hi:[0,1]
    v_pk_fma_f32 v[220:221], v[220:221], v[42:43], v[128:129]
    v_pk_fma_f32 v[222:223], v[222:223], v[42:43], v[130:131]
    v_pk_fma_f32 v[224:225], v[224:225], v[42:43], v[132:133]
    v_pk_fma_f32 v[226:227], v[226:227], v[42:43], v[134:135]
    v_pk_fma_f32 v[228:229], v[228:229], v[42:43], v[136:137]
    v_pk_fma_f32 v[230:231], v[230:231], v[42:43], v[138:139]
    v_pk_fma_f32 v[232:233], v[232:233], v[42:43], v[140:141]
    v_pk_fma_f32 v[234:235], v[234:235], v[42:43], v[142:143]
    v_pk_fma_f32 v[236:237], v[236:237], v[44:45], v[144:145]
    v_pk_fma_f32 v[238:239], v[238:239], v[44:45], v[146:147]
    v_pk_fma_f32 v[240:241], v[240:241], v[44:45], v[148:149]
    v_pk_fma_f32 v[242:243], v[242:243], v[44:45], v[150:151]
    v_pk_fma_f32 v[244:245], v[244:245], v[44:45], v[152:153]
    v_pk_fma_f32 v[246:247], v[246:247], v[44:45], v[154:155]
    v_pk_fma_f32 v[248:249], v[248:249], v[44:45], v[156:157]
    v_pk_fma_f32 v[250:251], v[250:251], v[44:45], v[158:159]
    v_cvt_pk_bf16_f32 v220, v220, v221
    v_cvt_pk_bf16_f32 v221, v222, v223
    v_cvt_pk_bf16_f32 v222, v224, v225
    v_cvt_pk_bf16_f32 v223, v226, v227
    v_cvt_pk_bf16_f32 v228, v228, v229
    v_cvt_pk_bf16_f32 v229, v230, v231
    v_cvt_pk_bf16_f32 v230, v232, v233
    v_cvt_pk_bf16_f32 v231, v234, v235
    v_cvt_pk_bf16_f32 v236, v236, v237
    v_cvt_pk_bf16_f32 v237, v238, v239
    v_cvt_pk_bf16_f32 v238, v240, v241
    v_cvt_pk_bf16_f32 v239, v242, v243
    v_cvt_pk_bf16_f32 v244, v244, v245
    v_cvt_pk_bf16_f32 v245, v246, v247
    v_cvt_pk_bf16_f32 v246, v248, v249
    v_cvt_pk_bf16_f32 v247, v250, v251
    v_permlane16_swap_b32 v220, v222
    v_permlane16_swap_b32 v221, v223
    v_permlane16_swap_b32 v228, v230
    v_permlane16_swap_b32 v229, v231
    v_permlane16_swap_b32 v236, v238
    v_permlane16_swap_b32 v237, v239
    v_permlane16_swap_b32 v244, v246
    v_permlane16_swap_b32 v245, v247
    buffer_store_dwordx4 v[220:223], v46, s[8:11], s46 offen offset:0
    buffer_store_dwordx4 v[228:231], v46, s[8:11], s46 offen offset:64
    buffer_store_dwordx4 v[236:239], v46, s[8:11], s47 offen offset:0
    buffer_store_dwordx4 v[244:247], v46, s[8:11], s47 offen offset:64
L_end:
    s_endpgm
L_codeend:
.section .rodata,"a"
.p2align 6
.amdhsa_kernel gated_mix__sliding_local_dilated__mixer_gmlp__prompt_kernel
  .amdhsa_next_free_vgpr 512
  .amdhsa_next_free_sgpr 102
  .amdhsa_accum_offset 256
  .amdhsa_group_segment_fixed_size 0
  .amdhsa_kernarg_size 96
  .amdhsa_user_sgpr_count 2
  .amdhsa_user_sgpr_kernarg_segment_ptr 1
  .amdhsa_system_sgpr_workgroup_id_x 1
  .amdhsa_float_denorm_mode_32 3
.end_amdhsa_kernel
```
